```python
import torch

def _softmax(x, axis=-1):
    return torch.softmax(x, dim=axis)

def _gelu(x):
    return torch.nn.functional.gelu(x, approximate='tanh')

def _silu(x):
    return torch.nn.functional.silu(x)

def _sigmoid(x):
    return torch.sigmoid(x)

def _layernorm(x, axis=-1, eps=1e-05):
    m = x.mean(dim=axis, keepdim=True)
    v = x.var(dim=axis, keepdim=True, unbiased=False)
    return (x - m) / torch.sqrt(v + eps)

def _scatter_add(tgt, idx, src, axis=0):
    return tgt.clone().index_add_(axis, idx, src)

def _segment_sum(src, seg, n):
    out = torch.zeros((n,) + src.shape[1:], dtype=src.dtype)
    return out.index_add_(0, seg, src)

def _pad(x, pw):
    flat = tuple((v for pair in reversed(pw) for v in pair))
    return torch.nn.functional.pad(x, flat)
kernel_name = 'concat_heads__memory_aug_recurrent_mem_tr__linear_attn_block__prompt'

def setup_inputs():

    _w = lambda a: (lambda t: t.to(torch.bfloat16) if t.is_floating_point() else t)(torch.as_tensor(a))

    def _A_setup():
        B, S, Dm = (1, 2048, 576)
        H, Dh = (32, 128)
        M, seg = (8, 32)
        seg = min(seg, S)
        S = S // seg * seg
        return {'x': _w((lambda *s: torch.randn(*s, dtype=torch.bfloat16) * 0.05)(B, S, Dm)), 'mem0': _w((lambda *s: torch.randn(*s, dtype=torch.bfloat16) * 0.8)(B, M, Dm)), 'Wq': _w((lambda *s: torch.randn(*s, dtype=torch.bfloat16) * 1.6)(Dm, H, Dh) * Dm ** (-0.5)), 'Wk': _w((lambda *s: torch.randn(*s, dtype=torch.bfloat16) * 1.6)(Dm, H, Dh) * Dm ** (-0.5)), 'Wv': _w((lambda *s: torch.randn(*s, dtype=torch.bfloat16) * 0.8)(Dm, H, Dh) * Dm ** (-0.5)), 'Wo': _w((lambda *s: torch.randn(*s, dtype=torch.bfloat16) * 0.8)(H, Dh, Dm) * (H * Dh) ** (-0.5)), 'seg_len': seg}
    _A_in = _A_setup()

    def _B_setup():
        B, S, D = (1, 2048, 576)
        return {'x': _w((lambda *s: torch.randn(*s, dtype=torch.bfloat16) * 0.05)(B, S, D)), 'wqkv': _w((lambda *s: torch.randn(*s, dtype=torch.bfloat16) * 1.6)(D, 3 * D)), 'wo': _w((lambda *s: torch.randn(*s, dtype=torch.bfloat16) * 0.1)(D, D))}
    _B_in = _B_setup()
    return {'A_x': _A_in['x'], 'A_mem0': _A_in['mem0'], 'A_Wq': _A_in['Wq'], 'A_Wk': _A_in['Wk'], 'A_Wv': _A_in['Wv'], 'A_Wo': _A_in['Wo'], 'A_seg_len': _A_in['seg_len'], 'B_x': _B_in['x'], 'B_wqkv': _B_in['wqkv'], 'B_wo': _B_in['wo']}

def reference(A_x, A_mem0, A_Wq, A_Wk, A_Wv, A_Wo, A_seg_len, B_x, B_wqkv, B_wo):

    def _A_ref(x, mem0, Wq, Wk, Wv, Wo, seg_len):
        B, S, Dm = x.shape
        H, Dh = (Wq.shape[1], Wq.shape[2])
        M = mem0.shape[1]
        scale = Dh ** (-0.5)
        n_seg = S // seg_len
        L = M + seg_len
        idx = torch.arange(L)
        mask = (idx[:, None] < M) | (idx[:, None] >= idx[None, :])
        mem = mem0
        outs = []
        for s in range(n_seg):
            xs = x[:, s * seg_len:(s + 1) * seg_len, :].clone()
            h = torch.concatenate([mem, xs], axis=1)
            q = torch.einsum('btd,dhe->bhte', h, Wq)
            k = torch.einsum('btd,dhe->bhte', h, Wk)
            v = torch.einsum('btd,dhe->bhte', h, Wv)
            scores = torch.einsum('bhqe,bhke->bhqk', q, k) * scale
            scores = torch.where(mask[None, None], scores, -1000000000.0)
            p = _softmax(scores, axis=-1)
            o = torch.einsum('bhqk,bhke->bhqe', p, v)
            o = torch.einsum('bhte,hed->btd', o, Wo)
            mem = o[:, :M, :].clone()
            outs.append(o[:, M:, :])
        return torch.concatenate(outs, axis=1)

    def _B_ref(x, wqkv, wo):
        B, S, D = x.shape
        H = 32
        Dh = D // H
        qkv = (lambda x, *d: x.permute(*d))((x @ wqkv).reshape(B, S, 3, H, Dh), 2, 0, 3, 1, 4)
        q, k, v = (qkv[0], qkv[1], qkv[2])
        phi = lambda t: torch.where(t > 0, t + 1, torch.exp(t)) + 1e-06
        pq, pk = (phi(q), phi(k))
        kv = torch.einsum('bhsd,bhse->bhde', pk, v)
        z = torch.einsum('bhsd->bhd', pk)
        num = torch.einsum('bhqd,bhde->bhqe', pq, kv)
        den = torch.einsum('bhqd,bhd->bhq', pq, z)[..., None] + 1e-06
        o = num / den
        return (lambda x, *d: x.permute(*d))(o, 0, 2, 1, 3).reshape(B, S, D) @ wo
    a = _A_ref(A_x, A_mem0, A_Wq, A_Wk, A_Wv, A_Wo, A_seg_len)
    b = _B_ref(B_x, B_wqkv, B_wo)
    return torch.concatenate([a, b], axis=-1)
```

```asm
; @launch grid=(256,1,1) block=(256,1,1) lds=163840
.amdgcn_target "amdgcn-amd-amdhsa--gfx950"
.text
.globl concat_heads__memory_aug_recurrent_mem_tr__linear_attn_block__prompt_kernel
.p2align 8
.type concat_heads__memory_aug_recurrent_mem_tr__linear_attn_block__prompt_kernel,@function
concat_heads__memory_aug_recurrent_mem_tr__linear_attn_block__prompt_kernel:
    s_load_dwordx2 s[90:91], s[0:1], 88
    s_getreg_b32 s96, hwreg(HW_REG_XCC_ID, 0, 4)
    s_memrealtime s[100:101]
    s_cmp_ge_u32 s2, 256
    s_cbranch_scc1 KEND
    s_waitcnt lgkmcnt(0)
    v_mov_b32 v1, 0
    v_mov_b32 v2, 1
    s_lshl_b32 s97, s96, 2
    s_add_u32 s98, s90, s97
    s_addc_u32 s99, s91, 0
    v_cmp_eq_u32 vcc, 0, v0
    s_and_saveexec_b64 s[28:29], vcc
    s_cbranch_execz LE_skip0
    global_atomic_add v3, v1, v2, s[98:99] sc0
    s_waitcnt vmcnt(0)
    ds_write_b32 v1, v3
    s_waitcnt lgkmcnt(0)
LE_skip0:
    s_mov_b64 exec, s[28:29]
    s_barrier
    ds_read_b32 v3, v1
    s_waitcnt lgkmcnt(0)
    v_readfirstlane_b32 s30, v3
    s_barrier
    s_mov_b32 s3, s100
    s_lshl_b32 s2, s96, 5
    s_add_u32 s2, s2, s30
    s_cmp_ge_u32 s30, 32
    s_cbranch_scc1 KEND
    s_cmp_eq_u32 s96, 0
    s_cbranch_scc1 ROLE_REC
    s_nop 0
    s_cmp_lt_u32 s96, 4
    s_cbranch_scc1 ROLE_XP
    s_sub_u32 s60, s96, 4
    s_lshl_b32 s60, s60, 5
    s_add_u32 s60, s60, s30
    s_cmp_lt_u32 s60, 96
    s_cbranch_scc1 ROLE_AG
    s_branch ROLE_B
ROLE_REC:
    s_load_dwordx2 s[92:93], s[0:1], 96
    s_load_dwordx4 s[80:83], s[0:1], 16
    s_load_dwordx4 s[84:87], s[0:1], 32
    s_load_dwordx2 s[88:89], s[0:1], 8
    s_waitcnt lgkmcnt(0)
    s_mov_b32 s4, s92
    s_and_b32 s5, s93, 0xffff
    s_mov_b32 s6, 268435456
    s_mov_b32 s7, 0x00020000
    s_mov_b32 s8, s80
    s_and_b32 s9, s81, 0xffff
    s_mov_b32 s10, 4718592
    s_mov_b32 s11, 0x00020000
    s_mov_b32 s12, s82
    s_and_b32 s13, s83, 0xffff
    s_mov_b32 s14, 4718592
    s_mov_b32 s15, 0x00020000
    s_mov_b32 s16, s84
    s_and_b32 s17, s85, 0xffff
    s_mov_b32 s18, 4718592
    s_mov_b32 s19, 0x00020000
    s_mov_b32 s20, s86
    s_and_b32 s21, s87, 0xffff
    s_mov_b32 s22, 4718592
    s_mov_b32 s23, 0x00020000
    s_mov_b32 s24, s88
    s_and_b32 s25, s89, 0xffff
    s_mov_b32 s26, 9216
    s_mov_b32 s27, 0x00020000
    v_mov_b32 v30, v0
    v_lshrrev_b32 v10, 6, v0
    s_nop 0
    v_readfirstlane_b32 s31, v10
    v_and_b32 v11, 63, v0
    v_lshrrev_b32 v12, 4, v11
    v_and_b32 v13, 15, v11
    v_lshlrev_b32 v0, 4, v11
    v_and_b32 v14, 2, v11
    v_cmp_eq_u32 vcc, 0, v14
    v_mov_b32 v15, 0xeeee
    v_mov_b32 v16, 0x4444
    v_cndmask_b32 v1, v15, v16, vcc
    s_lshl_b32 s66, s31, 10
    v_lshlrev_b32 v14, 5, v13
    v_lshl_add_u32 v14, v12, 3, v14
    s_add_u32 s50, s66, 8192
    v_add_u32 v2, s50, v14
    v_lshrrev_b32 v14, 2, v11
    v_lshlrev_b32 v14, 5, v14
    v_and_b32 v16, 3, v11
    v_lshl_add_u32 v14, v16, 3, v14
    v_add_u32 v3, 8192, v14
    v_lshrrev_b32 v14, 2, v13
    v_and_b32 v15, 1, v13
    v_lshl_add_u32 v14, v14, 1, v15
    v_lshlrev_b32 v15, 4, v14
    v_lshl_add_u32 v15, v12, 7, v15
    s_lshl_b32 s50, s31, 9
    s_add_u32 s50, s50, 12288
    v_add_u32 v4, s50, v15
    v_and_b32 v16, 2, v13
    v_xor_b32 v16, 2, v16
    v_lshl_add_u32 v15, v16, 10, v15
    v_add_u32 v5, 12288, v15
    v_lshrrev_b32 v14, 1, v12
    v_lshlrev_b32 v14, 4, v14
    v_lshrrev_b32 v15, 2, v13
    v_lshl_add_u32 v14, v15, 2, v14
    v_and_b32 v15, 1, v12
    v_lshl_add_u32 v14, v15, 1, v14
    v_and_b32 v15, 1, v13
    v_add_u32 v14, v14, v15
    v_lshlrev_b32 v14, 4, v14
    s_lshr_b32 s50, s31, 1
    s_lshl_b32 s50, s50, 10
    s_and_b32 s51, s31, 1
    s_lshl_b32 s51, s51, 9
    s_add_u32 s50, s50, s51
    s_add_u32 s50, s50, 12288
    v_add_u32 v6, s50, v14
    s_mul_i32 s50, s31, 36864
    s_add_u32 s50, s50, 16384
    v_add_u32 v7, s50, v0
    v_add_u32 v8, s66, v0
    s_mov_b32 s80, 0xaaaaaaaa
    s_mov_b32 s81, 0xaaaaaaaa
    s_mov_b32 s82, 0x03030303
    s_mov_b32 s83, 0x03030303
    s_mov_b32 s84, 0x0c0c0c0c
    s_mov_b32 s85, 0x0c0c0c0c
    s_mov_b32 s86, 0x30303030
    s_mov_b32 s87, 0x30303030
    s_mov_b32 s88, 0xc0c0c0c0
    s_mov_b32 s89, 0xc0c0c0c0
    s_mov_b32 s97, 8960
    s_mov_b32 s60, 0xcccccccc
    s_mov_b32 s61, 0xcccccccc
    s_mov_b32 s64, 0x3e0293ee
    s_mov_b32 s65, 0x3e0293ee
    s_mov_b32 s63, 0xbe0293ee
    v_lshrrev_b32 v20, 4, v0
    v_lshrrev_b32 v21, 4, v20
    v_and_b32 v22, 15, v20
    v_and_b32 v23, 1, v21
    v_lshlrev_b32 v23, 1, v23
    v_xor_b32 v22, v22, v23
    v_lshlrev_b32 v22, 4, v22
    v_lshlrev_b32 v21, 13, v21
    v_add_u32 v10, v21, v22
    v_xor_b32 v11, 64, v10
    v_xor_b32 v12, 128, v10
    v_xor_b32 v13, 192, v10
    v_lshrrev_b32 v21, 4, v20
    v_lshrrev_b32 v22, 2, v20
    v_and_b32 v22, 3, v22
    v_and_b32 v23, 3, v20
    v_lshrrev_b32 v24, 1, v21
    v_and_b32 v25, 1, v21
    v_and_b32 v26, 1, v22
    v_lshrrev_b32 v27, 1, v22
    v_lshlrev_b32 v28, 4, v24
    v_lshl_add_u32 v28, v25, 2, v28
    v_add_u32 v28, v28, v26
    v_lshl_add_u32 v28, v27, 3, v28
    v_lshlrev_b32 v28, 8, v28
    v_lshl_or_b32 v29, v25, 1, v26
    v_lshl_or_b32 v29, v27, 2, v29
    s_lshl_b32 s50, s31, 1
    v_xor_b32 v29, s50, v29
    v_lshlrev_b32 v29, 5, v29
    v_lshlrev_b32 v23, 3, v23
    v_add3_u32 v14, v28, v29, v23
    v_xor_b32 v15, 32, v14
    s_lshl_b32 s54, s31, 17
    s_lshl_b32 s53, s30, 8
    s_add_u32 s54, s54, s53
    s_lshl_b32 s55, s31, 12
    s_add_u32 s52, s54, 0
    s_add_u32 m0, s55, 16384
    s_nop 0
    buffer_load_dwordx4 v10, s[8:11], s52 offen lds
    s_add_u32 s52, s54, 32768
    s_add_u32 m0, s55, 17408
    s_nop 0
    buffer_load_dwordx4 v11, s[8:11], s52 offen lds
    s_add_u32 s52, s54, 65536
    s_add_u32 m0, s55, 18432
    s_nop 0
    buffer_load_dwordx4 v12, s[8:11], s52 offen lds
    s_add_u32 s52, s54, 98304
    s_add_u32 m0, s55, 19456
    s_nop 0
    buffer_load_dwordx4 v13, s[8:11], s52 offen lds
    s_add_u32 s52, s54, 524288
    s_add_u32 m0, s55, 32768
    s_nop 0
    buffer_load_dwordx4 v10, s[8:11], s52 offen lds
    s_add_u32 s52, s54, 557056
    s_add_u32 m0, s55, 33792
    s_nop 0
    buffer_load_dwordx4 v11, s[8:11], s52 offen lds
    s_add_u32 s52, s54, 589824
    s_add_u32 m0, s55, 34816
    s_nop 0
    buffer_load_dwordx4 v12, s[8:11], s52 offen lds
    s_add_u32 s52, s54, 622592
    s_add_u32 m0, s55, 35840
    s_nop 0
    buffer_load_dwordx4 v13, s[8:11], s52 offen lds
    s_add_u32 s52, s54, 1048576
    s_add_u32 m0, s55, 49152
    s_nop 0
    buffer_load_dwordx4 v10, s[8:11], s52 offen lds
    s_add_u32 s52, s54, 1081344
    s_add_u32 m0, s55, 50176
    s_nop 0
    buffer_load_dwordx4 v11, s[8:11], s52 offen lds
    s_add_u32 s52, s54, 1114112
    s_add_u32 m0, s55, 51200
    s_nop 0
    buffer_load_dwordx4 v12, s[8:11], s52 offen lds
    s_add_u32 s52, s54, 1146880
    s_add_u32 m0, s55, 52224
    s_nop 0
    buffer_load_dwordx4 v13, s[8:11], s52 offen lds
    s_add_u32 s52, s54, 1572864
    s_add_u32 m0, s55, 65536
    s_nop 0
    buffer_load_dwordx4 v10, s[8:11], s52 offen lds
    s_add_u32 s52, s54, 1605632
    s_add_u32 m0, s55, 66560
    s_nop 0
    buffer_load_dwordx4 v11, s[8:11], s52 offen lds
    s_add_u32 s52, s54, 1638400
    s_add_u32 m0, s55, 67584
    s_nop 0
    buffer_load_dwordx4 v12, s[8:11], s52 offen lds
    s_add_u32 s52, s54, 1671168
    s_add_u32 m0, s55, 68608
    s_nop 0
    buffer_load_dwordx4 v13, s[8:11], s52 offen lds
    s_add_u32 s52, s54, 2097152
    s_add_u32 m0, s55, 81920
    s_nop 0
    buffer_load_dwordx4 v10, s[8:11], s52 offen lds
    s_add_u32 s52, s54, 2129920
    s_add_u32 m0, s55, 82944
    s_nop 0
    buffer_load_dwordx4 v11, s[8:11], s52 offen lds
    s_add_u32 s52, s54, 2162688
    s_add_u32 m0, s55, 83968
    s_nop 0
    buffer_load_dwordx4 v12, s[8:11], s52 offen lds
    s_add_u32 s52, s54, 2195456
    s_add_u32 m0, s55, 84992
    s_nop 0
    buffer_load_dwordx4 v13, s[8:11], s52 offen lds
    s_add_u32 s52, s54, 2621440
    s_add_u32 m0, s55, 98304
    s_nop 0
    buffer_load_dwordx4 v10, s[8:11], s52 offen lds
    s_add_u32 s52, s54, 2654208
    s_add_u32 m0, s55, 99328
    s_nop 0
    buffer_load_dwordx4 v11, s[8:11], s52 offen lds
    s_add_u32 s52, s54, 2686976
    s_add_u32 m0, s55, 100352
    s_nop 0
    buffer_load_dwordx4 v12, s[8:11], s52 offen lds
    s_add_u32 s52, s54, 2719744
    s_add_u32 m0, s55, 101376
    s_nop 0
    buffer_load_dwordx4 v13, s[8:11], s52 offen lds
    s_add_u32 s52, s54, 3145728
    s_add_u32 m0, s55, 114688
    s_nop 0
    buffer_load_dwordx4 v10, s[8:11], s52 offen lds
    s_add_u32 s52, s54, 3178496
    s_add_u32 m0, s55, 115712
    s_nop 0
    buffer_load_dwordx4 v11, s[8:11], s52 offen lds
    s_add_u32 s52, s54, 3211264
    s_add_u32 m0, s55, 116736
    s_nop 0
    buffer_load_dwordx4 v12, s[8:11], s52 offen lds
    s_add_u32 s52, s54, 3244032
    s_add_u32 m0, s55, 117760
    s_nop 0
    buffer_load_dwordx4 v13, s[8:11], s52 offen lds
    s_add_u32 s52, s54, 3670016
    s_add_u32 m0, s55, 131072
    s_nop 0
    buffer_load_dwordx4 v10, s[8:11], s52 offen lds
    s_add_u32 s52, s54, 3702784
    s_add_u32 m0, s55, 132096
    s_nop 0
    buffer_load_dwordx4 v11, s[8:11], s52 offen lds
    s_add_u32 s52, s54, 3735552
    s_add_u32 m0, s55, 133120
    s_nop 0
    buffer_load_dwordx4 v12, s[8:11], s52 offen lds
    s_add_u32 s52, s54, 3768320
    s_add_u32 m0, s55, 134144
    s_nop 0
    buffer_load_dwordx4 v13, s[8:11], s52 offen lds
    s_add_u32 s52, s54, 4194304
    s_add_u32 m0, s55, 147456
    s_nop 0
    buffer_load_dwordx4 v10, s[8:11], s52 offen lds
    s_add_u32 s52, s54, 4227072
    s_add_u32 m0, s55, 148480
    s_nop 0
    buffer_load_dwordx4 v11, s[8:11], s52 offen lds
    s_add_u32 s52, s54, 4259840
    s_add_u32 m0, s55, 149504
    s_nop 0
    buffer_load_dwordx4 v12, s[8:11], s52 offen lds
    s_add_u32 s52, s54, 4292608
    s_add_u32 m0, s55, 150528
    s_nop 0
    buffer_load_dwordx4 v13, s[8:11], s52 offen lds
    v_mov_b32 v40, -1
    v_mov_b32 v41, -1
    v_mov_b32 v42, -1
    v_mov_b32 v43, -1
    v_lshlrev_b32 v44, 4, v30
    s_mul_i32 s36, s30, 9216
    s_add_u32 s37, s36, 2097152
    s_add_u32 s38, s36, 2392064
    s_lshl_b32 s39, s36, 1
    s_add_u32 s39, s39, 1048576
    s_add_u32 s40, s39, 9216
    s_cmp_lt_u32 s30, 2
    s_cselect_b32 s39, s39, 0x7ff00000
    s_cselect_b32 s40, s40, 0x7ff00000
    s_add_u32 s42, s36, 2686976
    buffer_store_dwordx4 v[40:43], v44, s[4:7], s37 offen
    s_add_u32 s41, s37, 4096
    buffer_store_dwordx4 v[40:43], v44, s[4:7], s41 offen
    s_add_u32 s41, s37, 8192
    v_cmp_gt_u32 vcc, 64, v30
    s_and_saveexec_b64 s[28:29], vcc
    s_cbranch_execz RL_si37
    buffer_store_dwordx4 v[40:43], v44, s[4:7], s41 offen
RL_si37:
    s_mov_b64 exec, s[28:29]
    buffer_store_dwordx4 v[40:43], v44, s[4:7], s38 offen
    s_add_u32 s41, s38, 4096
    buffer_store_dwordx4 v[40:43], v44, s[4:7], s41 offen
    s_add_u32 s41, s38, 8192
    v_cmp_gt_u32 vcc, 64, v30
    s_and_saveexec_b64 s[28:29], vcc
    s_cbranch_execz RL_si38
    buffer_store_dwordx4 v[40:43], v44, s[4:7], s41 offen
RL_si38:
    s_mov_b64 exec, s[28:29]
    buffer_store_dwordx4 v[40:43], v44, s[4:7], s39 offen
    s_add_u32 s41, s39, 4096
    buffer_store_dwordx4 v[40:43], v44, s[4:7], s41 offen
    s_add_u32 s41, s39, 8192
    v_cmp_gt_u32 vcc, 64, v30
    s_and_saveexec_b64 s[28:29], vcc
    s_cbranch_execz RL_si39
    buffer_store_dwordx4 v[40:43], v44, s[4:7], s41 offen
RL_si39:
    s_mov_b64 exec, s[28:29]
    buffer_store_dwordx4 v[40:43], v44, s[4:7], s40 offen
    s_add_u32 s41, s40, 4096
    buffer_store_dwordx4 v[40:43], v44, s[4:7], s41 offen
    s_add_u32 s41, s40, 8192
    v_cmp_gt_u32 vcc, 64, v30
    s_and_saveexec_b64 s[28:29], vcc
    s_cbranch_execz RL_si40
    buffer_store_dwordx4 v[40:43], v44, s[4:7], s41 offen
RL_si40:
    s_mov_b64 exec, s[28:29]
    buffer_store_dwordx4 v[40:43], v44, s[4:7], s42 offen
    s_add_u32 s41, s42, 4096
    buffer_store_dwordx4 v[40:43], v44, s[4:7], s41 offen
    s_add_u32 s41, s42, 8192
    v_cmp_gt_u32 vcc, 64, v30
    s_and_saveexec_b64 s[28:29], vcc
    s_cbranch_execz RL_si42
    buffer_store_dwordx4 v[40:43], v44, s[4:7], s41 offen
RL_si42:
    s_mov_b64 exec, s[28:29]
    s_lshl_b32 s93, s30, 7
    s_add_u32 s93, s93, 3145728
    v_mov_b32 v45, 0
    s_mov_b64 exec, 1
    buffer_store_dword v45, v45, s[4:7], s93 offen sc1
    s_mov_b64 exec, -1
    s_cmp_eq_u32 s30, 0
    s_cbranch_scc0 RL_NOG0a
    v_lshrrev_b32 v78, 4, v0
    v_bfe_u32 v79, v78, 2, 2
    v_lshlrev_b32 v79, 1, v79
    v_and_b32 v77, 1, v78
    v_add_u32 v79, v79, v77
    v_mul_u32_u24 v79, 1152, v79
    v_lshrrev_b32 v77, 4, v78
    v_lshlrev_b32 v77, 1, v77
    v_bfe_u32 v76, v78, 1, 1
    v_add_u32 v77, v77, v76
    v_lshl_add_u32 v79, v77, 4, v79
    s_lshl_b32 s33, s31, 7
    s_add_u32 s34, s33, 512
    s_mov_b32 s35, 1024
    buffer_load_dwordx4 v[60:63], v79, s[24:27], s33 offen
    buffer_load_dwordx4 v[64:67], v79, s[24:27], s34 offen
    buffer_load_dwordx4 v[68:71], v79, s[24:27], s35 offen
RL_NOG0a:
    v_lshrrev_b32 v16, 4, v0
    v_lshrrev_b32 v17, 1, v16
    v_mul_u32_u24 v17, 1152, v17
    v_and_b32 v16, 1, v16
    v_lshl_add_u32 v16, v16, 4, v17
    s_mul_i32 s56, s30, 147456
    s_mul_i32 s57, s31, 36864
    s_add_u32 s57, s57, 16384
    s_lshl_b32 s50, s31, 8
    s_add_u32 s51, s56, s50
    s_lshl_b32 s50, s31, 5
    s_add_u32 s56, s56, s50
    s_add_u32 s56, s56, 1024
    s_mov_b32 s28, s51
    s_waitcnt vmcnt(31)
    s_barrier
    s_xor_b32 s50, s31, 0
    s_lshl_b32 s50, s50, 14
    s_add_u32 s50, s50, 16384
    v_add_u32 v18, s50, v14
    v_add_u32 v19, s50, v15
    ds_read_b64_tr_b16 a[0:1], v18 offset:0
    ds_read_b64_tr_b16 a[2:3], v18 offset:512
    ds_read_b64_tr_b16 a[4:5], v18 offset:8192
    ds_read_b64_tr_b16 a[6:7], v18 offset:8704
    ds_read_b64_tr_b16 a[72:73], v19 offset:0
    ds_read_b64_tr_b16 a[74:75], v19 offset:512
    ds_read_b64_tr_b16 a[76:77], v19 offset:8192
    ds_read_b64_tr_b16 a[78:79], v19 offset:8704
    s_waitcnt lgkmcnt(0)
    s_xor_b32 s50, s31, 1
    s_lshl_b32 s50, s50, 14
    s_add_u32 s50, s50, 16384
    v_add_u32 v18, s50, v14
    v_add_u32 v19, s50, v15
    ds_read_b64_tr_b16 a[24:25], v18 offset:0
    ds_read_b64_tr_b16 a[26:27], v18 offset:512
    ds_read_b64_tr_b16 a[28:29], v18 offset:8192
    ds_read_b64_tr_b16 a[30:31], v18 offset:8704
    ds_read_b64_tr_b16 a[96:97], v19 offset:0
    ds_read_b64_tr_b16 a[98:99], v19 offset:512
    ds_read_b64_tr_b16 a[100:101], v19 offset:8192
    ds_read_b64_tr_b16 a[102:103], v19 offset:8704
    s_waitcnt lgkmcnt(0)
    s_xor_b32 s50, s31, 2
    s_lshl_b32 s50, s50, 14
    s_add_u32 s50, s50, 16384
    v_add_u32 v18, s50, v14
    v_add_u32 v19, s50, v15
    ds_read_b64_tr_b16 a[40:41], v18 offset:0
    ds_read_b64_tr_b16 a[42:43], v18 offset:512
    ds_read_b64_tr_b16 a[44:45], v18 offset:8192
    ds_read_b64_tr_b16 a[46:47], v18 offset:8704
    ds_read_b64_tr_b16 a[112:113], v19 offset:0
    ds_read_b64_tr_b16 a[114:115], v19 offset:512
    ds_read_b64_tr_b16 a[116:117], v19 offset:8192
    ds_read_b64_tr_b16 a[118:119], v19 offset:8704
    s_waitcnt lgkmcnt(0)
    s_xor_b32 s50, s31, 3
    s_lshl_b32 s50, s50, 14
    s_add_u32 s50, s50, 16384
    v_add_u32 v18, s50, v14
    v_add_u32 v19, s50, v15
    ds_read_b64_tr_b16 a[56:57], v18 offset:0
    ds_read_b64_tr_b16 a[58:59], v18 offset:512
    ds_read_b64_tr_b16 a[60:61], v18 offset:8192
    ds_read_b64_tr_b16 a[62:63], v18 offset:8704
    ds_read_b64_tr_b16 a[128:129], v19 offset:0
    ds_read_b64_tr_b16 a[130:131], v19 offset:512
    ds_read_b64_tr_b16 a[132:133], v19 offset:8192
    ds_read_b64_tr_b16 a[134:135], v19 offset:8704
    s_waitcnt lgkmcnt(0)
    s_barrier
    s_add_u32 s52, s54, 0
    s_add_u32 m0, s55, 16384
    s_nop 0
    buffer_load_dwordx4 v10, s[12:15], s52 offen lds
    s_add_u32 s52, s54, 32768
    s_add_u32 m0, s55, 17408
    s_nop 0
    buffer_load_dwordx4 v11, s[12:15], s52 offen lds
    s_add_u32 s52, s54, 65536
    s_add_u32 m0, s55, 18432
    s_nop 0
    buffer_load_dwordx4 v12, s[12:15], s52 offen lds
    s_add_u32 s52, s54, 98304
    s_add_u32 m0, s55, 19456
    s_nop 0
    buffer_load_dwordx4 v13, s[12:15], s52 offen lds
    s_add_u32 s52, s54, 524288
    s_add_u32 m0, s55, 32768
    s_nop 0
    buffer_load_dwordx4 v10, s[12:15], s52 offen lds
    s_add_u32 s52, s54, 557056
    s_add_u32 m0, s55, 33792
    s_nop 0
    buffer_load_dwordx4 v11, s[12:15], s52 offen lds
    s_add_u32 s52, s54, 589824
    s_add_u32 m0, s55, 34816
    s_nop 0
    buffer_load_dwordx4 v12, s[12:15], s52 offen lds
    s_add_u32 s52, s54, 622592
    s_add_u32 m0, s55, 35840
    s_nop 0
    buffer_load_dwordx4 v13, s[12:15], s52 offen lds
    s_add_u32 s52, s54, 1048576
    s_add_u32 m0, s55, 49152
    s_nop 0
    buffer_load_dwordx4 v10, s[12:15], s52 offen lds
    s_add_u32 s52, s54, 1081344
    s_add_u32 m0, s55, 50176
    s_nop 0
    buffer_load_dwordx4 v11, s[12:15], s52 offen lds
    s_add_u32 s52, s54, 1114112
    s_add_u32 m0, s55, 51200
    s_nop 0
    buffer_load_dwordx4 v12, s[12:15], s52 offen lds
    s_add_u32 s52, s54, 1146880
    s_add_u32 m0, s55, 52224
    s_nop 0
    buffer_load_dwordx4 v13, s[12:15], s52 offen lds
    s_add_u32 s52, s54, 1572864
    s_add_u32 m0, s55, 65536
    s_nop 0
    buffer_load_dwordx4 v10, s[12:15], s52 offen lds
    s_add_u32 s52, s54, 1605632
    s_add_u32 m0, s55, 66560
    s_nop 0
    buffer_load_dwordx4 v11, s[12:15], s52 offen lds
    s_add_u32 s52, s54, 1638400
    s_add_u32 m0, s55, 67584
    s_nop 0
    buffer_load_dwordx4 v12, s[12:15], s52 offen lds
    s_add_u32 s52, s54, 1671168
    s_add_u32 m0, s55, 68608
    s_nop 0
    buffer_load_dwordx4 v13, s[12:15], s52 offen lds
    s_waitcnt vmcnt(31)
    s_barrier
    s_xor_b32 s50, s31, 0
    s_lshl_b32 s50, s50, 14
    s_add_u32 s50, s50, 81920
    v_add_u32 v18, s50, v14
    v_add_u32 v19, s50, v15
    ds_read_b64_tr_b16 a[8:9], v18 offset:0
    ds_read_b64_tr_b16 a[10:11], v18 offset:512
    ds_read_b64_tr_b16 a[12:13], v18 offset:8192
    ds_read_b64_tr_b16 a[14:15], v18 offset:8704
    ds_read_b64_tr_b16 a[80:81], v19 offset:0
    ds_read_b64_tr_b16 a[82:83], v19 offset:512
    ds_read_b64_tr_b16 a[84:85], v19 offset:8192
    ds_read_b64_tr_b16 a[86:87], v19 offset:8704
    s_waitcnt lgkmcnt(0)
    s_xor_b32 s50, s31, 1
    s_lshl_b32 s50, s50, 14
    s_add_u32 s50, s50, 81920
    v_add_u32 v18, s50, v14
    v_add_u32 v19, s50, v15
    ds_read_b64_tr_b16 a[32:33], v18 offset:0
    ds_read_b64_tr_b16 a[34:35], v18 offset:512
    ds_read_b64_tr_b16 a[36:37], v18 offset:8192
    ds_read_b64_tr_b16 a[38:39], v18 offset:8704
    ds_read_b64_tr_b16 a[104:105], v19 offset:0
    ds_read_b64_tr_b16 a[106:107], v19 offset:512
    ds_read_b64_tr_b16 a[108:109], v19 offset:8192
    ds_read_b64_tr_b16 a[110:111], v19 offset:8704
    s_waitcnt lgkmcnt(0)
    s_xor_b32 s50, s31, 2
    s_lshl_b32 s50, s50, 14
    s_add_u32 s50, s50, 81920
    v_add_u32 v18, s50, v14
    v_add_u32 v19, s50, v15
    ds_read_b64_tr_b16 a[48:49], v18 offset:0
    ds_read_b64_tr_b16 a[50:51], v18 offset:512
    ds_read_b64_tr_b16 a[52:53], v18 offset:8192
    ds_read_b64_tr_b16 a[54:55], v18 offset:8704
    ds_read_b64_tr_b16 a[120:121], v19 offset:0
    ds_read_b64_tr_b16 a[122:123], v19 offset:512
    ds_read_b64_tr_b16 a[124:125], v19 offset:8192
    ds_read_b64_tr_b16 a[126:127], v19 offset:8704
    s_waitcnt lgkmcnt(0)
    s_xor_b32 s50, s31, 3
    s_lshl_b32 s50, s50, 14
    s_add_u32 s50, s50, 81920
    v_add_u32 v18, s50, v14
    v_add_u32 v19, s50, v15
    ds_read_b64_tr_b16 a[64:65], v18 offset:0
    ds_read_b64_tr_b16 a[66:67], v18 offset:512
    ds_read_b64_tr_b16 a[68:69], v18 offset:8192
    ds_read_b64_tr_b16 a[70:71], v18 offset:8704
    ds_read_b64_tr_b16 a[136:137], v19 offset:0
    ds_read_b64_tr_b16 a[138:139], v19 offset:512
    ds_read_b64_tr_b16 a[140:141], v19 offset:8192
    ds_read_b64_tr_b16 a[142:143], v19 offset:8704
    s_waitcnt lgkmcnt(0)
    s_barrier
    s_add_u32 s52, s54, 2097152
    s_add_u32 m0, s55, 81920
    s_nop 0
    buffer_load_dwordx4 v10, s[12:15], s52 offen lds
    s_add_u32 s52, s54, 2129920
    s_add_u32 m0, s55, 82944
    s_nop 0
    buffer_load_dwordx4 v11, s[12:15], s52 offen lds
    s_add_u32 s52, s54, 2162688
    s_add_u32 m0, s55, 83968
    s_nop 0
    buffer_load_dwordx4 v12, s[12:15], s52 offen lds
    s_add_u32 s52, s54, 2195456
    s_add_u32 m0, s55, 84992
    s_nop 0
    buffer_load_dwordx4 v13, s[12:15], s52 offen lds
    s_add_u32 s52, s54, 2621440
    s_add_u32 m0, s55, 98304
    s_nop 0
    buffer_load_dwordx4 v10, s[12:15], s52 offen lds
    s_add_u32 s52, s54, 2654208
    s_add_u32 m0, s55, 99328
    s_nop 0
    buffer_load_dwordx4 v11, s[12:15], s52 offen lds
    s_add_u32 s52, s54, 2686976
    s_add_u32 m0, s55, 100352
    s_nop 0
    buffer_load_dwordx4 v12, s[12:15], s52 offen lds
    s_add_u32 s52, s54, 2719744
    s_add_u32 m0, s55, 101376
    s_nop 0
    buffer_load_dwordx4 v13, s[12:15], s52 offen lds
    s_add_u32 s52, s54, 3145728
    s_add_u32 m0, s55, 114688
    s_nop 0
    buffer_load_dwordx4 v10, s[12:15], s52 offen lds
    s_add_u32 s52, s54, 3178496
    s_add_u32 m0, s55, 115712
    s_nop 0
    buffer_load_dwordx4 v11, s[12:15], s52 offen lds
    s_add_u32 s52, s54, 3211264
    s_add_u32 m0, s55, 116736
    s_nop 0
    buffer_load_dwordx4 v12, s[12:15], s52 offen lds
    s_add_u32 s52, s54, 3244032
    s_add_u32 m0, s55, 117760
    s_nop 0
    buffer_load_dwordx4 v13, s[12:15], s52 offen lds
    s_add_u32 s52, s54, 3670016
    s_add_u32 m0, s55, 131072
    s_nop 0
    buffer_load_dwordx4 v10, s[12:15], s52 offen lds
    s_add_u32 s52, s54, 3702784
    s_add_u32 m0, s55, 132096
    s_nop 0
    buffer_load_dwordx4 v11, s[12:15], s52 offen lds
    s_add_u32 s52, s54, 3735552
    s_add_u32 m0, s55, 133120
    s_nop 0
    buffer_load_dwordx4 v12, s[12:15], s52 offen lds
    s_add_u32 s52, s54, 3768320
    s_add_u32 m0, s55, 134144
    s_nop 0
    buffer_load_dwordx4 v13, s[12:15], s52 offen lds
    s_waitcnt vmcnt(43)
    s_barrier
    v_add_u32 v18, 147456, v14
    v_add_u32 v19, 147456, v15
    ds_read_b64_tr_b16 a[16:17], v18 offset:0
    ds_read_b64_tr_b16 a[18:19], v18 offset:512
    ds_read_b64_tr_b16 a[20:21], v18 offset:8192
    ds_read_b64_tr_b16 a[22:23], v18 offset:8704
    ds_read_b64_tr_b16 a[88:89], v19 offset:0
    ds_read_b64_tr_b16 a[90:91], v19 offset:512
    ds_read_b64_tr_b16 a[92:93], v19 offset:8192
    ds_read_b64_tr_b16 a[94:95], v19 offset:8704
    s_waitcnt lgkmcnt(0)
    s_barrier
    s_add_u32 s52, s54, 4194304
    s_add_u32 m0, s55, 147456
    s_nop 0
    buffer_load_dwordx4 v10, s[12:15], s52 offen lds
    s_add_u32 s52, s54, 4227072
    s_add_u32 m0, s55, 148480
    s_nop 0
    buffer_load_dwordx4 v11, s[12:15], s52 offen lds
    s_add_u32 s52, s54, 4259840
    s_add_u32 m0, s55, 149504
    s_nop 0
    buffer_load_dwordx4 v12, s[12:15], s52 offen lds
    s_add_u32 s52, s54, 4292608
    s_add_u32 m0, s55, 150528
    s_nop 0
    buffer_load_dwordx4 v13, s[12:15], s52 offen lds
    s_waitcnt vmcnt(20)
    s_barrier
    s_xor_b32 s50, s31, 0
    s_lshl_b32 s50, s50, 14
    s_add_u32 s50, s50, 16384
    v_add_u32 v18, s50, v14
    v_add_u32 v19, s50, v15
    ds_read_b64_tr_b16 a[144:145], v18 offset:0
    ds_read_b64_tr_b16 a[146:147], v18 offset:512
    ds_read_b64_tr_b16 a[148:149], v18 offset:8192
    ds_read_b64_tr_b16 a[150:151], v18 offset:8704
    ds_read_b64_tr_b16 a[216:217], v19 offset:0
    ds_read_b64_tr_b16 a[218:219], v19 offset:512
    ds_read_b64_tr_b16 a[220:221], v19 offset:8192
    ds_read_b64_tr_b16 a[222:223], v19 offset:8704
    s_waitcnt lgkmcnt(0)
    s_xor_b32 s50, s31, 1
    s_lshl_b32 s50, s50, 14
    s_add_u32 s50, s50, 16384
    v_add_u32 v18, s50, v14
    v_add_u32 v19, s50, v15
    ds_read_b64_tr_b16 a[168:169], v18 offset:0
    ds_read_b64_tr_b16 a[170:171], v18 offset:512
    ds_read_b64_tr_b16 a[172:173], v18 offset:8192
    ds_read_b64_tr_b16 a[174:175], v18 offset:8704
    ds_read_b64_tr_b16 a[240:241], v19 offset:0
    ds_read_b64_tr_b16 a[242:243], v19 offset:512
    ds_read_b64_tr_b16 a[244:245], v19 offset:8192
    ds_read_b64_tr_b16 a[246:247], v19 offset:8704
    s_waitcnt lgkmcnt(0)
    s_xor_b32 s50, s31, 2
    s_lshl_b32 s50, s50, 14
    s_add_u32 s50, s50, 16384
    v_add_u32 v18, s50, v14
    v_add_u32 v19, s50, v15
    ds_read_b64_tr_b16 a[184:185], v18 offset:0
    ds_read_b64_tr_b16 a[186:187], v18 offset:512
    ds_read_b64_tr_b16 a[188:189], v18 offset:8192
    ds_read_b64_tr_b16 a[190:191], v18 offset:8704
    ds_read_b64_tr_b16 v[80:81], v19 offset:0
    ds_read_b64_tr_b16 v[82:83], v19 offset:512
    ds_read_b64_tr_b16 v[84:85], v19 offset:8192
    ds_read_b64_tr_b16 v[86:87], v19 offset:8704
    s_waitcnt lgkmcnt(0)
    s_xor_b32 s50, s31, 3
    s_lshl_b32 s50, s50, 14
    s_add_u32 s50, s50, 16384
    v_add_u32 v18, s50, v14
    v_add_u32 v19, s50, v15
    ds_read_b64_tr_b16 a[200:201], v18 offset:0
    ds_read_b64_tr_b16 a[202:203], v18 offset:512
    ds_read_b64_tr_b16 a[204:205], v18 offset:8192
    ds_read_b64_tr_b16 a[206:207], v18 offset:8704
    ds_read_b64_tr_b16 v[96:97], v19 offset:0
    ds_read_b64_tr_b16 v[98:99], v19 offset:512
    ds_read_b64_tr_b16 v[100:101], v19 offset:8192
    ds_read_b64_tr_b16 v[102:103], v19 offset:8704
    s_waitcnt lgkmcnt(0)
    s_barrier
        s_cmp_eq_u32 s30, 0
    s_cbranch_scc0 RL_NOG0b
    s_mov_b32 s33, 1048576
    s_mov_b32 s34, 1052672
    s_mov_b32 s35, 1056768
    buffer_store_dwordx4 v[60:63], v8, s[4:7], s33 offen
    buffer_store_dwordx4 v[64:67], v8, s[4:7], s34 offen
    buffer_store_dwordx4 v[68:71], v0, s[4:7], s35 offen
RL_NOG0b:
    s_add_u32 s52, s54, 0
    s_add_u32 m0, s55, 16384
    s_nop 0
    buffer_load_dwordx4 v10, s[16:19], s52 offen lds
    s_add_u32 s52, s54, 32768
    s_add_u32 m0, s55, 17408
    s_nop 0
    buffer_load_dwordx4 v11, s[16:19], s52 offen lds
    s_add_u32 s52, s54, 65536
    s_add_u32 m0, s55, 18432
    s_nop 0
    buffer_load_dwordx4 v12, s[16:19], s52 offen lds
    s_add_u32 s52, s54, 98304
    s_add_u32 m0, s55, 19456
    s_nop 0
    buffer_load_dwordx4 v13, s[16:19], s52 offen lds
    s_add_u32 s52, s54, 524288
    s_add_u32 m0, s55, 32768
    s_nop 0
    buffer_load_dwordx4 v10, s[16:19], s52 offen lds
    s_add_u32 s52, s54, 557056
    s_add_u32 m0, s55, 33792
    s_nop 0
    buffer_load_dwordx4 v11, s[16:19], s52 offen lds
    s_add_u32 s52, s54, 589824
    s_add_u32 m0, s55, 34816
    s_nop 0
    buffer_load_dwordx4 v12, s[16:19], s52 offen lds
    s_add_u32 s52, s54, 622592
    s_add_u32 m0, s55, 35840
    s_nop 0
    buffer_load_dwordx4 v13, s[16:19], s52 offen lds
    s_add_u32 s52, s54, 1048576
    s_add_u32 m0, s55, 49152
    s_nop 0
    buffer_load_dwordx4 v10, s[16:19], s52 offen lds
    s_add_u32 s52, s54, 1081344
    s_add_u32 m0, s55, 50176
    s_nop 0
    buffer_load_dwordx4 v11, s[16:19], s52 offen lds
    s_add_u32 s52, s54, 1114112
    s_add_u32 m0, s55, 51200
    s_nop 0
    buffer_load_dwordx4 v12, s[16:19], s52 offen lds
    s_add_u32 s52, s54, 1146880
    s_add_u32 m0, s55, 52224
    s_nop 0
    buffer_load_dwordx4 v13, s[16:19], s52 offen lds
    s_add_u32 s52, s54, 1572864
    s_add_u32 m0, s55, 65536
    s_nop 0
    buffer_load_dwordx4 v10, s[16:19], s52 offen lds
    s_add_u32 s52, s54, 1605632
    s_add_u32 m0, s55, 66560
    s_nop 0
    buffer_load_dwordx4 v11, s[16:19], s52 offen lds
    s_add_u32 s52, s54, 1638400
    s_add_u32 m0, s55, 67584
    s_nop 0
    buffer_load_dwordx4 v12, s[16:19], s52 offen lds
    s_add_u32 s52, s54, 1671168
    s_add_u32 m0, s55, 68608
    s_nop 0
    buffer_load_dwordx4 v13, s[16:19], s52 offen lds
    s_waitcnt vmcnt(20)
    s_barrier
    s_xor_b32 s50, s31, 0
    s_lshl_b32 s50, s50, 14
    s_add_u32 s50, s50, 81920
    v_add_u32 v18, s50, v14
    v_add_u32 v19, s50, v15
    ds_read_b64_tr_b16 a[152:153], v18 offset:0
    ds_read_b64_tr_b16 a[154:155], v18 offset:512
    ds_read_b64_tr_b16 a[156:157], v18 offset:8192
    ds_read_b64_tr_b16 a[158:159], v18 offset:8704
    ds_read_b64_tr_b16 a[224:225], v19 offset:0
    ds_read_b64_tr_b16 a[226:227], v19 offset:512
    ds_read_b64_tr_b16 a[228:229], v19 offset:8192
    ds_read_b64_tr_b16 a[230:231], v19 offset:8704
    s_waitcnt lgkmcnt(0)
    s_xor_b32 s50, s31, 1
    s_lshl_b32 s50, s50, 14
    s_add_u32 s50, s50, 81920
    v_add_u32 v18, s50, v14
    v_add_u32 v19, s50, v15
    ds_read_b64_tr_b16 a[176:177], v18 offset:0
    ds_read_b64_tr_b16 a[178:179], v18 offset:512
    ds_read_b64_tr_b16 a[180:181], v18 offset:8192
    ds_read_b64_tr_b16 a[182:183], v18 offset:8704
    ds_read_b64_tr_b16 a[248:249], v19 offset:0
    ds_read_b64_tr_b16 a[250:251], v19 offset:512
    ds_read_b64_tr_b16 a[252:253], v19 offset:8192
    ds_read_b64_tr_b16 a[254:255], v19 offset:8704
    s_waitcnt lgkmcnt(0)
    s_xor_b32 s50, s31, 2
    s_lshl_b32 s50, s50, 14
    s_add_u32 s50, s50, 81920
    v_add_u32 v18, s50, v14
    v_add_u32 v19, s50, v15
    ds_read_b64_tr_b16 a[192:193], v18 offset:0
    ds_read_b64_tr_b16 a[194:195], v18 offset:512
    ds_read_b64_tr_b16 a[196:197], v18 offset:8192
    ds_read_b64_tr_b16 a[198:199], v18 offset:8704
    ds_read_b64_tr_b16 v[88:89], v19 offset:0
    ds_read_b64_tr_b16 v[90:91], v19 offset:512
    ds_read_b64_tr_b16 v[92:93], v19 offset:8192
    ds_read_b64_tr_b16 v[94:95], v19 offset:8704
    s_waitcnt lgkmcnt(0)
    s_xor_b32 s50, s31, 3
    s_lshl_b32 s50, s50, 14
    s_add_u32 s50, s50, 81920
    v_add_u32 v18, s50, v14
    v_add_u32 v19, s50, v15
    ds_read_b64_tr_b16 a[208:209], v18 offset:0
    ds_read_b64_tr_b16 a[210:211], v18 offset:512
    ds_read_b64_tr_b16 a[212:213], v18 offset:8192
    ds_read_b64_tr_b16 a[214:215], v18 offset:8704
    ds_read_b64_tr_b16 v[104:105], v19 offset:0
    ds_read_b64_tr_b16 v[106:107], v19 offset:512
    ds_read_b64_tr_b16 v[108:109], v19 offset:8192
    ds_read_b64_tr_b16 v[110:111], v19 offset:8704
    s_waitcnt lgkmcnt(0)
    s_barrier
    s_add_u32 s52, s54, 2097152
    s_add_u32 m0, s55, 81920
    s_nop 0
    buffer_load_dwordx4 v10, s[16:19], s52 offen lds
    s_add_u32 s52, s54, 2129920
    s_add_u32 m0, s55, 82944
    s_nop 0
    buffer_load_dwordx4 v11, s[16:19], s52 offen lds
    s_add_u32 s52, s54, 2162688
    s_add_u32 m0, s55, 83968
    s_nop 0
    buffer_load_dwordx4 v12, s[16:19], s52 offen lds
    s_add_u32 s52, s54, 2195456
    s_add_u32 m0, s55, 84992
    s_nop 0
    buffer_load_dwordx4 v13, s[16:19], s52 offen lds
    s_add_u32 s52, s54, 2621440
    s_add_u32 m0, s55, 98304
    s_nop 0
    buffer_load_dwordx4 v10, s[16:19], s52 offen lds
    s_add_u32 s52, s54, 2654208
    s_add_u32 m0, s55, 99328
    s_nop 0
    buffer_load_dwordx4 v11, s[16:19], s52 offen lds
    s_add_u32 s52, s54, 2686976
    s_add_u32 m0, s55, 100352
    s_nop 0
    buffer_load_dwordx4 v12, s[16:19], s52 offen lds
    s_add_u32 s52, s54, 2719744
    s_add_u32 m0, s55, 101376
    s_nop 0
    buffer_load_dwordx4 v13, s[16:19], s52 offen lds
    s_add_u32 s52, s54, 3145728
    s_add_u32 m0, s55, 114688
    s_nop 0
    buffer_load_dwordx4 v10, s[16:19], s52 offen lds
    s_add_u32 s52, s54, 3178496
    s_add_u32 m0, s55, 115712
    s_nop 0
    buffer_load_dwordx4 v11, s[16:19], s52 offen lds
    s_add_u32 s52, s54, 3211264
    s_add_u32 m0, s55, 116736
    s_nop 0
    buffer_load_dwordx4 v12, s[16:19], s52 offen lds
    s_add_u32 s52, s54, 3244032
    s_add_u32 m0, s55, 117760
    s_nop 0
    buffer_load_dwordx4 v13, s[16:19], s52 offen lds
    s_add_u32 s52, s54, 3670016
    s_add_u32 m0, s55, 131072
    s_nop 0
    buffer_load_dwordx4 v10, s[16:19], s52 offen lds
    s_add_u32 s52, s54, 3702784
    s_add_u32 m0, s55, 132096
    s_nop 0
    buffer_load_dwordx4 v11, s[16:19], s52 offen lds
    s_add_u32 s52, s54, 3735552
    s_add_u32 m0, s55, 133120
    s_nop 0
    buffer_load_dwordx4 v12, s[16:19], s52 offen lds
    s_add_u32 s52, s54, 3768320
    s_add_u32 m0, s55, 134144
    s_nop 0
    buffer_load_dwordx4 v13, s[16:19], s52 offen lds
    s_waitcnt vmcnt(32)
    s_barrier
    v_add_u32 v18, 147456, v14
    v_add_u32 v19, 147456, v15
    ds_read_b64_tr_b16 a[160:161], v18 offset:0
    ds_read_b64_tr_b16 a[162:163], v18 offset:512
    ds_read_b64_tr_b16 a[164:165], v18 offset:8192
    ds_read_b64_tr_b16 a[166:167], v18 offset:8704
    ds_read_b64_tr_b16 a[232:233], v19 offset:0
    ds_read_b64_tr_b16 a[234:235], v19 offset:512
    ds_read_b64_tr_b16 a[236:237], v19 offset:8192
    ds_read_b64_tr_b16 a[238:239], v19 offset:8704
    s_waitcnt lgkmcnt(0)
    s_barrier
    s_add_u32 s52, s54, 4194304
    s_add_u32 m0, s55, 147456
    s_nop 0
    buffer_load_dwordx4 v10, s[16:19], s52 offen lds
    s_add_u32 s52, s54, 4227072
    s_add_u32 m0, s55, 148480
    s_nop 0
    buffer_load_dwordx4 v11, s[16:19], s52 offen lds
    s_add_u32 s52, s54, 4259840
    s_add_u32 m0, s55, 149504
    s_nop 0
    buffer_load_dwordx4 v12, s[16:19], s52 offen lds
    s_add_u32 s52, s54, 4292608
    s_add_u32 m0, s55, 150528
    s_nop 0
    buffer_load_dwordx4 v13, s[16:19], s52 offen lds
    s_waitcnt vmcnt(20)
    s_barrier
    s_xor_b32 s50, s31, 0
    s_lshl_b32 s50, s50, 14
    s_add_u32 s50, s50, 16384
    v_add_u32 v18, s50, v14
    v_add_u32 v19, s50, v15
    ds_read_b64_tr_b16 v[112:113], v18 offset:0
    ds_read_b64_tr_b16 v[114:115], v18 offset:512
    ds_read_b64_tr_b16 v[116:117], v18 offset:8192
    ds_read_b64_tr_b16 v[118:119], v18 offset:8704
    ds_read_b64_tr_b16 v[184:185], v19 offset:0
    ds_read_b64_tr_b16 v[186:187], v19 offset:512
    ds_read_b64_tr_b16 v[188:189], v19 offset:8192
    ds_read_b64_tr_b16 v[190:191], v19 offset:8704
    s_waitcnt lgkmcnt(0)
    s_xor_b32 s50, s31, 1
    s_lshl_b32 s50, s50, 14
    s_add_u32 s50, s50, 16384
    v_add_u32 v18, s50, v14
    v_add_u32 v19, s50, v15
    ds_read_b64_tr_b16 v[136:137], v18 offset:0
    ds_read_b64_tr_b16 v[138:139], v18 offset:512
    ds_read_b64_tr_b16 v[140:141], v18 offset:8192
    ds_read_b64_tr_b16 v[142:143], v18 offset:8704
    ds_read_b64_tr_b16 v[208:209], v19 offset:0
    ds_read_b64_tr_b16 v[210:211], v19 offset:512
    ds_read_b64_tr_b16 v[212:213], v19 offset:8192
    ds_read_b64_tr_b16 v[214:215], v19 offset:8704
    s_waitcnt lgkmcnt(0)
    s_xor_b32 s50, s31, 2
    s_lshl_b32 s50, s50, 14
    s_add_u32 s50, s50, 16384
    v_add_u32 v18, s50, v14
    v_add_u32 v19, s50, v15
    ds_read_b64_tr_b16 v[152:153], v18 offset:0
    ds_read_b64_tr_b16 v[154:155], v18 offset:512
    ds_read_b64_tr_b16 v[156:157], v18 offset:8192
    ds_read_b64_tr_b16 v[158:159], v18 offset:8704
    ds_read_b64_tr_b16 v[224:225], v19 offset:0
    ds_read_b64_tr_b16 v[226:227], v19 offset:512
    ds_read_b64_tr_b16 v[228:229], v19 offset:8192
    ds_read_b64_tr_b16 v[230:231], v19 offset:8704
    s_waitcnt lgkmcnt(0)
    s_xor_b32 s50, s31, 3
    s_lshl_b32 s50, s50, 14
    s_add_u32 s50, s50, 16384
    v_add_u32 v18, s50, v14
    v_add_u32 v19, s50, v15
    ds_read_b64_tr_b16 v[168:169], v18 offset:0
    ds_read_b64_tr_b16 v[170:171], v18 offset:512
    ds_read_b64_tr_b16 v[172:173], v18 offset:8192
    ds_read_b64_tr_b16 v[174:175], v18 offset:8704
    ds_read_b64_tr_b16 v[240:241], v19 offset:0
    ds_read_b64_tr_b16 v[242:243], v19 offset:512
    ds_read_b64_tr_b16 v[244:245], v19 offset:8192
    ds_read_b64_tr_b16 v[246:247], v19 offset:8704
    s_waitcnt lgkmcnt(0)
    s_barrier
    s_cmp_eq_u32 s31, 0
    s_cbranch_scc0 RL_arv
    v_mov_b32 v40, 32
    v_mov_b32 v41, 1
    s_mov_b64 exec, 1
    global_atomic_add v40, v41, s[90:91]
    s_mov_b64 exec, -1
RL_arv:
    s_cmp_eq_u32 s31, 0
    s_cbranch_scc0 RL_wo_1
    s_add_u32 s52, s28, 0
    s_add_u32 m0, s57, 0
    s_nop 0
    buffer_load_dwordx4 v16, s[20:23], s52 offen lds
    s_add_u32 s52, s28, 36864
    s_add_u32 m0, s57, 1024
    s_nop 0
    buffer_load_dwordx4 v16, s[20:23], s52 offen lds
    s_add_u32 s52, s28, 73728
    s_add_u32 m0, s57, 2048
    s_nop 0
    buffer_load_dwordx4 v16, s[20:23], s52 offen lds
    s_add_u32 s52, s28, 110592
    s_add_u32 m0, s57, 3072
    s_nop 0
    buffer_load_dwordx4 v16, s[20:23], s52 offen lds
    s_add_u32 s52, s28, 32
    s_add_u32 m0, s57, 4096
    s_nop 0
    buffer_load_dwordx4 v16, s[20:23], s52 offen lds
    s_add_u32 s52, s28, 36896
    s_add_u32 m0, s57, 5120
    s_nop 0
    buffer_load_dwordx4 v16, s[20:23], s52 offen lds
    s_add_u32 s52, s28, 73760
    s_add_u32 m0, s57, 6144
    s_nop 0
    buffer_load_dwordx4 v16, s[20:23], s52 offen lds
    s_add_u32 s52, s28, 110624
    s_add_u32 m0, s57, 7168
    s_nop 0
    buffer_load_dwordx4 v16, s[20:23], s52 offen lds
    s_add_u32 s52, s28, 64
    s_add_u32 m0, s57, 8192
    s_nop 0
    buffer_load_dwordx4 v16, s[20:23], s52 offen lds
    s_add_u32 s52, s28, 36928
    s_add_u32 m0, s57, 9216
    s_nop 0
    buffer_load_dwordx4 v16, s[20:23], s52 offen lds
    s_add_u32 s52, s28, 73792
    s_add_u32 m0, s57, 10240
    s_nop 0
    buffer_load_dwordx4 v16, s[20:23], s52 offen lds
    s_add_u32 s52, s28, 110656
    s_add_u32 m0, s57, 11264
    s_nop 0
    buffer_load_dwordx4 v16, s[20:23], s52 offen lds
    s_add_u32 s52, s28, 96
    s_add_u32 m0, s57, 12288
    s_nop 0
    buffer_load_dwordx4 v16, s[20:23], s52 offen lds
    s_add_u32 s52, s28, 36960
    s_add_u32 m0, s57, 13312
    s_nop 0
    buffer_load_dwordx4 v16, s[20:23], s52 offen lds
    s_add_u32 s52, s28, 73824
    s_add_u32 m0, s57, 14336
    s_nop 0
    buffer_load_dwordx4 v16, s[20:23], s52 offen lds
    s_add_u32 s52, s28, 110688
    s_add_u32 m0, s57, 15360
    s_nop 0
    buffer_load_dwordx4 v16, s[20:23], s52 offen lds
    s_add_u32 s52, s28, 128
    s_add_u32 m0, s57, 16384
    s_nop 0
    buffer_load_dwordx4 v16, s[20:23], s52 offen lds
    s_add_u32 s52, s28, 36992
    s_add_u32 m0, s57, 17408
    s_nop 0
    buffer_load_dwordx4 v16, s[20:23], s52 offen lds
    s_add_u32 s52, s28, 73856
    s_add_u32 m0, s57, 18432
    s_nop 0
    buffer_load_dwordx4 v16, s[20:23], s52 offen lds
    s_add_u32 s52, s28, 110720
    s_add_u32 m0, s57, 19456
    s_nop 0
    buffer_load_dwordx4 v16, s[20:23], s52 offen lds
    s_add_u32 s52, s28, 160
    s_add_u32 m0, s57, 20480
    s_nop 0
    buffer_load_dwordx4 v16, s[20:23], s52 offen lds
    s_add_u32 s52, s28, 37024
    s_add_u32 m0, s57, 21504
    s_nop 0
    buffer_load_dwordx4 v16, s[20:23], s52 offen lds
    s_add_u32 s52, s28, 73888
    s_add_u32 m0, s57, 22528
    s_nop 0
    buffer_load_dwordx4 v16, s[20:23], s52 offen lds
    s_add_u32 s52, s28, 110752
    s_add_u32 m0, s57, 23552
    s_nop 0
    buffer_load_dwordx4 v16, s[20:23], s52 offen lds
    s_add_u32 s52, s28, 192
    s_add_u32 m0, s57, 24576
    s_nop 0
    buffer_load_dwordx4 v16, s[20:23], s52 offen lds
    s_add_u32 s52, s28, 37056
    s_add_u32 m0, s57, 25600
    s_nop 0
    buffer_load_dwordx4 v16, s[20:23], s52 offen lds
    s_add_u32 s52, s28, 73920
    s_add_u32 m0, s57, 26624
    s_nop 0
    buffer_load_dwordx4 v16, s[20:23], s52 offen lds
    s_add_u32 s52, s28, 110784
    s_add_u32 m0, s57, 27648
    s_nop 0
    buffer_load_dwordx4 v16, s[20:23], s52 offen lds
    s_add_u32 s52, s28, 224
    s_add_u32 m0, s57, 28672
    s_nop 0
    buffer_load_dwordx4 v16, s[20:23], s52 offen lds
    s_add_u32 s52, s28, 37088
    s_add_u32 m0, s57, 29696
    s_nop 0
    buffer_load_dwordx4 v16, s[20:23], s52 offen lds
    s_add_u32 s52, s28, 73952
    s_add_u32 m0, s57, 30720
    s_nop 0
    buffer_load_dwordx4 v16, s[20:23], s52 offen lds
    s_add_u32 s52, s28, 110816
    s_add_u32 m0, s57, 31744
    s_nop 0
    buffer_load_dwordx4 v16, s[20:23], s52 offen lds
    s_add_u32 s52, s56, 0
    s_add_u32 m0, s57, 32768
    s_nop 0
    buffer_load_dwordx4 v16, s[20:23], s52 offen lds
    s_add_u32 s52, s56, 36864
    s_add_u32 m0, s57, 33792
    s_nop 0
    buffer_load_dwordx4 v16, s[20:23], s52 offen lds
    s_add_u32 s52, s56, 73728
    s_add_u32 m0, s57, 34816
    s_nop 0
    buffer_load_dwordx4 v16, s[20:23], s52 offen lds
    s_add_u32 s52, s56, 110592
    s_add_u32 m0, s57, 35840
    s_nop 0
    buffer_load_dwordx4 v16, s[20:23], s52 offen lds
RL_wo_1:
    s_cmp_eq_u32 s31, 0
    s_cbranch_scc1 RL_wv_2a
    s_waitcnt vmcnt(4)
    s_branch RL_wv_2b
RL_wv_2a:
    s_waitcnt vmcnt(40)
RL_wv_2b:
    s_barrier
    s_xor_b32 s50, s31, 0
    s_lshl_b32 s50, s50, 14
    s_add_u32 s50, s50, 81920
    v_add_u32 v18, s50, v14
    v_add_u32 v19, s50, v15
    ds_read_b64_tr_b16 v[120:121], v18 offset:0
    ds_read_b64_tr_b16 v[122:123], v18 offset:512
    ds_read_b64_tr_b16 v[124:125], v18 offset:8192
    ds_read_b64_tr_b16 v[126:127], v18 offset:8704
    ds_read_b64_tr_b16 v[192:193], v19 offset:0
    ds_read_b64_tr_b16 v[194:195], v19 offset:512
    ds_read_b64_tr_b16 v[196:197], v19 offset:8192
    ds_read_b64_tr_b16 v[198:199], v19 offset:8704
    s_waitcnt lgkmcnt(0)
    s_xor_b32 s50, s31, 1
    s_lshl_b32 s50, s50, 14
    s_add_u32 s50, s50, 81920
    v_add_u32 v18, s50, v14
    v_add_u32 v19, s50, v15
    ds_read_b64_tr_b16 v[144:145], v18 offset:0
    ds_read_b64_tr_b16 v[146:147], v18 offset:512
    ds_read_b64_tr_b16 v[148:149], v18 offset:8192
    ds_read_b64_tr_b16 v[150:151], v18 offset:8704
    ds_read_b64_tr_b16 v[216:217], v19 offset:0
    ds_read_b64_tr_b16 v[218:219], v19 offset:512
    ds_read_b64_tr_b16 v[220:221], v19 offset:8192
    ds_read_b64_tr_b16 v[222:223], v19 offset:8704
    s_waitcnt lgkmcnt(0)
    s_xor_b32 s50, s31, 2
    s_lshl_b32 s50, s50, 14
    s_add_u32 s50, s50, 81920
    v_add_u32 v18, s50, v14
    v_add_u32 v19, s50, v15
    ds_read_b64_tr_b16 v[160:161], v18 offset:0
    ds_read_b64_tr_b16 v[162:163], v18 offset:512
    ds_read_b64_tr_b16 v[164:165], v18 offset:8192
    ds_read_b64_tr_b16 v[166:167], v18 offset:8704
    ds_read_b64_tr_b16 v[232:233], v19 offset:0
    ds_read_b64_tr_b16 v[234:235], v19 offset:512
    ds_read_b64_tr_b16 v[236:237], v19 offset:8192
    ds_read_b64_tr_b16 v[238:239], v19 offset:8704
    s_waitcnt lgkmcnt(0)
    s_xor_b32 s50, s31, 3
    s_lshl_b32 s50, s50, 14
    s_add_u32 s50, s50, 81920
    v_add_u32 v18, s50, v14
    v_add_u32 v19, s50, v15
    ds_read_b64_tr_b16 v[176:177], v18 offset:0
    ds_read_b64_tr_b16 v[178:179], v18 offset:512
    ds_read_b64_tr_b16 v[180:181], v18 offset:8192
    ds_read_b64_tr_b16 v[182:183], v18 offset:8704
    ds_read_b64_tr_b16 v[248:249], v19 offset:0
    ds_read_b64_tr_b16 v[250:251], v19 offset:512
    ds_read_b64_tr_b16 v[252:253], v19 offset:8192
    ds_read_b64_tr_b16 v[254:255], v19 offset:8704
    s_waitcnt lgkmcnt(0)
    s_barrier
    s_sub_u32 s50, s31, 1
    s_cmp_le_u32 s50, 1
    s_cbranch_scc0 RL_wo_3
    s_add_u32 s52, s28, 0
    s_add_u32 m0, s57, 0
    s_nop 0
    buffer_load_dwordx4 v16, s[20:23], s52 offen lds
    s_add_u32 s52, s28, 36864
    s_add_u32 m0, s57, 1024
    s_nop 0
    buffer_load_dwordx4 v16, s[20:23], s52 offen lds
    s_add_u32 s52, s28, 73728
    s_add_u32 m0, s57, 2048
    s_nop 0
    buffer_load_dwordx4 v16, s[20:23], s52 offen lds
    s_add_u32 s52, s28, 110592
    s_add_u32 m0, s57, 3072
    s_nop 0
    buffer_load_dwordx4 v16, s[20:23], s52 offen lds
    s_add_u32 s52, s28, 32
    s_add_u32 m0, s57, 4096
    s_nop 0
    buffer_load_dwordx4 v16, s[20:23], s52 offen lds
    s_add_u32 s52, s28, 36896
    s_add_u32 m0, s57, 5120
    s_nop 0
    buffer_load_dwordx4 v16, s[20:23], s52 offen lds
    s_add_u32 s52, s28, 73760
    s_add_u32 m0, s57, 6144
    s_nop 0
    buffer_load_dwordx4 v16, s[20:23], s52 offen lds
    s_add_u32 s52, s28, 110624
    s_add_u32 m0, s57, 7168
    s_nop 0
    buffer_load_dwordx4 v16, s[20:23], s52 offen lds
    s_add_u32 s52, s28, 64
    s_add_u32 m0, s57, 8192
    s_nop 0
    buffer_load_dwordx4 v16, s[20:23], s52 offen lds
    s_add_u32 s52, s28, 36928
    s_add_u32 m0, s57, 9216
    s_nop 0
    buffer_load_dwordx4 v16, s[20:23], s52 offen lds
    s_add_u32 s52, s28, 73792
    s_add_u32 m0, s57, 10240
    s_nop 0
    buffer_load_dwordx4 v16, s[20:23], s52 offen lds
    s_add_u32 s52, s28, 110656
    s_add_u32 m0, s57, 11264
    s_nop 0
    buffer_load_dwordx4 v16, s[20:23], s52 offen lds
    s_add_u32 s52, s28, 96
    s_add_u32 m0, s57, 12288
    s_nop 0
    buffer_load_dwordx4 v16, s[20:23], s52 offen lds
    s_add_u32 s52, s28, 36960
    s_add_u32 m0, s57, 13312
    s_nop 0
    buffer_load_dwordx4 v16, s[20:23], s52 offen lds
    s_add_u32 s52, s28, 73824
    s_add_u32 m0, s57, 14336
    s_nop 0
    buffer_load_dwordx4 v16, s[20:23], s52 offen lds
    s_add_u32 s52, s28, 110688
    s_add_u32 m0, s57, 15360
    s_nop 0
    buffer_load_dwordx4 v16, s[20:23], s52 offen lds
    s_add_u32 s52, s28, 128
    s_add_u32 m0, s57, 16384
    s_nop 0
    buffer_load_dwordx4 v16, s[20:23], s52 offen lds
    s_add_u32 s52, s28, 36992
    s_add_u32 m0, s57, 17408
    s_nop 0
    buffer_load_dwordx4 v16, s[20:23], s52 offen lds
    s_add_u32 s52, s28, 73856
    s_add_u32 m0, s57, 18432
    s_nop 0
    buffer_load_dwordx4 v16, s[20:23], s52 offen lds
    s_add_u32 s52, s28, 110720
    s_add_u32 m0, s57, 19456
    s_nop 0
    buffer_load_dwordx4 v16, s[20:23], s52 offen lds
    s_add_u32 s52, s28, 160
    s_add_u32 m0, s57, 20480
    s_nop 0
    buffer_load_dwordx4 v16, s[20:23], s52 offen lds
    s_add_u32 s52, s28, 37024
    s_add_u32 m0, s57, 21504
    s_nop 0
    buffer_load_dwordx4 v16, s[20:23], s52 offen lds
    s_add_u32 s52, s28, 73888
    s_add_u32 m0, s57, 22528
    s_nop 0
    buffer_load_dwordx4 v16, s[20:23], s52 offen lds
    s_add_u32 s52, s28, 110752
    s_add_u32 m0, s57, 23552
    s_nop 0
    buffer_load_dwordx4 v16, s[20:23], s52 offen lds
    s_add_u32 s52, s28, 192
    s_add_u32 m0, s57, 24576
    s_nop 0
    buffer_load_dwordx4 v16, s[20:23], s52 offen lds
    s_add_u32 s52, s28, 37056
    s_add_u32 m0, s57, 25600
    s_nop 0
    buffer_load_dwordx4 v16, s[20:23], s52 offen lds
    s_add_u32 s52, s28, 73920
    s_add_u32 m0, s57, 26624
    s_nop 0
    buffer_load_dwordx4 v16, s[20:23], s52 offen lds
    s_add_u32 s52, s28, 110784
    s_add_u32 m0, s57, 27648
    s_nop 0
    buffer_load_dwordx4 v16, s[20:23], s52 offen lds
    s_add_u32 s52, s28, 224
    s_add_u32 m0, s57, 28672
    s_nop 0
    buffer_load_dwordx4 v16, s[20:23], s52 offen lds
    s_add_u32 s52, s28, 37088
    s_add_u32 m0, s57, 29696
    s_nop 0
    buffer_load_dwordx4 v16, s[20:23], s52 offen lds
    s_add_u32 s52, s28, 73952
    s_add_u32 m0, s57, 30720
    s_nop 0
    buffer_load_dwordx4 v16, s[20:23], s52 offen lds
    s_add_u32 s52, s28, 110816
    s_add_u32 m0, s57, 31744
    s_nop 0
    buffer_load_dwordx4 v16, s[20:23], s52 offen lds
    s_add_u32 s52, s56, 0
    s_add_u32 m0, s57, 32768
    s_nop 0
    buffer_load_dwordx4 v16, s[20:23], s52 offen lds
    s_add_u32 s52, s56, 36864
    s_add_u32 m0, s57, 33792
    s_nop 0
    buffer_load_dwordx4 v16, s[20:23], s52 offen lds
    s_add_u32 s52, s56, 73728
    s_add_u32 m0, s57, 34816
    s_nop 0
    buffer_load_dwordx4 v16, s[20:23], s52 offen lds
    s_add_u32 s52, s56, 110592
    s_add_u32 m0, s57, 35840
    s_nop 0
    buffer_load_dwordx4 v16, s[20:23], s52 offen lds
RL_wo_3:
    s_cmp_le_u32 s31, 2
    s_cbranch_scc1 RL_wv_4a
    s_waitcnt vmcnt(0)
    s_branch RL_wv_4b
RL_wv_4a:
    s_waitcnt vmcnt(36)
RL_wv_4b:
    s_barrier
    v_add_u32 v18, 147456, v14
    v_add_u32 v19, 147456, v15
    ds_read_b64_tr_b16 v[128:129], v18 offset:0
    ds_read_b64_tr_b16 v[130:131], v18 offset:512
    ds_read_b64_tr_b16 v[132:133], v18 offset:8192
    ds_read_b64_tr_b16 v[134:135], v18 offset:8704
    ds_read_b64_tr_b16 v[200:201], v19 offset:0
    ds_read_b64_tr_b16 v[202:203], v19 offset:512
    ds_read_b64_tr_b16 v[204:205], v19 offset:8192
    ds_read_b64_tr_b16 v[206:207], v19 offset:8704
    s_waitcnt lgkmcnt(0)
    s_barrier
    s_cmp_eq_u32 s31, 3
    s_cbranch_scc0 RL_wo_5
    s_add_u32 s52, s28, 0
    s_add_u32 m0, s57, 0
    s_nop 0
    buffer_load_dwordx4 v16, s[20:23], s52 offen lds
    s_add_u32 s52, s28, 36864
    s_add_u32 m0, s57, 1024
    s_nop 0
    buffer_load_dwordx4 v16, s[20:23], s52 offen lds
    s_add_u32 s52, s28, 73728
    s_add_u32 m0, s57, 2048
    s_nop 0
    buffer_load_dwordx4 v16, s[20:23], s52 offen lds
    s_add_u32 s52, s28, 110592
    s_add_u32 m0, s57, 3072
    s_nop 0
    buffer_load_dwordx4 v16, s[20:23], s52 offen lds
    s_add_u32 s52, s28, 32
    s_add_u32 m0, s57, 4096
    s_nop 0
    buffer_load_dwordx4 v16, s[20:23], s52 offen lds
    s_add_u32 s52, s28, 36896
    s_add_u32 m0, s57, 5120
    s_nop 0
    buffer_load_dwordx4 v16, s[20:23], s52 offen lds
    s_add_u32 s52, s28, 73760
    s_add_u32 m0, s57, 6144
    s_nop 0
    buffer_load_dwordx4 v16, s[20:23], s52 offen lds
    s_add_u32 s52, s28, 110624
    s_add_u32 m0, s57, 7168
    s_nop 0
    buffer_load_dwordx4 v16, s[20:23], s52 offen lds
    s_add_u32 s52, s28, 64
    s_add_u32 m0, s57, 8192
    s_nop 0
    buffer_load_dwordx4 v16, s[20:23], s52 offen lds
    s_add_u32 s52, s28, 36928
    s_add_u32 m0, s57, 9216
    s_nop 0
    buffer_load_dwordx4 v16, s[20:23], s52 offen lds
    s_add_u32 s52, s28, 73792
    s_add_u32 m0, s57, 10240
    s_nop 0
    buffer_load_dwordx4 v16, s[20:23], s52 offen lds
    s_add_u32 s52, s28, 110656
    s_add_u32 m0, s57, 11264
    s_nop 0
    buffer_load_dwordx4 v16, s[20:23], s52 offen lds
    s_add_u32 s52, s28, 96
    s_add_u32 m0, s57, 12288
    s_nop 0
    buffer_load_dwordx4 v16, s[20:23], s52 offen lds
    s_add_u32 s52, s28, 36960
    s_add_u32 m0, s57, 13312
    s_nop 0
    buffer_load_dwordx4 v16, s[20:23], s52 offen lds
    s_add_u32 s52, s28, 73824
    s_add_u32 m0, s57, 14336
    s_nop 0
    buffer_load_dwordx4 v16, s[20:23], s52 offen lds
    s_add_u32 s52, s28, 110688
    s_add_u32 m0, s57, 15360
    s_nop 0
    buffer_load_dwordx4 v16, s[20:23], s52 offen lds
    s_add_u32 s52, s28, 128
    s_add_u32 m0, s57, 16384
    s_nop 0
    buffer_load_dwordx4 v16, s[20:23], s52 offen lds
    s_add_u32 s52, s28, 36992
    s_add_u32 m0, s57, 17408
    s_nop 0
    buffer_load_dwordx4 v16, s[20:23], s52 offen lds
    s_add_u32 s52, s28, 73856
    s_add_u32 m0, s57, 18432
    s_nop 0
    buffer_load_dwordx4 v16, s[20:23], s52 offen lds
    s_add_u32 s52, s28, 110720
    s_add_u32 m0, s57, 19456
    s_nop 0
    buffer_load_dwordx4 v16, s[20:23], s52 offen lds
    s_add_u32 s52, s28, 160
    s_add_u32 m0, s57, 20480
    s_nop 0
    buffer_load_dwordx4 v16, s[20:23], s52 offen lds
    s_add_u32 s52, s28, 37024
    s_add_u32 m0, s57, 21504
    s_nop 0
    buffer_load_dwordx4 v16, s[20:23], s52 offen lds
    s_add_u32 s52, s28, 73888
    s_add_u32 m0, s57, 22528
    s_nop 0
    buffer_load_dwordx4 v16, s[20:23], s52 offen lds
    s_add_u32 s52, s28, 110752
    s_add_u32 m0, s57, 23552
    s_nop 0
    buffer_load_dwordx4 v16, s[20:23], s52 offen lds
    s_add_u32 s52, s28, 192
    s_add_u32 m0, s57, 24576
    s_nop 0
    buffer_load_dwordx4 v16, s[20:23], s52 offen lds
    s_add_u32 s52, s28, 37056
    s_add_u32 m0, s57, 25600
    s_nop 0
    buffer_load_dwordx4 v16, s[20:23], s52 offen lds
    s_add_u32 s52, s28, 73920
    s_add_u32 m0, s57, 26624
    s_nop 0
    buffer_load_dwordx4 v16, s[20:23], s52 offen lds
    s_add_u32 s52, s28, 110784
    s_add_u32 m0, s57, 27648
    s_nop 0
    buffer_load_dwordx4 v16, s[20:23], s52 offen lds
    s_add_u32 s52, s28, 224
    s_add_u32 m0, s57, 28672
    s_nop 0
    buffer_load_dwordx4 v16, s[20:23], s52 offen lds
    s_add_u32 s52, s28, 37088
    s_add_u32 m0, s57, 29696
    s_nop 0
    buffer_load_dwordx4 v16, s[20:23], s52 offen lds
    s_add_u32 s52, s28, 73952
    s_add_u32 m0, s57, 30720
    s_nop 0
    buffer_load_dwordx4 v16, s[20:23], s52 offen lds
    s_add_u32 s52, s28, 110816
    s_add_u32 m0, s57, 31744
    s_nop 0
    buffer_load_dwordx4 v16, s[20:23], s52 offen lds
    s_add_u32 s52, s56, 0
    s_add_u32 m0, s57, 32768
    s_nop 0
    buffer_load_dwordx4 v16, s[20:23], s52 offen lds
    s_add_u32 s52, s56, 36864
    s_add_u32 m0, s57, 33792
    s_nop 0
    buffer_load_dwordx4 v16, s[20:23], s52 offen lds
    s_add_u32 s52, s56, 73728
    s_add_u32 m0, s57, 34816
    s_nop 0
    buffer_load_dwordx4 v16, s[20:23], s52 offen lds
    s_add_u32 s52, s56, 110592
    s_add_u32 m0, s57, 35840
    s_nop 0
    buffer_load_dwordx4 v16, s[20:23], s52 offen lds
RL_wo_5:
    s_waitcnt vmcnt(0)
    v_lshrrev_b32 v20, 4, v0
    v_lshrrev_b32 v21, 4, v20
    v_lshrrev_b32 v22, 2, v20
    v_and_b32 v22, 3, v22
    v_and_b32 v23, 3, v20
    v_and_b32 v24, 1, v21
    v_lshlrev_b32 v24, 4, v24
    v_lshrrev_b32 v25, 1, v21
    v_lshl_add_u32 v24, v25, 3, v24
    v_and_b32 v25, 1, v22
    v_add_u32 v24, v24, v25
    v_lshrrev_b32 v25, 1, v22
    v_lshl_add_u32 v24, v25, 2, v24
    v_lshlrev_b32 v24, 5, v24
    v_lshl_add_u32 v24, v23, 3, v24
    v_add_u32 v17, s57, v24
    ds_read_b64_tr_b16 v[20:21], v17 offset:0
    ds_read_b64_tr_b16 v[22:23], v17 offset:64
    ds_read_b64_tr_b16 v[24:25], v17 offset:1024
    ds_read_b64_tr_b16 v[26:27], v17 offset:1088
    ds_read_b64_tr_b16 v[28:29], v17 offset:2048
    ds_read_b64_tr_b16 v[30:31], v17 offset:2112
    ds_read_b64_tr_b16 v[32:33], v17 offset:3072
    ds_read_b64_tr_b16 v[34:35], v17 offset:3136
    ds_read_b64_tr_b16 v[36:37], v17 offset:4096
    ds_read_b64_tr_b16 v[38:39], v17 offset:4160
    ds_read_b64_tr_b16 v[40:41], v17 offset:5120
    ds_read_b64_tr_b16 v[42:43], v17 offset:5184
    ds_read_b64_tr_b16 v[44:45], v17 offset:6144
    ds_read_b64_tr_b16 v[46:47], v17 offset:6208
    ds_read_b64_tr_b16 v[48:49], v17 offset:7168
    ds_read_b64_tr_b16 v[50:51], v17 offset:7232
    ds_read_b64_tr_b16 v[52:53], v17 offset:8192
    ds_read_b64_tr_b16 v[54:55], v17 offset:8256
    ds_read_b64_tr_b16 v[56:57], v17 offset:9216
    ds_read_b64_tr_b16 v[58:59], v17 offset:9280
    ds_read_b64_tr_b16 v[60:61], v17 offset:10240
    ds_read_b64_tr_b16 v[62:63], v17 offset:10304
    ds_read_b64_tr_b16 v[64:65], v17 offset:11264
    ds_read_b64_tr_b16 v[66:67], v17 offset:11328
    s_waitcnt lgkmcnt(0)
    ds_write_b128 v7, v[20:23] offset:0
    ds_write_b128 v7, v[24:27] offset:1024
    ds_write_b128 v7, v[176:179] offset:2048
    ds_write_b128 v7, v[180:183] offset:3072
    ds_write_b128 v7, v[36:39] offset:4096
    ds_write_b128 v7, v[40:43] offset:5120
    ds_write_b128 v7, v[248:251] offset:6144
    ds_write_b128 v7, v[252:255] offset:7168
    ds_write_b128 v7, v[52:55] offset:8192
    ds_write_b128 v7, v[56:59] offset:9216
    ds_write_b128 v7, v[128:131] offset:10240
    ds_write_b128 v7, v[132:135] offset:11264
    s_waitcnt lgkmcnt(0)
    v_mov_b64 v[176:177], v[28:29]
    v_mov_b64 v[178:179], v[30:31]
    v_mov_b64 v[180:181], v[32:33]
    v_mov_b64 v[182:183], v[34:35]
    v_mov_b64 v[248:249], v[44:45]
    v_mov_b64 v[250:251], v[46:47]
    v_mov_b64 v[252:253], v[48:49]
    v_mov_b64 v[254:255], v[50:51]
    v_mov_b64 v[128:129], v[60:61]
    v_mov_b64 v[130:131], v[62:63]
    v_mov_b64 v[132:133], v[64:65]
    v_mov_b64 v[134:135], v[66:67]
    ds_read_b64_tr_b16 v[20:21], v17 offset:12288
    ds_read_b64_tr_b16 v[22:23], v17 offset:12352
    ds_read_b64_tr_b16 v[24:25], v17 offset:13312
    ds_read_b64_tr_b16 v[26:27], v17 offset:13376
    ds_read_b64_tr_b16 v[28:29], v17 offset:14336
    ds_read_b64_tr_b16 v[30:31], v17 offset:14400
    ds_read_b64_tr_b16 v[32:33], v17 offset:15360
    ds_read_b64_tr_b16 v[34:35], v17 offset:15424
    ds_read_b64_tr_b16 v[36:37], v17 offset:16384
    ds_read_b64_tr_b16 v[38:39], v17 offset:16448
    ds_read_b64_tr_b16 v[40:41], v17 offset:17408
    ds_read_b64_tr_b16 v[42:43], v17 offset:17472
    ds_read_b64_tr_b16 v[44:45], v17 offset:18432
    ds_read_b64_tr_b16 v[46:47], v17 offset:18496
    ds_read_b64_tr_b16 v[48:49], v17 offset:19456
    ds_read_b64_tr_b16 v[50:51], v17 offset:19520
    ds_read_b64_tr_b16 v[52:53], v17 offset:20480
    ds_read_b64_tr_b16 v[54:55], v17 offset:20544
    ds_read_b64_tr_b16 v[56:57], v17 offset:21504
    ds_read_b64_tr_b16 v[58:59], v17 offset:21568
    ds_read_b64_tr_b16 v[60:61], v17 offset:22528
    ds_read_b64_tr_b16 v[62:63], v17 offset:22592
    ds_read_b64_tr_b16 v[64:65], v17 offset:23552
    ds_read_b64_tr_b16 v[66:67], v17 offset:23616
    s_waitcnt lgkmcnt(0)
    ds_write_b128 v7, v[20:23] offset:12288
    ds_write_b128 v7, v[24:27] offset:13312
    ds_write_b128 v7, v[200:203] offset:14336
    ds_write_b128 v7, v[204:207] offset:15360
    ds_write_b128 v7, v[36:39] offset:16384
    ds_write_b128 v7, v[40:43] offset:17408
    ds_write_b128 v7, v[112:115] offset:18432
    ds_write_b128 v7, v[116:119] offset:19456
    ds_write_b128 v7, v[52:55] offset:20480
    ds_write_b128 v7, v[56:59] offset:21504
    ds_write_b128 v7, v[184:187] offset:22528
    ds_write_b128 v7, v[188:191] offset:23552
    s_waitcnt lgkmcnt(0)
    v_mov_b64 v[200:201], v[28:29]
    v_mov_b64 v[202:203], v[30:31]
    v_mov_b64 v[204:205], v[32:33]
    v_mov_b64 v[206:207], v[34:35]
    v_mov_b64 v[112:113], v[44:45]
    v_mov_b64 v[114:115], v[46:47]
    v_mov_b64 v[116:117], v[48:49]
    v_mov_b64 v[118:119], v[50:51]
    v_mov_b64 v[184:185], v[60:61]
    v_mov_b64 v[186:187], v[62:63]
    v_mov_b64 v[188:189], v[64:65]
    v_mov_b64 v[190:191], v[66:67]
    ds_read_b64_tr_b16 v[20:21], v17 offset:24576
    ds_read_b64_tr_b16 v[22:23], v17 offset:24640
    ds_read_b64_tr_b16 v[24:25], v17 offset:25600
    ds_read_b64_tr_b16 v[26:27], v17 offset:25664
    ds_read_b64_tr_b16 v[28:29], v17 offset:26624
    ds_read_b64_tr_b16 v[30:31], v17 offset:26688
    ds_read_b64_tr_b16 v[32:33], v17 offset:27648
    ds_read_b64_tr_b16 v[34:35], v17 offset:27712
    ds_read_b64_tr_b16 v[36:37], v17 offset:28672
    ds_read_b64_tr_b16 v[38:39], v17 offset:28736
    ds_read_b64_tr_b16 v[40:41], v17 offset:29696
    ds_read_b64_tr_b16 v[42:43], v17 offset:29760
    ds_read_b64_tr_b16 v[44:45], v17 offset:30720
    ds_read_b64_tr_b16 v[46:47], v17 offset:30784
    ds_read_b64_tr_b16 v[48:49], v17 offset:31744
    ds_read_b64_tr_b16 v[50:51], v17 offset:31808
    ds_read_b64_tr_b16 v[52:53], v17 offset:32768
    ds_read_b64_tr_b16 v[54:55], v17 offset:32832
    ds_read_b64_tr_b16 v[56:57], v17 offset:33792
    ds_read_b64_tr_b16 v[58:59], v17 offset:33856
    ds_read_b64_tr_b16 v[60:61], v17 offset:34816
    ds_read_b64_tr_b16 v[62:63], v17 offset:34880
    ds_read_b64_tr_b16 v[64:65], v17 offset:35840
    ds_read_b64_tr_b16 v[66:67], v17 offset:35904
    s_waitcnt lgkmcnt(0)
    ds_write_b128 v7, v[20:23] offset:24576
    ds_write_b128 v7, v[24:27] offset:25600
    ds_write_b128 v7, v[120:123] offset:26624
    ds_write_b128 v7, v[124:127] offset:27648
    ds_write_b128 v7, v[36:39] offset:28672
    ds_write_b128 v7, v[40:43] offset:29696
    ds_write_b128 v7, v[192:195] offset:30720
    ds_write_b128 v7, v[196:199] offset:31744
    ds_write_b128 v7, v[52:55] offset:32768
    ds_write_b128 v7, v[56:59] offset:33792
    ds_write_b128 v7, v[60:63] offset:34816
    ds_write_b128 v7, v[64:67] offset:35840
    s_waitcnt lgkmcnt(0)
    v_mov_b64 v[120:121], v[28:29]
    v_mov_b64 v[122:123], v[30:31]
    v_mov_b64 v[124:125], v[32:33]
    v_mov_b64 v[126:127], v[34:35]
    v_mov_b64 v[192:193], v[44:45]
    v_mov_b64 v[194:195], v[46:47]
    v_mov_b64 v[196:197], v[48:49]
    v_mov_b64 v[198:199], v[50:51]
    v_mov_b32 v20, 32
    s_mov_b64 exec, 1
    s_mov_b32 s56, 0x40000
RL_wtb:
    global_load_dword v21, v20, s[90:91] sc1
    s_waitcnt vmcnt(0)
    v_readfirstlane_b32 s55, v21
    s_sub_u32 s56, s56, 1
    s_cbranch_scc1 RL_wtb_o
    s_cmp_lt_u32 s55, 32
    s_cbranch_scc0 RL_wtb_o
    s_sleep 8
    s_branch RL_wtb
RL_wtb_o:
    s_mov_b64 exec, -1
    v_bfe_u32 v14, v0, 5, 2
    v_lshlrev_b32 v14, 8, v14
    v_bfe_u32 v15, v0, 9, 1
    v_lshl_add_u32 v14, v15, 5, v14
    v_bfe_u32 v15, v0, 4, 1
    v_lshl_add_u32 v14, v15, 4, v14
    v_bfe_u32 v15, v0, 8, 1
    v_lshl_add_u32 v10, v15, 3, v14
    s_mov_b32 s99, 0x8000
    s_mov_b32 s92, 0
    s_mov_b32 s32, 0
    s_mov_b32 s34, 1048576
    s_mov_b32 s35, 1052672
    s_mov_b32 s36, 1056768
    s_mov_b32 s48, 1057792
    s_lshl_b32 s37, s30, 13
    s_add_u32 s37, s37, 16777216
    s_lshl_b32 s49, s30, 12
    s_add_u32 s49, s49, 67108864
    s_mul_i32 s38, s30, 9216
    s_lshl_b32 s50, s31, 11
    s_add_u32 s38, s38, s50
    s_add_u32 s38, s38, 2097152
    s_add_u32 s39, s38, 294912
    s_mul_i32 s67, s31, 2044
    s_sub_u32 s67, 8192, s67
    s_mov_b32 s58, 294912
    s_mov_b32 s33, 99
    s_cmp_eq_u32 s31, 0
    s_cselect_b32 s33, s30, s33
    s_add_u32 s50, s30, 32
    s_cmp_lt_u32 s30, 4
    s_cselect_b32 s50, s50, 99
    s_cmp_eq_u32 s31, 1
    s_cselect_b32 s33, s50, s33
    s_lshl_b32 s50, s33, 8
    s_add_u32 s40, s50, 2097152
    s_lshl_b32 s50, s33, 8
    s_add_u32 s41, s50, 2134016
    s_lshl_b32 s50, s33, 8
    s_add_u32 s42, s50, 2170880
    s_lshl_b32 s50, s33, 8
    s_add_u32 s43, s50, 2207744
    s_lshl_b32 s50, s33, 8
    s_add_u32 s44, s50, 2244608
    s_lshl_b32 s50, s33, 8
    s_add_u32 s45, s50, 2281472
    s_lshl_b32 s50, s33, 8
    s_add_u32 s46, s50, 2318336
    s_lshl_b32 s50, s33, 8
    s_add_u32 s47, s50, 2355200
    s_lshr_b32 s50, s33, 2
    s_lshl_b32 s50, s50, 10
    s_and_b32 s51, s33, 3
    s_lshl_b32 s51, s51, 6
    s_add_u32 s98, s50, s51
    s_add_u32 s14, s49, 8388608
    s_add_u32 s15, s37, 16777216
    s_add_u32 s16, s37, 262144
    s_add_u32 s11, s37, 524288
    s_lshl_b32 s17, s31, 11
    s_add_u32 s18, s39, 294912
    s_mov_b32 s21, 0
    s_mov_b32 s25, 0
    s_mov_b32 s26, 0
    s_mov_b32 s12, 16
    s_mov_b32 s9, 0
    s_mov_b32 s23, 4294377472
    s_mov_b32 s8, 294912
    s_mul_i32 s67, s31, 1792
    s_sub_u32 s67, 8192, s67
    s_add_u32 s19, s38, s67
    s_add_u32 s10, s39, s67
    v_lshrrev_b32 v20, 2, v0
    v_and_b32 v20, 0xc0, v20
    v_and_b32 v21, 0x30, v0
    v_bfe_u32 v22, v0, 6, 2
    v_lshlrev_b32 v22, 2, v22
    v_or3_b32 v9, v20, v21, v22
    s_cmp_ge_u32 s33, 32
    s_cbranch_scc0 RL_NOQ8
    v_bfe_u32 v20, v0, 8, 2
    v_lshlrev_b32 v20, 6, v20
    v_bfe_u32 v21, v0, 6, 1
    v_lshl_add_u32 v20, v21, 5, v20
    v_bfe_u32 v21, v0, 4, 1
    v_lshl_add_u32 v20, v21, 4, v20
    v_bfe_u32 v21, v0, 5, 1
    v_lshl_add_u32 v10, v21, 3, v20
    s_lshl_b32 s98, s33, 8
RL_NOQ8:
    s_add_u32 s20, s48, s98
    s_add_u32 s27, s98, 1076224
    s_mov_b32 s48, 0
    s_lshl_b32 s54, s30, 2
    s_add_u32 s54, s54, 128
    v_mov_b32 v20, s54
    s_mov_b64 exec, 1
    s_mov_b32 s56, 0x40000
RL_wk0:
    global_load_dword v21, v20, s[90:91] sc1
    s_waitcnt vmcnt(0)
    v_readfirstlane_b32 s55, v21
    s_and_b32 s55, s55, 255
    s_sub_u32 s56, s56, 1
    s_cbranch_scc1 RL_wk0_o
    s_cmp_lt_u32 s55, 1
    s_cbranch_scc0 RL_wk0_o
    s_sleep 8
    s_branch RL_wk0
RL_wk0_o:
    s_mov_b64 exec, -1
    v_mov_b32 v20, s54
    s_mov_b64 exec, 1
    s_mov_b32 s56, 0x40000
RL_wv0:
    global_load_dword v21, v20, s[90:91] sc1
    s_waitcnt vmcnt(0)
    v_readfirstlane_b32 s55, v21
    s_lshr_b32 s55, s55, 8
    s_and_b32 s55, s55, 255
    s_sub_u32 s56, s56, 1
    s_cbranch_scc1 RL_wv0_o
    s_cmp_lt_u32 s55, 1
    s_cbranch_scc0 RL_wv0_o
    s_sleep 8
    s_branch RL_wv0
RL_wv0_o:
    s_mov_b64 exec, -1
    v_add_u32 v20, s66, v8
    buffer_load_dwordx4 v[76:79], v20, s[4:7], s37 offen sc1
    buffer_load_dwordx4 v[72:75], v20, s[4:7], s37 offen offset:1024 sc1
    s_waitcnt vmcnt(0)
    s_mov_b32 s22, s93
    s_cmp_eq_u32 s31, 3
    s_cselect_b32 s93, s93, 0x7ffffff0
RL_STEP:
    v_mov_b64 v[12:13], 0
    v_mov_b64 v[14:15], 0
    v_mov_b64 v[16:17], 0
    v_mov_b64 v[18:19], 0
    v_mov_b64 v[20:21], 0
    v_mov_b64 v[22:23], 0
    v_mov_b64 v[24:25], 0
    v_mov_b64 v[26:27], 0
    s_add_u32 s50, s32, 2
    s_min_u32 s50, s50, 63
    s_lshr_b32 s50, s50, 2
    s_cmp_gt_u32 s92, s50
    s_cbranch_scc1 RL_KVOK
    s_lshl_b32 s51, s30, 2
    s_add_u32 s51, s51, 128
    v_mov_b32 v28, s51
    s_mov_b32 s62, 0x40000
RL_KVP:
    global_load_dword v29, v28, s[90:91] sc1
    s_waitcnt vmcnt(0)
    v_readfirstlane_b32 s52, v29
    s_and_b32 s53, s52, 0xff
    s_bfe_u32 s52, s52, 0x80008
    s_min_u32 s92, s52, s53
    s_sub_u32 s62, s62, 1
    s_cbranch_scc1 RL_KVOK
    s_cmp_gt_u32 s92, s50
    s_cbranch_scc0 RL_KVP
RL_KVOK:
    s_mov_b32 s62, s99
RL_GPOLL:
    buffer_load_dwordx4 v[28:31], v8, s[4:7], s34 offen sc1
    buffer_load_dwordx4 v[32:35], v8, s[4:7], s35 offen sc1
    buffer_load_dwordx4 v[36:39], v0, s[4:7], s36 offen sc1
    s_sub_u32 s62, s62, 1
    s_cbranch_scc1 RL_GTO
    s_waitcnt vmcnt(2)
    v_max3_u32 v40, v28, v29, v30
    s_waitcnt vmcnt(1)
    v_max3_u32 v40, v40, v31, v32
    v_max3_u32 v40, v40, v33, v34
    s_waitcnt vmcnt(0)
    v_max3_u32 v40, v40, v35, v36
    v_max3_u32 v40, v40, v37, v38
    v_max_u32 v40, v40, v39
    v_cmp_eq_u32 vcc, -1, v40
    s_cbranch_vccnz RL_GPOLL
    s_branch RL_ENTRY0
RL_GTO:
    s_mov_b32 s99, 0
    s_waitcnt vmcnt(0)
RL_ENTRY0:
    ds_write_b128 v8, v[28:31] offset:0
    ds_write_b128 v8, v[32:35] offset:4096
    v_smfmac_f32_16x16x64_bf16 v[12:15], v[28:31], a[0:7], v1
    v_xor_b32 v40, 1024, v8
    v_smfmac_f32_16x16x64_bf16 v[16:19], v[28:31], a[72:79], v1
    v_smfmac_f32_16x16x64_bf16 v[12:15], v[32:35], a[8:15], v1
    v_xor_b32 v41, 2048, v8
    v_xor_b32 v42, 3072, v8
    v_smfmac_f32_16x16x64_bf16 v[16:19], v[32:35], a[80:87], v1
    v_smfmac_f32_16x16x64_bf16 v[12:15], v[36:39], a[16:23], v1
    s_waitcnt lgkmcnt(0)
    s_barrier
    ds_read_b128 v[44:47], v41 offset:0
    v_smfmac_f32_16x16x64_bf16 v[16:19], v[36:39], a[88:95], v1
    ds_read_b128 v[48:51], v40 offset:0
    ds_read_b128 v[52:55], v40 offset:4096
    v_smfmac_f32_16x16x64_bf16 v[20:23], v[28:31], a[144:151], v1
    ds_read_b128 v[56:59], v41 offset:4096
    ds_read_b128 v[60:63], v42 offset:0
    v_smfmac_f32_16x16x64_bf16 v[24:27], v[28:31], a[216:223], v1
    v_smfmac_f32_16x16x64_bf16 v[20:23], v[32:35], a[152:159], v1
    v_smfmac_f32_16x16x64_bf16 v[24:27], v[32:35], a[224:231], v1
    v_smfmac_f32_16x16x64_bf16 v[20:23], v[36:39], a[160:167], v1
    v_smfmac_f32_16x16x64_bf16 v[24:27], v[36:39], a[232:239], v1
    s_waitcnt lgkmcnt(3)
    v_smfmac_f32_16x16x64_bf16 v[12:15], v[48:51], a[24:31], v1
    v_smfmac_f32_16x16x64_bf16 v[16:19], v[48:51], a[96:103], v1
    v_add_u32 v40, s66, v3
    s_waitcnt lgkmcnt(2)
    v_smfmac_f32_16x16x64_bf16 v[12:15], v[52:55], a[32:39], v1
    v_smfmac_f32_16x16x64_bf16 v[16:19], v[52:55], a[104:111], v1
    v_smfmac_f32_16x16x64_bf16 v[12:15], v[44:47], a[40:47], v1
    v_smfmac_f32_16x16x64_bf16 v[16:19], v[44:47], a[112:119], v1
    s_waitcnt lgkmcnt(1)
    v_smfmac_f32_16x16x64_bf16 v[12:15], v[56:59], a[48:55], v1
    ds_read_b128 v[28:31], v42 offset:4096
    v_smfmac_f32_16x16x64_bf16 v[16:19], v[56:59], a[120:127], v1
    s_waitcnt lgkmcnt(1)
    v_smfmac_f32_16x16x64_bf16 v[12:15], v[60:63], a[56:63], v1
    v_smfmac_f32_16x16x64_bf16 v[16:19], v[60:63], a[128:135], v1
    s_waitcnt lgkmcnt(0)
    v_smfmac_f32_16x16x64_bf16 v[12:15], v[28:31], a[64:71], v1
    v_smfmac_f32_16x16x64_bf16 v[16:19], v[28:31], a[136:143], v1
    s_nop 3
    v_add_f32 v12, v12, v14
    v_add_f32 v13, v13, v15
    v_cvt_pk_bf16_f32 v42, v12, v13
    v_smfmac_f32_16x16x64_bf16 v[20:23], v[48:51], a[168:175], v1
    v_add_f32 v16, v16, v18
    v_add_f32 v17, v17, v19
    v_cvt_pk_bf16_f32 v43, v16, v17
    v_smfmac_f32_16x16x64_bf16 v[24:27], v[48:51], a[240:247], v1
    ds_write2_b32 v2, v42, v43 offset0:1 offset1:129
    v_smfmac_f32_16x16x64_bf16 v[20:23], v[52:55], a[176:183], v1
    ds_read_b64_tr_b16 v[12:13], v40
    ds_read_b64_tr_b16 v[14:15], v40 offset:512
    v_smfmac_f32_16x16x64_bf16 v[24:27], v[52:55], a[248:255], v1
    v_mov_b64 v[18:19], 0
    v_smfmac_f32_16x16x64_bf16 v[20:23], v[44:47], a[184:191], v1
    v_mov_b64 v[16:17], 0
    v_mov_b64 v[32:33], 0
    v_smfmac_f32_16x16x64_bf16 v[24:27], v[44:47], v[80:87], v1
    v_smfmac_f32_16x16x64_bf16 v[20:23], v[56:59], a[192:199], v1
    v_mov_b64 v[34:35], 0
    s_waitcnt lgkmcnt(0)
    v_mfma_f32_16x16x32_bf16 v[40:43], v[76:79], v[12:15], 0
    v_mfma_f32_16x16x32_bf16 v[76:79], v[72:75], v[12:15], 0
    v_add_u32 v12, s66, v8
    v_and_b32 v13, 0xf0, v0
    v_smfmac_f32_16x16x64_bf16 v[24:27], v[56:59], v[88:95], v1
    buffer_load_dwordx4 v[72:75], v12, s[4:7], s15 offen sc1
    v_smfmac_f32_16x16x64_bf16 v[20:23], v[60:63], a[200:207], v1
    s_mov_b64 exec, s[60:61]
    ds_write_b128 v4, v[40:43]
    ds_write_b128 v4, v[76:79] offset:2048
    s_mov_b64 exec, -1
    v_smfmac_f32_16x16x64_bf16 v[24:27], v[60:63], v[96:103], v1
    buffer_load_dwordx4 v[40:43], v12, s[4:7], s15 offen offset:1024 sc1
    v_bfe_u32 v12, v0, 8, 1
    v_lshlrev_b32 v12, 24, v12
    v_smfmac_f32_16x16x64_bf16 v[20:23], v[28:31], a[208:215], v1
    v_lshlrev_b32 v13, 3, v13
    v_smfmac_f32_16x16x64_bf16 v[24:27], v[28:31], v[104:111], v1
    s_nop 3
    v_add_f32 v20, v20, v22
    v_add_f32 v21, v21, v23
    v_cvt_pk_bf16_f32 v14, v20, v21
    s_nop 0
    v_add_f32 v24, v24, v26
    v_add_f32 v25, v25, v27
    v_cvt_pk_bf16_f32 v15, v24, v25
    v_smfmac_f32_16x16x64_bf16 v[16:19], v[48:51], v[136:143], v1
    ds_write2_b32 v2, v14, v15 offset0:0 offset1:128
    v_smfmac_f32_16x16x64_bf16 v[32:35], v[48:51], v[208:215], v1
    v_add3_u32 v13, v13, v12, s17
    v_smfmac_f32_16x16x64_bf16 v[16:19], v[52:55], v[144:151], v1
    s_mov_b32 exec_hi, 0
    buffer_load_dword v11, v13, s[4:7], s16 offen sc1
    s_mov_b32 exec_hi, -1
    v_smfmac_f32_16x16x64_bf16 v[32:35], v[52:55], v[216:223], v1
    v_smfmac_f32_16x16x64_bf16 v[16:19], v[44:47], v[152:159], v1
    s_waitcnt lgkmcnt(0)
    s_barrier
    ds_read_b64_tr_b16 v[12:13], v3 offset:0
    ds_read_b64_tr_b16 v[14:15], v3 offset:512
    ds_read_b64_tr_b16 v[20:21], v3 offset:1024
    ds_read_b64_tr_b16 v[22:23], v3 offset:1536
    ds_read_b64_tr_b16 v[24:25], v3 offset:2048
    ds_read_b64_tr_b16 v[26:27], v3 offset:2560
    v_smfmac_f32_16x16x64_bf16 v[32:35], v[44:47], v[224:231], v1
    ds_read_b128 v[44:47], v5 offset:0
    ds_read_b128 v[76:79], v5 offset:512
    ds_read_b128 v[48:51], v5 offset:1024
    v_smfmac_f32_16x16x64_bf16 v[16:19], v[56:59], v[160:167], v1
    ds_read_b128 v[52:55], v5 offset:1536
    v_smfmac_f32_16x16x64_bf16 v[32:35], v[56:59], v[232:239], v1
    s_waitcnt lgkmcnt(8)
    v_mfma_f32_16x16x32_bf16 v[56:59], v[12:15], v[12:15], 0
    ds_read_b64_tr_b16 v[14:15], v3 offset:3584
    ds_read_b64_tr_b16 v[12:13], v3 offset:3072
    s_waitcnt lgkmcnt(8)
    v_mfma_f32_16x16x32_bf16 v[56:59], v[20:23], v[20:23], v[56:59]
    s_waitcnt lgkmcnt(6)
    v_mfma_f32_16x16x32_bf16 v[56:59], v[24:27], v[24:27], v[56:59]
    v_smfmac_f32_16x16x64_bf16 v[16:19], v[60:63], v[168:175], v1
    v_smfmac_f32_16x16x64_bf16 v[32:35], v[60:63], v[240:247], v1
    s_waitcnt lgkmcnt(4)
    v_add_f32 v45, v45, v77
    v_add_f32 v46, v46, v78
    v_add_f32 v47, v47, v79
    s_waitcnt lgkmcnt(2)
    v_add_f32 v48, v48, v52
    v_add_f32 v49, v49, v53
    v_add_f32 v44, v44, v76
    v_add_f32 v50, v50, v54
    v_add_f32 v51, v51, v55
    v_add_f32 v44, v44, v48
    s_waitcnt lgkmcnt(0)
    v_mfma_f32_16x16x32_bf16 v[56:59], v[12:15], v[12:15], v[56:59]
    ds_read_b128 v[68:71], v7 offset:3072
    ds_read_b128 v[64:67], v7 offset:2048
    ds_read_b128 v[20:23], v7 offset:6144
    ds_read_b128 v[24:27], v7 offset:7168
    ds_read_b128 v[12:15], v8 offset:0
    v_add_f32 v45, v45, v49
    v_add_f32 v46, v46, v50
    v_add_f32 v47, v47, v51
    v_max3_f32 v60, v44, v45, v46
    v_max_f32 v60, v60, v47
    s_nop 1
    v_max_f32_dpp v60, v60, v60 quad_perm:[2,3,0,1] row_mask:0xf bank_mask:0xf
    v_max3_f32 v61, v56, v57, v60
    v_cndmask_b32 v60, v60, v61, s[60:61]
    v_mov_b32 v61, v60
    v_mov_b32 v76, 0x3f803f80
    s_nop 0
    v_permlane16_swap_b32 v60, v61
    v_max_f32 v60, v60, v61
    v_mov_b32 v61, v60
    s_waitcnt lgkmcnt(3)
    v_smfmac_f32_16x16x64_bf16 v[16:19], v[28:31], v[64:71], v1
    ds_read_b128 v[64:67], v7 offset:10240
    ds_read_b128 v[48:51], v8 offset:4096
    ds_read_b128 v[68:71], v7 offset:11264
    v_permlane32_swap_b32 v60, v61
    s_waitcnt lgkmcnt(4)
    v_smfmac_f32_16x16x64_bf16 v[32:35], v[28:31], v[20:27], v1
    ds_read_b128 v[20:23], v7 offset:14336
    ds_read_b128 v[24:27], v7 offset:15360
    v_add_u32 v62, s66, v3
    v_lshrrev_b32 v63, 1, v8
    v_mov_b32 v28, s32
    v_mov_b32 v29, 0
    v_max_f32 v60, v60, v61
    s_nop 1
    v_mov_b32_dpp v60, v60 quad_perm:[2,3,2,3] row_mask:0xf bank_mask:0xf
    v_mul_f32 v61, s63, v60
    v_fma_f32 v44, v44, s64, v61
    v_fma_f32 v45, v45, s64, v61
    v_fma_f32 v46, v46, s64, v61
    s_waitcnt lgkmcnt(2)
    v_smfmac_f32_16x16x64_bf16 v[16:19], v[36:39], v[64:71], v1
    ds_read_b128 v[68:71], v7 offset:19456
    ds_read_b128 v[64:67], v7 offset:18432
    ds_read_b64_tr_b16 v[52:53], v62
    ds_read_b64_tr_b16 v[54:55], v62 offset:512
    v_fma_f32 v47, v47, s64, v61
    v_exp_f32 v45, v45
    s_waitcnt lgkmcnt(4)
    v_smfmac_f32_16x16x64_bf16 v[32:35], v[36:39], v[20:27], v1
    ds_read_b128 v[20:23], v7 offset:22528
    ds_read_b128 v[24:27], v7 offset:23552
    v_exp_f32 v46, v46
    v_exp_f32 v47, v47
    v_fma_f32 v56, v56, s64, v61
    v_fma_f32 v57, v57, s64, v61
    v_exp_f32 v44, v44
    s_waitcnt lgkmcnt(4)
    v_smfmac_f32_16x16x64_bf16 v[16:19], v[12:15], v[64:71], v1
    ds_read_b128 v[68:71], v7 offset:27648
    ds_read_b128 v[64:67], v7 offset:26624
    v_cvt_pk_bf16_f32 v36, v44, v45
    v_cvt_pk_bf16_f32 v37, v46, v47
    v_exp_f32 v56, v56
    v_exp_f32 v57, v57
    v_mov_b32_dpp v38, v36 quad_perm:[2,3,0,1] row_mask:0xf bank_mask:0xf
    s_waitcnt lgkmcnt(2)
    v_smfmac_f32_16x16x64_bf16 v[32:35], v[12:15], v[20:27], v1
    ds_read_b128 v[20:23], v7 offset:30720
    ds_read_b128 v[24:27], v7 offset:31744
    buffer_store_dwordx4 v[52:55], v8, s[4:7], s49 offen sc1
    v_mov_b32_dpp v39, v37 quad_perm:[2,3,0,1] row_mask:0xf bank_mask:0xf
    s_waitcnt lgkmcnt(2)
    v_smfmac_f32_16x16x64_bf16 v[16:19], v[48:51], v[64:71], v1
    v_mov_b32 v77, 0x3f803f80
    v_mov_b32 v78, 0x3f803f80
    v_mov_b32 v79, 0x3f803f80
    v_cvt_pk_bf16_f32 v12, v56, v57
    v_mov_b32 v13, 0
    v_mfma_f32_16x16x32_bf16 v[44:47], v[76:79], v[36:39], 0
    v_cvt_pk_bf16_f32 v15, v56, v57
    s_nop 0
    v_add_f32 v16, v16, v18
    v_add_f32 v17, v17, v19
    v_mov_b32 v14, 0
    v_cvt_pk_bf16_f32 v30, v16, v17
    s_waitcnt lgkmcnt(0)
    v_smfmac_f32_16x16x64_bf16 v[32:35], v[48:51], v[20:27], v1
    ds_read_b128 v[16:19], v7 offset:34816
    s_waitcnt vmcnt(2)
    v_mfma_f32_16x16x32_bf16 v[24:27], v[40:43], v[36:39], 0
    ds_read_b128 v[52:55], v7 offset:33792
    v_mfma_f32_16x16x32_bf16 v[40:43], v[72:75], v[36:39], 0
    ds_read_b128 v[20:23], v7 offset:35840
    v_add_f32 v32, v32, v34
    v_add_f32 v33, v33, v35
    v_mfma_f32_16x16x16_bf16 v[44:47], v[76:77], v[12:13], v[44:47]
    v_cvt_pk_bf16_f32 v31, v32, v33
    s_nop 1
    v_mfma_f32_16x16x16_bf16 v[40:43], v[30:31], v[12:13], v[40:43]
    buffer_store_dwordx2 v[30:31], v63, s[4:7], s14 offen sc1
    s_mov_b64 exec, 1
    buffer_store_dword v28, v29, s[4:7], s93 offen sc1
    s_mov_b64 exec, -1
    v_mfma_f32_16x16x16_bf16 v[24:27], v[30:31], v[14:15], v[24:27]
    ds_read_b128 v[32:35], v7 offset:0
    ds_read_b128 v[48:51], v7 offset:32768
    v_rcp_f32 v12, v44
    s_nop 0
    v_mul_f32 v43, v43, v12
    v_mul_f32 v41, v41, v12
    v_mul_f32 v42, v42, v12
    v_mul_f32 v40, v40, v12
    v_mul_f32 v24, v24, v12
    v_mul_f32 v27, v27, v12
    v_mul_f32 v25, v25, v12
    v_mul_f32 v26, v26, v12
    v_mov_b64 v[14:15], 0
    v_cvt_pk_bf16_f32 v28, v40, v41
    v_cvt_pk_bf16_f32 v29, v42, v43
    v_cvt_pk_bf16_f32 v30, v24, v25
    v_cvt_pk_bf16_f32 v31, v26, v27
    v_mov_b64 v[12:13], 0
    s_mov_b64 exec, s[60:61]
    ds_write_b128 v6, v[28:31]
    s_mov_b64 exec, -1
    v_mov_b64 v[24:25], 0
    v_mov_b64 v[26:27], 0
    ds_read_b128 v[36:39], v7 offset:1024
    s_waitcnt lgkmcnt(1)
    s_barrier
    s_cmp_ge_u32 s32, 63
    s_cbranch_scc1 RL_DONE
    ds_read_b128 v[28:31], v0 offset:12288
    s_waitcnt lgkmcnt(0)
    v_smfmac_f32_16x16x64_bf16 v[12:15], v[28:31], v[48:55], v1
    ds_read_b128 v[40:43], v0 offset:13312
    ds_read_b128 v[48:51], v7 offset:4096
    ds_read_b128 v[52:55], v7 offset:5120
    v_mov_b64 v[44:45], 0
    v_smfmac_f32_16x16x64_bf16 v[24:27], v[28:31], v[32:39], v1
    v_mov_b64 v[46:47], 0
    s_waitcnt lgkmcnt(2)
    v_smfmac_f32_16x16x64_bf16 v[12:15], v[40:43], v[16:23], v1
    ds_read_b128 v[16:19], v7 offset:8192
    ds_read_b128 v[20:23], v7 offset:9216
    v_smfmac_f32_16x16x64_bf16 v[24:27], v[40:43], v[176:183], v1
    ds_read_b128 v[32:35], v7 offset:12288
    s_waitcnt lgkmcnt(3)
    v_smfmac_f32_16x16x64_bf16 v[44:47], v[28:31], v[48:55], v1
    ds_read_b128 v[36:39], v7 offset:13312
    v_add_f32 v12, v12, v14
    v_add_f32 v13, v13, v15
    v_cvt_pk_bf16_f32 v56, v12, v13
    v_bfi_b32 v56, 1, s25, v56
    v_add_f32 v24, v24, v26
    v_add_f32 v25, v25, v27
    v_cvt_pk_bf16_f32 v12, v24, v25
    v_smfmac_f32_16x16x64_bf16 v[44:47], v[40:43], v[248:255], v1
    ds_read_b128 v[48:51], v7 offset:16384
    ds_read_b128 v[52:55], v7 offset:17408
    v_mov_b64 v[26:27], 0
    v_mov_b64 v[24:25], 0
    v_bfi_b32 v12, 1, s25, v12
    v_mov_b64 v[62:63], 0
    s_waitcnt lgkmcnt(4)
    v_smfmac_f32_16x16x64_bf16 v[24:27], v[28:31], v[16:23], v1
    v_mov_b64 v[60:61], 0
    v_add_f32 v44, v44, v46
    v_add_f32 v45, v45, v47
    v_smfmac_f32_16x16x64_bf16 v[24:27], v[40:43], v[128:135], v1
    v_cvt_pk_bf16_f32 v13, v44, v45
    v_mov_b64 v[44:45], 0
    v_mov_b64 v[46:47], 0
    s_waitcnt lgkmcnt(2)
    v_smfmac_f32_16x16x64_bf16 v[60:63], v[28:31], v[32:39], v1
    ds_read_b128 v[16:19], v7 offset:20480
    s_waitcnt lgkmcnt(1)
    v_smfmac_f32_16x16x64_bf16 v[44:47], v[28:31], v[48:55], v1
    ds_read_b128 v[36:39], v7 offset:25600
    v_add_f32 v25, v25, v27
    v_add_f32 v24, v24, v26
    v_smfmac_f32_16x16x64_bf16 v[44:47], v[40:43], v[112:119], v1
    ds_read_b128 v[20:23], v7 offset:21504
    ds_read_b128 v[48:51], v7 offset:28672
    v_smfmac_f32_16x16x64_bf16 v[60:63], v[40:43], v[200:207], v1
    ds_read_b128 v[32:35], v7 offset:24576
    v_cvt_pk_bf16_f32 v14, v24, v25
    v_mov_b64 v[26:27], 0
    s_nop 0
    v_add_f32 v44, v44, v46
    v_add_f32 v45, v45, v47
    v_cvt_pk_bf16_f32 v64, v44, v45
    v_bfi_b32 v64, 1, s25, v64
    v_add_f32 v61, v61, v63
    v_add_f32 v60, v60, v62
    v_cvt_pk_bf16_f32 v15, v60, v61
    v_mov_b64 v[44:45], 0
    v_mov_b64 v[24:25], 0
    s_waitcnt lgkmcnt(2)
    s_nop 0
    v_smfmac_f32_16x16x64_bf16 v[24:27], v[28:31], v[16:23], v1
    ds_read_b128 v[52:55], v7 offset:29696
    v_smfmac_f32_16x16x64_bf16 v[24:27], v[40:43], v[184:191], v1
    buffer_store_dword v56, v9, s[4:7], s19 offen
    v_mov_b64 v[70:71], 0
    v_mov_b64 v[46:47], 0
    v_mov_b64 v[68:69], 0
    s_waitcnt lgkmcnt(1)
    v_smfmac_f32_16x16x64_bf16 v[44:47], v[28:31], v[32:39], v1
    s_nop 1
    v_add_f32 v24, v24, v26
    v_add_f32 v25, v25, v27
    v_cvt_pk_bf16_f32 v65, v24, v25
    v_smfmac_f32_16x16x64_bf16 v[44:47], v[40:43], v[120:127], v1
    buffer_store_dwordx4 v[12:15], v0, s[4:7], s38 offen
    s_waitcnt lgkmcnt(0)
    v_smfmac_f32_16x16x64_bf16 v[68:71], v[28:31], v[48:55], v1
    v_smfmac_f32_16x16x64_bf16 v[68:71], v[40:43], v[192:199], v1
    v_add_f32 v44, v44, v46
    v_add_f32 v45, v45, v47
    v_cvt_pk_bf16_f32 v66, v44, v45
    s_nop 4
    v_add_f32 v68, v68, v70
    v_add_f32 v69, v69, v71
    v_cvt_pk_bf16_f32 v67, v68, v69
    buffer_store_dwordx4 v[64:67], v0, s[4:7], s38 offen offset:1024
    s_cmp_ge_u32 s33, 36
    s_cbranch_scc1 RL_IDLE
    v_lshrrev_b32 v12, 8, v0
    v_mov_b32 v13, 0x3f80
    v_mad_u32_u24 v14, v12, s97, v0
    v_lshlrev_b32 v12, 16, v13
    v_add_u32 v14, s48, v14
    v_cndmask_b32 v13, v13, v12, s[80:81]
    v_cndmask_b32 v16, 0, v13, s[82:83]
    v_cndmask_b32 v17, 0, v13, s[84:85]
    v_cndmask_b32 v18, 0, v13, s[86:87]
    v_cndmask_b32 v19, 0, v13, s[88:89]
    s_add_u32 s58, s32, 1
    s_and_b32 s50, s58, 3
    s_mul_i32 s50, s50, 9216
    s_add_u32 s34, s50, 1048576
    s_add_u32 s35, s34, 4096
    s_add_u32 s36, s34, 8192
    s_add_u32 s50, s58, 1
    s_and_b32 s50, s50, 3
    s_mul_i32 s50, s50, 9216
    s_add_u32 s50, s50, s98
    s_add_u32 s56, s50, 1048576
    s_add_u32 s50, s58, 3
    s_and_b32 s50, s50, 3
    s_mul_i32 s50, s50, 9216
    s_add_u32 s50, s50, s98
    s_add_u32 s57, s50, 1048576
    s_add_u32 s37, s37, 262144
    s_add_u32 s15, s15, 262144
    s_add_u32 s11, s11, 262144
    s_add_u32 s49, s49, 131072
    s_add_u32 s14, s14, 131072
    s_mov_b32 s50, s38
    s_mov_b32 s38, s39
    s_mov_b32 s39, s18
    s_mov_b32 s18, s50
    s_add_u32 s19, s38, s67
    s_add_u32 s21, s21, 1
    s_cmp_eq_u32 s21, 3
    s_cselect_b32 s21, 0, s21
    s_cselect_b32 s50, 1, 0
    s_xor_b32 s25, s25, s50
    s_mul_i32 s48, s21, 294912
    s_sleep 5
    s_mov_b32 s62, s99
RL_PPOLL:
    buffer_load_dwordx4 v[20:23], v14, s[4:7], s40 offen sc1
    buffer_load_dwordx4 v[24:27], v14, s[4:7], s41 offen sc1
    buffer_load_dwordx4 v[28:31], v14, s[4:7], s42 offen sc1
    buffer_load_dwordx4 v[32:35], v14, s[4:7], s43 offen sc1
    buffer_load_dwordx4 v[36:39], v14, s[4:7], s44 offen sc1
    buffer_load_dwordx4 v[40:43], v14, s[4:7], s45 offen sc1
    buffer_load_dwordx4 v[44:47], v14, s[4:7], s46 offen sc1
    buffer_load_dwordx4 v[48:51], v14, s[4:7], s47 offen sc1
    s_sub_u32 s62, s62, 1
    s_cbranch_scc1 RL_PTO
    s_waitcnt vmcnt(7)
    v_mfma_f32_16x16x32_bf16 v[52:55], v[20:23], v[16:19], 0
    v_lshlrev_b32 v12, 31, v20
    s_waitcnt vmcnt(6)
    v_mfma_f32_16x16x32_bf16 v[52:55], v[24:27], v[16:19], v[52:55]
    v_alignbit_b32 v12, v24, v12, 1
    s_waitcnt vmcnt(5)
    v_mfma_f32_16x16x32_bf16 v[52:55], v[28:31], v[16:19], v[52:55]
    v_alignbit_b32 v12, v28, v12, 1
    s_waitcnt vmcnt(4)
    v_mfma_f32_16x16x32_bf16 v[52:55], v[32:35], v[16:19], v[52:55]
    v_alignbit_b32 v12, v32, v12, 1
    s_waitcnt vmcnt(3)
    v_mfma_f32_16x16x32_bf16 v[52:55], v[36:39], v[16:19], v[52:55]
    v_alignbit_b32 v12, v36, v12, 1
    s_waitcnt vmcnt(2)
    v_mfma_f32_16x16x32_bf16 v[52:55], v[40:43], v[16:19], v[52:55]
    v_alignbit_b32 v12, v40, v12, 1
    s_waitcnt vmcnt(1)
    v_mfma_f32_16x16x32_bf16 v[52:55], v[44:47], v[16:19], v[52:55]
    v_alignbit_b32 v12, v44, v12, 1
    s_waitcnt vmcnt(0)
    v_mfma_f32_16x16x32_bf16 v[52:55], v[48:51], v[16:19], v[52:55]
    v_alignbit_b32 v12, v48, v12, 1
    v_cmp_ne_u32 vcc, s26, v12
    s_cbranch_vccz RL_PDONE
    s_sleep 1
    s_branch RL_PPOLL
    s_branch RL_PDONE
RL_PTO:
    s_mov_b32 s99, 0
    s_waitcnt vmcnt(0)
RL_PDONE:
    v_cvt_pk_bf16_f32 v12, v52, v53
    v_cvt_pk_bf16_f32 v13, v54, v55
    s_mov_b32 exec_lo, 0x00ff00ff
    s_mov_b32 exec_hi, 0x00ff00ff
    buffer_store_dwordx2 v[12:13], v10, s[4:7], s20 offen
    v_mov_b32 v12, -1
    v_mov_b32 v13, -1
    buffer_store_dwordx2 v[12:13], v10, s[4:7], s27 offen
    s_mov_b64 exec, -1
    v_add_u32 v12, s66, v8
    buffer_load_dwordx4 v[76:79], v12, s[4:7], s16 offen sc1
    buffer_load_dwordx4 v[72:75], v12, s[4:7], s16 offen offset:1024 sc1
    s_branch RL_NORED
RL_IDLE:
    s_add_u32 s58, s32, 1
    s_and_b32 s50, s58, 3
    s_mul_i32 s50, s50, 9216
    s_add_u32 s34, s50, 1048576
    s_add_u32 s35, s34, 4096
    s_add_u32 s36, s34, 8192
    s_add_u32 s50, s58, 1
    s_and_b32 s50, s50, 3
    s_mul_i32 s50, s50, 9216
    s_add_u32 s50, s50, s98
    s_add_u32 s56, s50, 1048576
    s_add_u32 s50, s58, 3
    s_and_b32 s50, s50, 3
    s_mul_i32 s50, s50, 9216
    s_add_u32 s50, s50, s98
    s_add_u32 s57, s50, 1048576
    s_add_u32 s37, s37, 262144
    s_add_u32 s15, s15, 262144
    s_add_u32 s11, s11, 262144
    s_add_u32 s49, s49, 131072
    s_add_u32 s14, s14, 131072
    s_mov_b32 s50, s38
    s_mov_b32 s38, s39
    s_mov_b32 s39, s18
    s_mov_b32 s18, s50
    s_add_u32 s19, s38, s67
    s_add_u32 s21, s21, 1
    s_cmp_eq_u32 s21, 3
    s_cselect_b32 s21, 0, s21
    s_cselect_b32 s50, 1, 0
    s_xor_b32 s25, s25, s50
    s_mul_i32 s48, s21, 294912
    v_add_u32 v12, s66, v8
    buffer_load_dwordx4 v[76:79], v12, s[4:7], s16 offen sc1
    buffer_load_dwordx4 v[72:75], v12, s[4:7], s16 offen offset:1024 sc1
    s_cmp_lt_u32 s31, 2
    s_cbranch_scc1 RL_NORED
RL_NORED:
    s_mov_b32 s32, s58
    s_mov_b32 s20, s56
    s_mov_b32 s27, s57
    s_mul_i32 s26, s25, 0xff000000
    s_add_u32 s16, s16, 262144
    s_barrier
    s_branch RL_STEP
RL_DONE:
    s_waitcnt vmcnt(0)
    s_barrier
    s_cmp_eq_u32 s31, 3
    s_cbranch_scc0 RL_RFIN
    v_mov_b32 v20, 64
    v_mov_b32 v21, 0
    s_mov_b64 exec, 1
    buffer_store_dword v20, v21, s[4:7], s22 offen sc1
    s_waitcnt vmcnt(0)
RL_RFIN:
    s_branch KEND
ROLE_XP:
    s_load_dwordx2 s[92:93], s[0:1], 96
    s_load_dwordx2 s[86:87], s[0:1], 40
    s_load_dwordx2 s[94:95], s[0:1], 80
    s_waitcnt lgkmcnt(0)
    s_sub_u32 s97, s96, 1
    s_mov_b32 s4, s92
    s_and_b32 s5, s93, 0xffff
    s_mov_b32 s6, 268435456
    s_mov_b32 s7, 0x00020000
    s_mov_b32 s8, s86
    s_and_b32 s9, s87, 0xffff
    s_mov_b32 s10, 4718592
    s_mov_b32 s11, 0x00020000
    s_mov_b32 s12, s94
    s_and_b32 s13, s95, 0xffff
    s_mov_b32 s14, 4718592
    s_mov_b32 s15, 0x00020000
    v_lshrrev_b32 v20, 6, v0
    s_nop 0
    v_readfirstlane_b32 s31, v20
    v_and_b32 v21, 63, v0
    v_lshlrev_b32 v0, 4, v21
    v_lshrrev_b32 v22, 4, v21
    v_and_b32 v23, 15, v21
    v_mul_u32_u24 v24, 36864, v22
    v_lshl_add_u32 v2, v23, 4, v24
    v_mul_u32_u24 v24, 2304, v23
    v_and_b32 v25, 1, v22
    v_lshl_add_u32 v3, v25, 3, v24
    v_and_b32 v24, 1, v21
    v_lshlrev_b32 v24, 4, v24
    v_mov_b32 v25, 0x3f80
    v_lshlrev_b32 v25, v24, v25
    v_bfe_u32 v24, v21, 1, 2
    v_cmp_eq_u32 vcc, 0, v24
    s_nop 1
    v_cndmask_b32 v8, 0, v25, vcc
    v_mov_b32 v12, 0x3f803f80
    v_cmp_eq_u32 vcc, 1, v24
    s_nop 1
    v_cndmask_b32 v9, 0, v25, vcc
    v_mov_b32 v13, 0x3f803f80
    v_cmp_eq_u32 vcc, 2, v24
    s_nop 1
    v_cndmask_b32 v10, 0, v25, vcc
    v_mov_b32 v14, 0x3f803f80
    v_cmp_eq_u32 vcc, 3, v24
    s_nop 1
    v_cndmask_b32 v11, 0, v25, vcc
    v_mov_b32 v15, 0x3f803f80
    v_lshlrev_b32 v24, 2, v22
    v_add_u32 v25, 0, v24
    v_cmp_le_u32 s[50:51], v25, v23
    s_nop 3
    s_and_b32 s52, s31, 1
    s_cmp_eq_u32 s52, 1
    s_cselect_b64 s[60:61], -1, s[50:51]
    s_cselect_b64 s[68:69], s[50:51], 0
    v_add_u32 v25, 1, v24
    v_cmp_le_u32 s[50:51], v25, v23
    s_nop 3
    s_and_b32 s52, s31, 1
    s_cmp_eq_u32 s52, 1
    s_cselect_b64 s[62:63], -1, s[50:51]
    s_cselect_b64 s[70:71], s[50:51], 0
    v_add_u32 v25, 2, v24
    v_cmp_le_u32 s[50:51], v25, v23
    s_nop 3
    s_and_b32 s52, s31, 1
    s_cmp_eq_u32 s52, 1
    s_cselect_b64 s[64:65], -1, s[50:51]
    s_cselect_b64 s[72:73], s[50:51], 0
    v_add_u32 v25, 3, v24
    v_cmp_le_u32 s[50:51], v25, v23
    s_nop 3
    s_and_b32 s52, s31, 1
    s_cmp_eq_u32 s52, 1
    s_cselect_b64 s[66:67], -1, s[50:51]
    s_cselect_b64 s[74:75], s[50:51], 0
    s_mov_b32 s76, 0x3e0293ee
    s_mov_b32 s77, 0x3e0293ee
    s_mov_b32 s78, 0xbe0293ee
    s_mov_b32 s79, 0xff800000
    s_and_b32 s50, s31, 1
    s_lshl_b32 s50, s50, 12
    s_lshr_b32 s51, s31, 1
    s_lshl_b32 s51, s51, 11
    s_add_u32 s50, s50, s51
    v_add_u32 v4, s50, v0
    s_mul_i32 s43, s31, 5
    s_mov_b32 s42, 5
    s_cmp_ge_u32 s31, 2
    s_cselect_b32 s42, 4, s42
    s_cmp_eq_u32 s31, 3
    s_cselect_b32 s43, 14, s43
    s_mov_b32 s32, s97
    s_mov_b32 s33, 3
    s_mov_b32 s34, 1
    s_lshl_b32 s50, s32, 18
    s_lshl_b32 s51, s30, 13
    s_add_u32 s35, s50, s51
    s_add_u32 s35, s35, 16777216
    s_lshl_b32 s50, s32, 17
    s_lshl_b32 s51, s30, 12
    s_add_u32 s36, s50, s51
    s_add_u32 s36, s36, 67108864
    s_mul_i32 s41, s32, 73728
    s_mul_i32 s38, s97, 2359296
    s_add_u32 s38, s38, 4194304
    s_mul_i32 s50, s30, 36864
    s_add_u32 s37, s38, s50
    s_lshl_b32 s50, s43, 11
    s_add_u32 s37, s37, s50
    s_mov_b32 s39, 1179648
    s_lshl_b32 s40, s97, 8
    s_add_u32 s40, s40, 3670016
    s_lshl_b32 s81, s31, 5
    s_add_u32 s81, s81, s30
    s_lshr_b32 s50, s30, 1
    s_add_u32 s82, s50, 128
    s_and_b32 s50, s50, 3
    s_cmp_eq_u32 s50, s31
    s_cselect_b32 s82, s82, 999
    s_and_b32 s50, s30, 1
    s_cmp_eq_u32 s50, 0
    s_cselect_b32 s82, s82, 999
    v_mov_b32 v20, 0
    s_lshl_b32 s50, s30, 2
    v_mov_b32 v21, s50
    s_mov_b64 exec, 1
    buffer_store_dword v20, v21, s[4:7], s40 offen
    s_mov_b64 exec, -1
    s_mul_i32 s50, s30, 147456
    s_mul_i32 s51, s31, 36864
    s_add_u32 s50, s50, s51
    s_add_u32 m0, s51, 0
    s_add_u32 s52, s50, 0
    buffer_load_dwordx4 v0, s[8:11], s52 offen lds
    s_add_u32 m0, s51, 1024
    s_add_u32 s52, s50, 1024
    buffer_load_dwordx4 v0, s[8:11], s52 offen lds
    s_add_u32 m0, s51, 2048
    s_add_u32 s52, s50, 2048
    buffer_load_dwordx4 v0, s[8:11], s52 offen lds
    s_add_u32 m0, s51, 3072
    s_add_u32 s52, s50, 3072
    buffer_load_dwordx4 v0, s[8:11], s52 offen lds
    s_add_u32 m0, s51, 4096
    s_add_u32 s52, s50, 4096
    buffer_load_dwordx4 v0, s[8:11], s52 offen lds
    s_add_u32 m0, s51, 5120
    s_add_u32 s52, s50, 5120
    buffer_load_dwordx4 v0, s[8:11], s52 offen lds
    s_add_u32 m0, s51, 6144
    s_add_u32 s52, s50, 6144
    buffer_load_dwordx4 v0, s[8:11], s52 offen lds
    s_add_u32 m0, s51, 7168
    s_add_u32 s52, s50, 7168
    buffer_load_dwordx4 v0, s[8:11], s52 offen lds
    s_add_u32 m0, s51, 8192
    s_add_u32 s52, s50, 8192
    buffer_load_dwordx4 v0, s[8:11], s52 offen lds
    s_add_u32 m0, s51, 9216
    s_add_u32 s52, s50, 9216
    buffer_load_dwordx4 v0, s[8:11], s52 offen lds
    s_add_u32 m0, s51, 10240
    s_add_u32 s52, s50, 10240
    buffer_load_dwordx4 v0, s[8:11], s52 offen lds
    s_add_u32 m0, s51, 11264
    s_add_u32 s52, s50, 11264
    buffer_load_dwordx4 v0, s[8:11], s52 offen lds
    s_add_u32 m0, s51, 12288
    s_add_u32 s52, s50, 12288
    buffer_load_dwordx4 v0, s[8:11], s52 offen lds
    s_add_u32 m0, s51, 13312
    s_add_u32 s52, s50, 13312
    buffer_load_dwordx4 v0, s[8:11], s52 offen lds
    s_add_u32 m0, s51, 14336
    s_add_u32 s52, s50, 14336
    buffer_load_dwordx4 v0, s[8:11], s52 offen lds
    s_add_u32 m0, s51, 15360
    s_add_u32 s52, s50, 15360
    buffer_load_dwordx4 v0, s[8:11], s52 offen lds
    s_add_u32 m0, s51, 16384
    s_add_u32 s52, s50, 16384
    buffer_load_dwordx4 v0, s[8:11], s52 offen lds
    s_add_u32 m0, s51, 17408
    s_add_u32 s52, s50, 17408
    buffer_load_dwordx4 v0, s[8:11], s52 offen lds
    s_add_u32 m0, s51, 18432
    s_add_u32 s52, s50, 18432
    buffer_load_dwordx4 v0, s[8:11], s52 offen lds
    s_add_u32 m0, s51, 19456
    s_add_u32 s52, s50, 19456
    buffer_load_dwordx4 v0, s[8:11], s52 offen lds
    s_add_u32 m0, s51, 20480
    s_add_u32 s52, s50, 20480
    buffer_load_dwordx4 v0, s[8:11], s52 offen lds
    s_add_u32 m0, s51, 21504
    s_add_u32 s52, s50, 21504
    buffer_load_dwordx4 v0, s[8:11], s52 offen lds
    s_add_u32 m0, s51, 22528
    s_add_u32 s52, s50, 22528
    buffer_load_dwordx4 v0, s[8:11], s52 offen lds
    s_add_u32 m0, s51, 23552
    s_add_u32 s52, s50, 23552
    buffer_load_dwordx4 v0, s[8:11], s52 offen lds
    s_add_u32 m0, s51, 24576
    s_add_u32 s52, s50, 24576
    buffer_load_dwordx4 v0, s[8:11], s52 offen lds
    s_add_u32 m0, s51, 25600
    s_add_u32 s52, s50, 25600
    buffer_load_dwordx4 v0, s[8:11], s52 offen lds
    s_add_u32 m0, s51, 26624
    s_add_u32 s52, s50, 26624
    buffer_load_dwordx4 v0, s[8:11], s52 offen lds
    s_add_u32 m0, s51, 27648
    s_add_u32 s52, s50, 27648
    buffer_load_dwordx4 v0, s[8:11], s52 offen lds
    s_add_u32 m0, s51, 28672
    s_add_u32 s52, s50, 28672
    buffer_load_dwordx4 v0, s[8:11], s52 offen lds
    s_add_u32 m0, s51, 29696
    s_add_u32 s52, s50, 29696
    buffer_load_dwordx4 v0, s[8:11], s52 offen lds
    s_add_u32 m0, s51, 30720
    s_add_u32 s52, s50, 30720
    buffer_load_dwordx4 v0, s[8:11], s52 offen lds
    s_add_u32 m0, s51, 31744
    s_add_u32 s52, s50, 31744
    buffer_load_dwordx4 v0, s[8:11], s52 offen lds
    s_add_u32 m0, s51, 32768
    s_add_u32 s52, s50, 32768
    buffer_load_dwordx4 v0, s[8:11], s52 offen lds
    s_add_u32 m0, s51, 33792
    s_add_u32 s52, s50, 33792
    buffer_load_dwordx4 v0, s[8:11], s52 offen lds
    s_add_u32 m0, s51, 34816
    s_add_u32 s52, s50, 34816
    buffer_load_dwordx4 v0, s[8:11], s52 offen lds
    s_add_u32 m0, s51, 35840
    s_add_u32 s52, s50, 35840
    buffer_load_dwordx4 v0, s[8:11], s52 offen lds
    v_lshrrev_b32 v20, 4, v0
    v_lshrrev_b32 v21, 2, v20
    v_mul_u32_u24 v21, 1152, v21
    v_and_b32 v22, 3, v20
    v_lshl_add_u32 v21, v22, 4, v21
    s_lshl_b32 s50, s43, 6
    v_add_u32 v21, s50, v21
    v_add_u32 v22, 0x10000, v21
    v_add_u32 v23, 0x20000, v21
    s_waitcnt vmcnt(0)
    s_barrier
    ds_read_b64_tr_b16 a[0:1], v21 offset:0
    ds_read_b64_tr_b16 a[2:3], v21 offset:18432
    ds_read_b64_tr_b16 a[4:5], v21 offset:36864
    ds_read_b64_tr_b16 a[6:7], v21 offset:55296
    ds_read_b64_tr_b16 a[8:9], v22 offset:8192
    ds_read_b64_tr_b16 a[10:11], v22 offset:26624
    ds_read_b64_tr_b16 a[12:13], v22 offset:45056
    ds_read_b64_tr_b16 a[14:15], v22 offset:63488
    ds_read_b64_tr_b16 a[16:17], v21 offset:8
    ds_read_b64_tr_b16 a[18:19], v21 offset:18440
    ds_read_b64_tr_b16 a[20:21], v21 offset:36872
    ds_read_b64_tr_b16 a[22:23], v21 offset:55304
    ds_read_b64_tr_b16 a[24:25], v22 offset:8200
    ds_read_b64_tr_b16 a[26:27], v22 offset:26632
    ds_read_b64_tr_b16 a[28:29], v22 offset:45064
    ds_read_b64_tr_b16 a[30:31], v22 offset:63496
    s_waitcnt lgkmcnt(0)
    ds_read_b64_tr_b16 a[32:33], v21 offset:64
    ds_read_b64_tr_b16 a[34:35], v21 offset:18496
    ds_read_b64_tr_b16 a[36:37], v21 offset:36928
    ds_read_b64_tr_b16 a[38:39], v21 offset:55360
    ds_read_b64_tr_b16 a[40:41], v22 offset:8256
    ds_read_b64_tr_b16 a[42:43], v22 offset:26688
    ds_read_b64_tr_b16 a[44:45], v22 offset:45120
    ds_read_b64_tr_b16 a[46:47], v22 offset:63552
    ds_read_b64_tr_b16 a[48:49], v21 offset:72
    ds_read_b64_tr_b16 a[50:51], v21 offset:18504
    ds_read_b64_tr_b16 a[52:53], v21 offset:36936
    ds_read_b64_tr_b16 a[54:55], v21 offset:55368
    ds_read_b64_tr_b16 a[56:57], v22 offset:8264
    ds_read_b64_tr_b16 a[58:59], v22 offset:26696
    ds_read_b64_tr_b16 a[60:61], v22 offset:45128
    ds_read_b64_tr_b16 a[62:63], v22 offset:63560
    s_waitcnt lgkmcnt(0)
    ds_read_b64_tr_b16 a[64:65], v21 offset:128
    ds_read_b64_tr_b16 a[66:67], v21 offset:18560
    ds_read_b64_tr_b16 a[68:69], v21 offset:36992
    ds_read_b64_tr_b16 a[70:71], v21 offset:55424
    ds_read_b64_tr_b16 a[72:73], v22 offset:8320
    ds_read_b64_tr_b16 a[74:75], v22 offset:26752
    ds_read_b64_tr_b16 a[76:77], v22 offset:45184
    ds_read_b64_tr_b16 a[78:79], v22 offset:63616
    ds_read_b64_tr_b16 a[80:81], v21 offset:136
    ds_read_b64_tr_b16 a[82:83], v21 offset:18568
    ds_read_b64_tr_b16 a[84:85], v21 offset:37000
    ds_read_b64_tr_b16 a[86:87], v21 offset:55432
    ds_read_b64_tr_b16 a[88:89], v22 offset:8328
    ds_read_b64_tr_b16 a[90:91], v22 offset:26760
    ds_read_b64_tr_b16 a[92:93], v22 offset:45192
    ds_read_b64_tr_b16 a[94:95], v22 offset:63624
    s_waitcnt lgkmcnt(0)
    ds_read_b64_tr_b16 a[96:97], v21 offset:192
    ds_read_b64_tr_b16 a[98:99], v21 offset:18624
    ds_read_b64_tr_b16 a[100:101], v21 offset:37056
    ds_read_b64_tr_b16 a[102:103], v21 offset:55488
    ds_read_b64_tr_b16 a[104:105], v22 offset:8384
    ds_read_b64_tr_b16 a[106:107], v22 offset:26816
    ds_read_b64_tr_b16 a[108:109], v22 offset:45248
    ds_read_b64_tr_b16 a[110:111], v22 offset:63680
    ds_read_b64_tr_b16 a[112:113], v21 offset:200
    ds_read_b64_tr_b16 a[114:115], v21 offset:18632
    ds_read_b64_tr_b16 a[116:117], v21 offset:37064
    ds_read_b64_tr_b16 a[118:119], v21 offset:55496
    ds_read_b64_tr_b16 a[120:121], v22 offset:8392
    ds_read_b64_tr_b16 a[122:123], v22 offset:26824
    ds_read_b64_tr_b16 a[124:125], v22 offset:45256
    ds_read_b64_tr_b16 a[126:127], v22 offset:63688
    s_waitcnt lgkmcnt(0)
    ds_read_b64_tr_b16 a[128:129], v21 offset:256
    ds_read_b64_tr_b16 a[130:131], v21 offset:18688
    ds_read_b64_tr_b16 a[132:133], v21 offset:37120
    ds_read_b64_tr_b16 a[134:135], v21 offset:55552
    ds_read_b64_tr_b16 a[136:137], v22 offset:8448
    ds_read_b64_tr_b16 a[138:139], v22 offset:26880
    ds_read_b64_tr_b16 a[140:141], v22 offset:45312
    ds_read_b64_tr_b16 a[142:143], v22 offset:63744
    ds_read_b64_tr_b16 a[144:145], v21 offset:264
    ds_read_b64_tr_b16 a[146:147], v21 offset:18696
    ds_read_b64_tr_b16 a[148:149], v21 offset:37128
    ds_read_b64_tr_b16 a[150:151], v21 offset:55560
    ds_read_b64_tr_b16 a[152:153], v22 offset:8456
    ds_read_b64_tr_b16 a[154:155], v22 offset:26888
    ds_read_b64_tr_b16 a[156:157], v22 offset:45320
    ds_read_b64_tr_b16 a[158:159], v22 offset:63752
    s_waitcnt lgkmcnt(0)
    s_barrier
    s_waitcnt vmcnt(0)
    s_barrier
    s_lshl_b32 s51, s97, 2
    s_add_u32 s51, s51, 36
    s_cmp_eq_u32 s31, 0
    s_cbranch_scc0 XL_arr_other
    v_mov_b32 v20, s51
    v_mov_b32 v21, 1
    s_mov_b64 exec, 1
    global_atomic_add v20, v21, s[90:91]
    s_mov_b32 s80, 0x100000
XL_arr:
    global_load_dword v22, v20, s[90:91] sc1
    s_waitcnt vmcnt(0)
    v_readfirstlane_b32 s50, v22
    s_sub_u32 s80, s80, 1
    s_cbranch_scc1 XL_arr_out
    s_cmp_lt_u32 s50, 32
    s_cbranch_scc1 XL_arr
XL_arr_out:
    s_mov_b64 exec, -1
XL_arr_other:
    s_barrier
    v_mov_b32 v20, 32
    s_mov_b64 exec, 1
    s_mov_b32 s57, 0x40000
XL_wrec:
    global_load_dword v21, v20, s[90:91] sc1
    s_waitcnt vmcnt(0)
    v_readfirstlane_b32 s56, v21
    s_sub_u32 s57, s57, 1
    s_cbranch_scc1 XL_wrec_o
    s_cmp_lt_u32 s56, 32
    s_cbranch_scc0 XL_wrec_o
    s_sleep 8
    s_branch XL_wrec
XL_wrec_o:
    s_mov_b64 exec, -1
    s_mov_b32 s99, 0x8000
    s_mov_b32 s84, 0
    s_mov_b32 s85, 0
    s_lshl_b32 s86, s30, 2
    s_add_u32 s86, s86, 128
    s_lshl_b32 s87, s30, 7
    s_add_u32 s87, s87, 3145728
XL_XSEG:
    s_lshr_b32 s50, s32, 2
    s_cmp_gt_u32 s84, s50
    s_cbranch_scc1 XL_XKVOK
    v_mov_b32 v16, s86
    s_mov_b32 s80, 0x40000
XL_XKVP:
    global_load_dword v17, v16, s[90:91] sc1
    s_waitcnt vmcnt(0)
    v_readfirstlane_b32 s52, v17
    s_and_b32 s53, s52, 0xff
    s_bfe_u32 s54, s52, 0x80008
    s_min_u32 s84, s54, s53
    s_bfe_u32 s54, s52, 0x80010
    s_min_u32 s84, s84, s54
    s_sub_u32 s80, s80, 1
    s_cbranch_scc1 XL_XKVOK
    s_cmp_gt_u32 s84, s50
    s_cbranch_scc1 XL_XKVOK
    s_sleep 16
    s_branch XL_XKVP
XL_XKVOK:
    s_and_b32 s50, s31, 1
    s_lshl_b32 s50, s50, 10
    s_add_u32 s50, s50, s35
    s_add_u32 s50, s50, 33554432
    s_add_u32 s51, s50, 0
    buffer_load_dwordx4 v[16:19], v0, s[4:7], s51 offen sc1
    s_add_u32 s51, s50, 2048
    buffer_load_dwordx4 v[20:23], v0, s[4:7], s51 offen sc1
    s_add_u32 s51, s50, 4096
    buffer_load_dwordx4 v[24:27], v0, s[4:7], s51 offen sc1
    s_add_u32 s51, s50, 6144
    buffer_load_dwordx4 v[28:31], v0, s[4:7], s51 offen sc1
    s_add_u32 s51, s35, 0
    buffer_load_dwordx4 v[32:35], v0, s[4:7], s51 offen offset:0 sc1
    buffer_load_dwordx4 v[36:39], v0, s[4:7], s51 offen offset:1024 sc1
    s_add_u32 s51, s35, 2048
    buffer_load_dwordx4 v[40:43], v0, s[4:7], s51 offen offset:0 sc1
    buffer_load_dwordx4 v[44:47], v0, s[4:7], s51 offen offset:1024 sc1
    s_add_u32 s51, s35, 4096
    buffer_load_dwordx4 v[48:51], v0, s[4:7], s51 offen offset:0 sc1
    buffer_load_dwordx4 v[52:55], v0, s[4:7], s51 offen offset:1024 sc1
    s_add_u32 s51, s35, 6144
    buffer_load_dwordx4 v[56:59], v0, s[4:7], s51 offen offset:0 sc1
    buffer_load_dwordx4 v[60:63], v0, s[4:7], s51 offen offset:1024 sc1
    s_lshr_b32 s50, s31, 1
    s_lshl_b32 s50, s50, 12
    s_add_u32 s50, s50, s35
    s_add_u32 s50, s50, 16777216
    buffer_load_dwordx4 v[64:67], v0, s[4:7], s50 offen offset:0 sc1
    buffer_load_dwordx4 v[68:71], v0, s[4:7], s50 offen offset:1024 sc1
    buffer_load_dwordx4 v[72:75], v0, s[4:7], s50 offen offset:2048 sc1
    buffer_load_dwordx4 v[76:79], v0, s[4:7], s50 offen offset:3072 sc1
    s_waitcnt vmcnt(11)
    v_mfma_f32_16x16x32_bf16 v[80:83], v[32:35], v[16:19], 0
    s_waitcnt vmcnt(9)
    v_mfma_f32_16x16x32_bf16 v[80:83], v[40:43], v[20:23], v[80:83]
    s_waitcnt vmcnt(7)
    v_mfma_f32_16x16x32_bf16 v[80:83], v[48:51], v[24:27], v[80:83]
    s_waitcnt vmcnt(5)
    v_mfma_f32_16x16x32_bf16 v[80:83], v[56:59], v[28:31], v[80:83]
    v_mfma_f32_16x16x32_bf16 v[32:35], v[36:39], v[16:19], 0
    v_mfma_f32_16x16x32_bf16 v[32:35], v[44:47], v[20:23], v[32:35]
    v_mfma_f32_16x16x32_bf16 v[32:35], v[52:55], v[24:27], v[32:35]
    s_waitcnt vmcnt(4)
    v_mfma_f32_16x16x32_bf16 v[32:35], v[60:63], v[28:31], v[32:35]
    s_cmp_gt_u32 s85, s32
    s_cbranch_scc1 XL_XKMOK
    v_mov_b32 v36, 0
    s_mov_b32 s80, 0x80000
XL_XKMP:
    buffer_load_dword v37, v36, s[4:7], s87 offen sc1
    s_waitcnt vmcnt(0)
    v_readfirstlane_b32 s85, v37
    s_sub_u32 s80, s80, 1
    s_cbranch_scc1 XL_XKMOK
    s_cmp_gt_u32 s85, s32
    s_cbranch_scc1 XL_XKMOK
    s_sleep 2
    s_branch XL_XKMP
XL_XKMOK:
    s_add_u32 s51, s36, 0
    buffer_load_dwordx4 v[36:39], v0, s[4:7], s51 offen sc1
    s_add_u32 s51, s36, 1024
    buffer_load_dwordx4 v[84:87], v0, s[4:7], s51 offen sc1
    s_add_u32 s51, s36, 2048
    buffer_load_dwordx4 v[40:43], v0, s[4:7], s51 offen sc1
    s_add_u32 s51, s36, 3072
    buffer_load_dwordx4 v[44:47], v0, s[4:7], s51 offen sc1
    v_lshrrev_b32 v48, 1, v0
    s_lshr_b32 s50, s31, 1
    s_lshl_b32 s50, s50, 10
    s_add_u32 s50, s50, s36
    s_add_u32 s50, s50, 8388608
    buffer_load_dwordx2 v[50:51], v48, s[4:7], s50 offen offset:0 sc1
    buffer_load_dwordx2 v[52:53], v48, s[4:7], s50 offen offset:512 sc1
    v_mov_b32 v48, s79
    v_cndmask_b32 v80, v48, v80, s[60:61]
    v_cndmask_b32 v81, v48, v81, s[62:63]
    v_cndmask_b32 v82, v48, v82, s[64:65]
    v_cndmask_b32 v83, v48, v83, s[66:67]
    v_cndmask_b32 v32, v48, v32, s[68:69]
    v_cndmask_b32 v33, v48, v33, s[70:71]
    v_cndmask_b32 v34, v48, v34, s[72:73]
    v_cndmask_b32 v35, v48, v35, s[74:75]
    s_waitcnt vmcnt(5)
    v_mfma_f32_16x16x32_bf16 v[56:59], v[36:39], v[16:19], 0
    s_waitcnt vmcnt(4)
    v_mfma_f32_16x16x32_bf16 v[56:59], v[84:87], v[20:23], v[56:59]
    s_waitcnt vmcnt(3)
    v_mfma_f32_16x16x32_bf16 v[56:59], v[40:43], v[24:27], v[56:59]
    s_waitcnt vmcnt(2)
    v_mfma_f32_16x16x32_bf16 v[56:59], v[44:47], v[28:31], v[56:59]
    v_max3_f32 v48, v80, v81, v82
    v_max3_f32 v48, v48, v83, v32
    v_max3_f32 v48, v48, v33, v34
    v_max_f32 v48, v48, v35
    s_nop 3
    v_max3_f32 v48, v48, v56, v57
    v_mov_b32 v49, v48
    s_nop 1
    v_permlane16_swap_b32 v48, v49
    v_max_f32 v48, v48, v49
    v_mov_b32 v49, v48
    s_nop 1
    v_permlane32_swap_b32 v48, v49
    v_max_f32 v48, v48, v49
    v_mul_f32 v54, s78, v48
    v_pk_fma_f32 v[80:81], v[80:81], s[76:77], v[54:55] op_sel_hi:[1,1,0]
    v_pk_fma_f32 v[82:83], v[82:83], s[76:77], v[54:55] op_sel_hi:[1,1,0]
    v_pk_fma_f32 v[32:33], v[32:33], s[76:77], v[54:55] op_sel_hi:[1,1,0]
    v_pk_fma_f32 v[34:35], v[34:35], s[76:77], v[54:55] op_sel_hi:[1,1,0]
    v_pk_fma_f32 v[56:57], v[56:57], s[76:77], v[54:55] op_sel_hi:[1,1,0]
    v_exp_f32 v80, v80
    v_exp_f32 v81, v81
    v_exp_f32 v82, v82
    v_exp_f32 v83, v83
    v_exp_f32 v32, v32
    v_exp_f32 v33, v33
    v_exp_f32 v34, v34
    v_exp_f32 v35, v35
    v_exp_f32 v56, v56
    v_exp_f32 v57, v57
    v_cvt_pk_bf16_f32 v36, v80, v81
    v_cvt_pk_bf16_f32 v37, v82, v83
    v_cvt_pk_bf16_f32 v38, v32, v33
    v_cvt_pk_bf16_f32 v39, v34, v35
    v_cvt_pk_bf16_f32 v32, v56, v57
    v_mov_b32 v33, 0
    v_mov_b32 v34, 0
    v_mov_b32 v35, v32
    v_mfma_f32_16x16x32_bf16 v[16:19], v[12:15], v[36:39], 0
    v_mfma_f32_16x16x32_bf16 v[20:23], v[64:67], v[36:39], 0
    v_mfma_f32_16x16x32_bf16 v[64:67], v[68:71], v[36:39], 0
    v_mfma_f32_16x16x32_bf16 v[68:71], v[72:75], v[36:39], 0
    v_mfma_f32_16x16x32_bf16 v[72:75], v[76:79], v[36:39], 0
    v_mfma_f32_16x16x16_bf16 v[16:19], v[12:13], v[32:33], v[16:19]
    s_waitcnt vmcnt(1)
    v_mfma_f32_16x16x16_bf16 v[20:23], v[50:51], v[32:33], v[20:23]
    v_mfma_f32_16x16x16_bf16 v[64:67], v[50:51], v[34:35], v[64:67]
    s_waitcnt vmcnt(0)
    v_mfma_f32_16x16x16_bf16 v[68:71], v[52:53], v[32:33], v[68:71]
    v_mfma_f32_16x16x16_bf16 v[72:75], v[52:53], v[34:35], v[72:75]
    v_rcp_f32 v76, v16
    s_nop 0
    v_pk_mul_f32 v[20:21], v[20:21], v[76:77] op_sel_hi:[1,0]
    v_pk_mul_f32 v[22:23], v[22:23], v[76:77] op_sel_hi:[1,0]
    v_pk_mul_f32 v[64:65], v[64:65], v[76:77] op_sel_hi:[1,0]
    v_pk_mul_f32 v[66:67], v[66:67], v[76:77] op_sel_hi:[1,0]
    v_pk_mul_f32 v[68:69], v[68:69], v[76:77] op_sel_hi:[1,0]
    v_pk_mul_f32 v[70:71], v[70:71], v[76:77] op_sel_hi:[1,0]
    v_pk_mul_f32 v[72:73], v[72:73], v[76:77] op_sel_hi:[1,0]
    v_pk_mul_f32 v[74:75], v[74:75], v[76:77] op_sel_hi:[1,0]
    v_cvt_pk_bf16_f32 v16, v20, v21
    v_cvt_pk_bf16_f32 v17, v22, v23
    v_cvt_pk_bf16_f32 v18, v64, v65
    v_cvt_pk_bf16_f32 v19, v66, v67
    ds_write_b128 v4, v[16:19] offset:0
    v_cvt_pk_bf16_f32 v64, v68, v69
    v_cvt_pk_bf16_f32 v65, v70, v71
    v_cvt_pk_bf16_f32 v66, v72, v73
    v_cvt_pk_bf16_f32 v67, v74, v75
    ds_write_b128 v4, v[64:67] offset:1024
    s_waitcnt lgkmcnt(0)
    s_barrier
    ds_read_b128 v[16:19], v0 offset:0
    ds_read_b128 v[20:23], v0 offset:1024
    ds_read_b128 v[24:27], v0 offset:2048
    ds_read_b128 v[28:31], v0 offset:3072
    ds_read_b128 v[32:35], v0 offset:4096
    ds_read_b128 v[36:39], v0 offset:5120
    ds_read_b128 v[40:43], v0 offset:6144
    ds_read_b128 v[44:47], v0 offset:7168
    s_waitcnt lgkmcnt(7)
    v_mfma_f32_16x16x32_bf16 v[48:51], a[0:3], v[16:19], 0
    s_add_u32 s52, s37, 0
    s_add_u32 s53, s37, 0
    s_add_u32 s54, s37, 2048
    v_mfma_f32_16x16x32_bf16 v[52:55], a[16:19], v[16:19], 0
    s_add_u32 s55, s37, 2048
    s_waitcnt lgkmcnt(3)
    v_mfma_f32_16x16x32_bf16 v[56:59], a[0:3], v[32:35], 0
    v_mfma_f32_16x16x32_bf16 v[60:63], a[16:19], v[32:35], 0
    v_mfma_f32_16x16x32_bf16 v[48:51], a[4:7], v[20:23], v[48:51]
    v_mfma_f32_16x16x32_bf16 v[52:55], a[20:23], v[20:23], v[52:55]
    v_mfma_f32_16x16x32_bf16 v[64:67], a[32:35], v[16:19], 0
    v_mfma_f32_16x16x32_bf16 v[68:71], a[48:51], v[16:19], 0
    s_waitcnt lgkmcnt(2)
    v_mfma_f32_16x16x32_bf16 v[56:59], a[4:7], v[36:39], v[56:59]
    v_mfma_f32_16x16x32_bf16 v[60:63], a[20:23], v[36:39], v[60:63]
    v_mfma_f32_16x16x32_bf16 v[72:75], a[32:35], v[32:35], 0
    v_mfma_f32_16x16x32_bf16 v[76:79], a[48:51], v[32:35], 0
    v_mfma_f32_16x16x32_bf16 v[48:51], a[8:11], v[24:27], v[48:51]
    v_mfma_f32_16x16x32_bf16 v[52:55], a[24:27], v[24:27], v[52:55]
    v_mfma_f32_16x16x32_bf16 v[64:67], a[36:39], v[20:23], v[64:67]
    v_mfma_f32_16x16x32_bf16 v[68:71], a[52:55], v[20:23], v[68:71]
    v_mfma_f32_16x16x32_bf16 v[80:83], a[64:67], v[16:19], 0
    v_mfma_f32_16x16x32_bf16 v[84:87], a[80:83], v[16:19], 0
    s_waitcnt lgkmcnt(1)
    v_mfma_f32_16x16x32_bf16 v[56:59], a[8:11], v[40:43], v[56:59]
    v_mfma_f32_16x16x32_bf16 v[60:63], a[24:27], v[40:43], v[60:63]
    v_mfma_f32_16x16x32_bf16 v[72:75], a[36:39], v[36:39], v[72:75]
    v_mfma_f32_16x16x32_bf16 v[76:79], a[52:55], v[36:39], v[76:79]
    v_mfma_f32_16x16x32_bf16 v[88:91], a[64:67], v[32:35], 0
    v_mfma_f32_16x16x32_bf16 v[92:95], a[80:83], v[32:35], 0
    v_mfma_f32_16x16x32_bf16 v[48:51], a[12:15], v[28:31], v[48:51]
    v_mfma_f32_16x16x32_bf16 v[52:55], a[28:31], v[28:31], v[52:55]
    v_mfma_f32_16x16x32_bf16 v[64:67], a[40:43], v[24:27], v[64:67]
    v_cvt_pk_bf16_f32 v96, v48, v49
    v_cvt_pk_bf16_f32 v97, v50, v51
    v_mfma_f32_16x16x32_bf16 v[68:71], a[56:59], v[24:27], v[68:71]
    v_cvt_pk_bf16_f32 v98, v52, v53
    v_cvt_pk_bf16_f32 v99, v54, v55
    v_mfma_f32_16x16x32_bf16 v[80:83], a[68:71], v[20:23], v[80:83]
    buffer_store_dwordx4 v[96:99], v0, s[4:7], s52 offen offset:0
    v_mfma_f32_16x16x32_bf16 v[84:87], a[84:87], v[20:23], v[84:87]
    s_add_u32 s52, s37, 4096
    v_mfma_f32_16x16x32_bf16 v[48:51], a[96:99], v[16:19], 0
    v_mfma_f32_16x16x32_bf16 v[52:55], a[112:115], v[16:19], 0
    s_waitcnt lgkmcnt(0)
    v_mfma_f32_16x16x32_bf16 v[56:59], a[12:15], v[44:47], v[56:59]
    v_mfma_f32_16x16x32_bf16 v[60:63], a[28:31], v[44:47], v[60:63]
    v_mfma_f32_16x16x32_bf16 v[72:75], a[40:43], v[40:43], v[72:75]
    v_cvt_pk_bf16_f32 v96, v56, v57
    v_cvt_pk_bf16_f32 v97, v58, v59
    v_mfma_f32_16x16x32_bf16 v[76:79], a[56:59], v[40:43], v[76:79]
    v_cvt_pk_bf16_f32 v98, v60, v61
    v_cvt_pk_bf16_f32 v99, v62, v63
    v_mfma_f32_16x16x32_bf16 v[88:91], a[68:71], v[36:39], v[88:91]
    buffer_store_dwordx4 v[96:99], v0, s[4:7], s53 offen offset:1024
    v_mfma_f32_16x16x32_bf16 v[92:95], a[84:87], v[36:39], v[92:95]
    s_add_u32 s53, s37, 4096
    v_mfma_f32_16x16x32_bf16 v[56:59], a[96:99], v[32:35], 0
    v_mfma_f32_16x16x32_bf16 v[60:63], a[112:115], v[32:35], 0
    v_mfma_f32_16x16x32_bf16 v[64:67], a[44:47], v[28:31], v[64:67]
    v_mfma_f32_16x16x32_bf16 v[68:71], a[60:63], v[28:31], v[68:71]
    v_mfma_f32_16x16x32_bf16 v[80:83], a[72:75], v[24:27], v[80:83]
    v_cvt_pk_bf16_f32 v96, v64, v65
    v_cvt_pk_bf16_f32 v97, v66, v67
    v_mfma_f32_16x16x32_bf16 v[84:87], a[88:91], v[24:27], v[84:87]
    v_cvt_pk_bf16_f32 v98, v68, v69
    v_cvt_pk_bf16_f32 v99, v70, v71
    v_mfma_f32_16x16x32_bf16 v[48:51], a[100:103], v[20:23], v[48:51]
    buffer_store_dwordx4 v[96:99], v0, s[4:7], s54 offen offset:0
    v_mfma_f32_16x16x32_bf16 v[52:55], a[116:119], v[20:23], v[52:55]
    s_add_u32 s54, s37, 6144
    v_mfma_f32_16x16x32_bf16 v[72:75], a[44:47], v[44:47], v[72:75]
    v_mfma_f32_16x16x32_bf16 v[76:79], a[60:63], v[44:47], v[76:79]
    v_mfma_f32_16x16x32_bf16 v[88:91], a[72:75], v[40:43], v[88:91]
    v_cvt_pk_bf16_f32 v64, v72, v73
    v_cvt_pk_bf16_f32 v65, v74, v75
    v_mfma_f32_16x16x32_bf16 v[92:95], a[88:91], v[40:43], v[92:95]
    v_cvt_pk_bf16_f32 v66, v76, v77
    v_cvt_pk_bf16_f32 v67, v78, v79
    v_mfma_f32_16x16x32_bf16 v[56:59], a[100:103], v[36:39], v[56:59]
    buffer_store_dwordx4 v[64:67], v0, s[4:7], s55 offen offset:1024
    v_mfma_f32_16x16x32_bf16 v[60:63], a[116:119], v[36:39], v[60:63]
    s_add_u32 s55, s37, 6144
    v_mfma_f32_16x16x32_bf16 v[80:83], a[76:79], v[28:31], v[80:83]
    v_mfma_f32_16x16x32_bf16 v[84:87], a[92:95], v[28:31], v[84:87]
    v_mfma_f32_16x16x32_bf16 v[48:51], a[104:107], v[24:27], v[48:51]
    v_cvt_pk_bf16_f32 v64, v80, v81
    v_cvt_pk_bf16_f32 v65, v82, v83
    v_mfma_f32_16x16x32_bf16 v[52:55], a[120:123], v[24:27], v[52:55]
    v_cvt_pk_bf16_f32 v66, v84, v85
    v_cvt_pk_bf16_f32 v67, v86, v87
    v_mfma_f32_16x16x32_bf16 v[88:91], a[76:79], v[44:47], v[88:91]
    buffer_store_dwordx4 v[64:67], v0, s[4:7], s52 offen offset:0
    v_mfma_f32_16x16x32_bf16 v[92:95], a[92:95], v[44:47], v[92:95]
    v_mfma_f32_16x16x32_bf16 v[56:59], a[104:107], v[40:43], v[56:59]
    v_cvt_pk_bf16_f32 v64, v88, v89
    v_cvt_pk_bf16_f32 v65, v90, v91
    v_mfma_f32_16x16x32_bf16 v[60:63], a[120:123], v[40:43], v[60:63]
    v_cvt_pk_bf16_f32 v66, v92, v93
    v_cvt_pk_bf16_f32 v67, v94, v95
    v_mfma_f32_16x16x32_bf16 v[48:51], a[108:111], v[28:31], v[48:51]
    buffer_store_dwordx4 v[64:67], v0, s[4:7], s53 offen offset:1024
    v_mfma_f32_16x16x32_bf16 v[52:55], a[124:127], v[28:31], v[52:55]
    v_mfma_f32_16x16x32_bf16 v[56:59], a[108:111], v[44:47], v[56:59]
    v_cvt_pk_bf16_f32 v64, v48, v49
    v_cvt_pk_bf16_f32 v65, v50, v51
    v_mfma_f32_16x16x32_bf16 v[60:63], a[124:127], v[44:47], v[60:63]
    v_cvt_pk_bf16_f32 v66, v52, v53
    v_cvt_pk_bf16_f32 v67, v54, v55
    s_nop 1
    v_cvt_pk_bf16_f32 v68, v56, v57
    v_cvt_pk_bf16_f32 v69, v58, v59
    s_nop 1
    v_cvt_pk_bf16_f32 v70, v60, v61
    v_cvt_pk_bf16_f32 v71, v62, v63
    buffer_store_dwordx4 v[64:67], v0, s[4:7], s54 offen offset:0
    buffer_store_dwordx4 v[68:71], v0, s[4:7], s55 offen offset:1024
    s_cmp_lt_u32 s42, 5
    s_cbranch_scc1 XL_XNOP4
    v_mfma_f32_16x16x32_bf16 v[48:51], a[128:131], v[16:19], 0
    s_add_u32 s52, s37, 8192
    s_add_u32 s53, s37, 8192
    v_mfma_f32_16x16x32_bf16 v[52:55], a[144:147], v[16:19], 0
    v_mfma_f32_16x16x32_bf16 v[56:59], a[128:131], v[32:35], 0
    v_mfma_f32_16x16x32_bf16 v[60:63], a[144:147], v[32:35], 0
    v_mfma_f32_16x16x32_bf16 v[48:51], a[132:135], v[20:23], v[48:51]
    v_mfma_f32_16x16x32_bf16 v[52:55], a[148:151], v[20:23], v[52:55]
    v_mfma_f32_16x16x32_bf16 v[56:59], a[132:135], v[36:39], v[56:59]
    v_mfma_f32_16x16x32_bf16 v[60:63], a[148:151], v[36:39], v[60:63]
    v_mfma_f32_16x16x32_bf16 v[48:51], a[136:139], v[24:27], v[48:51]
    v_mfma_f32_16x16x32_bf16 v[52:55], a[152:155], v[24:27], v[52:55]
    v_mfma_f32_16x16x32_bf16 v[56:59], a[136:139], v[40:43], v[56:59]
    v_mfma_f32_16x16x32_bf16 v[60:63], a[152:155], v[40:43], v[60:63]
    v_mfma_f32_16x16x32_bf16 v[48:51], a[140:143], v[28:31], v[48:51]
    v_mfma_f32_16x16x32_bf16 v[52:55], a[156:159], v[28:31], v[52:55]
    v_mfma_f32_16x16x32_bf16 v[56:59], a[140:143], v[44:47], v[56:59]
    v_cvt_pk_bf16_f32 v64, v48, v49
    v_cvt_pk_bf16_f32 v65, v50, v51
    v_mfma_f32_16x16x32_bf16 v[60:63], a[156:159], v[44:47], v[60:63]
    v_cvt_pk_bf16_f32 v66, v52, v53
    v_cvt_pk_bf16_f32 v67, v54, v55
    s_nop 1
    v_cvt_pk_bf16_f32 v68, v56, v57
    v_cvt_pk_bf16_f32 v69, v58, v59
    s_nop 1
    v_cvt_pk_bf16_f32 v70, v60, v61
    v_cvt_pk_bf16_f32 v71, v62, v63
    buffer_store_dwordx4 v[64:67], v0, s[4:7], s52 offen offset:0
    buffer_store_dwordx4 v[68:71], v0, s[4:7], s53 offen offset:1024
XL_XNOP4:
    s_waitcnt vmcnt(0)
    s_barrier
    s_cmp_eq_u32 s31, 0
    s_cbranch_scc0 XL_XNOFL
    v_mov_b32 v16, s34
    s_lshl_b32 s50, s30, 2
    v_mov_b32 v17, s50
    s_mov_b64 exec, 1
    buffer_store_dword v16, v17, s[4:7], s40 offen
    s_mov_b64 exec, -1
XL_XNOFL:
    v_bfe_u32 v17, v0, 4, 5
    v_lshlrev_b32 v17, 2, v17
    s_mov_b32 s80, s99
XL_XPOLL:
    buffer_load_dword v16, v17, s[4:7], s40 offen sc1
    s_sub_u32 s80, s80, 1
    s_cbranch_scc1 XL_XTO
    s_waitcnt vmcnt(0)
    v_cmp_gt_u32 vcc, s34, v16
    s_cbranch_vccnz XL_XPOLL
    s_branch XL_XGO
XL_XTO:
    s_mov_b32 s99, 0
XL_XGO:
    s_cmp_ge_u32 s82, 144
    s_cbranch_scc1 XL_XONE
    s_lshl_b32 s50, s81, 8
    s_add_u32 s50, s50, s38
    buffer_load_dwordx4 v[16:19], v2, s[4:7], s50 offen sc1
    s_add_u32 s50, s50, 147456
    buffer_load_dwordx4 v[20:23], v2, s[4:7], s50 offen sc1
    s_add_u32 s50, s50, 147456
    buffer_load_dwordx4 v[24:27], v2, s[4:7], s50 offen sc1
    s_add_u32 s50, s50, 147456
    buffer_load_dwordx4 v[28:31], v2, s[4:7], s50 offen sc1
    s_add_u32 s50, s50, 147456
    buffer_load_dwordx4 v[32:35], v2, s[4:7], s50 offen sc1
    s_add_u32 s50, s50, 147456
    buffer_load_dwordx4 v[36:39], v2, s[4:7], s50 offen sc1
    s_add_u32 s50, s50, 147456
    buffer_load_dwordx4 v[40:43], v2, s[4:7], s50 offen sc1
    s_add_u32 s50, s50, 147456
    buffer_load_dwordx4 v[44:47], v2, s[4:7], s50 offen sc1
    s_lshl_b32 s53, s82, 8
    s_add_u32 s53, s53, s38
    buffer_load_dwordx4 v[48:51], v2, s[4:7], s53 offen sc1
    s_add_u32 s53, s53, 147456
    buffer_load_dwordx4 v[52:55], v2, s[4:7], s53 offen sc1
    s_add_u32 s53, s53, 147456
    buffer_load_dwordx4 v[56:59], v2, s[4:7], s53 offen sc1
    s_add_u32 s53, s53, 147456
    buffer_load_dwordx4 v[60:63], v2, s[4:7], s53 offen sc1
    s_add_u32 s53, s53, 147456
    buffer_load_dwordx4 v[64:67], v2, s[4:7], s53 offen sc1
    s_add_u32 s53, s53, 147456
    buffer_load_dwordx4 v[68:71], v2, s[4:7], s53 offen sc1
    s_add_u32 s53, s53, 147456
    buffer_load_dwordx4 v[72:75], v2, s[4:7], s53 offen sc1
    s_add_u32 s53, s53, 147456
    buffer_load_dwordx4 v[76:79], v2, s[4:7], s53 offen sc1
    s_lshr_b32 s51, s81, 3
    s_lshl_b32 s51, s51, 6
    s_and_b32 s52, s81, 3
    s_lshl_b32 s52, s52, 4
    s_add_u32 s51, s51, s52
    s_bfe_u32 s52, s81, 0x10002
    s_mul_i32 s52, s52, 36864
    s_add_u32 s51, s51, s52
    s_add_u32 s51, s51, s41
    s_waitcnt vmcnt(15)
    v_mfma_f32_16x16x32_bf16 v[80:83], v[8:11], v[16:19], 0
    s_waitcnt vmcnt(14)
    v_mfma_f32_16x16x32_bf16 v[80:83], v[8:11], v[20:23], v[80:83]
    s_waitcnt vmcnt(13)
    v_mfma_f32_16x16x32_bf16 v[80:83], v[8:11], v[24:27], v[80:83]
    s_waitcnt vmcnt(12)
    v_mfma_f32_16x16x32_bf16 v[80:83], v[8:11], v[28:31], v[80:83]
    s_waitcnt vmcnt(11)
    v_mfma_f32_16x16x32_bf16 v[80:83], v[8:11], v[32:35], v[80:83]
    s_waitcnt vmcnt(10)
    v_mfma_f32_16x16x32_bf16 v[80:83], v[8:11], v[36:39], v[80:83]
    s_waitcnt vmcnt(9)
    v_mfma_f32_16x16x32_bf16 v[80:83], v[8:11], v[40:43], v[80:83]
    s_waitcnt vmcnt(8)
    v_mfma_f32_16x16x32_bf16 v[80:83], v[8:11], v[44:47], v[80:83]
    s_nop 7
    v_cvt_pk_bf16_f32 v84, v80, v81
    v_cvt_pk_bf16_f32 v85, v82, v83
    s_mov_b32 exec_hi, 0
    buffer_store_dwordx2 v[84:85], v3, s[12:15], s51 offen
    s_mov_b32 exec_hi, -1
    s_lshr_b32 s51, s82, 3
    s_lshl_b32 s51, s51, 6
    s_and_b32 s52, s82, 3
    s_lshl_b32 s52, s52, 4
    s_add_u32 s51, s51, s52
    s_bfe_u32 s52, s82, 0x10002
    s_mul_i32 s52, s52, 36864
    s_add_u32 s51, s51, s52
    s_add_u32 s51, s51, s41
    s_waitcnt vmcnt(8)
    v_mfma_f32_16x16x32_bf16 v[16:19], v[8:11], v[48:51], 0
    s_waitcnt vmcnt(7)
    v_mfma_f32_16x16x32_bf16 v[16:19], v[8:11], v[52:55], v[16:19]
    s_waitcnt vmcnt(6)
    v_mfma_f32_16x16x32_bf16 v[16:19], v[8:11], v[56:59], v[16:19]
    s_waitcnt vmcnt(5)
    v_mfma_f32_16x16x32_bf16 v[16:19], v[8:11], v[60:63], v[16:19]
    s_waitcnt vmcnt(4)
    v_mfma_f32_16x16x32_bf16 v[16:19], v[8:11], v[64:67], v[16:19]
    s_waitcnt vmcnt(3)
    v_mfma_f32_16x16x32_bf16 v[16:19], v[8:11], v[68:71], v[16:19]
    s_waitcnt vmcnt(2)
    v_mfma_f32_16x16x32_bf16 v[16:19], v[8:11], v[72:75], v[16:19]
    s_waitcnt vmcnt(1)
    v_mfma_f32_16x16x32_bf16 v[16:19], v[8:11], v[76:79], v[16:19]
    s_nop 7
    v_cvt_pk_bf16_f32 v20, v16, v17
    v_cvt_pk_bf16_f32 v21, v18, v19
    s_mov_b32 exec_hi, 0
    buffer_store_dwordx2 v[20:21], v3, s[12:15], s51 offen
    s_mov_b32 exec_hi, -1
    s_branch XL_XNOT2
XL_XONE:
    s_lshl_b32 s50, s81, 8
    s_add_u32 s50, s50, s38
    buffer_load_dwordx4 v[16:19], v2, s[4:7], s50 offen sc1
    s_add_u32 s50, s50, 147456
    buffer_load_dwordx4 v[20:23], v2, s[4:7], s50 offen sc1
    s_add_u32 s50, s50, 147456
    buffer_load_dwordx4 v[24:27], v2, s[4:7], s50 offen sc1
    s_add_u32 s50, s50, 147456
    buffer_load_dwordx4 v[28:31], v2, s[4:7], s50 offen sc1
    s_add_u32 s50, s50, 147456
    buffer_load_dwordx4 v[32:35], v2, s[4:7], s50 offen sc1
    s_add_u32 s50, s50, 147456
    buffer_load_dwordx4 v[36:39], v2, s[4:7], s50 offen sc1
    s_add_u32 s50, s50, 147456
    buffer_load_dwordx4 v[40:43], v2, s[4:7], s50 offen sc1
    s_add_u32 s50, s50, 147456
    buffer_load_dwordx4 v[44:47], v2, s[4:7], s50 offen sc1
    s_lshr_b32 s51, s81, 3
    s_lshl_b32 s51, s51, 6
    s_and_b32 s52, s81, 3
    s_lshl_b32 s52, s52, 4
    s_add_u32 s51, s51, s52
    s_bfe_u32 s52, s81, 0x10002
    s_mul_i32 s52, s52, 36864
    s_add_u32 s51, s51, s52
    s_add_u32 s51, s51, s41
    s_waitcnt vmcnt(7)
    v_mfma_f32_16x16x32_bf16 v[48:51], v[8:11], v[16:19], 0
    s_waitcnt vmcnt(6)
    v_mfma_f32_16x16x32_bf16 v[48:51], v[8:11], v[20:23], v[48:51]
    s_waitcnt vmcnt(5)
    v_mfma_f32_16x16x32_bf16 v[48:51], v[8:11], v[24:27], v[48:51]
    s_waitcnt vmcnt(4)
    v_mfma_f32_16x16x32_bf16 v[48:51], v[8:11], v[28:31], v[48:51]
    s_waitcnt vmcnt(3)
    v_mfma_f32_16x16x32_bf16 v[48:51], v[8:11], v[32:35], v[48:51]
    s_waitcnt vmcnt(2)
    v_mfma_f32_16x16x32_bf16 v[48:51], v[8:11], v[36:39], v[48:51]
    s_waitcnt vmcnt(1)
    v_mfma_f32_16x16x32_bf16 v[48:51], v[8:11], v[40:43], v[48:51]
    s_waitcnt vmcnt(0)
    v_mfma_f32_16x16x32_bf16 v[48:51], v[8:11], v[44:47], v[48:51]
    s_nop 7
    v_cvt_pk_bf16_f32 v52, v48, v49
    v_cvt_pk_bf16_f32 v53, v50, v51
    s_mov_b32 exec_hi, 0
    buffer_store_dwordx2 v[52:53], v3, s[12:15], s51 offen
    s_mov_b32 exec_hi, -1
XL_XNOT2:
    s_add_u32 s32, s32, s33
    s_add_u32 s34, s34, 1
    s_mul_i32 s50, s33, 262144
    s_add_u32 s35, s35, s50
    s_mul_i32 s50, s33, 131072
    s_add_u32 s36, s36, s50
    s_mul_i32 s50, s33, 73728
    s_add_u32 s41, s41, s50
    s_add_u32 s37, s37, s39
    s_add_u32 s38, s38, s39
    s_sub_u32 s39, 0, s39
    s_cmp_lt_u32 s32, 64
    s_cbranch_scc1 XL_XSEG
    s_waitcnt vmcnt(0)
    s_branch KEND
ROLE_AG:
    s_load_dwordx2 s[92:93], s[0:1], 96
    s_load_dwordx4 s[80:83], s[0:1], 16
    s_load_dwordx2 s[84:85], s[0:1], 32
    s_load_dwordx2 s[86:87], s[0:1], 0
    s_waitcnt lgkmcnt(0)
    s_and_b32 s61, s60, 31
    s_lshr_b32 s60, s60, 5
    s_mov_b32 s4, s92
    s_and_b32 s5, s93, 0xffff
    s_mov_b32 s6, 268435456
    s_mov_b32 s7, 0x00020000
    s_mov_b32 s12, s86
    s_and_b32 s13, s87, 0xffff
    s_mov_b32 s14, 2359296
    s_mov_b32 s15, 0x00020000
    s_mov_b32 s88, s82
    s_mov_b32 s89, s83
    s_mov_b32 s62, 16777216
    s_cmp_eq_u32 s60, 1
    s_cselect_b32 s88, s84, s88
    s_cselect_b32 s89, s85, s89
    s_cselect_b32 s62, 33554432, s62
    s_cmp_eq_u32 s60, 2
    s_cselect_b32 s88, s80, s88
    s_cselect_b32 s89, s81, s89
    s_cselect_b32 s62, 50331648, s62
    s_mov_b32 s8, s88
    s_and_b32 s9, s89, 0xffff
    s_mov_b32 s10, 4718592
    s_mov_b32 s11, 0x00020000
    v_lshrrev_b32 v10, 6, v0
    s_nop 0
    v_readfirstlane_b32 s31, v10
    v_and_b32 v11, 63, v0
    v_lshlrev_b32 v0, 4, v11
    v_lshrrev_b32 v12, 3, v11
    v_mul_u32_u24 v12, 1152, v12
    v_and_b32 v13, 7, v11
    v_lshrrev_b32 v14, 4, v11
    v_xor_b32 v13, v13, v14
    v_lshl_add_u32 v1, v13, 4, v12
    v_xor_b32 v13, 4, v13
    v_lshl_add_u32 v2, v13, 4, v12
    v_and_b32 v12, 15, v11
    v_lshrrev_b32 v13, 4, v11
    v_lshrrev_b32 v14, 1, v12
    v_xor_b32 v13, v13, v14
    v_lshlrev_b32 v13, 4, v13
    v_lshl_add_u32 v3, v12, 7, v13
    v_xor_b32 v4, 64, v3
    s_mov_b32 s32, 8192
    s_lshl_b32 s33, s61, 8
    s_mov_b32 s34, 0
    s_mov_b32 s35, 16
    s_lshl_b32 s36, s61, 13
    s_add_u32 s36, s36, s62
    s_lshl_b32 s50, s31, 11
    s_add_u32 s36, s36, s50
    s_mov_b32 s37, 1048576
    s_lshl_b32 s63, s61, 2
    s_add_u32 s63, s63, 128
    s_lshl_b32 s64, s60, 3
    s_lshl_b32 s64, 1, s64
    s_mov_b32 s65, 0
    v_lshrrev_b32 v20, 4, v0
    v_lshrrev_b32 v21, 4, v20
    v_and_b32 v22, 15, v20
    v_lshlrev_b32 v23, 1, v21
    v_xor_b32 v22, v22, v23
    v_lshlrev_b32 v22, 4, v22
    v_mul_lo_u32 v21, v21, s32
    v_add_u32 v10, v21, v22
    v_add_u32 v11, v21, v22
    v_xor_b32 v22, 128, v22
    v_add_u32 v11, v21, v22
    s_mul_i32 s50, s31, 144
    s_mul_i32 s50, s50, s32
    s_add_u32 s50, s50, s33
    s_lshl_b32 s51, s32, 2
    s_mul_i32 s52, s31, 36864
    s_add_u32 m0, s52, 0
    s_nop 0
    buffer_load_dwordx4 v10, s[8:11], s50 offen lds
    s_add_u32 s50, s50, s51
    s_add_u32 m0, s52, 1024
    s_nop 0
    buffer_load_dwordx4 v10, s[8:11], s50 offen lds
    s_add_u32 s50, s50, s51
    s_add_u32 m0, s52, 2048
    s_nop 0
    buffer_load_dwordx4 v11, s[8:11], s50 offen lds
    s_add_u32 s50, s50, s51
    s_add_u32 m0, s52, 3072
    s_nop 0
    buffer_load_dwordx4 v11, s[8:11], s50 offen lds
    s_add_u32 s50, s50, s51
    s_add_u32 m0, s52, 4096
    s_nop 0
    buffer_load_dwordx4 v10, s[8:11], s50 offen lds
    s_add_u32 s50, s50, s51
    s_add_u32 m0, s52, 5120
    s_nop 0
    buffer_load_dwordx4 v10, s[8:11], s50 offen lds
    s_add_u32 s50, s50, s51
    s_add_u32 m0, s52, 6144
    s_nop 0
    buffer_load_dwordx4 v11, s[8:11], s50 offen lds
    s_add_u32 s50, s50, s51
    s_add_u32 m0, s52, 7168
    s_nop 0
    buffer_load_dwordx4 v11, s[8:11], s50 offen lds
    s_add_u32 s50, s50, s51
    s_add_u32 m0, s52, 8192
    s_nop 0
    buffer_load_dwordx4 v10, s[8:11], s50 offen lds
    s_add_u32 s50, s50, s51
    s_add_u32 m0, s52, 9216
    s_nop 0
    buffer_load_dwordx4 v10, s[8:11], s50 offen lds
    s_add_u32 s50, s50, s51
    s_add_u32 m0, s52, 10240
    s_nop 0
    buffer_load_dwordx4 v11, s[8:11], s50 offen lds
    s_add_u32 s50, s50, s51
    s_add_u32 m0, s52, 11264
    s_nop 0
    buffer_load_dwordx4 v11, s[8:11], s50 offen lds
    s_add_u32 s50, s50, s51
    s_add_u32 m0, s52, 12288
    s_nop 0
    buffer_load_dwordx4 v10, s[8:11], s50 offen lds
    s_add_u32 s50, s50, s51
    s_add_u32 m0, s52, 13312
    s_nop 0
    buffer_load_dwordx4 v10, s[8:11], s50 offen lds
    s_add_u32 s50, s50, s51
    s_add_u32 m0, s52, 14336
    s_nop 0
    buffer_load_dwordx4 v11, s[8:11], s50 offen lds
    s_add_u32 s50, s50, s51
    s_add_u32 m0, s52, 15360
    s_nop 0
    buffer_load_dwordx4 v11, s[8:11], s50 offen lds
    s_add_u32 s50, s50, s51
    s_add_u32 m0, s52, 16384
    s_nop 0
    buffer_load_dwordx4 v10, s[8:11], s50 offen lds
    s_add_u32 s50, s50, s51
    s_add_u32 m0, s52, 17408
    s_nop 0
    buffer_load_dwordx4 v10, s[8:11], s50 offen lds
    s_add_u32 s50, s50, s51
    s_add_u32 m0, s52, 18432
    s_nop 0
    buffer_load_dwordx4 v11, s[8:11], s50 offen lds
    s_add_u32 s50, s50, s51
    s_add_u32 m0, s52, 19456
    s_nop 0
    buffer_load_dwordx4 v11, s[8:11], s50 offen lds
    s_add_u32 s50, s50, s51
    s_add_u32 m0, s52, 20480
    s_nop 0
    buffer_load_dwordx4 v10, s[8:11], s50 offen lds
    s_add_u32 s50, s50, s51
    s_add_u32 m0, s52, 21504
    s_nop 0
    buffer_load_dwordx4 v10, s[8:11], s50 offen lds
    s_add_u32 s50, s50, s51
    s_add_u32 m0, s52, 22528
    s_nop 0
    buffer_load_dwordx4 v11, s[8:11], s50 offen lds
    s_add_u32 s50, s50, s51
    s_add_u32 m0, s52, 23552
    s_nop 0
    buffer_load_dwordx4 v11, s[8:11], s50 offen lds
    s_add_u32 s50, s50, s51
    s_add_u32 m0, s52, 24576
    s_nop 0
    buffer_load_dwordx4 v10, s[8:11], s50 offen lds
    s_add_u32 s50, s50, s51
    s_add_u32 m0, s52, 25600
    s_nop 0
    buffer_load_dwordx4 v10, s[8:11], s50 offen lds
    s_add_u32 s50, s50, s51
    s_add_u32 m0, s52, 26624
    s_nop 0
    buffer_load_dwordx4 v11, s[8:11], s50 offen lds
    s_add_u32 s50, s50, s51
    s_add_u32 m0, s52, 27648
    s_nop 0
    buffer_load_dwordx4 v11, s[8:11], s50 offen lds
    s_add_u32 s50, s50, s51
    s_add_u32 m0, s52, 28672
    s_nop 0
    buffer_load_dwordx4 v10, s[8:11], s50 offen lds
    s_add_u32 s50, s50, s51
    s_add_u32 m0, s52, 29696
    s_nop 0
    buffer_load_dwordx4 v10, s[8:11], s50 offen lds
    s_add_u32 s50, s50, s51
    s_add_u32 m0, s52, 30720
    s_nop 0
    buffer_load_dwordx4 v11, s[8:11], s50 offen lds
    s_add_u32 s50, s50, s51
    s_add_u32 m0, s52, 31744
    s_nop 0
    buffer_load_dwordx4 v11, s[8:11], s50 offen lds
    s_add_u32 s50, s50, s51
    s_add_u32 m0, s52, 32768
    s_nop 0
    buffer_load_dwordx4 v10, s[8:11], s50 offen lds
    s_add_u32 s50, s50, s51
    s_add_u32 m0, s52, 33792
    s_nop 0
    buffer_load_dwordx4 v10, s[8:11], s50 offen lds
    s_add_u32 s50, s50, s51
    s_add_u32 m0, s52, 34816
    s_nop 0
    buffer_load_dwordx4 v11, s[8:11], s50 offen lds
    s_add_u32 s50, s50, s51
    s_add_u32 m0, s52, 35840
    s_nop 0
    buffer_load_dwordx4 v11, s[8:11], s50 offen lds
    s_add_u32 s50, s50, s51
    v_lshrrev_b32 v21, 4, v20
    v_lshrrev_b32 v22, 2, v20
    v_and_b32 v22, 3, v22
    v_and_b32 v23, 3, v20
    v_lshl_add_u32 v24, v21, 3, v22
    v_lshlrev_b32 v24, 8, v24
    v_and_b32 v25, 1, v21
    v_lshl_or_b32 v25, v25, 2, v22
    s_lshl_b32 s50, s31, 1
    v_xor_b32 v25, s50, v25
    v_lshlrev_b32 v25, 5, v25
    v_lshlrev_b32 v23, 3, v23
    v_add3_u32 v5, v24, v25, v23
    v_xor_b32 v6, 32, v5
    v_add_u32 v26, 0x10000, v5
    v_add_u32 v27, 0x10000, v6
    v_add_u32 v28, 0x20000, v5
    v_add_u32 v29, 0x20000, v6
    s_waitcnt vmcnt(0)
    s_barrier
    ds_read_b64_tr_b16 a[0:1], v5 offset:0
    ds_read_b64_tr_b16 a[2:3], v5 offset:1024
    ds_read_b64_tr_b16 a[72:73], v6 offset:0
    ds_read_b64_tr_b16 a[74:75], v6 offset:1024
    ds_read_b64_tr_b16 a[4:5], v5 offset:8192
    ds_read_b64_tr_b16 a[6:7], v5 offset:9216
    ds_read_b64_tr_b16 a[76:77], v6 offset:8192
    ds_read_b64_tr_b16 a[78:79], v6 offset:9216
    ds_read_b64_tr_b16 a[8:9], v5 offset:16384
    ds_read_b64_tr_b16 a[10:11], v5 offset:17408
    ds_read_b64_tr_b16 a[80:81], v6 offset:16384
    ds_read_b64_tr_b16 a[82:83], v6 offset:17408
    s_waitcnt lgkmcnt(0)
    ds_read_b64_tr_b16 a[12:13], v5 offset:24576
    ds_read_b64_tr_b16 a[14:15], v5 offset:25600
    ds_read_b64_tr_b16 a[84:85], v6 offset:24576
    ds_read_b64_tr_b16 a[86:87], v6 offset:25600
    ds_read_b64_tr_b16 a[16:17], v5 offset:32768
    ds_read_b64_tr_b16 a[18:19], v5 offset:33792
    ds_read_b64_tr_b16 a[88:89], v6 offset:32768
    ds_read_b64_tr_b16 a[90:91], v6 offset:33792
    ds_read_b64_tr_b16 a[20:21], v5 offset:40960
    ds_read_b64_tr_b16 a[22:23], v5 offset:41984
    ds_read_b64_tr_b16 a[92:93], v6 offset:40960
    ds_read_b64_tr_b16 a[94:95], v6 offset:41984
    s_waitcnt lgkmcnt(0)
    ds_read_b64_tr_b16 a[24:25], v5 offset:49152
    ds_read_b64_tr_b16 a[26:27], v5 offset:50176
    ds_read_b64_tr_b16 a[96:97], v6 offset:49152
    ds_read_b64_tr_b16 a[98:99], v6 offset:50176
    ds_read_b64_tr_b16 a[28:29], v5 offset:57344
    ds_read_b64_tr_b16 a[30:31], v5 offset:58368
    ds_read_b64_tr_b16 a[100:101], v6 offset:57344
    ds_read_b64_tr_b16 a[102:103], v6 offset:58368
    ds_read_b64_tr_b16 a[32:33], v26 offset:0
    ds_read_b64_tr_b16 a[34:35], v26 offset:1024
    ds_read_b64_tr_b16 a[104:105], v27 offset:0
    ds_read_b64_tr_b16 a[106:107], v27 offset:1024
    s_waitcnt lgkmcnt(0)
    ds_read_b64_tr_b16 a[36:37], v26 offset:8192
    ds_read_b64_tr_b16 a[38:39], v26 offset:9216
    ds_read_b64_tr_b16 a[108:109], v27 offset:8192
    ds_read_b64_tr_b16 a[110:111], v27 offset:9216
    ds_read_b64_tr_b16 a[40:41], v26 offset:16384
    ds_read_b64_tr_b16 a[42:43], v26 offset:17408
    ds_read_b64_tr_b16 a[112:113], v27 offset:16384
    ds_read_b64_tr_b16 a[114:115], v27 offset:17408
    ds_read_b64_tr_b16 a[44:45], v26 offset:24576
    ds_read_b64_tr_b16 a[46:47], v26 offset:25600
    ds_read_b64_tr_b16 a[116:117], v27 offset:24576
    ds_read_b64_tr_b16 a[118:119], v27 offset:25600
    s_waitcnt lgkmcnt(0)
    ds_read_b64_tr_b16 a[48:49], v26 offset:32768
    ds_read_b64_tr_b16 a[50:51], v26 offset:33792
    ds_read_b64_tr_b16 a[120:121], v27 offset:32768
    ds_read_b64_tr_b16 a[122:123], v27 offset:33792
    ds_read_b64_tr_b16 a[52:53], v26 offset:40960
    ds_read_b64_tr_b16 a[54:55], v26 offset:41984
    ds_read_b64_tr_b16 a[124:125], v27 offset:40960
    ds_read_b64_tr_b16 a[126:127], v27 offset:41984
    ds_read_b64_tr_b16 a[56:57], v26 offset:49152
    ds_read_b64_tr_b16 a[58:59], v26 offset:50176
    ds_read_b64_tr_b16 a[128:129], v27 offset:49152
    ds_read_b64_tr_b16 a[130:131], v27 offset:50176
    s_waitcnt lgkmcnt(0)
    ds_read_b64_tr_b16 a[60:61], v26 offset:57344
    ds_read_b64_tr_b16 a[62:63], v26 offset:58368
    ds_read_b64_tr_b16 a[132:133], v27 offset:57344
    ds_read_b64_tr_b16 a[134:135], v27 offset:58368
    ds_read_b64_tr_b16 a[64:65], v28 offset:0
    ds_read_b64_tr_b16 a[66:67], v28 offset:1024
    ds_read_b64_tr_b16 a[136:137], v29 offset:0
    ds_read_b64_tr_b16 a[138:139], v29 offset:1024
    ds_read_b64_tr_b16 a[68:69], v28 offset:8192
    ds_read_b64_tr_b16 a[70:71], v28 offset:9216
    ds_read_b64_tr_b16 a[140:141], v29 offset:8192
    ds_read_b64_tr_b16 a[142:143], v29 offset:9216
    s_waitcnt lgkmcnt(0)
    s_barrier
    s_cmp_eq_u32 s60, 1
    s_cbranch_scc1 AL_V
    s_mul_i32 s38, s34, 147456
    s_mul_i32 s50, s31, 36864
    s_add_u32 s38, s38, s50
    s_lshl_b32 s39, s31, 12
    s_mov_b32 s41, 0
    s_add_u32 s50, s38, 0
    s_add_u32 m0, s39, 0
    s_nop 0
    buffer_load_dwordx4 v1, s[12:15], s50 offen  lds
    s_add_u32 s50, s38, 9216
    s_add_u32 m0, s39, 1024
    s_nop 0
    buffer_load_dwordx4 v2, s[12:15], s50 offen  lds
    s_add_u32 s50, s38, 18432
    s_add_u32 m0, s39, 2048
    s_nop 0
    buffer_load_dwordx4 v1, s[12:15], s50 offen  lds
    s_add_u32 s50, s38, 27648
    s_add_u32 m0, s39, 3072
    s_nop 0
    buffer_load_dwordx4 v2, s[12:15], s50 offen  lds
    s_add_u32 s38, s38, 128
    s_add_u32 s39, s39, 16384
    s_and_b32 s39, s39, 0x1ffff
    s_add_u32 s50, s38, 0
    s_add_u32 m0, s39, 0
    s_nop 0
    buffer_load_dwordx4 v1, s[12:15], s50 offen  lds
    s_add_u32 s50, s38, 9216
    s_add_u32 m0, s39, 1024
    s_nop 0
    buffer_load_dwordx4 v2, s[12:15], s50 offen  lds
    s_add_u32 s50, s38, 18432
    s_add_u32 m0, s39, 2048
    s_nop 0
    buffer_load_dwordx4 v1, s[12:15], s50 offen  lds
    s_add_u32 s50, s38, 27648
    s_add_u32 m0, s39, 3072
    s_nop 0
    buffer_load_dwordx4 v2, s[12:15], s50 offen  lds
    s_add_u32 s38, s38, 128
    s_add_u32 s39, s39, 16384
    s_and_b32 s39, s39, 0x1ffff
    s_add_u32 s50, s38, 0
    s_add_u32 m0, s39, 0
    s_nop 0
    buffer_load_dwordx4 v1, s[12:15], s50 offen  lds
    s_add_u32 s50, s38, 9216
    s_add_u32 m0, s39, 1024
    s_nop 0
    buffer_load_dwordx4 v2, s[12:15], s50 offen  lds
    s_add_u32 s50, s38, 18432
    s_add_u32 m0, s39, 2048
    s_nop 0
    buffer_load_dwordx4 v1, s[12:15], s50 offen  lds
    s_add_u32 s50, s38, 27648
    s_add_u32 m0, s39, 3072
    s_nop 0
    buffer_load_dwordx4 v2, s[12:15], s50 offen  lds
    s_add_u32 s38, s38, 128
    s_add_u32 s39, s39, 16384
    s_and_b32 s39, s39, 0x1ffff
    s_add_u32 s50, s38, 0
    s_add_u32 m0, s39, 0
    s_nop 0
    buffer_load_dwordx4 v1, s[12:15], s50 offen  lds
    s_add_u32 s50, s38, 9216
    s_add_u32 m0, s39, 1024
    s_nop 0
    buffer_load_dwordx4 v2, s[12:15], s50 offen  lds
    s_add_u32 s50, s38, 18432
    s_add_u32 m0, s39, 2048
    s_nop 0
    buffer_load_dwordx4 v1, s[12:15], s50 offen  lds
    s_add_u32 s50, s38, 27648
    s_add_u32 m0, s39, 3072
    s_nop 0
    buffer_load_dwordx4 v2, s[12:15], s50 offen  lds
    s_add_u32 s38, s38, 128
    s_add_u32 s39, s39, 16384
    s_and_b32 s39, s39, 0x1ffff
    s_add_u32 s50, s38, 0
    s_add_u32 m0, s39, 0
    s_nop 0
    buffer_load_dwordx4 v1, s[12:15], s50 offen  lds
    s_add_u32 s50, s38, 9216
    s_add_u32 m0, s39, 1024
    s_nop 0
    buffer_load_dwordx4 v2, s[12:15], s50 offen  lds
    s_add_u32 s50, s38, 18432
    s_add_u32 m0, s39, 2048
    s_nop 0
    buffer_load_dwordx4 v1, s[12:15], s50 offen  lds
    s_add_u32 s50, s38, 27648
    s_add_u32 m0, s39, 3072
    s_nop 0
    buffer_load_dwordx4 v2, s[12:15], s50 offen  lds
    s_add_u32 s38, s38, 128
    s_add_u32 s39, s39, 16384
    s_and_b32 s39, s39, 0x1ffff
    s_add_u32 s50, s38, 0
    s_add_u32 m0, s39, 0
    s_nop 0
    buffer_load_dwordx4 v1, s[12:15], s50 offen  lds
    s_add_u32 s50, s38, 9216
    s_add_u32 m0, s39, 1024
    s_nop 0
    buffer_load_dwordx4 v2, s[12:15], s50 offen  lds
    s_add_u32 s50, s38, 18432
    s_add_u32 m0, s39, 2048
    s_nop 0
    buffer_load_dwordx4 v1, s[12:15], s50 offen  lds
    s_add_u32 s50, s38, 27648
    s_add_u32 m0, s39, 3072
    s_nop 0
    buffer_load_dwordx4 v2, s[12:15], s50 offen  lds
    s_add_u32 s38, s38, 128
    s_add_u32 s39, s39, 16384
    s_and_b32 s39, s39, 0x1ffff
    s_waitcnt vmcnt(0)
ALT_BLK:
    s_waitcnt vmcnt(28)
    s_barrier
    s_add_u32 s50, s38, 0
    s_add_u32 m0, s39, 0
    s_nop 0
    buffer_load_dwordx4 v1, s[12:15], s50 offen  lds
    s_add_u32 s50, s38, 9216
    s_add_u32 m0, s39, 1024
    s_nop 0
    buffer_load_dwordx4 v2, s[12:15], s50 offen  lds
    s_add_u32 s50, s38, 18432
    s_add_u32 m0, s39, 2048
    s_nop 0
    buffer_load_dwordx4 v1, s[12:15], s50 offen  lds
    s_add_u32 s50, s38, 27648
    s_add_u32 m0, s39, 3072
    s_nop 0
    buffer_load_dwordx4 v2, s[12:15], s50 offen  lds
    s_add_u32 s38, s38, 128
    s_add_u32 s39, s39, 16384
    s_and_b32 s39, s39, 0x1ffff
    v_add_u32 v7, s41, v3
    v_add_u32 v8, s41, v4
    s_add_u32 s41, s41, 16384
    s_and_b32 s41, s41, 0x1ffff
    ds_read_b128 v[80:83], v7 offset:0
    ds_read_b128 v[84:87], v7 offset:2048
    ds_read_b128 v[88:91], v7 offset:4096
    ds_read_b128 v[92:95], v7 offset:6144
    ds_read_b128 v[96:99], v7 offset:8192
    ds_read_b128 v[100:103], v7 offset:10240
    ds_read_b128 v[104:107], v7 offset:12288
    ds_read_b128 v[108:111], v7 offset:14336
    s_waitcnt lgkmcnt(7)
    v_mfma_f32_16x16x32_bf16 v[16:19], a[0:3], v[80:83], 0
    v_mfma_f32_16x16x32_bf16 v[20:23], a[72:75], v[80:83], 0
    ds_read_b128 v[112:115], v8 offset:0
    s_waitcnt lgkmcnt(7)
    v_mfma_f32_16x16x32_bf16 v[24:27], a[0:3], v[84:87], 0
    v_mfma_f32_16x16x32_bf16 v[28:31], a[72:75], v[84:87], 0
    ds_read_b128 v[116:119], v8 offset:2048
    s_waitcnt lgkmcnt(7)
    v_mfma_f32_16x16x32_bf16 v[32:35], a[0:3], v[88:91], 0
    v_mfma_f32_16x16x32_bf16 v[36:39], a[72:75], v[88:91], 0
    ds_read_b128 v[120:123], v8 offset:4096
    s_waitcnt lgkmcnt(7)
    v_mfma_f32_16x16x32_bf16 v[40:43], a[0:3], v[92:95], 0
    v_mfma_f32_16x16x32_bf16 v[44:47], a[72:75], v[92:95], 0
    ds_read_b128 v[124:127], v8 offset:6144
    s_waitcnt lgkmcnt(7)
    v_mfma_f32_16x16x32_bf16 v[48:51], a[0:3], v[96:99], 0
    v_mfma_f32_16x16x32_bf16 v[52:55], a[72:75], v[96:99], 0
    ds_read_b128 v[128:131], v8 offset:8192
    s_waitcnt lgkmcnt(7)
    v_mfma_f32_16x16x32_bf16 v[56:59], a[0:3], v[100:103], 0
    v_mfma_f32_16x16x32_bf16 v[60:63], a[72:75], v[100:103], 0
    ds_read_b128 v[132:135], v8 offset:10240
    s_waitcnt lgkmcnt(7)
    v_mfma_f32_16x16x32_bf16 v[64:67], a[0:3], v[104:107], 0
    v_mfma_f32_16x16x32_bf16 v[68:71], a[72:75], v[104:107], 0
    ds_read_b128 v[136:139], v8 offset:12288
    s_waitcnt lgkmcnt(7)
    v_mfma_f32_16x16x32_bf16 v[72:75], a[0:3], v[108:111], 0
    v_mfma_f32_16x16x32_bf16 v[76:79], a[72:75], v[108:111], 0
    ds_read_b128 v[140:143], v8 offset:14336
    s_waitcnt lgkmcnt(7)
    v_mfma_f32_16x16x32_bf16 v[16:19], a[4:7], v[112:115], v[16:19]
    v_mfma_f32_16x16x32_bf16 v[20:23], a[76:79], v[112:115], v[20:23]
    s_waitcnt lgkmcnt(6)
    v_mfma_f32_16x16x32_bf16 v[24:27], a[4:7], v[116:119], v[24:27]
    v_mfma_f32_16x16x32_bf16 v[28:31], a[76:79], v[116:119], v[28:31]
    s_waitcnt lgkmcnt(5)
    v_mfma_f32_16x16x32_bf16 v[32:35], a[4:7], v[120:123], v[32:35]
    v_mfma_f32_16x16x32_bf16 v[36:39], a[76:79], v[120:123], v[36:39]
    s_waitcnt lgkmcnt(4)
    v_mfma_f32_16x16x32_bf16 v[40:43], a[4:7], v[124:127], v[40:43]
    v_mfma_f32_16x16x32_bf16 v[44:47], a[76:79], v[124:127], v[44:47]
    s_waitcnt lgkmcnt(3)
    v_mfma_f32_16x16x32_bf16 v[48:51], a[4:7], v[128:131], v[48:51]
    v_mfma_f32_16x16x32_bf16 v[52:55], a[76:79], v[128:131], v[52:55]
    s_waitcnt lgkmcnt(2)
    v_mfma_f32_16x16x32_bf16 v[56:59], a[4:7], v[132:135], v[56:59]
    v_mfma_f32_16x16x32_bf16 v[60:63], a[76:79], v[132:135], v[60:63]
    s_waitcnt lgkmcnt(1)
    v_mfma_f32_16x16x32_bf16 v[64:67], a[4:7], v[136:139], v[64:67]
    v_mfma_f32_16x16x32_bf16 v[68:71], a[76:79], v[136:139], v[68:71]
    s_waitcnt lgkmcnt(0)
    v_mfma_f32_16x16x32_bf16 v[72:75], a[4:7], v[140:143], v[72:75]
    v_mfma_f32_16x16x32_bf16 v[76:79], a[76:79], v[140:143], v[76:79]
    s_waitcnt vmcnt(28)
    s_barrier
    s_add_u32 s50, s38, 0
    s_add_u32 m0, s39, 0
    s_nop 0
    buffer_load_dwordx4 v1, s[12:15], s50 offen  lds
    s_add_u32 s50, s38, 9216
    s_add_u32 m0, s39, 1024
    s_nop 0
    buffer_load_dwordx4 v2, s[12:15], s50 offen  lds
    s_add_u32 s50, s38, 18432
    s_add_u32 m0, s39, 2048
    s_nop 0
    buffer_load_dwordx4 v1, s[12:15], s50 offen  lds
    s_add_u32 s50, s38, 27648
    s_add_u32 m0, s39, 3072
    s_nop 0
    buffer_load_dwordx4 v2, s[12:15], s50 offen  lds
    s_add_u32 s38, s38, 128
    s_add_u32 s39, s39, 16384
    s_and_b32 s39, s39, 0x1ffff
    v_add_u32 v7, s41, v3
    v_add_u32 v8, s41, v4
    s_add_u32 s41, s41, 16384
    s_and_b32 s41, s41, 0x1ffff
    ds_read_b128 v[80:83], v7 offset:0
    ds_read_b128 v[84:87], v7 offset:2048
    ds_read_b128 v[88:91], v7 offset:4096
    ds_read_b128 v[92:95], v7 offset:6144
    ds_read_b128 v[96:99], v7 offset:8192
    ds_read_b128 v[100:103], v7 offset:10240
    ds_read_b128 v[104:107], v7 offset:12288
    ds_read_b128 v[108:111], v7 offset:14336
    s_waitcnt lgkmcnt(7)
    v_mfma_f32_16x16x32_bf16 v[16:19], a[8:11], v[80:83], v[16:19]
    v_mfma_f32_16x16x32_bf16 v[20:23], a[80:83], v[80:83], v[20:23]
    ds_read_b128 v[112:115], v8 offset:0
    s_waitcnt lgkmcnt(7)
    v_mfma_f32_16x16x32_bf16 v[24:27], a[8:11], v[84:87], v[24:27]
    v_mfma_f32_16x16x32_bf16 v[28:31], a[80:83], v[84:87], v[28:31]
    ds_read_b128 v[116:119], v8 offset:2048
    s_waitcnt lgkmcnt(7)
    v_mfma_f32_16x16x32_bf16 v[32:35], a[8:11], v[88:91], v[32:35]
    v_mfma_f32_16x16x32_bf16 v[36:39], a[80:83], v[88:91], v[36:39]
    ds_read_b128 v[120:123], v8 offset:4096
    s_waitcnt lgkmcnt(7)
    v_mfma_f32_16x16x32_bf16 v[40:43], a[8:11], v[92:95], v[40:43]
    v_mfma_f32_16x16x32_bf16 v[44:47], a[80:83], v[92:95], v[44:47]
    ds_read_b128 v[124:127], v8 offset:6144
    s_waitcnt lgkmcnt(7)
    v_mfma_f32_16x16x32_bf16 v[48:51], a[8:11], v[96:99], v[48:51]
    v_mfma_f32_16x16x32_bf16 v[52:55], a[80:83], v[96:99], v[52:55]
    ds_read_b128 v[128:131], v8 offset:8192
    s_waitcnt lgkmcnt(7)
    v_mfma_f32_16x16x32_bf16 v[56:59], a[8:11], v[100:103], v[56:59]
    v_mfma_f32_16x16x32_bf16 v[60:63], a[80:83], v[100:103], v[60:63]
    ds_read_b128 v[132:135], v8 offset:10240
    s_waitcnt lgkmcnt(7)
    v_mfma_f32_16x16x32_bf16 v[64:67], a[8:11], v[104:107], v[64:67]
    v_mfma_f32_16x16x32_bf16 v[68:71], a[80:83], v[104:107], v[68:71]
    ds_read_b128 v[136:139], v8 offset:12288
    s_waitcnt lgkmcnt(7)
    v_mfma_f32_16x16x32_bf16 v[72:75], a[8:11], v[108:111], v[72:75]
    v_mfma_f32_16x16x32_bf16 v[76:79], a[80:83], v[108:111], v[76:79]
    ds_read_b128 v[140:143], v8 offset:14336
    s_waitcnt lgkmcnt(7)
    v_mfma_f32_16x16x32_bf16 v[16:19], a[12:15], v[112:115], v[16:19]
    v_mfma_f32_16x16x32_bf16 v[20:23], a[84:87], v[112:115], v[20:23]
    s_waitcnt lgkmcnt(6)
    v_mfma_f32_16x16x32_bf16 v[24:27], a[12:15], v[116:119], v[24:27]
    v_mfma_f32_16x16x32_bf16 v[28:31], a[84:87], v[116:119], v[28:31]
    s_waitcnt lgkmcnt(5)
    v_mfma_f32_16x16x32_bf16 v[32:35], a[12:15], v[120:123], v[32:35]
    v_mfma_f32_16x16x32_bf16 v[36:39], a[84:87], v[120:123], v[36:39]
    s_waitcnt lgkmcnt(4)
    v_mfma_f32_16x16x32_bf16 v[40:43], a[12:15], v[124:127], v[40:43]
    v_mfma_f32_16x16x32_bf16 v[44:47], a[84:87], v[124:127], v[44:47]
    s_waitcnt lgkmcnt(3)
    v_mfma_f32_16x16x32_bf16 v[48:51], a[12:15], v[128:131], v[48:51]
    v_mfma_f32_16x16x32_bf16 v[52:55], a[84:87], v[128:131], v[52:55]
    s_waitcnt lgkmcnt(2)
    v_mfma_f32_16x16x32_bf16 v[56:59], a[12:15], v[132:135], v[56:59]
    v_mfma_f32_16x16x32_bf16 v[60:63], a[84:87], v[132:135], v[60:63]
    s_waitcnt lgkmcnt(1)
    v_mfma_f32_16x16x32_bf16 v[64:67], a[12:15], v[136:139], v[64:67]
    v_mfma_f32_16x16x32_bf16 v[68:71], a[84:87], v[136:139], v[68:71]
    s_waitcnt lgkmcnt(0)
    v_mfma_f32_16x16x32_bf16 v[72:75], a[12:15], v[140:143], v[72:75]
    v_mfma_f32_16x16x32_bf16 v[76:79], a[84:87], v[140:143], v[76:79]
    s_waitcnt vmcnt(28)
    s_barrier
    s_add_u32 s50, s38, 0
    s_add_u32 m0, s39, 0
    s_nop 0
    buffer_load_dwordx4 v1, s[12:15], s50 offen  lds
    s_add_u32 s50, s38, 9216
    s_add_u32 m0, s39, 1024
    s_nop 0
    buffer_load_dwordx4 v2, s[12:15], s50 offen  lds
    s_add_u32 s50, s38, 18432
    s_add_u32 m0, s39, 2048
    s_nop 0
    buffer_load_dwordx4 v1, s[12:15], s50 offen  lds
    s_add_u32 s50, s38, 27648
    s_add_u32 m0, s39, 3072
    s_nop 0
    buffer_load_dwordx4 v2, s[12:15], s50 offen  lds
    s_add_u32 s38, s38, 146432
    s_add_u32 s39, s39, 16384
    s_and_b32 s39, s39, 0x1ffff
    v_add_u32 v7, s41, v3
    v_add_u32 v8, s41, v4
    s_add_u32 s41, s41, 16384
    s_and_b32 s41, s41, 0x1ffff
    ds_read_b128 v[80:83], v7 offset:0
    ds_read_b128 v[84:87], v7 offset:2048
    ds_read_b128 v[88:91], v7 offset:4096
    ds_read_b128 v[92:95], v7 offset:6144
    ds_read_b128 v[96:99], v7 offset:8192
    ds_read_b128 v[100:103], v7 offset:10240
    ds_read_b128 v[104:107], v7 offset:12288
    ds_read_b128 v[108:111], v7 offset:14336
    s_waitcnt lgkmcnt(7)
    v_mfma_f32_16x16x32_bf16 v[16:19], a[16:19], v[80:83], v[16:19]
    v_mfma_f32_16x16x32_bf16 v[20:23], a[88:91], v[80:83], v[20:23]
    ds_read_b128 v[112:115], v8 offset:0
    s_waitcnt lgkmcnt(7)
    v_mfma_f32_16x16x32_bf16 v[24:27], a[16:19], v[84:87], v[24:27]
    v_mfma_f32_16x16x32_bf16 v[28:31], a[88:91], v[84:87], v[28:31]
    ds_read_b128 v[116:119], v8 offset:2048
    s_waitcnt lgkmcnt(7)
    v_mfma_f32_16x16x32_bf16 v[32:35], a[16:19], v[88:91], v[32:35]
    v_mfma_f32_16x16x32_bf16 v[36:39], a[88:91], v[88:91], v[36:39]
    ds_read_b128 v[120:123], v8 offset:4096
    s_waitcnt lgkmcnt(7)
    v_mfma_f32_16x16x32_bf16 v[40:43], a[16:19], v[92:95], v[40:43]
    v_mfma_f32_16x16x32_bf16 v[44:47], a[88:91], v[92:95], v[44:47]
    ds_read_b128 v[124:127], v8 offset:6144
    s_waitcnt lgkmcnt(7)
    v_mfma_f32_16x16x32_bf16 v[48:51], a[16:19], v[96:99], v[48:51]
    v_mfma_f32_16x16x32_bf16 v[52:55], a[88:91], v[96:99], v[52:55]
    ds_read_b128 v[128:131], v8 offset:8192
    s_waitcnt lgkmcnt(7)
    v_mfma_f32_16x16x32_bf16 v[56:59], a[16:19], v[100:103], v[56:59]
    v_mfma_f32_16x16x32_bf16 v[60:63], a[88:91], v[100:103], v[60:63]
    ds_read_b128 v[132:135], v8 offset:10240
    s_waitcnt lgkmcnt(7)
    v_mfma_f32_16x16x32_bf16 v[64:67], a[16:19], v[104:107], v[64:67]
    v_mfma_f32_16x16x32_bf16 v[68:71], a[88:91], v[104:107], v[68:71]
    ds_read_b128 v[136:139], v8 offset:12288
    s_waitcnt lgkmcnt(7)
    v_mfma_f32_16x16x32_bf16 v[72:75], a[16:19], v[108:111], v[72:75]
    v_mfma_f32_16x16x32_bf16 v[76:79], a[88:91], v[108:111], v[76:79]
    ds_read_b128 v[140:143], v8 offset:14336
    s_waitcnt lgkmcnt(7)
    v_mfma_f32_16x16x32_bf16 v[16:19], a[20:23], v[112:115], v[16:19]
    v_mfma_f32_16x16x32_bf16 v[20:23], a[92:95], v[112:115], v[20:23]
    s_waitcnt lgkmcnt(6)
    v_mfma_f32_16x16x32_bf16 v[24:27], a[20:23], v[116:119], v[24:27]
    v_mfma_f32_16x16x32_bf16 v[28:31], a[92:95], v[116:119], v[28:31]
    s_waitcnt lgkmcnt(5)
    v_mfma_f32_16x16x32_bf16 v[32:35], a[20:23], v[120:123], v[32:35]
    v_mfma_f32_16x16x32_bf16 v[36:39], a[92:95], v[120:123], v[36:39]
    s_waitcnt lgkmcnt(4)
    v_mfma_f32_16x16x32_bf16 v[40:43], a[20:23], v[124:127], v[40:43]
    v_mfma_f32_16x16x32_bf16 v[44:47], a[92:95], v[124:127], v[44:47]
    s_waitcnt lgkmcnt(3)
    v_mfma_f32_16x16x32_bf16 v[48:51], a[20:23], v[128:131], v[48:51]
    v_mfma_f32_16x16x32_bf16 v[52:55], a[92:95], v[128:131], v[52:55]
    s_waitcnt lgkmcnt(2)
    v_mfma_f32_16x16x32_bf16 v[56:59], a[20:23], v[132:135], v[56:59]
    v_mfma_f32_16x16x32_bf16 v[60:63], a[92:95], v[132:135], v[60:63]
    s_waitcnt lgkmcnt(1)
    v_mfma_f32_16x16x32_bf16 v[64:67], a[20:23], v[136:139], v[64:67]
    v_mfma_f32_16x16x32_bf16 v[68:71], a[92:95], v[136:139], v[68:71]
    s_waitcnt lgkmcnt(0)
    v_mfma_f32_16x16x32_bf16 v[72:75], a[20:23], v[140:143], v[72:75]
    v_mfma_f32_16x16x32_bf16 v[76:79], a[92:95], v[140:143], v[76:79]
    s_waitcnt vmcnt(28)
    s_barrier
    s_add_u32 s50, s38, 0
    s_add_u32 m0, s39, 0
    s_nop 0
    buffer_load_dwordx4 v1, s[12:15], s50 offen  lds
    s_add_u32 s50, s38, 9216
    s_add_u32 m0, s39, 1024
    s_nop 0
    buffer_load_dwordx4 v2, s[12:15], s50 offen  lds
    s_add_u32 s50, s38, 18432
    s_add_u32 m0, s39, 2048
    s_nop 0
    buffer_load_dwordx4 v1, s[12:15], s50 offen  lds
    s_add_u32 s50, s38, 27648
    s_add_u32 m0, s39, 3072
    s_nop 0
    buffer_load_dwordx4 v2, s[12:15], s50 offen  lds
    s_add_u32 s38, s38, 128
    s_add_u32 s39, s39, 16384
    s_and_b32 s39, s39, 0x1ffff
    v_add_u32 v7, s41, v3
    v_add_u32 v8, s41, v4
    s_add_u32 s41, s41, 16384
    s_and_b32 s41, s41, 0x1ffff
    ds_read_b128 v[80:83], v7 offset:0
    ds_read_b128 v[84:87], v7 offset:2048
    ds_read_b128 v[88:91], v7 offset:4096
    ds_read_b128 v[92:95], v7 offset:6144
    ds_read_b128 v[96:99], v7 offset:8192
    ds_read_b128 v[100:103], v7 offset:10240
    ds_read_b128 v[104:107], v7 offset:12288
    ds_read_b128 v[108:111], v7 offset:14336
    s_waitcnt lgkmcnt(7)
    v_mfma_f32_16x16x32_bf16 v[16:19], a[24:27], v[80:83], v[16:19]
    v_mfma_f32_16x16x32_bf16 v[20:23], a[96:99], v[80:83], v[20:23]
    ds_read_b128 v[112:115], v8 offset:0
    s_waitcnt lgkmcnt(7)
    v_mfma_f32_16x16x32_bf16 v[24:27], a[24:27], v[84:87], v[24:27]
    v_mfma_f32_16x16x32_bf16 v[28:31], a[96:99], v[84:87], v[28:31]
    ds_read_b128 v[116:119], v8 offset:2048
    s_waitcnt lgkmcnt(7)
    v_mfma_f32_16x16x32_bf16 v[32:35], a[24:27], v[88:91], v[32:35]
    v_mfma_f32_16x16x32_bf16 v[36:39], a[96:99], v[88:91], v[36:39]
    ds_read_b128 v[120:123], v8 offset:4096
    s_waitcnt lgkmcnt(7)
    v_mfma_f32_16x16x32_bf16 v[40:43], a[24:27], v[92:95], v[40:43]
    v_mfma_f32_16x16x32_bf16 v[44:47], a[96:99], v[92:95], v[44:47]
    ds_read_b128 v[124:127], v8 offset:6144
    s_waitcnt lgkmcnt(7)
    v_mfma_f32_16x16x32_bf16 v[48:51], a[24:27], v[96:99], v[48:51]
    v_mfma_f32_16x16x32_bf16 v[52:55], a[96:99], v[96:99], v[52:55]
    ds_read_b128 v[128:131], v8 offset:8192
    s_waitcnt lgkmcnt(7)
    v_mfma_f32_16x16x32_bf16 v[56:59], a[24:27], v[100:103], v[56:59]
    v_mfma_f32_16x16x32_bf16 v[60:63], a[96:99], v[100:103], v[60:63]
    ds_read_b128 v[132:135], v8 offset:10240
    s_waitcnt lgkmcnt(7)
    v_mfma_f32_16x16x32_bf16 v[64:67], a[24:27], v[104:107], v[64:67]
    v_mfma_f32_16x16x32_bf16 v[68:71], a[96:99], v[104:107], v[68:71]
    ds_read_b128 v[136:139], v8 offset:12288
    s_waitcnt lgkmcnt(7)
    v_mfma_f32_16x16x32_bf16 v[72:75], a[24:27], v[108:111], v[72:75]
    v_mfma_f32_16x16x32_bf16 v[76:79], a[96:99], v[108:111], v[76:79]
    ds_read_b128 v[140:143], v8 offset:14336
    s_waitcnt lgkmcnt(7)
    v_mfma_f32_16x16x32_bf16 v[16:19], a[28:31], v[112:115], v[16:19]
    v_mfma_f32_16x16x32_bf16 v[20:23], a[100:103], v[112:115], v[20:23]
    s_waitcnt lgkmcnt(6)
    v_mfma_f32_16x16x32_bf16 v[24:27], a[28:31], v[116:119], v[24:27]
    v_mfma_f32_16x16x32_bf16 v[28:31], a[100:103], v[116:119], v[28:31]
    s_waitcnt lgkmcnt(5)
    v_mfma_f32_16x16x32_bf16 v[32:35], a[28:31], v[120:123], v[32:35]
    v_mfma_f32_16x16x32_bf16 v[36:39], a[100:103], v[120:123], v[36:39]
    s_waitcnt lgkmcnt(4)
    v_mfma_f32_16x16x32_bf16 v[40:43], a[28:31], v[124:127], v[40:43]
    v_mfma_f32_16x16x32_bf16 v[44:47], a[100:103], v[124:127], v[44:47]
    s_waitcnt lgkmcnt(3)
    v_mfma_f32_16x16x32_bf16 v[48:51], a[28:31], v[128:131], v[48:51]
    v_mfma_f32_16x16x32_bf16 v[52:55], a[100:103], v[128:131], v[52:55]
    s_waitcnt lgkmcnt(2)
    v_mfma_f32_16x16x32_bf16 v[56:59], a[28:31], v[132:135], v[56:59]
    v_mfma_f32_16x16x32_bf16 v[60:63], a[100:103], v[132:135], v[60:63]
    s_waitcnt lgkmcnt(1)
    v_mfma_f32_16x16x32_bf16 v[64:67], a[28:31], v[136:139], v[64:67]
    v_mfma_f32_16x16x32_bf16 v[68:71], a[100:103], v[136:139], v[68:71]
    s_waitcnt lgkmcnt(0)
    v_mfma_f32_16x16x32_bf16 v[72:75], a[28:31], v[140:143], v[72:75]
    v_mfma_f32_16x16x32_bf16 v[76:79], a[100:103], v[140:143], v[76:79]
    s_waitcnt vmcnt(28)
    s_barrier
    s_add_u32 s50, s38, 0
    s_add_u32 m0, s39, 0
    s_nop 0
    buffer_load_dwordx4 v1, s[12:15], s50 offen  lds
    s_add_u32 s50, s38, 9216
    s_add_u32 m0, s39, 1024
    s_nop 0
    buffer_load_dwordx4 v2, s[12:15], s50 offen  lds
    s_add_u32 s50, s38, 18432
    s_add_u32 m0, s39, 2048
    s_nop 0
    buffer_load_dwordx4 v1, s[12:15], s50 offen  lds
    s_add_u32 s50, s38, 27648
    s_add_u32 m0, s39, 3072
    s_nop 0
    buffer_load_dwordx4 v2, s[12:15], s50 offen  lds
    s_add_u32 s38, s38, 128
    s_add_u32 s39, s39, 16384
    s_and_b32 s39, s39, 0x1ffff
    v_add_u32 v7, s41, v3
    v_add_u32 v8, s41, v4
    s_add_u32 s41, s41, 16384
    s_and_b32 s41, s41, 0x1ffff
    ds_read_b128 v[80:83], v7 offset:0
    ds_read_b128 v[84:87], v7 offset:2048
    ds_read_b128 v[88:91], v7 offset:4096
    ds_read_b128 v[92:95], v7 offset:6144
    ds_read_b128 v[96:99], v7 offset:8192
    ds_read_b128 v[100:103], v7 offset:10240
    ds_read_b128 v[104:107], v7 offset:12288
    ds_read_b128 v[108:111], v7 offset:14336
    s_waitcnt lgkmcnt(7)
    v_mfma_f32_16x16x32_bf16 v[16:19], a[32:35], v[80:83], v[16:19]
    v_mfma_f32_16x16x32_bf16 v[20:23], a[104:107], v[80:83], v[20:23]
    ds_read_b128 v[112:115], v8 offset:0
    s_waitcnt lgkmcnt(7)
    v_mfma_f32_16x16x32_bf16 v[24:27], a[32:35], v[84:87], v[24:27]
    v_mfma_f32_16x16x32_bf16 v[28:31], a[104:107], v[84:87], v[28:31]
    ds_read_b128 v[116:119], v8 offset:2048
    s_waitcnt lgkmcnt(7)
    v_mfma_f32_16x16x32_bf16 v[32:35], a[32:35], v[88:91], v[32:35]
    v_mfma_f32_16x16x32_bf16 v[36:39], a[104:107], v[88:91], v[36:39]
    ds_read_b128 v[120:123], v8 offset:4096
    s_waitcnt lgkmcnt(7)
    v_mfma_f32_16x16x32_bf16 v[40:43], a[32:35], v[92:95], v[40:43]
    v_mfma_f32_16x16x32_bf16 v[44:47], a[104:107], v[92:95], v[44:47]
    ds_read_b128 v[124:127], v8 offset:6144
    s_waitcnt lgkmcnt(7)
    v_mfma_f32_16x16x32_bf16 v[48:51], a[32:35], v[96:99], v[48:51]
    v_mfma_f32_16x16x32_bf16 v[52:55], a[104:107], v[96:99], v[52:55]
    ds_read_b128 v[128:131], v8 offset:8192
    s_waitcnt lgkmcnt(7)
    v_mfma_f32_16x16x32_bf16 v[56:59], a[32:35], v[100:103], v[56:59]
    v_mfma_f32_16x16x32_bf16 v[60:63], a[104:107], v[100:103], v[60:63]
    ds_read_b128 v[132:135], v8 offset:10240
    s_waitcnt lgkmcnt(7)
    v_mfma_f32_16x16x32_bf16 v[64:67], a[32:35], v[104:107], v[64:67]
    v_mfma_f32_16x16x32_bf16 v[68:71], a[104:107], v[104:107], v[68:71]
    ds_read_b128 v[136:139], v8 offset:12288
    s_waitcnt lgkmcnt(7)
    v_mfma_f32_16x16x32_bf16 v[72:75], a[32:35], v[108:111], v[72:75]
    v_mfma_f32_16x16x32_bf16 v[76:79], a[104:107], v[108:111], v[76:79]
    ds_read_b128 v[140:143], v8 offset:14336
    s_waitcnt lgkmcnt(7)
    v_mfma_f32_16x16x32_bf16 v[16:19], a[36:39], v[112:115], v[16:19]
    v_mfma_f32_16x16x32_bf16 v[20:23], a[108:111], v[112:115], v[20:23]
    s_waitcnt lgkmcnt(6)
    v_mfma_f32_16x16x32_bf16 v[24:27], a[36:39], v[116:119], v[24:27]
    v_mfma_f32_16x16x32_bf16 v[28:31], a[108:111], v[116:119], v[28:31]
    s_waitcnt lgkmcnt(5)
    v_mfma_f32_16x16x32_bf16 v[32:35], a[36:39], v[120:123], v[32:35]
    v_mfma_f32_16x16x32_bf16 v[36:39], a[108:111], v[120:123], v[36:39]
    s_waitcnt lgkmcnt(4)
    v_mfma_f32_16x16x32_bf16 v[40:43], a[36:39], v[124:127], v[40:43]
    v_mfma_f32_16x16x32_bf16 v[44:47], a[108:111], v[124:127], v[44:47]
    s_waitcnt lgkmcnt(3)
    v_mfma_f32_16x16x32_bf16 v[48:51], a[36:39], v[128:131], v[48:51]
    v_mfma_f32_16x16x32_bf16 v[52:55], a[108:111], v[128:131], v[52:55]
    s_waitcnt lgkmcnt(2)
    v_mfma_f32_16x16x32_bf16 v[56:59], a[36:39], v[132:135], v[56:59]
    v_mfma_f32_16x16x32_bf16 v[60:63], a[108:111], v[132:135], v[60:63]
    s_waitcnt lgkmcnt(1)
    v_mfma_f32_16x16x32_bf16 v[64:67], a[36:39], v[136:139], v[64:67]
    v_mfma_f32_16x16x32_bf16 v[68:71], a[108:111], v[136:139], v[68:71]
    s_waitcnt lgkmcnt(0)
    v_mfma_f32_16x16x32_bf16 v[72:75], a[36:39], v[140:143], v[72:75]
    v_mfma_f32_16x16x32_bf16 v[76:79], a[108:111], v[140:143], v[76:79]
    s_waitcnt vmcnt(28)
    s_barrier
    s_add_u32 s50, s38, 0
    s_add_u32 m0, s39, 0
    s_nop 0
    buffer_load_dwordx4 v1, s[12:15], s50 offen  lds
    s_add_u32 s50, s38, 9216
    s_add_u32 m0, s39, 1024
    s_nop 0
    buffer_load_dwordx4 v2, s[12:15], s50 offen  lds
    s_add_u32 s50, s38, 18432
    s_add_u32 m0, s39, 2048
    s_nop 0
    buffer_load_dwordx4 v1, s[12:15], s50 offen  lds
    s_add_u32 s50, s38, 27648
    s_add_u32 m0, s39, 3072
    s_nop 0
    buffer_load_dwordx4 v2, s[12:15], s50 offen  lds
    s_add_u32 s38, s38, 128
    s_add_u32 s39, s39, 16384
    s_and_b32 s39, s39, 0x1ffff
    v_add_u32 v7, s41, v3
    v_add_u32 v8, s41, v4
    s_add_u32 s41, s41, 16384
    s_and_b32 s41, s41, 0x1ffff
    ds_read_b128 v[80:83], v7 offset:0
    ds_read_b128 v[84:87], v7 offset:2048
    ds_read_b128 v[88:91], v7 offset:4096
    ds_read_b128 v[92:95], v7 offset:6144
    ds_read_b128 v[96:99], v7 offset:8192
    ds_read_b128 v[100:103], v7 offset:10240
    ds_read_b128 v[104:107], v7 offset:12288
    ds_read_b128 v[108:111], v7 offset:14336
    s_waitcnt lgkmcnt(7)
    v_mfma_f32_16x16x32_bf16 v[16:19], a[40:43], v[80:83], v[16:19]
    v_mfma_f32_16x16x32_bf16 v[20:23], a[112:115], v[80:83], v[20:23]
    ds_read_b128 v[112:115], v8 offset:0
    s_waitcnt lgkmcnt(7)
    v_mfma_f32_16x16x32_bf16 v[24:27], a[40:43], v[84:87], v[24:27]
    v_mfma_f32_16x16x32_bf16 v[28:31], a[112:115], v[84:87], v[28:31]
    ds_read_b128 v[116:119], v8 offset:2048
    s_waitcnt lgkmcnt(7)
    v_mfma_f32_16x16x32_bf16 v[32:35], a[40:43], v[88:91], v[32:35]
    v_mfma_f32_16x16x32_bf16 v[36:39], a[112:115], v[88:91], v[36:39]
    ds_read_b128 v[120:123], v8 offset:4096
    s_waitcnt lgkmcnt(7)
    v_mfma_f32_16x16x32_bf16 v[40:43], a[40:43], v[92:95], v[40:43]
    v_mfma_f32_16x16x32_bf16 v[44:47], a[112:115], v[92:95], v[44:47]
    ds_read_b128 v[124:127], v8 offset:6144
    s_waitcnt lgkmcnt(7)
    v_mfma_f32_16x16x32_bf16 v[48:51], a[40:43], v[96:99], v[48:51]
    v_mfma_f32_16x16x32_bf16 v[52:55], a[112:115], v[96:99], v[52:55]
    ds_read_b128 v[128:131], v8 offset:8192
    s_waitcnt lgkmcnt(7)
    v_mfma_f32_16x16x32_bf16 v[56:59], a[40:43], v[100:103], v[56:59]
    v_mfma_f32_16x16x32_bf16 v[60:63], a[112:115], v[100:103], v[60:63]
    ds_read_b128 v[132:135], v8 offset:10240
    s_waitcnt lgkmcnt(7)
    v_mfma_f32_16x16x32_bf16 v[64:67], a[40:43], v[104:107], v[64:67]
    v_mfma_f32_16x16x32_bf16 v[68:71], a[112:115], v[104:107], v[68:71]
    ds_read_b128 v[136:139], v8 offset:12288
    s_waitcnt lgkmcnt(7)
    v_mfma_f32_16x16x32_bf16 v[72:75], a[40:43], v[108:111], v[72:75]
    v_mfma_f32_16x16x32_bf16 v[76:79], a[112:115], v[108:111], v[76:79]
    ds_read_b128 v[140:143], v8 offset:14336
    s_waitcnt lgkmcnt(7)
    v_mfma_f32_16x16x32_bf16 v[16:19], a[44:47], v[112:115], v[16:19]
    v_mfma_f32_16x16x32_bf16 v[20:23], a[116:119], v[112:115], v[20:23]
    s_waitcnt lgkmcnt(6)
    v_mfma_f32_16x16x32_bf16 v[24:27], a[44:47], v[116:119], v[24:27]
    v_mfma_f32_16x16x32_bf16 v[28:31], a[116:119], v[116:119], v[28:31]
    s_waitcnt lgkmcnt(5)
    v_mfma_f32_16x16x32_bf16 v[32:35], a[44:47], v[120:123], v[32:35]
    v_mfma_f32_16x16x32_bf16 v[36:39], a[116:119], v[120:123], v[36:39]
    s_waitcnt lgkmcnt(4)
    v_mfma_f32_16x16x32_bf16 v[40:43], a[44:47], v[124:127], v[40:43]
    v_mfma_f32_16x16x32_bf16 v[44:47], a[116:119], v[124:127], v[44:47]
    s_waitcnt lgkmcnt(3)
    v_mfma_f32_16x16x32_bf16 v[48:51], a[44:47], v[128:131], v[48:51]
    v_mfma_f32_16x16x32_bf16 v[52:55], a[116:119], v[128:131], v[52:55]
    s_waitcnt lgkmcnt(2)
    v_mfma_f32_16x16x32_bf16 v[56:59], a[44:47], v[132:135], v[56:59]
    v_mfma_f32_16x16x32_bf16 v[60:63], a[116:119], v[132:135], v[60:63]
    s_waitcnt lgkmcnt(1)
    v_mfma_f32_16x16x32_bf16 v[64:67], a[44:47], v[136:139], v[64:67]
    v_mfma_f32_16x16x32_bf16 v[68:71], a[116:119], v[136:139], v[68:71]
    s_waitcnt lgkmcnt(0)
    v_mfma_f32_16x16x32_bf16 v[72:75], a[44:47], v[140:143], v[72:75]
    v_mfma_f32_16x16x32_bf16 v[76:79], a[116:119], v[140:143], v[76:79]
    s_waitcnt vmcnt(20)
    s_barrier
    s_cmp_eq_u32 s65, 0
    s_mov_b32 s65, 1
    s_cbranch_scc1 AL_fl1
    s_cmp_eq_u32 s31, 0
    s_cbranch_scc0 AL_fl1a
    v_mov_b32 v13, s63
    v_mov_b32 v14, s64
    s_mov_b64 exec, 1
    global_atomic_add v13, v14, s[90:91]
    s_mov_b64 exec, -1
AL_fl1a:
AL_fl1:
    s_add_u32 s50, s38, 0
    s_add_u32 m0, s39, 0
    s_nop 0
    buffer_load_dwordx4 v1, s[12:15], s50 offen  lds
    s_add_u32 s50, s38, 9216
    s_add_u32 m0, s39, 1024
    s_nop 0
    buffer_load_dwordx4 v2, s[12:15], s50 offen  lds
    s_add_u32 s50, s38, 18432
    s_add_u32 m0, s39, 2048
    s_nop 0
    buffer_load_dwordx4 v1, s[12:15], s50 offen  lds
    s_add_u32 s50, s38, 27648
    s_add_u32 m0, s39, 3072
    s_nop 0
    buffer_load_dwordx4 v2, s[12:15], s50 offen  lds
    s_add_u32 s38, s38, 128
    s_add_u32 s39, s39, 16384
    s_and_b32 s39, s39, 0x1ffff
    v_add_u32 v7, s41, v3
    v_add_u32 v8, s41, v4
    s_add_u32 s41, s41, 16384
    s_and_b32 s41, s41, 0x1ffff
    ds_read_b128 v[80:83], v7 offset:0
    ds_read_b128 v[84:87], v7 offset:2048
    ds_read_b128 v[88:91], v7 offset:4096
    ds_read_b128 v[92:95], v7 offset:6144
    ds_read_b128 v[96:99], v7 offset:8192
    ds_read_b128 v[100:103], v7 offset:10240
    ds_read_b128 v[104:107], v7 offset:12288
    ds_read_b128 v[108:111], v7 offset:14336
    s_waitcnt lgkmcnt(7)
    v_mfma_f32_16x16x32_bf16 v[16:19], a[48:51], v[80:83], v[16:19]
    v_mfma_f32_16x16x32_bf16 v[20:23], a[120:123], v[80:83], v[20:23]
    ds_read_b128 v[112:115], v8 offset:0
    s_waitcnt lgkmcnt(7)
    v_mfma_f32_16x16x32_bf16 v[24:27], a[48:51], v[84:87], v[24:27]
    v_mfma_f32_16x16x32_bf16 v[28:31], a[120:123], v[84:87], v[28:31]
    ds_read_b128 v[116:119], v8 offset:2048
    s_waitcnt lgkmcnt(7)
    v_mfma_f32_16x16x32_bf16 v[32:35], a[48:51], v[88:91], v[32:35]
    v_mfma_f32_16x16x32_bf16 v[36:39], a[120:123], v[88:91], v[36:39]
    ds_read_b128 v[120:123], v8 offset:4096
    s_waitcnt lgkmcnt(7)
    v_mfma_f32_16x16x32_bf16 v[40:43], a[48:51], v[92:95], v[40:43]
    v_mfma_f32_16x16x32_bf16 v[44:47], a[120:123], v[92:95], v[44:47]
    ds_read_b128 v[124:127], v8 offset:6144
    s_waitcnt lgkmcnt(7)
    v_mfma_f32_16x16x32_bf16 v[48:51], a[48:51], v[96:99], v[48:51]
    v_mfma_f32_16x16x32_bf16 v[52:55], a[120:123], v[96:99], v[52:55]
    ds_read_b128 v[128:131], v8 offset:8192
    s_waitcnt lgkmcnt(7)
    v_mfma_f32_16x16x32_bf16 v[56:59], a[48:51], v[100:103], v[56:59]
    v_mfma_f32_16x16x32_bf16 v[60:63], a[120:123], v[100:103], v[60:63]
    ds_read_b128 v[132:135], v8 offset:10240
    s_waitcnt lgkmcnt(7)
    v_mfma_f32_16x16x32_bf16 v[64:67], a[48:51], v[104:107], v[64:67]
    v_mfma_f32_16x16x32_bf16 v[68:71], a[120:123], v[104:107], v[68:71]
    ds_read_b128 v[136:139], v8 offset:12288
    s_waitcnt lgkmcnt(7)
    v_mfma_f32_16x16x32_bf16 v[72:75], a[48:51], v[108:111], v[72:75]
    v_mfma_f32_16x16x32_bf16 v[76:79], a[120:123], v[108:111], v[76:79]
    ds_read_b128 v[140:143], v8 offset:14336
    s_waitcnt lgkmcnt(7)
    v_mfma_f32_16x16x32_bf16 v[16:19], a[52:55], v[112:115], v[16:19]
    v_mfma_f32_16x16x32_bf16 v[20:23], a[124:127], v[112:115], v[20:23]
    s_waitcnt lgkmcnt(6)
    v_mfma_f32_16x16x32_bf16 v[24:27], a[52:55], v[116:119], v[24:27]
    v_mfma_f32_16x16x32_bf16 v[28:31], a[124:127], v[116:119], v[28:31]
    s_waitcnt lgkmcnt(5)
    v_mfma_f32_16x16x32_bf16 v[32:35], a[52:55], v[120:123], v[32:35]
    v_mfma_f32_16x16x32_bf16 v[36:39], a[124:127], v[120:123], v[36:39]
    s_waitcnt lgkmcnt(4)
    v_mfma_f32_16x16x32_bf16 v[40:43], a[52:55], v[124:127], v[40:43]
    v_mfma_f32_16x16x32_bf16 v[44:47], a[124:127], v[124:127], v[44:47]
    s_waitcnt lgkmcnt(3)
    v_mfma_f32_16x16x32_bf16 v[48:51], a[52:55], v[128:131], v[48:51]
    v_mfma_f32_16x16x32_bf16 v[52:55], a[124:127], v[128:131], v[52:55]
    s_waitcnt lgkmcnt(2)
    v_mfma_f32_16x16x32_bf16 v[56:59], a[52:55], v[132:135], v[56:59]
    v_mfma_f32_16x16x32_bf16 v[60:63], a[124:127], v[132:135], v[60:63]
    s_waitcnt lgkmcnt(1)
    v_mfma_f32_16x16x32_bf16 v[64:67], a[52:55], v[136:139], v[64:67]
    v_mfma_f32_16x16x32_bf16 v[68:71], a[124:127], v[136:139], v[68:71]
    s_waitcnt lgkmcnt(0)
    v_mfma_f32_16x16x32_bf16 v[72:75], a[52:55], v[140:143], v[72:75]
    v_mfma_f32_16x16x32_bf16 v[76:79], a[124:127], v[140:143], v[76:79]
    s_waitcnt vmcnt(20)
    s_barrier
    s_add_u32 s50, s38, 0
    s_add_u32 m0, s39, 0
    s_nop 0
    buffer_load_dwordx4 v1, s[12:15], s50 offen  lds
    s_add_u32 s50, s38, 9216
    s_add_u32 m0, s39, 1024
    s_nop 0
    buffer_load_dwordx4 v2, s[12:15], s50 offen  lds
    s_add_u32 s50, s38, 18432
    s_add_u32 m0, s39, 2048
    s_nop 0
    buffer_load_dwordx4 v1, s[12:15], s50 offen  lds
    s_add_u32 s50, s38, 27648
    s_add_u32 m0, s39, 3072
    s_nop 0
    buffer_load_dwordx4 v2, s[12:15], s50 offen  lds
    s_add_u32 s38, s38, 128
    s_add_u32 s39, s39, 16384
    s_and_b32 s39, s39, 0x1ffff
    v_add_u32 v7, s41, v3
    v_add_u32 v8, s41, v4
    s_add_u32 s41, s41, 16384
    s_and_b32 s41, s41, 0x1ffff
    ds_read_b128 v[80:83], v7 offset:0
    ds_read_b128 v[84:87], v7 offset:2048
    ds_read_b128 v[88:91], v7 offset:4096
    ds_read_b128 v[92:95], v7 offset:6144
    ds_read_b128 v[96:99], v7 offset:8192
    ds_read_b128 v[100:103], v7 offset:10240
    ds_read_b128 v[104:107], v7 offset:12288
    ds_read_b128 v[108:111], v7 offset:14336
    s_waitcnt lgkmcnt(7)
    v_mfma_f32_16x16x32_bf16 v[16:19], a[56:59], v[80:83], v[16:19]
    v_mfma_f32_16x16x32_bf16 v[20:23], a[128:131], v[80:83], v[20:23]
    ds_read_b128 v[112:115], v8 offset:0
    s_waitcnt lgkmcnt(7)
    v_mfma_f32_16x16x32_bf16 v[24:27], a[56:59], v[84:87], v[24:27]
    v_mfma_f32_16x16x32_bf16 v[28:31], a[128:131], v[84:87], v[28:31]
    ds_read_b128 v[116:119], v8 offset:2048
    s_waitcnt lgkmcnt(7)
    v_mfma_f32_16x16x32_bf16 v[32:35], a[56:59], v[88:91], v[32:35]
    v_mfma_f32_16x16x32_bf16 v[36:39], a[128:131], v[88:91], v[36:39]
    ds_read_b128 v[120:123], v8 offset:4096
    s_waitcnt lgkmcnt(7)
    v_mfma_f32_16x16x32_bf16 v[40:43], a[56:59], v[92:95], v[40:43]
    v_mfma_f32_16x16x32_bf16 v[44:47], a[128:131], v[92:95], v[44:47]
    ds_read_b128 v[124:127], v8 offset:6144
    s_waitcnt lgkmcnt(7)
    v_mfma_f32_16x16x32_bf16 v[48:51], a[56:59], v[96:99], v[48:51]
    v_mfma_f32_16x16x32_bf16 v[52:55], a[128:131], v[96:99], v[52:55]
    ds_read_b128 v[128:131], v8 offset:8192
    s_waitcnt lgkmcnt(7)
    v_mfma_f32_16x16x32_bf16 v[56:59], a[56:59], v[100:103], v[56:59]
    v_mfma_f32_16x16x32_bf16 v[60:63], a[128:131], v[100:103], v[60:63]
    ds_read_b128 v[132:135], v8 offset:10240
    s_waitcnt lgkmcnt(7)
    v_mfma_f32_16x16x32_bf16 v[64:67], a[56:59], v[104:107], v[64:67]
    v_mfma_f32_16x16x32_bf16 v[68:71], a[128:131], v[104:107], v[68:71]
    ds_read_b128 v[136:139], v8 offset:12288
    s_waitcnt lgkmcnt(7)
    v_mfma_f32_16x16x32_bf16 v[72:75], a[56:59], v[108:111], v[72:75]
    v_mfma_f32_16x16x32_bf16 v[76:79], a[128:131], v[108:111], v[76:79]
    ds_read_b128 v[140:143], v8 offset:14336
    s_waitcnt lgkmcnt(7)
    v_mfma_f32_16x16x32_bf16 v[16:19], a[60:63], v[112:115], v[16:19]
    v_mfma_f32_16x16x32_bf16 v[20:23], a[132:135], v[112:115], v[20:23]
    s_waitcnt lgkmcnt(6)
    v_mfma_f32_16x16x32_bf16 v[24:27], a[60:63], v[116:119], v[24:27]
    v_mfma_f32_16x16x32_bf16 v[28:31], a[132:135], v[116:119], v[28:31]
    s_waitcnt lgkmcnt(5)
    v_mfma_f32_16x16x32_bf16 v[32:35], a[60:63], v[120:123], v[32:35]
    v_mfma_f32_16x16x32_bf16 v[36:39], a[132:135], v[120:123], v[36:39]
    s_waitcnt lgkmcnt(4)
    v_mfma_f32_16x16x32_bf16 v[40:43], a[60:63], v[124:127], v[40:43]
    v_mfma_f32_16x16x32_bf16 v[44:47], a[132:135], v[124:127], v[44:47]
    s_waitcnt lgkmcnt(3)
    v_mfma_f32_16x16x32_bf16 v[48:51], a[60:63], v[128:131], v[48:51]
    v_mfma_f32_16x16x32_bf16 v[52:55], a[132:135], v[128:131], v[52:55]
    s_waitcnt lgkmcnt(2)
    v_mfma_f32_16x16x32_bf16 v[56:59], a[60:63], v[132:135], v[56:59]
    v_mfma_f32_16x16x32_bf16 v[60:63], a[132:135], v[132:135], v[60:63]
    s_waitcnt lgkmcnt(1)
    v_mfma_f32_16x16x32_bf16 v[64:67], a[60:63], v[136:139], v[64:67]
    v_mfma_f32_16x16x32_bf16 v[68:71], a[132:135], v[136:139], v[68:71]
    s_waitcnt lgkmcnt(0)
    v_mfma_f32_16x16x32_bf16 v[72:75], a[60:63], v[140:143], v[72:75]
    v_mfma_f32_16x16x32_bf16 v[76:79], a[132:135], v[140:143], v[76:79]
    s_waitcnt vmcnt(20)
    s_barrier
    s_add_u32 s50, s38, 0
    s_add_u32 m0, s39, 0
    s_nop 0
    buffer_load_dwordx4 v1, s[12:15], s50 offen  lds
    s_add_u32 s50, s38, 9216
    s_add_u32 m0, s39, 1024
    s_nop 0
    buffer_load_dwordx4 v2, s[12:15], s50 offen  lds
    s_add_u32 s50, s38, 18432
    s_add_u32 m0, s39, 2048
    s_nop 0
    buffer_load_dwordx4 v1, s[12:15], s50 offen  lds
    s_add_u32 s50, s38, 27648
    s_add_u32 m0, s39, 3072
    s_nop 0
    buffer_load_dwordx4 v2, s[12:15], s50 offen  lds
    s_add_u32 s38, s38, 128
    s_add_u32 s39, s39, 16384
    s_and_b32 s39, s39, 0x1ffff
    v_add_u32 v7, s41, v3
    v_add_u32 v8, s41, v4
    s_add_u32 s41, s41, 16384
    s_and_b32 s41, s41, 0x1ffff
    ds_read_b128 v[80:83], v7 offset:0
    ds_read_b128 v[84:87], v7 offset:2048
    ds_read_b128 v[88:91], v7 offset:4096
    ds_read_b128 v[92:95], v7 offset:6144
    ds_read_b128 v[96:99], v7 offset:8192
    ds_read_b128 v[100:103], v7 offset:10240
    ds_read_b128 v[104:107], v7 offset:12288
    ds_read_b128 v[108:111], v7 offset:14336
    s_waitcnt lgkmcnt(7)
    v_mfma_f32_16x16x32_bf16 v[16:19], a[64:67], v[80:83], v[16:19]
    v_mfma_f32_16x16x32_bf16 v[20:23], a[136:139], v[80:83], v[20:23]
    ds_read_b128 v[112:115], v8 offset:0
    s_waitcnt lgkmcnt(7)
    v_mfma_f32_16x16x32_bf16 v[24:27], a[64:67], v[84:87], v[24:27]
    v_mfma_f32_16x16x32_bf16 v[28:31], a[136:139], v[84:87], v[28:31]
    ds_read_b128 v[116:119], v8 offset:2048
    s_waitcnt lgkmcnt(7)
    v_mfma_f32_16x16x32_bf16 v[32:35], a[64:67], v[88:91], v[32:35]
    v_mfma_f32_16x16x32_bf16 v[36:39], a[136:139], v[88:91], v[36:39]
    ds_read_b128 v[120:123], v8 offset:4096
    s_waitcnt lgkmcnt(7)
    v_mfma_f32_16x16x32_bf16 v[40:43], a[64:67], v[92:95], v[40:43]
    v_mfma_f32_16x16x32_bf16 v[44:47], a[136:139], v[92:95], v[44:47]
    ds_read_b128 v[124:127], v8 offset:6144
    s_waitcnt lgkmcnt(7)
    v_mfma_f32_16x16x32_bf16 v[48:51], a[64:67], v[96:99], v[48:51]
    v_mfma_f32_16x16x32_bf16 v[52:55], a[136:139], v[96:99], v[52:55]
    ds_read_b128 v[128:131], v8 offset:8192
    s_waitcnt lgkmcnt(7)
    v_mfma_f32_16x16x32_bf16 v[56:59], a[64:67], v[100:103], v[56:59]
    v_mfma_f32_16x16x32_bf16 v[60:63], a[136:139], v[100:103], v[60:63]
    ds_read_b128 v[132:135], v8 offset:10240
    s_waitcnt lgkmcnt(7)
    v_mfma_f32_16x16x32_bf16 v[64:67], a[64:67], v[104:107], v[64:67]
    v_mfma_f32_16x16x32_bf16 v[68:71], a[136:139], v[104:107], v[68:71]
    ds_read_b128 v[136:139], v8 offset:12288
    s_waitcnt lgkmcnt(7)
    v_mfma_f32_16x16x32_bf16 v[72:75], a[64:67], v[108:111], v[72:75]
    v_mfma_f32_16x16x32_bf16 v[76:79], a[136:139], v[108:111], v[76:79]
    ds_read_b128 v[140:143], v8 offset:14336
    s_waitcnt lgkmcnt(7)
    v_mfma_f32_16x16x32_bf16 v[16:19], a[68:71], v[112:115], v[16:19]
    v_mfma_f32_16x16x32_bf16 v[20:23], a[140:143], v[112:115], v[20:23]
    s_waitcnt lgkmcnt(6)
    v_mfma_f32_16x16x32_bf16 v[24:27], a[68:71], v[116:119], v[24:27]
    v_mfma_f32_16x16x32_bf16 v[28:31], a[140:143], v[116:119], v[28:31]
    s_waitcnt lgkmcnt(5)
    v_mfma_f32_16x16x32_bf16 v[32:35], a[68:71], v[120:123], v[32:35]
    v_mfma_f32_16x16x32_bf16 v[36:39], a[140:143], v[120:123], v[36:39]
    s_waitcnt lgkmcnt(4)
    v_mfma_f32_16x16x32_bf16 v[40:43], a[68:71], v[124:127], v[40:43]
    v_mfma_f32_16x16x32_bf16 v[44:47], a[140:143], v[124:127], v[44:47]
    s_waitcnt lgkmcnt(3)
    v_mfma_f32_16x16x32_bf16 v[48:51], a[68:71], v[128:131], v[48:51]
    v_mfma_f32_16x16x32_bf16 v[52:55], a[140:143], v[128:131], v[52:55]
    s_waitcnt lgkmcnt(2)
    v_mfma_f32_16x16x32_bf16 v[56:59], a[68:71], v[132:135], v[56:59]
    v_mfma_f32_16x16x32_bf16 v[60:63], a[140:143], v[132:135], v[60:63]
    s_waitcnt lgkmcnt(1)
    v_mfma_f32_16x16x32_bf16 v[64:67], a[68:71], v[136:139], v[64:67]
    v_mfma_f32_16x16x32_bf16 v[68:71], a[140:143], v[136:139], v[68:71]
    s_waitcnt lgkmcnt(0)
    v_mfma_f32_16x16x32_bf16 v[72:75], a[68:71], v[140:143], v[72:75]
    v_mfma_f32_16x16x32_bf16 v[76:79], a[140:143], v[140:143], v[76:79]
    v_cvt_pk_bf16_f32 v144, v16, v17
    v_cvt_pk_bf16_f32 v145, v18, v19
    v_cvt_pk_bf16_f32 v146, v20, v21
    v_cvt_pk_bf16_f32 v147, v22, v23
    s_add_u32 s50, s36, 0
    buffer_store_dwordx4 v[144:147], v0, s[4:7], s50 offen offset:0 sc1
    v_cvt_pk_bf16_f32 v148, v24, v25
    v_cvt_pk_bf16_f32 v149, v26, v27
    v_cvt_pk_bf16_f32 v150, v28, v29
    v_cvt_pk_bf16_f32 v151, v30, v31
    s_add_u32 s50, s36, 0
    buffer_store_dwordx4 v[148:151], v0, s[4:7], s50 offen offset:1024 sc1
    v_cvt_pk_bf16_f32 v152, v32, v33
    v_cvt_pk_bf16_f32 v153, v34, v35
    v_cvt_pk_bf16_f32 v154, v36, v37
    v_cvt_pk_bf16_f32 v155, v38, v39
    s_add_u32 s50, s36, 262144
    buffer_store_dwordx4 v[152:155], v0, s[4:7], s50 offen offset:0 sc1
    v_cvt_pk_bf16_f32 v156, v40, v41
    v_cvt_pk_bf16_f32 v157, v42, v43
    v_cvt_pk_bf16_f32 v158, v44, v45
    v_cvt_pk_bf16_f32 v159, v46, v47
    s_add_u32 s50, s36, 262144
    buffer_store_dwordx4 v[156:159], v0, s[4:7], s50 offen offset:1024 sc1
    v_cvt_pk_bf16_f32 v144, v48, v49
    v_cvt_pk_bf16_f32 v145, v50, v51
    v_cvt_pk_bf16_f32 v146, v52, v53
    v_cvt_pk_bf16_f32 v147, v54, v55
    s_add_u32 s50, s36, 524288
    buffer_store_dwordx4 v[144:147], v0, s[4:7], s50 offen offset:0 sc1
    v_cvt_pk_bf16_f32 v148, v56, v57
    v_cvt_pk_bf16_f32 v149, v58, v59
    v_cvt_pk_bf16_f32 v150, v60, v61
    v_cvt_pk_bf16_f32 v151, v62, v63
    s_add_u32 s50, s36, 524288
    buffer_store_dwordx4 v[148:151], v0, s[4:7], s50 offen offset:1024 sc1
    v_cvt_pk_bf16_f32 v152, v64, v65
    v_cvt_pk_bf16_f32 v153, v66, v67
    v_cvt_pk_bf16_f32 v154, v68, v69
    v_cvt_pk_bf16_f32 v155, v70, v71
    s_add_u32 s50, s36, 786432
    buffer_store_dwordx4 v[152:155], v0, s[4:7], s50 offen offset:0 sc1
    v_cvt_pk_bf16_f32 v156, v72, v73
    v_cvt_pk_bf16_f32 v157, v74, v75
    v_cvt_pk_bf16_f32 v158, v76, v77
    v_cvt_pk_bf16_f32 v159, v78, v79
    s_add_u32 s50, s36, 786432
    buffer_store_dwordx4 v[156:159], v0, s[4:7], s50 offen offset:1024 sc1
    s_add_u32 s34, s34, 1
    s_add_u32 s36, s36, s37
    s_cmp_lt_u32 s34, s35
    s_cbranch_scc1 ALT_BLK
    s_waitcnt vmcnt(0)
    s_barrier
    s_cmp_eq_u32 s31, 0
    s_cbranch_scc0 AL_fl2a
    v_mov_b32 v13, s63
    v_mov_b32 v14, s64
    s_mov_b64 exec, 1
    global_atomic_add v13, v14, s[90:91]
    s_mov_b64 exec, -1
AL_fl2a:
AL_fl2:
    s_branch KEND
AL_V:
    s_mul_i32 s38, s34, 147456
    s_mul_i32 s50, s31, 36864
    s_add_u32 s38, s38, s50
    s_lshl_b32 s39, s31, 12
    s_mov_b32 s41, 0
    s_add_u32 s50, s38, 0
    s_add_u32 m0, s39, 0
    s_nop 0
    buffer_load_dwordx4 v1, s[12:15], s50 offen  lds
    s_add_u32 s50, s38, 9216
    s_add_u32 m0, s39, 1024
    s_nop 0
    buffer_load_dwordx4 v2, s[12:15], s50 offen  lds
    s_add_u32 s50, s38, 18432
    s_add_u32 m0, s39, 2048
    s_nop 0
    buffer_load_dwordx4 v1, s[12:15], s50 offen  lds
    s_add_u32 s50, s38, 27648
    s_add_u32 m0, s39, 3072
    s_nop 0
    buffer_load_dwordx4 v2, s[12:15], s50 offen  lds
    s_add_u32 s38, s38, 128
    s_add_u32 s39, s39, 16384
    s_and_b32 s39, s39, 0x1ffff
    s_add_u32 s50, s38, 0
    s_add_u32 m0, s39, 0
    s_nop 0
    buffer_load_dwordx4 v1, s[12:15], s50 offen  lds
    s_add_u32 s50, s38, 9216
    s_add_u32 m0, s39, 1024
    s_nop 0
    buffer_load_dwordx4 v2, s[12:15], s50 offen  lds
    s_add_u32 s50, s38, 18432
    s_add_u32 m0, s39, 2048
    s_nop 0
    buffer_load_dwordx4 v1, s[12:15], s50 offen  lds
    s_add_u32 s50, s38, 27648
    s_add_u32 m0, s39, 3072
    s_nop 0
    buffer_load_dwordx4 v2, s[12:15], s50 offen  lds
    s_add_u32 s38, s38, 128
    s_add_u32 s39, s39, 16384
    s_and_b32 s39, s39, 0x1ffff
    s_add_u32 s50, s38, 0
    s_add_u32 m0, s39, 0
    s_nop 0
    buffer_load_dwordx4 v1, s[12:15], s50 offen  lds
    s_add_u32 s50, s38, 9216
    s_add_u32 m0, s39, 1024
    s_nop 0
    buffer_load_dwordx4 v2, s[12:15], s50 offen  lds
    s_add_u32 s50, s38, 18432
    s_add_u32 m0, s39, 2048
    s_nop 0
    buffer_load_dwordx4 v1, s[12:15], s50 offen  lds
    s_add_u32 s50, s38, 27648
    s_add_u32 m0, s39, 3072
    s_nop 0
    buffer_load_dwordx4 v2, s[12:15], s50 offen  lds
    s_add_u32 s38, s38, 128
    s_add_u32 s39, s39, 16384
    s_and_b32 s39, s39, 0x1ffff
    s_add_u32 s50, s38, 0
    s_add_u32 m0, s39, 0
    s_nop 0
    buffer_load_dwordx4 v1, s[12:15], s50 offen  lds
    s_add_u32 s50, s38, 9216
    s_add_u32 m0, s39, 1024
    s_nop 0
    buffer_load_dwordx4 v2, s[12:15], s50 offen  lds
    s_add_u32 s50, s38, 18432
    s_add_u32 m0, s39, 2048
    s_nop 0
    buffer_load_dwordx4 v1, s[12:15], s50 offen  lds
    s_add_u32 s50, s38, 27648
    s_add_u32 m0, s39, 3072
    s_nop 0
    buffer_load_dwordx4 v2, s[12:15], s50 offen  lds
    s_add_u32 s38, s38, 128
    s_add_u32 s39, s39, 16384
    s_and_b32 s39, s39, 0x1ffff
    s_add_u32 s50, s38, 0
    s_add_u32 m0, s39, 0
    s_nop 0
    buffer_load_dwordx4 v1, s[12:15], s50 offen  lds
    s_add_u32 s50, s38, 9216
    s_add_u32 m0, s39, 1024
    s_nop 0
    buffer_load_dwordx4 v2, s[12:15], s50 offen  lds
    s_add_u32 s50, s38, 18432
    s_add_u32 m0, s39, 2048
    s_nop 0
    buffer_load_dwordx4 v1, s[12:15], s50 offen  lds
    s_add_u32 s50, s38, 27648
    s_add_u32 m0, s39, 3072
    s_nop 0
    buffer_load_dwordx4 v2, s[12:15], s50 offen  lds
    s_add_u32 s38, s38, 128
    s_add_u32 s39, s39, 16384
    s_and_b32 s39, s39, 0x1ffff
    s_add_u32 s50, s38, 0
    s_add_u32 m0, s39, 0
    s_nop 0
    buffer_load_dwordx4 v1, s[12:15], s50 offen  lds
    s_add_u32 s50, s38, 9216
    s_add_u32 m0, s39, 1024
    s_nop 0
    buffer_load_dwordx4 v2, s[12:15], s50 offen  lds
    s_add_u32 s50, s38, 18432
    s_add_u32 m0, s39, 2048
    s_nop 0
    buffer_load_dwordx4 v1, s[12:15], s50 offen  lds
    s_add_u32 s50, s38, 27648
    s_add_u32 m0, s39, 3072
    s_nop 0
    buffer_load_dwordx4 v2, s[12:15], s50 offen  lds
    s_add_u32 s38, s38, 128
    s_add_u32 s39, s39, 16384
    s_and_b32 s39, s39, 0x1ffff
    s_waitcnt vmcnt(0)
ALN_BLK:
    s_waitcnt vmcnt(28)
    s_barrier
    s_add_u32 s50, s38, 0
    s_add_u32 m0, s39, 0
    s_nop 0
    buffer_load_dwordx4 v1, s[12:15], s50 offen  lds
    s_add_u32 s50, s38, 9216
    s_add_u32 m0, s39, 1024
    s_nop 0
    buffer_load_dwordx4 v2, s[12:15], s50 offen  lds
    s_add_u32 s50, s38, 18432
    s_add_u32 m0, s39, 2048
    s_nop 0
    buffer_load_dwordx4 v1, s[12:15], s50 offen  lds
    s_add_u32 s50, s38, 27648
    s_add_u32 m0, s39, 3072
    s_nop 0
    buffer_load_dwordx4 v2, s[12:15], s50 offen  lds
    s_add_u32 s38, s38, 128
    s_add_u32 s39, s39, 16384
    s_and_b32 s39, s39, 0x1ffff
    v_add_u32 v7, s41, v3
    v_add_u32 v8, s41, v4
    s_add_u32 s41, s41, 16384
    s_and_b32 s41, s41, 0x1ffff
    ds_read_b128 v[80:83], v7 offset:0
    ds_read_b128 v[84:87], v7 offset:2048
    ds_read_b128 v[88:91], v7 offset:4096
    ds_read_b128 v[92:95], v7 offset:6144
    ds_read_b128 v[96:99], v7 offset:8192
    ds_read_b128 v[100:103], v7 offset:10240
    ds_read_b128 v[104:107], v7 offset:12288
    ds_read_b128 v[108:111], v7 offset:14336
    s_waitcnt lgkmcnt(7)
    v_mfma_f32_16x16x32_bf16 v[16:19], v[80:83], a[0:3], 0
    v_mfma_f32_16x16x32_bf16 v[20:23], v[80:83], a[72:75], 0
    ds_read_b128 v[112:115], v8 offset:0
    s_waitcnt lgkmcnt(7)
    v_mfma_f32_16x16x32_bf16 v[24:27], v[84:87], a[0:3], 0
    v_mfma_f32_16x16x32_bf16 v[28:31], v[84:87], a[72:75], 0
    ds_read_b128 v[116:119], v8 offset:2048
    s_waitcnt lgkmcnt(7)
    v_mfma_f32_16x16x32_bf16 v[32:35], v[88:91], a[0:3], 0
    v_mfma_f32_16x16x32_bf16 v[36:39], v[88:91], a[72:75], 0
    ds_read_b128 v[120:123], v8 offset:4096
    s_waitcnt lgkmcnt(7)
    v_mfma_f32_16x16x32_bf16 v[40:43], v[92:95], a[0:3], 0
    v_mfma_f32_16x16x32_bf16 v[44:47], v[92:95], a[72:75], 0
    ds_read_b128 v[124:127], v8 offset:6144
    s_waitcnt lgkmcnt(7)
    v_mfma_f32_16x16x32_bf16 v[48:51], v[96:99], a[0:3], 0
    v_mfma_f32_16x16x32_bf16 v[52:55], v[96:99], a[72:75], 0
    ds_read_b128 v[128:131], v8 offset:8192
    s_waitcnt lgkmcnt(7)
    v_mfma_f32_16x16x32_bf16 v[56:59], v[100:103], a[0:3], 0
    v_mfma_f32_16x16x32_bf16 v[60:63], v[100:103], a[72:75], 0
    ds_read_b128 v[132:135], v8 offset:10240
    s_waitcnt lgkmcnt(7)
    v_mfma_f32_16x16x32_bf16 v[64:67], v[104:107], a[0:3], 0
    v_mfma_f32_16x16x32_bf16 v[68:71], v[104:107], a[72:75], 0
    ds_read_b128 v[136:139], v8 offset:12288
    s_waitcnt lgkmcnt(7)
    v_mfma_f32_16x16x32_bf16 v[72:75], v[108:111], a[0:3], 0
    v_mfma_f32_16x16x32_bf16 v[76:79], v[108:111], a[72:75], 0
    ds_read_b128 v[140:143], v8 offset:14336
    s_waitcnt lgkmcnt(7)
    v_mfma_f32_16x16x32_bf16 v[16:19], v[112:115], a[4:7], v[16:19]
    v_mfma_f32_16x16x32_bf16 v[20:23], v[112:115], a[76:79], v[20:23]
    s_waitcnt lgkmcnt(6)
    v_mfma_f32_16x16x32_bf16 v[24:27], v[116:119], a[4:7], v[24:27]
    v_mfma_f32_16x16x32_bf16 v[28:31], v[116:119], a[76:79], v[28:31]
    s_waitcnt lgkmcnt(5)
    v_mfma_f32_16x16x32_bf16 v[32:35], v[120:123], a[4:7], v[32:35]
    v_mfma_f32_16x16x32_bf16 v[36:39], v[120:123], a[76:79], v[36:39]
    s_waitcnt lgkmcnt(4)
    v_mfma_f32_16x16x32_bf16 v[40:43], v[124:127], a[4:7], v[40:43]
    v_mfma_f32_16x16x32_bf16 v[44:47], v[124:127], a[76:79], v[44:47]
    s_waitcnt lgkmcnt(3)
    v_mfma_f32_16x16x32_bf16 v[48:51], v[128:131], a[4:7], v[48:51]
    v_mfma_f32_16x16x32_bf16 v[52:55], v[128:131], a[76:79], v[52:55]
    s_waitcnt lgkmcnt(2)
    v_mfma_f32_16x16x32_bf16 v[56:59], v[132:135], a[4:7], v[56:59]
    v_mfma_f32_16x16x32_bf16 v[60:63], v[132:135], a[76:79], v[60:63]
    s_waitcnt lgkmcnt(1)
    v_mfma_f32_16x16x32_bf16 v[64:67], v[136:139], a[4:7], v[64:67]
    v_mfma_f32_16x16x32_bf16 v[68:71], v[136:139], a[76:79], v[68:71]
    s_waitcnt lgkmcnt(0)
    v_mfma_f32_16x16x32_bf16 v[72:75], v[140:143], a[4:7], v[72:75]
    v_mfma_f32_16x16x32_bf16 v[76:79], v[140:143], a[76:79], v[76:79]
    s_waitcnt vmcnt(28)
    s_barrier
    s_add_u32 s50, s38, 0
    s_add_u32 m0, s39, 0
    s_nop 0
    buffer_load_dwordx4 v1, s[12:15], s50 offen  lds
    s_add_u32 s50, s38, 9216
    s_add_u32 m0, s39, 1024
    s_nop 0
    buffer_load_dwordx4 v2, s[12:15], s50 offen  lds
    s_add_u32 s50, s38, 18432
    s_add_u32 m0, s39, 2048
    s_nop 0
    buffer_load_dwordx4 v1, s[12:15], s50 offen  lds
    s_add_u32 s50, s38, 27648
    s_add_u32 m0, s39, 3072
    s_nop 0
    buffer_load_dwordx4 v2, s[12:15], s50 offen  lds
    s_add_u32 s38, s38, 128
    s_add_u32 s39, s39, 16384
    s_and_b32 s39, s39, 0x1ffff
    v_add_u32 v7, s41, v3
    v_add_u32 v8, s41, v4
    s_add_u32 s41, s41, 16384
    s_and_b32 s41, s41, 0x1ffff
    ds_read_b128 v[80:83], v7 offset:0
    ds_read_b128 v[84:87], v7 offset:2048
    ds_read_b128 v[88:91], v7 offset:4096
    ds_read_b128 v[92:95], v7 offset:6144
    ds_read_b128 v[96:99], v7 offset:8192
    ds_read_b128 v[100:103], v7 offset:10240
    ds_read_b128 v[104:107], v7 offset:12288
    ds_read_b128 v[108:111], v7 offset:14336
    s_waitcnt lgkmcnt(7)
    v_mfma_f32_16x16x32_bf16 v[16:19], v[80:83], a[8:11], v[16:19]
    v_mfma_f32_16x16x32_bf16 v[20:23], v[80:83], a[80:83], v[20:23]
    ds_read_b128 v[112:115], v8 offset:0
    s_waitcnt lgkmcnt(7)
    v_mfma_f32_16x16x32_bf16 v[24:27], v[84:87], a[8:11], v[24:27]
    v_mfma_f32_16x16x32_bf16 v[28:31], v[84:87], a[80:83], v[28:31]
    ds_read_b128 v[116:119], v8 offset:2048
    s_waitcnt lgkmcnt(7)
    v_mfma_f32_16x16x32_bf16 v[32:35], v[88:91], a[8:11], v[32:35]
    v_mfma_f32_16x16x32_bf16 v[36:39], v[88:91], a[80:83], v[36:39]
    ds_read_b128 v[120:123], v8 offset:4096
    s_waitcnt lgkmcnt(7)
    v_mfma_f32_16x16x32_bf16 v[40:43], v[92:95], a[8:11], v[40:43]
    v_mfma_f32_16x16x32_bf16 v[44:47], v[92:95], a[80:83], v[44:47]
    ds_read_b128 v[124:127], v8 offset:6144
    s_waitcnt lgkmcnt(7)
    v_mfma_f32_16x16x32_bf16 v[48:51], v[96:99], a[8:11], v[48:51]
    v_mfma_f32_16x16x32_bf16 v[52:55], v[96:99], a[80:83], v[52:55]
    ds_read_b128 v[128:131], v8 offset:8192
    s_waitcnt lgkmcnt(7)
    v_mfma_f32_16x16x32_bf16 v[56:59], v[100:103], a[8:11], v[56:59]
    v_mfma_f32_16x16x32_bf16 v[60:63], v[100:103], a[80:83], v[60:63]
    ds_read_b128 v[132:135], v8 offset:10240
    s_waitcnt lgkmcnt(7)
    v_mfma_f32_16x16x32_bf16 v[64:67], v[104:107], a[8:11], v[64:67]
    v_mfma_f32_16x16x32_bf16 v[68:71], v[104:107], a[80:83], v[68:71]
    ds_read_b128 v[136:139], v8 offset:12288
    s_waitcnt lgkmcnt(7)
    v_mfma_f32_16x16x32_bf16 v[72:75], v[108:111], a[8:11], v[72:75]
    v_mfma_f32_16x16x32_bf16 v[76:79], v[108:111], a[80:83], v[76:79]
    ds_read_b128 v[140:143], v8 offset:14336
    s_waitcnt lgkmcnt(7)
    v_mfma_f32_16x16x32_bf16 v[16:19], v[112:115], a[12:15], v[16:19]
    v_mfma_f32_16x16x32_bf16 v[20:23], v[112:115], a[84:87], v[20:23]
    s_waitcnt lgkmcnt(6)
    v_mfma_f32_16x16x32_bf16 v[24:27], v[116:119], a[12:15], v[24:27]
    v_mfma_f32_16x16x32_bf16 v[28:31], v[116:119], a[84:87], v[28:31]
    s_waitcnt lgkmcnt(5)
    v_mfma_f32_16x16x32_bf16 v[32:35], v[120:123], a[12:15], v[32:35]
    v_mfma_f32_16x16x32_bf16 v[36:39], v[120:123], a[84:87], v[36:39]
    s_waitcnt lgkmcnt(4)
    v_mfma_f32_16x16x32_bf16 v[40:43], v[124:127], a[12:15], v[40:43]
    v_mfma_f32_16x16x32_bf16 v[44:47], v[124:127], a[84:87], v[44:47]
    s_waitcnt lgkmcnt(3)
    v_mfma_f32_16x16x32_bf16 v[48:51], v[128:131], a[12:15], v[48:51]
    v_mfma_f32_16x16x32_bf16 v[52:55], v[128:131], a[84:87], v[52:55]
    s_waitcnt lgkmcnt(2)
    v_mfma_f32_16x16x32_bf16 v[56:59], v[132:135], a[12:15], v[56:59]
    v_mfma_f32_16x16x32_bf16 v[60:63], v[132:135], a[84:87], v[60:63]
    s_waitcnt lgkmcnt(1)
    v_mfma_f32_16x16x32_bf16 v[64:67], v[136:139], a[12:15], v[64:67]
    v_mfma_f32_16x16x32_bf16 v[68:71], v[136:139], a[84:87], v[68:71]
    s_waitcnt lgkmcnt(0)
    v_mfma_f32_16x16x32_bf16 v[72:75], v[140:143], a[12:15], v[72:75]
    v_mfma_f32_16x16x32_bf16 v[76:79], v[140:143], a[84:87], v[76:79]
    s_waitcnt vmcnt(28)
    s_barrier
    s_add_u32 s50, s38, 0
    s_add_u32 m0, s39, 0
    s_nop 0
    buffer_load_dwordx4 v1, s[12:15], s50 offen  lds
    s_add_u32 s50, s38, 9216
    s_add_u32 m0, s39, 1024
    s_nop 0
    buffer_load_dwordx4 v2, s[12:15], s50 offen  lds
    s_add_u32 s50, s38, 18432
    s_add_u32 m0, s39, 2048
    s_nop 0
    buffer_load_dwordx4 v1, s[12:15], s50 offen  lds
    s_add_u32 s50, s38, 27648
    s_add_u32 m0, s39, 3072
    s_nop 0
    buffer_load_dwordx4 v2, s[12:15], s50 offen  lds
    s_add_u32 s38, s38, 146432
    s_add_u32 s39, s39, 16384
    s_and_b32 s39, s39, 0x1ffff
    v_add_u32 v7, s41, v3
    v_add_u32 v8, s41, v4
    s_add_u32 s41, s41, 16384
    s_and_b32 s41, s41, 0x1ffff
    ds_read_b128 v[80:83], v7 offset:0
    ds_read_b128 v[84:87], v7 offset:2048
    ds_read_b128 v[88:91], v7 offset:4096
    ds_read_b128 v[92:95], v7 offset:6144
    ds_read_b128 v[96:99], v7 offset:8192
    ds_read_b128 v[100:103], v7 offset:10240
    ds_read_b128 v[104:107], v7 offset:12288
    ds_read_b128 v[108:111], v7 offset:14336
    s_waitcnt lgkmcnt(7)
    v_mfma_f32_16x16x32_bf16 v[16:19], v[80:83], a[16:19], v[16:19]
    v_mfma_f32_16x16x32_bf16 v[20:23], v[80:83], a[88:91], v[20:23]
    ds_read_b128 v[112:115], v8 offset:0
    s_waitcnt lgkmcnt(7)
    v_mfma_f32_16x16x32_bf16 v[24:27], v[84:87], a[16:19], v[24:27]
    v_mfma_f32_16x16x32_bf16 v[28:31], v[84:87], a[88:91], v[28:31]
    ds_read_b128 v[116:119], v8 offset:2048
    s_waitcnt lgkmcnt(7)
    v_mfma_f32_16x16x32_bf16 v[32:35], v[88:91], a[16:19], v[32:35]
    v_mfma_f32_16x16x32_bf16 v[36:39], v[88:91], a[88:91], v[36:39]
    ds_read_b128 v[120:123], v8 offset:4096
    s_waitcnt lgkmcnt(7)
    v_mfma_f32_16x16x32_bf16 v[40:43], v[92:95], a[16:19], v[40:43]
    v_mfma_f32_16x16x32_bf16 v[44:47], v[92:95], a[88:91], v[44:47]
    ds_read_b128 v[124:127], v8 offset:6144
    s_waitcnt lgkmcnt(7)
    v_mfma_f32_16x16x32_bf16 v[48:51], v[96:99], a[16:19], v[48:51]
    v_mfma_f32_16x16x32_bf16 v[52:55], v[96:99], a[88:91], v[52:55]
    ds_read_b128 v[128:131], v8 offset:8192
    s_waitcnt lgkmcnt(7)
    v_mfma_f32_16x16x32_bf16 v[56:59], v[100:103], a[16:19], v[56:59]
    v_mfma_f32_16x16x32_bf16 v[60:63], v[100:103], a[88:91], v[60:63]
    ds_read_b128 v[132:135], v8 offset:10240
    s_waitcnt lgkmcnt(7)
    v_mfma_f32_16x16x32_bf16 v[64:67], v[104:107], a[16:19], v[64:67]
    v_mfma_f32_16x16x32_bf16 v[68:71], v[104:107], a[88:91], v[68:71]
    ds_read_b128 v[136:139], v8 offset:12288
    s_waitcnt lgkmcnt(7)
    v_mfma_f32_16x16x32_bf16 v[72:75], v[108:111], a[16:19], v[72:75]
    v_mfma_f32_16x16x32_bf16 v[76:79], v[108:111], a[88:91], v[76:79]
    ds_read_b128 v[140:143], v8 offset:14336
    s_waitcnt lgkmcnt(7)
    v_mfma_f32_16x16x32_bf16 v[16:19], v[112:115], a[20:23], v[16:19]
    v_mfma_f32_16x16x32_bf16 v[20:23], v[112:115], a[92:95], v[20:23]
    s_waitcnt lgkmcnt(6)
    v_mfma_f32_16x16x32_bf16 v[24:27], v[116:119], a[20:23], v[24:27]
    v_mfma_f32_16x16x32_bf16 v[28:31], v[116:119], a[92:95], v[28:31]
    s_waitcnt lgkmcnt(5)
    v_mfma_f32_16x16x32_bf16 v[32:35], v[120:123], a[20:23], v[32:35]
    v_mfma_f32_16x16x32_bf16 v[36:39], v[120:123], a[92:95], v[36:39]
    s_waitcnt lgkmcnt(4)
    v_mfma_f32_16x16x32_bf16 v[40:43], v[124:127], a[20:23], v[40:43]
    v_mfma_f32_16x16x32_bf16 v[44:47], v[124:127], a[92:95], v[44:47]
    s_waitcnt lgkmcnt(3)
    v_mfma_f32_16x16x32_bf16 v[48:51], v[128:131], a[20:23], v[48:51]
    v_mfma_f32_16x16x32_bf16 v[52:55], v[128:131], a[92:95], v[52:55]
    s_waitcnt lgkmcnt(2)
    v_mfma_f32_16x16x32_bf16 v[56:59], v[132:135], a[20:23], v[56:59]
    v_mfma_f32_16x16x32_bf16 v[60:63], v[132:135], a[92:95], v[60:63]
    s_waitcnt lgkmcnt(1)
    v_mfma_f32_16x16x32_bf16 v[64:67], v[136:139], a[20:23], v[64:67]
    v_mfma_f32_16x16x32_bf16 v[68:71], v[136:139], a[92:95], v[68:71]
    s_waitcnt lgkmcnt(0)
    v_mfma_f32_16x16x32_bf16 v[72:75], v[140:143], a[20:23], v[72:75]
    v_mfma_f32_16x16x32_bf16 v[76:79], v[140:143], a[92:95], v[76:79]
    s_waitcnt vmcnt(28)
    s_barrier
    s_add_u32 s50, s38, 0
    s_add_u32 m0, s39, 0
    s_nop 0
    buffer_load_dwordx4 v1, s[12:15], s50 offen  lds
    s_add_u32 s50, s38, 9216
    s_add_u32 m0, s39, 1024
    s_nop 0
    buffer_load_dwordx4 v2, s[12:15], s50 offen  lds
    s_add_u32 s50, s38, 18432
    s_add_u32 m0, s39, 2048
    s_nop 0
    buffer_load_dwordx4 v1, s[12:15], s50 offen  lds
    s_add_u32 s50, s38, 27648
    s_add_u32 m0, s39, 3072
    s_nop 0
    buffer_load_dwordx4 v2, s[12:15], s50 offen  lds
    s_add_u32 s38, s38, 128
    s_add_u32 s39, s39, 16384
    s_and_b32 s39, s39, 0x1ffff
    v_add_u32 v7, s41, v3
    v_add_u32 v8, s41, v4
    s_add_u32 s41, s41, 16384
    s_and_b32 s41, s41, 0x1ffff
    ds_read_b128 v[80:83], v7 offset:0
    ds_read_b128 v[84:87], v7 offset:2048
    ds_read_b128 v[88:91], v7 offset:4096
    ds_read_b128 v[92:95], v7 offset:6144
    ds_read_b128 v[96:99], v7 offset:8192
    ds_read_b128 v[100:103], v7 offset:10240
    ds_read_b128 v[104:107], v7 offset:12288
    ds_read_b128 v[108:111], v7 offset:14336
    s_waitcnt lgkmcnt(7)
    v_mfma_f32_16x16x32_bf16 v[16:19], v[80:83], a[24:27], v[16:19]
    v_mfma_f32_16x16x32_bf16 v[20:23], v[80:83], a[96:99], v[20:23]
    ds_read_b128 v[112:115], v8 offset:0
    s_waitcnt lgkmcnt(7)
    v_mfma_f32_16x16x32_bf16 v[24:27], v[84:87], a[24:27], v[24:27]
    v_mfma_f32_16x16x32_bf16 v[28:31], v[84:87], a[96:99], v[28:31]
    ds_read_b128 v[116:119], v8 offset:2048
    s_waitcnt lgkmcnt(7)
    v_mfma_f32_16x16x32_bf16 v[32:35], v[88:91], a[24:27], v[32:35]
    v_mfma_f32_16x16x32_bf16 v[36:39], v[88:91], a[96:99], v[36:39]
    ds_read_b128 v[120:123], v8 offset:4096
    s_waitcnt lgkmcnt(7)
    v_mfma_f32_16x16x32_bf16 v[40:43], v[92:95], a[24:27], v[40:43]
    v_mfma_f32_16x16x32_bf16 v[44:47], v[92:95], a[96:99], v[44:47]
    ds_read_b128 v[124:127], v8 offset:6144
    s_waitcnt lgkmcnt(7)
    v_mfma_f32_16x16x32_bf16 v[48:51], v[96:99], a[24:27], v[48:51]
    v_mfma_f32_16x16x32_bf16 v[52:55], v[96:99], a[96:99], v[52:55]
    ds_read_b128 v[128:131], v8 offset:8192
    s_waitcnt lgkmcnt(7)
    v_mfma_f32_16x16x32_bf16 v[56:59], v[100:103], a[24:27], v[56:59]
    v_mfma_f32_16x16x32_bf16 v[60:63], v[100:103], a[96:99], v[60:63]
    ds_read_b128 v[132:135], v8 offset:10240
    s_waitcnt lgkmcnt(7)
    v_mfma_f32_16x16x32_bf16 v[64:67], v[104:107], a[24:27], v[64:67]
    v_mfma_f32_16x16x32_bf16 v[68:71], v[104:107], a[96:99], v[68:71]
    ds_read_b128 v[136:139], v8 offset:12288
    s_waitcnt lgkmcnt(7)
    v_mfma_f32_16x16x32_bf16 v[72:75], v[108:111], a[24:27], v[72:75]
    v_mfma_f32_16x16x32_bf16 v[76:79], v[108:111], a[96:99], v[76:79]
    ds_read_b128 v[140:143], v8 offset:14336
    s_waitcnt lgkmcnt(7)
    v_mfma_f32_16x16x32_bf16 v[16:19], v[112:115], a[28:31], v[16:19]
    v_mfma_f32_16x16x32_bf16 v[20:23], v[112:115], a[100:103], v[20:23]
    s_waitcnt lgkmcnt(6)
    v_mfma_f32_16x16x32_bf16 v[24:27], v[116:119], a[28:31], v[24:27]
    v_mfma_f32_16x16x32_bf16 v[28:31], v[116:119], a[100:103], v[28:31]
    s_waitcnt lgkmcnt(5)
    v_mfma_f32_16x16x32_bf16 v[32:35], v[120:123], a[28:31], v[32:35]
    v_mfma_f32_16x16x32_bf16 v[36:39], v[120:123], a[100:103], v[36:39]
    s_waitcnt lgkmcnt(4)
    v_mfma_f32_16x16x32_bf16 v[40:43], v[124:127], a[28:31], v[40:43]
    v_mfma_f32_16x16x32_bf16 v[44:47], v[124:127], a[100:103], v[44:47]
    s_waitcnt lgkmcnt(3)
    v_mfma_f32_16x16x32_bf16 v[48:51], v[128:131], a[28:31], v[48:51]
    v_mfma_f32_16x16x32_bf16 v[52:55], v[128:131], a[100:103], v[52:55]
    s_waitcnt lgkmcnt(2)
    v_mfma_f32_16x16x32_bf16 v[56:59], v[132:135], a[28:31], v[56:59]
    v_mfma_f32_16x16x32_bf16 v[60:63], v[132:135], a[100:103], v[60:63]
    s_waitcnt lgkmcnt(1)
    v_mfma_f32_16x16x32_bf16 v[64:67], v[136:139], a[28:31], v[64:67]
    v_mfma_f32_16x16x32_bf16 v[68:71], v[136:139], a[100:103], v[68:71]
    s_waitcnt lgkmcnt(0)
    v_mfma_f32_16x16x32_bf16 v[72:75], v[140:143], a[28:31], v[72:75]
    v_mfma_f32_16x16x32_bf16 v[76:79], v[140:143], a[100:103], v[76:79]
    s_waitcnt vmcnt(28)
    s_barrier
    s_add_u32 s50, s38, 0
    s_add_u32 m0, s39, 0
    s_nop 0
    buffer_load_dwordx4 v1, s[12:15], s50 offen  lds
    s_add_u32 s50, s38, 9216
    s_add_u32 m0, s39, 1024
    s_nop 0
    buffer_load_dwordx4 v2, s[12:15], s50 offen  lds
    s_add_u32 s50, s38, 18432
    s_add_u32 m0, s39, 2048
    s_nop 0
    buffer_load_dwordx4 v1, s[12:15], s50 offen  lds
    s_add_u32 s50, s38, 27648
    s_add_u32 m0, s39, 3072
    s_nop 0
    buffer_load_dwordx4 v2, s[12:15], s50 offen  lds
    s_add_u32 s38, s38, 128
    s_add_u32 s39, s39, 16384
    s_and_b32 s39, s39, 0x1ffff
    v_add_u32 v7, s41, v3
    v_add_u32 v8, s41, v4
    s_add_u32 s41, s41, 16384
    s_and_b32 s41, s41, 0x1ffff
    ds_read_b128 v[80:83], v7 offset:0
    ds_read_b128 v[84:87], v7 offset:2048
    ds_read_b128 v[88:91], v7 offset:4096
    ds_read_b128 v[92:95], v7 offset:6144
    ds_read_b128 v[96:99], v7 offset:8192
    ds_read_b128 v[100:103], v7 offset:10240
    ds_read_b128 v[104:107], v7 offset:12288
    ds_read_b128 v[108:111], v7 offset:14336
    s_waitcnt lgkmcnt(7)
    v_mfma_f32_16x16x32_bf16 v[16:19], v[80:83], a[32:35], v[16:19]
    v_mfma_f32_16x16x32_bf16 v[20:23], v[80:83], a[104:107], v[20:23]
    ds_read_b128 v[112:115], v8 offset:0
    s_waitcnt lgkmcnt(7)
    v_mfma_f32_16x16x32_bf16 v[24:27], v[84:87], a[32:35], v[24:27]
    v_mfma_f32_16x16x32_bf16 v[28:31], v[84:87], a[104:107], v[28:31]
    ds_read_b128 v[116:119], v8 offset:2048
    s_waitcnt lgkmcnt(7)
    v_mfma_f32_16x16x32_bf16 v[32:35], v[88:91], a[32:35], v[32:35]
    v_mfma_f32_16x16x32_bf16 v[36:39], v[88:91], a[104:107], v[36:39]
    ds_read_b128 v[120:123], v8 offset:4096
    s_waitcnt lgkmcnt(7)
    v_mfma_f32_16x16x32_bf16 v[40:43], v[92:95], a[32:35], v[40:43]
    v_mfma_f32_16x16x32_bf16 v[44:47], v[92:95], a[104:107], v[44:47]
    ds_read_b128 v[124:127], v8 offset:6144
    s_waitcnt lgkmcnt(7)
    v_mfma_f32_16x16x32_bf16 v[48:51], v[96:99], a[32:35], v[48:51]
    v_mfma_f32_16x16x32_bf16 v[52:55], v[96:99], a[104:107], v[52:55]
    ds_read_b128 v[128:131], v8 offset:8192
    s_waitcnt lgkmcnt(7)
    v_mfma_f32_16x16x32_bf16 v[56:59], v[100:103], a[32:35], v[56:59]
    v_mfma_f32_16x16x32_bf16 v[60:63], v[100:103], a[104:107], v[60:63]
    ds_read_b128 v[132:135], v8 offset:10240
    s_waitcnt lgkmcnt(7)
    v_mfma_f32_16x16x32_bf16 v[64:67], v[104:107], a[32:35], v[64:67]
    v_mfma_f32_16x16x32_bf16 v[68:71], v[104:107], a[104:107], v[68:71]
    ds_read_b128 v[136:139], v8 offset:12288
    s_waitcnt lgkmcnt(7)
    v_mfma_f32_16x16x32_bf16 v[72:75], v[108:111], a[32:35], v[72:75]
    v_mfma_f32_16x16x32_bf16 v[76:79], v[108:111], a[104:107], v[76:79]
    ds_read_b128 v[140:143], v8 offset:14336
    s_waitcnt lgkmcnt(7)
    v_mfma_f32_16x16x32_bf16 v[16:19], v[112:115], a[36:39], v[16:19]
    v_mfma_f32_16x16x32_bf16 v[20:23], v[112:115], a[108:111], v[20:23]
    s_waitcnt lgkmcnt(6)
    v_mfma_f32_16x16x32_bf16 v[24:27], v[116:119], a[36:39], v[24:27]
    v_mfma_f32_16x16x32_bf16 v[28:31], v[116:119], a[108:111], v[28:31]
    s_waitcnt lgkmcnt(5)
    v_mfma_f32_16x16x32_bf16 v[32:35], v[120:123], a[36:39], v[32:35]
    v_mfma_f32_16x16x32_bf16 v[36:39], v[120:123], a[108:111], v[36:39]
    s_waitcnt lgkmcnt(4)
    v_mfma_f32_16x16x32_bf16 v[40:43], v[124:127], a[36:39], v[40:43]
    v_mfma_f32_16x16x32_bf16 v[44:47], v[124:127], a[108:111], v[44:47]
    s_waitcnt lgkmcnt(3)
    v_mfma_f32_16x16x32_bf16 v[48:51], v[128:131], a[36:39], v[48:51]
    v_mfma_f32_16x16x32_bf16 v[52:55], v[128:131], a[108:111], v[52:55]
    s_waitcnt lgkmcnt(2)
    v_mfma_f32_16x16x32_bf16 v[56:59], v[132:135], a[36:39], v[56:59]
    v_mfma_f32_16x16x32_bf16 v[60:63], v[132:135], a[108:111], v[60:63]
    s_waitcnt lgkmcnt(1)
    v_mfma_f32_16x16x32_bf16 v[64:67], v[136:139], a[36:39], v[64:67]
    v_mfma_f32_16x16x32_bf16 v[68:71], v[136:139], a[108:111], v[68:71]
    s_waitcnt lgkmcnt(0)
    v_mfma_f32_16x16x32_bf16 v[72:75], v[140:143], a[36:39], v[72:75]
    v_mfma_f32_16x16x32_bf16 v[76:79], v[140:143], a[108:111], v[76:79]
    s_waitcnt vmcnt(28)
    s_barrier
    s_add_u32 s50, s38, 0
    s_add_u32 m0, s39, 0
    s_nop 0
    buffer_load_dwordx4 v1, s[12:15], s50 offen  lds
    s_add_u32 s50, s38, 9216
    s_add_u32 m0, s39, 1024
    s_nop 0
    buffer_load_dwordx4 v2, s[12:15], s50 offen  lds
    s_add_u32 s50, s38, 18432
    s_add_u32 m0, s39, 2048
    s_nop 0
    buffer_load_dwordx4 v1, s[12:15], s50 offen  lds
    s_add_u32 s50, s38, 27648
    s_add_u32 m0, s39, 3072
    s_nop 0
    buffer_load_dwordx4 v2, s[12:15], s50 offen  lds
    s_add_u32 s38, s38, 128
    s_add_u32 s39, s39, 16384
    s_and_b32 s39, s39, 0x1ffff
    v_add_u32 v7, s41, v3
    v_add_u32 v8, s41, v4
    s_add_u32 s41, s41, 16384
    s_and_b32 s41, s41, 0x1ffff
    ds_read_b128 v[80:83], v7 offset:0
    ds_read_b128 v[84:87], v7 offset:2048
    ds_read_b128 v[88:91], v7 offset:4096
    ds_read_b128 v[92:95], v7 offset:6144
    ds_read_b128 v[96:99], v7 offset:8192
    ds_read_b128 v[100:103], v7 offset:10240
    ds_read_b128 v[104:107], v7 offset:12288
    ds_read_b128 v[108:111], v7 offset:14336
    s_waitcnt lgkmcnt(7)
    v_mfma_f32_16x16x32_bf16 v[16:19], v[80:83], a[40:43], v[16:19]
    v_mfma_f32_16x16x32_bf16 v[20:23], v[80:83], a[112:115], v[20:23]
    ds_read_b128 v[112:115], v8 offset:0
    s_waitcnt lgkmcnt(7)
    v_mfma_f32_16x16x32_bf16 v[24:27], v[84:87], a[40:43], v[24:27]
    v_mfma_f32_16x16x32_bf16 v[28:31], v[84:87], a[112:115], v[28:31]
    ds_read_b128 v[116:119], v8 offset:2048
    s_waitcnt lgkmcnt(7)
    v_mfma_f32_16x16x32_bf16 v[32:35], v[88:91], a[40:43], v[32:35]
    v_mfma_f32_16x16x32_bf16 v[36:39], v[88:91], a[112:115], v[36:39]
    ds_read_b128 v[120:123], v8 offset:4096
    s_waitcnt lgkmcnt(7)
    v_mfma_f32_16x16x32_bf16 v[40:43], v[92:95], a[40:43], v[40:43]
    v_mfma_f32_16x16x32_bf16 v[44:47], v[92:95], a[112:115], v[44:47]
    ds_read_b128 v[124:127], v8 offset:6144
    s_waitcnt lgkmcnt(7)
    v_mfma_f32_16x16x32_bf16 v[48:51], v[96:99], a[40:43], v[48:51]
    v_mfma_f32_16x16x32_bf16 v[52:55], v[96:99], a[112:115], v[52:55]
    ds_read_b128 v[128:131], v8 offset:8192
    s_waitcnt lgkmcnt(7)
    v_mfma_f32_16x16x32_bf16 v[56:59], v[100:103], a[40:43], v[56:59]
    v_mfma_f32_16x16x32_bf16 v[60:63], v[100:103], a[112:115], v[60:63]
    ds_read_b128 v[132:135], v8 offset:10240
    s_waitcnt lgkmcnt(7)
    v_mfma_f32_16x16x32_bf16 v[64:67], v[104:107], a[40:43], v[64:67]
    v_mfma_f32_16x16x32_bf16 v[68:71], v[104:107], a[112:115], v[68:71]
    ds_read_b128 v[136:139], v8 offset:12288
    s_waitcnt lgkmcnt(7)
    v_mfma_f32_16x16x32_bf16 v[72:75], v[108:111], a[40:43], v[72:75]
    v_mfma_f32_16x16x32_bf16 v[76:79], v[108:111], a[112:115], v[76:79]
    ds_read_b128 v[140:143], v8 offset:14336
    s_waitcnt lgkmcnt(7)
    v_mfma_f32_16x16x32_bf16 v[16:19], v[112:115], a[44:47], v[16:19]
    v_mfma_f32_16x16x32_bf16 v[20:23], v[112:115], a[116:119], v[20:23]
    s_waitcnt lgkmcnt(6)
    v_mfma_f32_16x16x32_bf16 v[24:27], v[116:119], a[44:47], v[24:27]
    v_mfma_f32_16x16x32_bf16 v[28:31], v[116:119], a[116:119], v[28:31]
    s_waitcnt lgkmcnt(5)
    v_mfma_f32_16x16x32_bf16 v[32:35], v[120:123], a[44:47], v[32:35]
    v_mfma_f32_16x16x32_bf16 v[36:39], v[120:123], a[116:119], v[36:39]
    s_waitcnt lgkmcnt(4)
    v_mfma_f32_16x16x32_bf16 v[40:43], v[124:127], a[44:47], v[40:43]
    v_mfma_f32_16x16x32_bf16 v[44:47], v[124:127], a[116:119], v[44:47]
    s_waitcnt lgkmcnt(3)
    v_mfma_f32_16x16x32_bf16 v[48:51], v[128:131], a[44:47], v[48:51]
    v_mfma_f32_16x16x32_bf16 v[52:55], v[128:131], a[116:119], v[52:55]
    s_waitcnt lgkmcnt(2)
    v_mfma_f32_16x16x32_bf16 v[56:59], v[132:135], a[44:47], v[56:59]
    v_mfma_f32_16x16x32_bf16 v[60:63], v[132:135], a[116:119], v[60:63]
    s_waitcnt lgkmcnt(1)
    v_mfma_f32_16x16x32_bf16 v[64:67], v[136:139], a[44:47], v[64:67]
    v_mfma_f32_16x16x32_bf16 v[68:71], v[136:139], a[116:119], v[68:71]
    s_waitcnt lgkmcnt(0)
    v_mfma_f32_16x16x32_bf16 v[72:75], v[140:143], a[44:47], v[72:75]
    v_mfma_f32_16x16x32_bf16 v[76:79], v[140:143], a[116:119], v[76:79]
    s_waitcnt vmcnt(20)
    s_barrier
    s_cmp_eq_u32 s65, 0
    s_mov_b32 s65, 1
    s_cbranch_scc1 AL_fl3
    s_cmp_eq_u32 s31, 0
    s_cbranch_scc0 AL_fl3a
    v_mov_b32 v13, s63
    v_mov_b32 v14, s64
    s_mov_b64 exec, 1
    global_atomic_add v13, v14, s[90:91]
    s_mov_b64 exec, -1
AL_fl3a:
AL_fl3:
    s_add_u32 s50, s38, 0
    s_add_u32 m0, s39, 0
    s_nop 0
    buffer_load_dwordx4 v1, s[12:15], s50 offen  lds
    s_add_u32 s50, s38, 9216
    s_add_u32 m0, s39, 1024
    s_nop 0
    buffer_load_dwordx4 v2, s[12:15], s50 offen  lds
    s_add_u32 s50, s38, 18432
    s_add_u32 m0, s39, 2048
    s_nop 0
    buffer_load_dwordx4 v1, s[12:15], s50 offen  lds
    s_add_u32 s50, s38, 27648
    s_add_u32 m0, s39, 3072
    s_nop 0
    buffer_load_dwordx4 v2, s[12:15], s50 offen  lds
    s_add_u32 s38, s38, 128
    s_add_u32 s39, s39, 16384
    s_and_b32 s39, s39, 0x1ffff
    v_add_u32 v7, s41, v3
    v_add_u32 v8, s41, v4
    s_add_u32 s41, s41, 16384
    s_and_b32 s41, s41, 0x1ffff
    ds_read_b128 v[80:83], v7 offset:0
    ds_read_b128 v[84:87], v7 offset:2048
    ds_read_b128 v[88:91], v7 offset:4096
    ds_read_b128 v[92:95], v7 offset:6144
    ds_read_b128 v[96:99], v7 offset:8192
    ds_read_b128 v[100:103], v7 offset:10240
    ds_read_b128 v[104:107], v7 offset:12288
    ds_read_b128 v[108:111], v7 offset:14336
    s_waitcnt lgkmcnt(7)
    v_mfma_f32_16x16x32_bf16 v[16:19], v[80:83], a[48:51], v[16:19]
    v_mfma_f32_16x16x32_bf16 v[20:23], v[80:83], a[120:123], v[20:23]
    ds_read_b128 v[112:115], v8 offset:0
    s_waitcnt lgkmcnt(7)
    v_mfma_f32_16x16x32_bf16 v[24:27], v[84:87], a[48:51], v[24:27]
    v_mfma_f32_16x16x32_bf16 v[28:31], v[84:87], a[120:123], v[28:31]
    ds_read_b128 v[116:119], v8 offset:2048
    s_waitcnt lgkmcnt(7)
    v_mfma_f32_16x16x32_bf16 v[32:35], v[88:91], a[48:51], v[32:35]
    v_mfma_f32_16x16x32_bf16 v[36:39], v[88:91], a[120:123], v[36:39]
    ds_read_b128 v[120:123], v8 offset:4096
    s_waitcnt lgkmcnt(7)
    v_mfma_f32_16x16x32_bf16 v[40:43], v[92:95], a[48:51], v[40:43]
    v_mfma_f32_16x16x32_bf16 v[44:47], v[92:95], a[120:123], v[44:47]
    ds_read_b128 v[124:127], v8 offset:6144
    s_waitcnt lgkmcnt(7)
    v_mfma_f32_16x16x32_bf16 v[48:51], v[96:99], a[48:51], v[48:51]
    v_mfma_f32_16x16x32_bf16 v[52:55], v[96:99], a[120:123], v[52:55]
    ds_read_b128 v[128:131], v8 offset:8192
    s_waitcnt lgkmcnt(7)
    v_mfma_f32_16x16x32_bf16 v[56:59], v[100:103], a[48:51], v[56:59]
    v_mfma_f32_16x16x32_bf16 v[60:63], v[100:103], a[120:123], v[60:63]
    ds_read_b128 v[132:135], v8 offset:10240
    s_waitcnt lgkmcnt(7)
    v_mfma_f32_16x16x32_bf16 v[64:67], v[104:107], a[48:51], v[64:67]
    v_mfma_f32_16x16x32_bf16 v[68:71], v[104:107], a[120:123], v[68:71]
    ds_read_b128 v[136:139], v8 offset:12288
    s_waitcnt lgkmcnt(7)
    v_mfma_f32_16x16x32_bf16 v[72:75], v[108:111], a[48:51], v[72:75]
    v_mfma_f32_16x16x32_bf16 v[76:79], v[108:111], a[120:123], v[76:79]
    ds_read_b128 v[140:143], v8 offset:14336
    s_waitcnt lgkmcnt(7)
    v_mfma_f32_16x16x32_bf16 v[16:19], v[112:115], a[52:55], v[16:19]
    v_mfma_f32_16x16x32_bf16 v[20:23], v[112:115], a[124:127], v[20:23]
    s_waitcnt lgkmcnt(6)
    v_mfma_f32_16x16x32_bf16 v[24:27], v[116:119], a[52:55], v[24:27]
    v_mfma_f32_16x16x32_bf16 v[28:31], v[116:119], a[124:127], v[28:31]
    s_waitcnt lgkmcnt(5)
    v_mfma_f32_16x16x32_bf16 v[32:35], v[120:123], a[52:55], v[32:35]
    v_mfma_f32_16x16x32_bf16 v[36:39], v[120:123], a[124:127], v[36:39]
    s_waitcnt lgkmcnt(4)
    v_mfma_f32_16x16x32_bf16 v[40:43], v[124:127], a[52:55], v[40:43]
    v_mfma_f32_16x16x32_bf16 v[44:47], v[124:127], a[124:127], v[44:47]
    s_waitcnt lgkmcnt(3)
    v_mfma_f32_16x16x32_bf16 v[48:51], v[128:131], a[52:55], v[48:51]
    v_mfma_f32_16x16x32_bf16 v[52:55], v[128:131], a[124:127], v[52:55]
    s_waitcnt lgkmcnt(2)
    v_mfma_f32_16x16x32_bf16 v[56:59], v[132:135], a[52:55], v[56:59]
    v_mfma_f32_16x16x32_bf16 v[60:63], v[132:135], a[124:127], v[60:63]
    s_waitcnt lgkmcnt(1)
    v_mfma_f32_16x16x32_bf16 v[64:67], v[136:139], a[52:55], v[64:67]
    v_mfma_f32_16x16x32_bf16 v[68:71], v[136:139], a[124:127], v[68:71]
    s_waitcnt lgkmcnt(0)
    v_mfma_f32_16x16x32_bf16 v[72:75], v[140:143], a[52:55], v[72:75]
    v_mfma_f32_16x16x32_bf16 v[76:79], v[140:143], a[124:127], v[76:79]
    s_waitcnt vmcnt(20)
    s_barrier
    s_add_u32 s50, s38, 0
    s_add_u32 m0, s39, 0
    s_nop 0
    buffer_load_dwordx4 v1, s[12:15], s50 offen  lds
    s_add_u32 s50, s38, 9216
    s_add_u32 m0, s39, 1024
    s_nop 0
    buffer_load_dwordx4 v2, s[12:15], s50 offen  lds
    s_add_u32 s50, s38, 18432
    s_add_u32 m0, s39, 2048
    s_nop 0
    buffer_load_dwordx4 v1, s[12:15], s50 offen  lds
    s_add_u32 s50, s38, 27648
    s_add_u32 m0, s39, 3072
    s_nop 0
    buffer_load_dwordx4 v2, s[12:15], s50 offen  lds
    s_add_u32 s38, s38, 128
    s_add_u32 s39, s39, 16384
    s_and_b32 s39, s39, 0x1ffff
    v_add_u32 v7, s41, v3
    v_add_u32 v8, s41, v4
    s_add_u32 s41, s41, 16384
    s_and_b32 s41, s41, 0x1ffff
    ds_read_b128 v[80:83], v7 offset:0
    ds_read_b128 v[84:87], v7 offset:2048
    ds_read_b128 v[88:91], v7 offset:4096
    ds_read_b128 v[92:95], v7 offset:6144
    ds_read_b128 v[96:99], v7 offset:8192
    ds_read_b128 v[100:103], v7 offset:10240
    ds_read_b128 v[104:107], v7 offset:12288
    ds_read_b128 v[108:111], v7 offset:14336
    s_waitcnt lgkmcnt(7)
    v_mfma_f32_16x16x32_bf16 v[16:19], v[80:83], a[56:59], v[16:19]
    v_mfma_f32_16x16x32_bf16 v[20:23], v[80:83], a[128:131], v[20:23]
    ds_read_b128 v[112:115], v8 offset:0
    s_waitcnt lgkmcnt(7)
    v_mfma_f32_16x16x32_bf16 v[24:27], v[84:87], a[56:59], v[24:27]
    v_mfma_f32_16x16x32_bf16 v[28:31], v[84:87], a[128:131], v[28:31]
    ds_read_b128 v[116:119], v8 offset:2048
    s_waitcnt lgkmcnt(7)
    v_mfma_f32_16x16x32_bf16 v[32:35], v[88:91], a[56:59], v[32:35]
    v_mfma_f32_16x16x32_bf16 v[36:39], v[88:91], a[128:131], v[36:39]
    ds_read_b128 v[120:123], v8 offset:4096
    s_waitcnt lgkmcnt(7)
    v_mfma_f32_16x16x32_bf16 v[40:43], v[92:95], a[56:59], v[40:43]
    v_mfma_f32_16x16x32_bf16 v[44:47], v[92:95], a[128:131], v[44:47]
    ds_read_b128 v[124:127], v8 offset:6144
    s_waitcnt lgkmcnt(7)
    v_mfma_f32_16x16x32_bf16 v[48:51], v[96:99], a[56:59], v[48:51]
    v_mfma_f32_16x16x32_bf16 v[52:55], v[96:99], a[128:131], v[52:55]
    ds_read_b128 v[128:131], v8 offset:8192
    s_waitcnt lgkmcnt(7)
    v_mfma_f32_16x16x32_bf16 v[56:59], v[100:103], a[56:59], v[56:59]
    v_mfma_f32_16x16x32_bf16 v[60:63], v[100:103], a[128:131], v[60:63]
    ds_read_b128 v[132:135], v8 offset:10240
    s_waitcnt lgkmcnt(7)
    v_mfma_f32_16x16x32_bf16 v[64:67], v[104:107], a[56:59], v[64:67]
    v_mfma_f32_16x16x32_bf16 v[68:71], v[104:107], a[128:131], v[68:71]
    ds_read_b128 v[136:139], v8 offset:12288
    s_waitcnt lgkmcnt(7)
    v_mfma_f32_16x16x32_bf16 v[72:75], v[108:111], a[56:59], v[72:75]
    v_mfma_f32_16x16x32_bf16 v[76:79], v[108:111], a[128:131], v[76:79]
    ds_read_b128 v[140:143], v8 offset:14336
    s_waitcnt lgkmcnt(7)
    v_mfma_f32_16x16x32_bf16 v[16:19], v[112:115], a[60:63], v[16:19]
    v_mfma_f32_16x16x32_bf16 v[20:23], v[112:115], a[132:135], v[20:23]
    s_waitcnt lgkmcnt(6)
    v_mfma_f32_16x16x32_bf16 v[24:27], v[116:119], a[60:63], v[24:27]
    v_mfma_f32_16x16x32_bf16 v[28:31], v[116:119], a[132:135], v[28:31]
    s_waitcnt lgkmcnt(5)
    v_mfma_f32_16x16x32_bf16 v[32:35], v[120:123], a[60:63], v[32:35]
    v_mfma_f32_16x16x32_bf16 v[36:39], v[120:123], a[132:135], v[36:39]
    s_waitcnt lgkmcnt(4)
    v_mfma_f32_16x16x32_bf16 v[40:43], v[124:127], a[60:63], v[40:43]
    v_mfma_f32_16x16x32_bf16 v[44:47], v[124:127], a[132:135], v[44:47]
    s_waitcnt lgkmcnt(3)
    v_mfma_f32_16x16x32_bf16 v[48:51], v[128:131], a[60:63], v[48:51]
    v_mfma_f32_16x16x32_bf16 v[52:55], v[128:131], a[132:135], v[52:55]
    s_waitcnt lgkmcnt(2)
    v_mfma_f32_16x16x32_bf16 v[56:59], v[132:135], a[60:63], v[56:59]
    v_mfma_f32_16x16x32_bf16 v[60:63], v[132:135], a[132:135], v[60:63]
    s_waitcnt lgkmcnt(1)
    v_mfma_f32_16x16x32_bf16 v[64:67], v[136:139], a[60:63], v[64:67]
    v_mfma_f32_16x16x32_bf16 v[68:71], v[136:139], a[132:135], v[68:71]
    s_waitcnt lgkmcnt(0)
    v_mfma_f32_16x16x32_bf16 v[72:75], v[140:143], a[60:63], v[72:75]
    v_mfma_f32_16x16x32_bf16 v[76:79], v[140:143], a[132:135], v[76:79]
    s_waitcnt vmcnt(20)
    s_barrier
    s_add_u32 s50, s38, 0
    s_add_u32 m0, s39, 0
    s_nop 0
    buffer_load_dwordx4 v1, s[12:15], s50 offen  lds
    s_add_u32 s50, s38, 9216
    s_add_u32 m0, s39, 1024
    s_nop 0
    buffer_load_dwordx4 v2, s[12:15], s50 offen  lds
    s_add_u32 s50, s38, 18432
    s_add_u32 m0, s39, 2048
    s_nop 0
    buffer_load_dwordx4 v1, s[12:15], s50 offen  lds
    s_add_u32 s50, s38, 27648
    s_add_u32 m0, s39, 3072
    s_nop 0
    buffer_load_dwordx4 v2, s[12:15], s50 offen  lds
    s_add_u32 s38, s38, 128
    s_add_u32 s39, s39, 16384
    s_and_b32 s39, s39, 0x1ffff
    v_add_u32 v7, s41, v3
    v_add_u32 v8, s41, v4
    s_add_u32 s41, s41, 16384
    s_and_b32 s41, s41, 0x1ffff
    ds_read_b128 v[80:83], v7 offset:0
    ds_read_b128 v[84:87], v7 offset:2048
    ds_read_b128 v[88:91], v7 offset:4096
    ds_read_b128 v[92:95], v7 offset:6144
    ds_read_b128 v[96:99], v7 offset:8192
    ds_read_b128 v[100:103], v7 offset:10240
    ds_read_b128 v[104:107], v7 offset:12288
    ds_read_b128 v[108:111], v7 offset:14336
    s_waitcnt lgkmcnt(7)
    v_mfma_f32_16x16x32_bf16 v[16:19], v[80:83], a[64:67], v[16:19]
    v_mfma_f32_16x16x32_bf16 v[20:23], v[80:83], a[136:139], v[20:23]
    ds_read_b128 v[112:115], v8 offset:0
    s_waitcnt lgkmcnt(7)
    v_mfma_f32_16x16x32_bf16 v[24:27], v[84:87], a[64:67], v[24:27]
    v_mfma_f32_16x16x32_bf16 v[28:31], v[84:87], a[136:139], v[28:31]
    ds_read_b128 v[116:119], v8 offset:2048
    s_waitcnt lgkmcnt(7)
    v_mfma_f32_16x16x32_bf16 v[32:35], v[88:91], a[64:67], v[32:35]
    v_mfma_f32_16x16x32_bf16 v[36:39], v[88:91], a[136:139], v[36:39]
    ds_read_b128 v[120:123], v8 offset:4096
    s_waitcnt lgkmcnt(7)
    v_mfma_f32_16x16x32_bf16 v[40:43], v[92:95], a[64:67], v[40:43]
    v_mfma_f32_16x16x32_bf16 v[44:47], v[92:95], a[136:139], v[44:47]
    ds_read_b128 v[124:127], v8 offset:6144
    s_waitcnt lgkmcnt(7)
    v_mfma_f32_16x16x32_bf16 v[48:51], v[96:99], a[64:67], v[48:51]
    v_mfma_f32_16x16x32_bf16 v[52:55], v[96:99], a[136:139], v[52:55]
    ds_read_b128 v[128:131], v8 offset:8192
    s_waitcnt lgkmcnt(7)
    v_mfma_f32_16x16x32_bf16 v[56:59], v[100:103], a[64:67], v[56:59]
    v_mfma_f32_16x16x32_bf16 v[60:63], v[100:103], a[136:139], v[60:63]
    ds_read_b128 v[132:135], v8 offset:10240
    s_waitcnt lgkmcnt(7)
    v_mfma_f32_16x16x32_bf16 v[64:67], v[104:107], a[64:67], v[64:67]
    v_mfma_f32_16x16x32_bf16 v[68:71], v[104:107], a[136:139], v[68:71]
    ds_read_b128 v[136:139], v8 offset:12288
    s_waitcnt lgkmcnt(7)
    v_mfma_f32_16x16x32_bf16 v[72:75], v[108:111], a[64:67], v[72:75]
    v_mfma_f32_16x16x32_bf16 v[76:79], v[108:111], a[136:139], v[76:79]
    ds_read_b128 v[140:143], v8 offset:14336
    s_waitcnt lgkmcnt(7)
    v_mfma_f32_16x16x32_bf16 v[16:19], v[112:115], a[68:71], v[16:19]
    v_mfma_f32_16x16x32_bf16 v[20:23], v[112:115], a[140:143], v[20:23]
    s_waitcnt lgkmcnt(6)
    v_mfma_f32_16x16x32_bf16 v[24:27], v[116:119], a[68:71], v[24:27]
    v_mfma_f32_16x16x32_bf16 v[28:31], v[116:119], a[140:143], v[28:31]
    s_waitcnt lgkmcnt(5)
    v_mfma_f32_16x16x32_bf16 v[32:35], v[120:123], a[68:71], v[32:35]
    v_mfma_f32_16x16x32_bf16 v[36:39], v[120:123], a[140:143], v[36:39]
    s_waitcnt lgkmcnt(4)
    v_mfma_f32_16x16x32_bf16 v[40:43], v[124:127], a[68:71], v[40:43]
    v_mfma_f32_16x16x32_bf16 v[44:47], v[124:127], a[140:143], v[44:47]
    s_waitcnt lgkmcnt(3)
    v_mfma_f32_16x16x32_bf16 v[48:51], v[128:131], a[68:71], v[48:51]
    v_mfma_f32_16x16x32_bf16 v[52:55], v[128:131], a[140:143], v[52:55]
    s_waitcnt lgkmcnt(2)
    v_mfma_f32_16x16x32_bf16 v[56:59], v[132:135], a[68:71], v[56:59]
    v_mfma_f32_16x16x32_bf16 v[60:63], v[132:135], a[140:143], v[60:63]
    s_waitcnt lgkmcnt(1)
    v_mfma_f32_16x16x32_bf16 v[64:67], v[136:139], a[68:71], v[64:67]
    v_mfma_f32_16x16x32_bf16 v[68:71], v[136:139], a[140:143], v[68:71]
    s_waitcnt lgkmcnt(0)
    v_mfma_f32_16x16x32_bf16 v[72:75], v[140:143], a[68:71], v[72:75]
    v_mfma_f32_16x16x32_bf16 v[76:79], v[140:143], a[140:143], v[76:79]
    v_cvt_pk_bf16_f32 v144, v16, v17
    v_cvt_pk_bf16_f32 v145, v18, v19
    v_cvt_pk_bf16_f32 v146, v24, v25
    v_cvt_pk_bf16_f32 v147, v26, v27
    s_add_u32 s50, s36, 0
    buffer_store_dwordx4 v[144:147], v0, s[4:7], s50 offen offset:0 sc1
    v_cvt_pk_bf16_f32 v148, v20, v21
    v_cvt_pk_bf16_f32 v149, v22, v23
    v_cvt_pk_bf16_f32 v150, v28, v29
    v_cvt_pk_bf16_f32 v151, v30, v31
    s_add_u32 s50, s36, 0
    buffer_store_dwordx4 v[148:151], v0, s[4:7], s50 offen offset:1024 sc1
    v_cvt_pk_bf16_f32 v152, v32, v33
    v_cvt_pk_bf16_f32 v153, v34, v35
    v_cvt_pk_bf16_f32 v154, v40, v41
    v_cvt_pk_bf16_f32 v155, v42, v43
    s_add_u32 s50, s36, 262144
    buffer_store_dwordx4 v[152:155], v0, s[4:7], s50 offen offset:0 sc1
    v_cvt_pk_bf16_f32 v156, v36, v37
    v_cvt_pk_bf16_f32 v157, v38, v39
    v_cvt_pk_bf16_f32 v158, v44, v45
    v_cvt_pk_bf16_f32 v159, v46, v47
    s_add_u32 s50, s36, 262144
    buffer_store_dwordx4 v[156:159], v0, s[4:7], s50 offen offset:1024 sc1
    v_cvt_pk_bf16_f32 v144, v48, v49
    v_cvt_pk_bf16_f32 v145, v50, v51
    v_cvt_pk_bf16_f32 v146, v56, v57
    v_cvt_pk_bf16_f32 v147, v58, v59
    s_add_u32 s50, s36, 524288
    buffer_store_dwordx4 v[144:147], v0, s[4:7], s50 offen offset:0 sc1
    v_cvt_pk_bf16_f32 v148, v52, v53
    v_cvt_pk_bf16_f32 v149, v54, v55
    v_cvt_pk_bf16_f32 v150, v60, v61
    v_cvt_pk_bf16_f32 v151, v62, v63
    s_add_u32 s50, s36, 524288
    buffer_store_dwordx4 v[148:151], v0, s[4:7], s50 offen offset:1024 sc1
    v_cvt_pk_bf16_f32 v152, v64, v65
    v_cvt_pk_bf16_f32 v153, v66, v67
    v_cvt_pk_bf16_f32 v154, v72, v73
    v_cvt_pk_bf16_f32 v155, v74, v75
    s_add_u32 s50, s36, 786432
    buffer_store_dwordx4 v[152:155], v0, s[4:7], s50 offen offset:0 sc1
    v_cvt_pk_bf16_f32 v156, v68, v69
    v_cvt_pk_bf16_f32 v157, v70, v71
    v_cvt_pk_bf16_f32 v158, v76, v77
    v_cvt_pk_bf16_f32 v159, v78, v79
    s_add_u32 s50, s36, 786432
    buffer_store_dwordx4 v[156:159], v0, s[4:7], s50 offen offset:1024 sc1
    s_add_u32 s34, s34, 1
    s_add_u32 s36, s36, s37
    s_cmp_lt_u32 s34, s35
    s_cbranch_scc1 ALN_BLK
    s_waitcnt vmcnt(0)
    s_barrier
    s_cmp_eq_u32 s31, 0
    s_cbranch_scc0 AL_fl4a
    v_mov_b32 v13, s63
    v_mov_b32 v14, s64
    s_mov_b64 exec, 1
    global_atomic_add v13, v14, s[90:91]
    s_mov_b64 exec, -1
AL_fl4a:
AL_fl4:
    s_branch KEND
ROLE_B:
    s_load_dwordx2 s[92:93], s[0:1], 96
    s_load_dwordx4 s[80:83], s[0:1], 56
    s_load_dwordx2 s[66:67], s[0:1], 72
    s_load_dwordx2 s[94:95], s[0:1], 80
    s_waitcnt lgkmcnt(0)
    s_sub_u32 s70, s60, 96
    s_mov_b32 s4, s92
    s_and_b32 s5, s93, 0xffff
    s_mov_b32 s6, 268435456
    s_mov_b32 s7, 0x00020000
    v_lshrrev_b32 v10, 6, v0
    s_nop 0
    v_readfirstlane_b32 s31, v10
    v_and_b32 v11, 63, v0
    v_lshlrev_b32 v0, 4, v11
    v_lshrrev_b32 v12, 3, v11
    v_mul_u32_u24 v12, 1152, v12
    v_and_b32 v13, 7, v11
    v_lshrrev_b32 v14, 4, v11
    v_xor_b32 v13, v13, v14
    v_lshl_add_u32 v1, v13, 4, v12
    v_xor_b32 v13, 4, v13
    v_lshl_add_u32 v2, v13, 4, v12
    v_and_b32 v12, 15, v11
    v_lshrrev_b32 v13, 4, v11
    v_lshrrev_b32 v14, 1, v12
    v_xor_b32 v13, v13, v14
    v_lshlrev_b32 v13, 4, v13
    v_lshl_add_u32 v3, v12, 7, v13
    v_xor_b32 v4, 64, v3
    s_cmp_ge_u32 s70, 30
    s_cbranch_scc1 BL_B1SKIP
    s_cmp_ge_u32 s70, 15
    s_cselect_b32 s60, 1, 0
    s_mul_i32 s61, s60, 15
    s_sub_u32 s61, s70, s61
    s_mul_i32 s62, s61, 13
    s_lshr_b32 s62, s62, 6
    s_mul_i32 s63, s62, 5
    s_sub_u32 s63, s61, s63
    s_mov_b32 s12, s80
    s_and_b32 s13, s81, 0xffff
    s_mov_b32 s14, 2359296
    s_mov_b32 s15, 0x00020000
    s_mov_b32 s8, s82
    s_and_b32 s9, s83, 0xffff
    s_mov_b32 s10, 1990656
    s_mov_b32 s11, 0x00020000
    s_mov_b32 s32, 3456
    s_mul_i32 s33, s62, 1152
    s_lshl_b32 s64, s63, 8
    s_add_u32 s33, s33, s64
    s_lshl_b32 s34, s60, 3
    s_add_u32 s35, s34, 8
    v_lshrrev_b32 v20, 4, v0
    v_lshrrev_b32 v21, 4, v20
    v_and_b32 v22, 15, v20
    v_lshlrev_b32 v23, 1, v21
    v_xor_b32 v22, v22, v23
    v_lshlrev_b32 v22, 4, v22
    v_mul_lo_u32 v21, v21, s32
    v_add_u32 v10, v21, v22
    v_add_u32 v11, v21, v22
    v_xor_b32 v22, 128, v22
    v_add_u32 v11, v21, v22
    s_mul_i32 s50, s31, 144
    s_mul_i32 s50, s50, s32
    s_add_u32 s50, s50, s33
    s_lshl_b32 s51, s32, 2
    s_mul_i32 s52, s31, 36864
    s_add_u32 m0, s52, 0
    s_nop 0
    buffer_load_dwordx4 v10, s[8:11], s50 offen lds
    s_add_u32 s50, s50, s51
    s_add_u32 m0, s52, 1024
    s_nop 0
    buffer_load_dwordx4 v10, s[8:11], s50 offen lds
    s_add_u32 s50, s50, s51
    s_add_u32 m0, s52, 2048
    s_nop 0
    buffer_load_dwordx4 v11, s[8:11], s50 offen lds
    s_add_u32 s50, s50, s51
    s_add_u32 m0, s52, 3072
    s_nop 0
    buffer_load_dwordx4 v11, s[8:11], s50 offen lds
    s_add_u32 s50, s50, s51
    s_add_u32 m0, s52, 4096
    s_nop 0
    buffer_load_dwordx4 v10, s[8:11], s50 offen lds
    s_add_u32 s50, s50, s51
    s_add_u32 m0, s52, 5120
    s_nop 0
    buffer_load_dwordx4 v10, s[8:11], s50 offen lds
    s_add_u32 s50, s50, s51
    s_add_u32 m0, s52, 6144
    s_nop 0
    buffer_load_dwordx4 v11, s[8:11], s50 offen lds
    s_add_u32 s50, s50, s51
    s_add_u32 m0, s52, 7168
    s_nop 0
    buffer_load_dwordx4 v11, s[8:11], s50 offen lds
    s_add_u32 s50, s50, s51
    s_add_u32 m0, s52, 8192
    s_nop 0
    buffer_load_dwordx4 v10, s[8:11], s50 offen lds
    s_add_u32 s50, s50, s51
    s_add_u32 m0, s52, 9216
    s_nop 0
    buffer_load_dwordx4 v10, s[8:11], s50 offen lds
    s_add_u32 s50, s50, s51
    s_add_u32 m0, s52, 10240
    s_nop 0
    buffer_load_dwordx4 v11, s[8:11], s50 offen lds
    s_add_u32 s50, s50, s51
    s_add_u32 m0, s52, 11264
    s_nop 0
    buffer_load_dwordx4 v11, s[8:11], s50 offen lds
    s_add_u32 s50, s50, s51
    s_add_u32 m0, s52, 12288
    s_nop 0
    buffer_load_dwordx4 v10, s[8:11], s50 offen lds
    s_add_u32 s50, s50, s51
    s_add_u32 m0, s52, 13312
    s_nop 0
    buffer_load_dwordx4 v10, s[8:11], s50 offen lds
    s_add_u32 s50, s50, s51
    s_add_u32 m0, s52, 14336
    s_nop 0
    buffer_load_dwordx4 v11, s[8:11], s50 offen lds
    s_add_u32 s50, s50, s51
    s_add_u32 m0, s52, 15360
    s_nop 0
    buffer_load_dwordx4 v11, s[8:11], s50 offen lds
    s_add_u32 s50, s50, s51
    s_add_u32 m0, s52, 16384
    s_nop 0
    buffer_load_dwordx4 v10, s[8:11], s50 offen lds
    s_add_u32 s50, s50, s51
    s_add_u32 m0, s52, 17408
    s_nop 0
    buffer_load_dwordx4 v10, s[8:11], s50 offen lds
    s_add_u32 s50, s50, s51
    s_add_u32 m0, s52, 18432
    s_nop 0
    buffer_load_dwordx4 v11, s[8:11], s50 offen lds
    s_add_u32 s50, s50, s51
    s_add_u32 m0, s52, 19456
    s_nop 0
    buffer_load_dwordx4 v11, s[8:11], s50 offen lds
    s_add_u32 s50, s50, s51
    s_add_u32 m0, s52, 20480
    s_nop 0
    buffer_load_dwordx4 v10, s[8:11], s50 offen lds
    s_add_u32 s50, s50, s51
    s_add_u32 m0, s52, 21504
    s_nop 0
    buffer_load_dwordx4 v10, s[8:11], s50 offen lds
    s_add_u32 s50, s50, s51
    s_add_u32 m0, s52, 22528
    s_nop 0
    buffer_load_dwordx4 v11, s[8:11], s50 offen lds
    s_add_u32 s50, s50, s51
    s_add_u32 m0, s52, 23552
    s_nop 0
    buffer_load_dwordx4 v11, s[8:11], s50 offen lds
    s_add_u32 s50, s50, s51
    s_add_u32 m0, s52, 24576
    s_nop 0
    buffer_load_dwordx4 v10, s[8:11], s50 offen lds
    s_add_u32 s50, s50, s51
    s_add_u32 m0, s52, 25600
    s_nop 0
    buffer_load_dwordx4 v10, s[8:11], s50 offen lds
    s_add_u32 s50, s50, s51
    s_add_u32 m0, s52, 26624
    s_nop 0
    buffer_load_dwordx4 v11, s[8:11], s50 offen lds
    s_add_u32 s50, s50, s51
    s_add_u32 m0, s52, 27648
    s_nop 0
    buffer_load_dwordx4 v11, s[8:11], s50 offen lds
    s_add_u32 s50, s50, s51
    s_add_u32 m0, s52, 28672
    s_nop 0
    buffer_load_dwordx4 v10, s[8:11], s50 offen lds
    s_add_u32 s50, s50, s51
    s_add_u32 m0, s52, 29696
    s_nop 0
    buffer_load_dwordx4 v10, s[8:11], s50 offen lds
    s_add_u32 s50, s50, s51
    s_add_u32 m0, s52, 30720
    s_nop 0
    buffer_load_dwordx4 v11, s[8:11], s50 offen lds
    s_add_u32 s50, s50, s51
    s_add_u32 m0, s52, 31744
    s_nop 0
    buffer_load_dwordx4 v11, s[8:11], s50 offen lds
    s_add_u32 s50, s50, s51
    s_add_u32 m0, s52, 32768
    s_nop 0
    buffer_load_dwordx4 v10, s[8:11], s50 offen lds
    s_add_u32 s50, s50, s51
    s_add_u32 m0, s52, 33792
    s_nop 0
    buffer_load_dwordx4 v10, s[8:11], s50 offen lds
    s_add_u32 s50, s50, s51
    s_add_u32 m0, s52, 34816
    s_nop 0
    buffer_load_dwordx4 v11, s[8:11], s50 offen lds
    s_add_u32 s50, s50, s51
    s_add_u32 m0, s52, 35840
    s_nop 0
    buffer_load_dwordx4 v11, s[8:11], s50 offen lds
    s_add_u32 s50, s50, s51
    v_lshrrev_b32 v21, 4, v20
    v_lshrrev_b32 v22, 2, v20
    v_and_b32 v22, 3, v22
    v_and_b32 v23, 3, v20
    v_lshl_add_u32 v24, v21, 3, v22
    v_lshlrev_b32 v24, 8, v24
    v_and_b32 v25, 1, v21
    v_lshl_or_b32 v25, v25, 2, v22
    s_lshl_b32 s50, s31, 1
    v_xor_b32 v25, s50, v25
    v_lshlrev_b32 v25, 5, v25
    v_lshlrev_b32 v23, 3, v23
    v_add3_u32 v5, v24, v25, v23
    v_xor_b32 v6, 32, v5
    v_add_u32 v26, 0x10000, v5
    v_add_u32 v27, 0x10000, v6
    v_add_u32 v28, 0x20000, v5
    v_add_u32 v29, 0x20000, v6
    s_waitcnt vmcnt(0)
    s_barrier
    ds_read_b64_tr_b16 a[0:1], v5 offset:0
    ds_read_b64_tr_b16 a[2:3], v5 offset:1024
    ds_read_b64_tr_b16 a[72:73], v6 offset:0
    ds_read_b64_tr_b16 a[74:75], v6 offset:1024
    ds_read_b64_tr_b16 a[4:5], v5 offset:8192
    ds_read_b64_tr_b16 a[6:7], v5 offset:9216
    ds_read_b64_tr_b16 a[76:77], v6 offset:8192
    ds_read_b64_tr_b16 a[78:79], v6 offset:9216
    ds_read_b64_tr_b16 a[8:9], v5 offset:16384
    ds_read_b64_tr_b16 a[10:11], v5 offset:17408
    ds_read_b64_tr_b16 a[80:81], v6 offset:16384
    ds_read_b64_tr_b16 a[82:83], v6 offset:17408
    s_waitcnt lgkmcnt(0)
    ds_read_b64_tr_b16 a[12:13], v5 offset:24576
    ds_read_b64_tr_b16 a[14:15], v5 offset:25600
    ds_read_b64_tr_b16 a[84:85], v6 offset:24576
    ds_read_b64_tr_b16 a[86:87], v6 offset:25600
    ds_read_b64_tr_b16 a[16:17], v5 offset:32768
    ds_read_b64_tr_b16 a[18:19], v5 offset:33792
    ds_read_b64_tr_b16 a[88:89], v6 offset:32768
    ds_read_b64_tr_b16 a[90:91], v6 offset:33792
    ds_read_b64_tr_b16 a[20:21], v5 offset:40960
    ds_read_b64_tr_b16 a[22:23], v5 offset:41984
    ds_read_b64_tr_b16 a[92:93], v6 offset:40960
    ds_read_b64_tr_b16 a[94:95], v6 offset:41984
    s_waitcnt lgkmcnt(0)
    ds_read_b64_tr_b16 a[24:25], v5 offset:49152
    ds_read_b64_tr_b16 a[26:27], v5 offset:50176
    ds_read_b64_tr_b16 a[96:97], v6 offset:49152
    ds_read_b64_tr_b16 a[98:99], v6 offset:50176
    ds_read_b64_tr_b16 a[28:29], v5 offset:57344
    ds_read_b64_tr_b16 a[30:31], v5 offset:58368
    ds_read_b64_tr_b16 a[100:101], v6 offset:57344
    ds_read_b64_tr_b16 a[102:103], v6 offset:58368
    ds_read_b64_tr_b16 a[32:33], v26 offset:0
    ds_read_b64_tr_b16 a[34:35], v26 offset:1024
    ds_read_b64_tr_b16 a[104:105], v27 offset:0
    ds_read_b64_tr_b16 a[106:107], v27 offset:1024
    s_waitcnt lgkmcnt(0)
    ds_read_b64_tr_b16 a[36:37], v26 offset:8192
    ds_read_b64_tr_b16 a[38:39], v26 offset:9216
    ds_read_b64_tr_b16 a[108:109], v27 offset:8192
    ds_read_b64_tr_b16 a[110:111], v27 offset:9216
    ds_read_b64_tr_b16 a[40:41], v26 offset:16384
    ds_read_b64_tr_b16 a[42:43], v26 offset:17408
    ds_read_b64_tr_b16 a[112:113], v27 offset:16384
    ds_read_b64_tr_b16 a[114:115], v27 offset:17408
    ds_read_b64_tr_b16 a[44:45], v26 offset:24576
    ds_read_b64_tr_b16 a[46:47], v26 offset:25600
    ds_read_b64_tr_b16 a[116:117], v27 offset:24576
    ds_read_b64_tr_b16 a[118:119], v27 offset:25600
    s_waitcnt lgkmcnt(0)
    ds_read_b64_tr_b16 a[48:49], v26 offset:32768
    ds_read_b64_tr_b16 a[50:51], v26 offset:33792
    ds_read_b64_tr_b16 a[120:121], v27 offset:32768
    ds_read_b64_tr_b16 a[122:123], v27 offset:33792
    ds_read_b64_tr_b16 a[52:53], v26 offset:40960
    ds_read_b64_tr_b16 a[54:55], v26 offset:41984
    ds_read_b64_tr_b16 a[124:125], v27 offset:40960
    ds_read_b64_tr_b16 a[126:127], v27 offset:41984
    ds_read_b64_tr_b16 a[56:57], v26 offset:49152
    ds_read_b64_tr_b16 a[58:59], v26 offset:50176
    ds_read_b64_tr_b16 a[128:129], v27 offset:49152
    ds_read_b64_tr_b16 a[130:131], v27 offset:50176
    s_waitcnt lgkmcnt(0)
    ds_read_b64_tr_b16 a[60:61], v26 offset:57344
    ds_read_b64_tr_b16 a[62:63], v26 offset:58368
    ds_read_b64_tr_b16 a[132:133], v27 offset:57344
    ds_read_b64_tr_b16 a[134:135], v27 offset:58368
    ds_read_b64_tr_b16 a[64:65], v28 offset:0
    ds_read_b64_tr_b16 a[66:67], v28 offset:1024
    ds_read_b64_tr_b16 a[136:137], v29 offset:0
    ds_read_b64_tr_b16 a[138:139], v29 offset:1024
    ds_read_b64_tr_b16 a[68:69], v28 offset:8192
    ds_read_b64_tr_b16 a[70:71], v28 offset:9216
    ds_read_b64_tr_b16 a[140:141], v29 offset:8192
    ds_read_b64_tr_b16 a[142:143], v29 offset:9216
    s_waitcnt lgkmcnt(0)
    s_barrier
    s_cmp_eq_u32 s62, 0
    s_cbranch_scc0 BL1_N
    s_mul_i32 s36, s34, 163840
    s_lshl_b32 s64, s63, 2
    s_add_u32 s64, s64, s31
    s_lshl_b32 s64, s64, 10
    s_add_u32 s36, s36, s64
    s_add_u32 s36, s36, 92274688
    s_mov_b32 s37, 163840
    s_mul_i32 s38, s34, 147456
    s_mul_i32 s50, s31, 36864
    s_add_u32 s38, s38, s50
    s_lshl_b32 s39, s31, 12
    s_mov_b32 s41, 0
    s_add_u32 s50, s38, 0
    s_add_u32 m0, s39, 0
    s_nop 0
    buffer_load_dwordx4 v1, s[12:15], s50 offen  lds
    s_add_u32 s50, s38, 9216
    s_add_u32 m0, s39, 1024
    s_nop 0
    buffer_load_dwordx4 v2, s[12:15], s50 offen  lds
    s_add_u32 s50, s38, 18432
    s_add_u32 m0, s39, 2048
    s_nop 0
    buffer_load_dwordx4 v1, s[12:15], s50 offen  lds
    s_add_u32 s50, s38, 27648
    s_add_u32 m0, s39, 3072
    s_nop 0
    buffer_load_dwordx4 v2, s[12:15], s50 offen  lds
    s_add_u32 s38, s38, 128
    s_add_u32 s39, s39, 16384
    s_and_b32 s39, s39, 0x1ffff
    s_add_u32 s50, s38, 0
    s_add_u32 m0, s39, 0
    s_nop 0
    buffer_load_dwordx4 v1, s[12:15], s50 offen  lds
    s_add_u32 s50, s38, 9216
    s_add_u32 m0, s39, 1024
    s_nop 0
    buffer_load_dwordx4 v2, s[12:15], s50 offen  lds
    s_add_u32 s50, s38, 18432
    s_add_u32 m0, s39, 2048
    s_nop 0
    buffer_load_dwordx4 v1, s[12:15], s50 offen  lds
    s_add_u32 s50, s38, 27648
    s_add_u32 m0, s39, 3072
    s_nop 0
    buffer_load_dwordx4 v2, s[12:15], s50 offen  lds
    s_add_u32 s38, s38, 128
    s_add_u32 s39, s39, 16384
    s_and_b32 s39, s39, 0x1ffff
    s_add_u32 s50, s38, 0
    s_add_u32 m0, s39, 0
    s_nop 0
    buffer_load_dwordx4 v1, s[12:15], s50 offen  lds
    s_add_u32 s50, s38, 9216
    s_add_u32 m0, s39, 1024
    s_nop 0
    buffer_load_dwordx4 v2, s[12:15], s50 offen  lds
    s_add_u32 s50, s38, 18432
    s_add_u32 m0, s39, 2048
    s_nop 0
    buffer_load_dwordx4 v1, s[12:15], s50 offen  lds
    s_add_u32 s50, s38, 27648
    s_add_u32 m0, s39, 3072
    s_nop 0
    buffer_load_dwordx4 v2, s[12:15], s50 offen  lds
    s_add_u32 s38, s38, 128
    s_add_u32 s39, s39, 16384
    s_and_b32 s39, s39, 0x1ffff
    s_add_u32 s50, s38, 0
    s_add_u32 m0, s39, 0
    s_nop 0
    buffer_load_dwordx4 v1, s[12:15], s50 offen  lds
    s_add_u32 s50, s38, 9216
    s_add_u32 m0, s39, 1024
    s_nop 0
    buffer_load_dwordx4 v2, s[12:15], s50 offen  lds
    s_add_u32 s50, s38, 18432
    s_add_u32 m0, s39, 2048
    s_nop 0
    buffer_load_dwordx4 v1, s[12:15], s50 offen  lds
    s_add_u32 s50, s38, 27648
    s_add_u32 m0, s39, 3072
    s_nop 0
    buffer_load_dwordx4 v2, s[12:15], s50 offen  lds
    s_add_u32 s38, s38, 128
    s_add_u32 s39, s39, 16384
    s_and_b32 s39, s39, 0x1ffff
    s_add_u32 s50, s38, 0
    s_add_u32 m0, s39, 0
    s_nop 0
    buffer_load_dwordx4 v1, s[12:15], s50 offen  lds
    s_add_u32 s50, s38, 9216
    s_add_u32 m0, s39, 1024
    s_nop 0
    buffer_load_dwordx4 v2, s[12:15], s50 offen  lds
    s_add_u32 s50, s38, 18432
    s_add_u32 m0, s39, 2048
    s_nop 0
    buffer_load_dwordx4 v1, s[12:15], s50 offen  lds
    s_add_u32 s50, s38, 27648
    s_add_u32 m0, s39, 3072
    s_nop 0
    buffer_load_dwordx4 v2, s[12:15], s50 offen  lds
    s_add_u32 s38, s38, 128
    s_add_u32 s39, s39, 16384
    s_and_b32 s39, s39, 0x1ffff
    s_add_u32 s50, s38, 0
    s_add_u32 m0, s39, 0
    s_nop 0
    buffer_load_dwordx4 v1, s[12:15], s50 offen  lds
    s_add_u32 s50, s38, 9216
    s_add_u32 m0, s39, 1024
    s_nop 0
    buffer_load_dwordx4 v2, s[12:15], s50 offen  lds
    s_add_u32 s50, s38, 18432
    s_add_u32 m0, s39, 2048
    s_nop 0
    buffer_load_dwordx4 v1, s[12:15], s50 offen  lds
    s_add_u32 s50, s38, 27648
    s_add_u32 m0, s39, 3072
    s_nop 0
    buffer_load_dwordx4 v2, s[12:15], s50 offen  lds
    s_add_u32 s38, s38, 128
    s_add_u32 s39, s39, 16384
    s_and_b32 s39, s39, 0x1ffff
    s_waitcnt vmcnt(0)
BL1Q_BLK:
    s_waitcnt vmcnt(28)
    s_barrier
    s_add_u32 s50, s38, 0
    s_add_u32 m0, s39, 0
    s_nop 0
    buffer_load_dwordx4 v1, s[12:15], s50 offen  lds
    s_add_u32 s50, s38, 9216
    s_add_u32 m0, s39, 1024
    s_nop 0
    buffer_load_dwordx4 v2, s[12:15], s50 offen  lds
    s_add_u32 s50, s38, 18432
    s_add_u32 m0, s39, 2048
    s_nop 0
    buffer_load_dwordx4 v1, s[12:15], s50 offen  lds
    s_add_u32 s50, s38, 27648
    s_add_u32 m0, s39, 3072
    s_nop 0
    buffer_load_dwordx4 v2, s[12:15], s50 offen  lds
    s_add_u32 s38, s38, 128
    s_add_u32 s39, s39, 16384
    s_and_b32 s39, s39, 0x1ffff
    v_add_u32 v7, s41, v3
    v_add_u32 v8, s41, v4
    s_add_u32 s41, s41, 16384
    s_and_b32 s41, s41, 0x1ffff
    ds_read_b128 v[80:83], v7 offset:0
    ds_read_b128 v[84:87], v7 offset:2048
    ds_read_b128 v[88:91], v7 offset:4096
    ds_read_b128 v[92:95], v7 offset:6144
    ds_read_b128 v[96:99], v7 offset:8192
    ds_read_b128 v[100:103], v7 offset:10240
    ds_read_b128 v[104:107], v7 offset:12288
    ds_read_b128 v[108:111], v7 offset:14336
    s_waitcnt lgkmcnt(7)
    v_mfma_f32_16x16x32_bf16 v[16:19], a[0:3], v[80:83], 0
    v_mfma_f32_16x16x32_bf16 v[20:23], a[72:75], v[80:83], 0
    ds_read_b128 v[112:115], v8 offset:0
    s_waitcnt lgkmcnt(7)
    v_mfma_f32_16x16x32_bf16 v[24:27], a[0:3], v[84:87], 0
    v_mfma_f32_16x16x32_bf16 v[28:31], a[72:75], v[84:87], 0
    ds_read_b128 v[116:119], v8 offset:2048
    s_waitcnt lgkmcnt(7)
    v_mfma_f32_16x16x32_bf16 v[32:35], a[0:3], v[88:91], 0
    v_mfma_f32_16x16x32_bf16 v[36:39], a[72:75], v[88:91], 0
    ds_read_b128 v[120:123], v8 offset:4096
    s_waitcnt lgkmcnt(7)
    v_mfma_f32_16x16x32_bf16 v[40:43], a[0:3], v[92:95], 0
    v_mfma_f32_16x16x32_bf16 v[44:47], a[72:75], v[92:95], 0
    ds_read_b128 v[124:127], v8 offset:6144
    s_waitcnt lgkmcnt(7)
    v_mfma_f32_16x16x32_bf16 v[48:51], a[0:3], v[96:99], 0
    v_mfma_f32_16x16x32_bf16 v[52:55], a[72:75], v[96:99], 0
    ds_read_b128 v[128:131], v8 offset:8192
    s_waitcnt lgkmcnt(7)
    v_mfma_f32_16x16x32_bf16 v[56:59], a[0:3], v[100:103], 0
    v_mfma_f32_16x16x32_bf16 v[60:63], a[72:75], v[100:103], 0
    ds_read_b128 v[132:135], v8 offset:10240
    s_waitcnt lgkmcnt(7)
    v_mfma_f32_16x16x32_bf16 v[64:67], a[0:3], v[104:107], 0
    v_mfma_f32_16x16x32_bf16 v[68:71], a[72:75], v[104:107], 0
    ds_read_b128 v[136:139], v8 offset:12288
    s_waitcnt lgkmcnt(7)
    v_mfma_f32_16x16x32_bf16 v[72:75], a[0:3], v[108:111], 0
    v_mfma_f32_16x16x32_bf16 v[76:79], a[72:75], v[108:111], 0
    ds_read_b128 v[140:143], v8 offset:14336
    s_waitcnt lgkmcnt(7)
    v_mfma_f32_16x16x32_bf16 v[16:19], a[4:7], v[112:115], v[16:19]
    v_mfma_f32_16x16x32_bf16 v[20:23], a[76:79], v[112:115], v[20:23]
    s_waitcnt lgkmcnt(6)
    v_mfma_f32_16x16x32_bf16 v[24:27], a[4:7], v[116:119], v[24:27]
    v_mfma_f32_16x16x32_bf16 v[28:31], a[76:79], v[116:119], v[28:31]
    s_waitcnt lgkmcnt(5)
    v_mfma_f32_16x16x32_bf16 v[32:35], a[4:7], v[120:123], v[32:35]
    v_mfma_f32_16x16x32_bf16 v[36:39], a[76:79], v[120:123], v[36:39]
    s_waitcnt lgkmcnt(4)
    v_mfma_f32_16x16x32_bf16 v[40:43], a[4:7], v[124:127], v[40:43]
    v_mfma_f32_16x16x32_bf16 v[44:47], a[76:79], v[124:127], v[44:47]
    s_waitcnt lgkmcnt(3)
    v_mfma_f32_16x16x32_bf16 v[48:51], a[4:7], v[128:131], v[48:51]
    v_mfma_f32_16x16x32_bf16 v[52:55], a[76:79], v[128:131], v[52:55]
    s_waitcnt lgkmcnt(2)
    v_mfma_f32_16x16x32_bf16 v[56:59], a[4:7], v[132:135], v[56:59]
    v_mfma_f32_16x16x32_bf16 v[60:63], a[76:79], v[132:135], v[60:63]
    s_waitcnt lgkmcnt(1)
    v_mfma_f32_16x16x32_bf16 v[64:67], a[4:7], v[136:139], v[64:67]
    v_mfma_f32_16x16x32_bf16 v[68:71], a[76:79], v[136:139], v[68:71]
    s_waitcnt lgkmcnt(0)
    v_mfma_f32_16x16x32_bf16 v[72:75], a[4:7], v[140:143], v[72:75]
    v_mfma_f32_16x16x32_bf16 v[76:79], a[76:79], v[140:143], v[76:79]
    s_waitcnt vmcnt(28)
    s_barrier
    s_add_u32 s50, s38, 0
    s_add_u32 m0, s39, 0
    s_nop 0
    buffer_load_dwordx4 v1, s[12:15], s50 offen  lds
    s_add_u32 s50, s38, 9216
    s_add_u32 m0, s39, 1024
    s_nop 0
    buffer_load_dwordx4 v2, s[12:15], s50 offen  lds
    s_add_u32 s50, s38, 18432
    s_add_u32 m0, s39, 2048
    s_nop 0
    buffer_load_dwordx4 v1, s[12:15], s50 offen  lds
    s_add_u32 s50, s38, 27648
    s_add_u32 m0, s39, 3072
    s_nop 0
    buffer_load_dwordx4 v2, s[12:15], s50 offen  lds
    s_add_u32 s38, s38, 128
    s_add_u32 s39, s39, 16384
    s_and_b32 s39, s39, 0x1ffff
    v_add_u32 v7, s41, v3
    v_add_u32 v8, s41, v4
    s_add_u32 s41, s41, 16384
    s_and_b32 s41, s41, 0x1ffff
    ds_read_b128 v[80:83], v7 offset:0
    ds_read_b128 v[84:87], v7 offset:2048
    ds_read_b128 v[88:91], v7 offset:4096
    ds_read_b128 v[92:95], v7 offset:6144
    ds_read_b128 v[96:99], v7 offset:8192
    ds_read_b128 v[100:103], v7 offset:10240
    ds_read_b128 v[104:107], v7 offset:12288
    ds_read_b128 v[108:111], v7 offset:14336
    s_waitcnt lgkmcnt(7)
    v_mfma_f32_16x16x32_bf16 v[16:19], a[8:11], v[80:83], v[16:19]
    v_mfma_f32_16x16x32_bf16 v[20:23], a[80:83], v[80:83], v[20:23]
    ds_read_b128 v[112:115], v8 offset:0
    s_waitcnt lgkmcnt(7)
    v_mfma_f32_16x16x32_bf16 v[24:27], a[8:11], v[84:87], v[24:27]
    v_mfma_f32_16x16x32_bf16 v[28:31], a[80:83], v[84:87], v[28:31]
    ds_read_b128 v[116:119], v8 offset:2048
    s_waitcnt lgkmcnt(7)
    v_mfma_f32_16x16x32_bf16 v[32:35], a[8:11], v[88:91], v[32:35]
    v_mfma_f32_16x16x32_bf16 v[36:39], a[80:83], v[88:91], v[36:39]
    ds_read_b128 v[120:123], v8 offset:4096
    s_waitcnt lgkmcnt(7)
    v_mfma_f32_16x16x32_bf16 v[40:43], a[8:11], v[92:95], v[40:43]
    v_mfma_f32_16x16x32_bf16 v[44:47], a[80:83], v[92:95], v[44:47]
    ds_read_b128 v[124:127], v8 offset:6144
    s_waitcnt lgkmcnt(7)
    v_mfma_f32_16x16x32_bf16 v[48:51], a[8:11], v[96:99], v[48:51]
    v_mfma_f32_16x16x32_bf16 v[52:55], a[80:83], v[96:99], v[52:55]
    ds_read_b128 v[128:131], v8 offset:8192
    s_waitcnt lgkmcnt(7)
    v_mfma_f32_16x16x32_bf16 v[56:59], a[8:11], v[100:103], v[56:59]
    v_mfma_f32_16x16x32_bf16 v[60:63], a[80:83], v[100:103], v[60:63]
    ds_read_b128 v[132:135], v8 offset:10240
    s_waitcnt lgkmcnt(7)
    v_mfma_f32_16x16x32_bf16 v[64:67], a[8:11], v[104:107], v[64:67]
    v_mfma_f32_16x16x32_bf16 v[68:71], a[80:83], v[104:107], v[68:71]
    ds_read_b128 v[136:139], v8 offset:12288
    s_waitcnt lgkmcnt(7)
    v_mfma_f32_16x16x32_bf16 v[72:75], a[8:11], v[108:111], v[72:75]
    v_mfma_f32_16x16x32_bf16 v[76:79], a[80:83], v[108:111], v[76:79]
    ds_read_b128 v[140:143], v8 offset:14336
    s_waitcnt lgkmcnt(7)
    v_mfma_f32_16x16x32_bf16 v[16:19], a[12:15], v[112:115], v[16:19]
    v_mfma_f32_16x16x32_bf16 v[20:23], a[84:87], v[112:115], v[20:23]
    s_waitcnt lgkmcnt(6)
    v_mfma_f32_16x16x32_bf16 v[24:27], a[12:15], v[116:119], v[24:27]
    v_mfma_f32_16x16x32_bf16 v[28:31], a[84:87], v[116:119], v[28:31]
    s_waitcnt lgkmcnt(5)
    v_mfma_f32_16x16x32_bf16 v[32:35], a[12:15], v[120:123], v[32:35]
    v_mfma_f32_16x16x32_bf16 v[36:39], a[84:87], v[120:123], v[36:39]
    s_waitcnt lgkmcnt(4)
    v_mfma_f32_16x16x32_bf16 v[40:43], a[12:15], v[124:127], v[40:43]
    v_mfma_f32_16x16x32_bf16 v[44:47], a[84:87], v[124:127], v[44:47]
    s_waitcnt lgkmcnt(3)
    v_mfma_f32_16x16x32_bf16 v[48:51], a[12:15], v[128:131], v[48:51]
    v_mfma_f32_16x16x32_bf16 v[52:55], a[84:87], v[128:131], v[52:55]
    s_waitcnt lgkmcnt(2)
    v_mfma_f32_16x16x32_bf16 v[56:59], a[12:15], v[132:135], v[56:59]
    v_mfma_f32_16x16x32_bf16 v[60:63], a[84:87], v[132:135], v[60:63]
    s_waitcnt lgkmcnt(1)
    v_mfma_f32_16x16x32_bf16 v[64:67], a[12:15], v[136:139], v[64:67]
    v_mfma_f32_16x16x32_bf16 v[68:71], a[84:87], v[136:139], v[68:71]
    s_waitcnt lgkmcnt(0)
    v_mfma_f32_16x16x32_bf16 v[72:75], a[12:15], v[140:143], v[72:75]
    v_mfma_f32_16x16x32_bf16 v[76:79], a[84:87], v[140:143], v[76:79]
    s_waitcnt vmcnt(28)
    s_barrier
    s_add_u32 s50, s38, 0
    s_add_u32 m0, s39, 0
    s_nop 0
    buffer_load_dwordx4 v1, s[12:15], s50 offen  lds
    s_add_u32 s50, s38, 9216
    s_add_u32 m0, s39, 1024
    s_nop 0
    buffer_load_dwordx4 v2, s[12:15], s50 offen  lds
    s_add_u32 s50, s38, 18432
    s_add_u32 m0, s39, 2048
    s_nop 0
    buffer_load_dwordx4 v1, s[12:15], s50 offen  lds
    s_add_u32 s50, s38, 27648
    s_add_u32 m0, s39, 3072
    s_nop 0
    buffer_load_dwordx4 v2, s[12:15], s50 offen  lds
    s_add_u32 s38, s38, 146432
    s_add_u32 s39, s39, 16384
    s_and_b32 s39, s39, 0x1ffff
    v_add_u32 v7, s41, v3
    v_add_u32 v8, s41, v4
    s_add_u32 s41, s41, 16384
    s_and_b32 s41, s41, 0x1ffff
    ds_read_b128 v[80:83], v7 offset:0
    ds_read_b128 v[84:87], v7 offset:2048
    ds_read_b128 v[88:91], v7 offset:4096
    ds_read_b128 v[92:95], v7 offset:6144
    ds_read_b128 v[96:99], v7 offset:8192
    ds_read_b128 v[100:103], v7 offset:10240
    ds_read_b128 v[104:107], v7 offset:12288
    ds_read_b128 v[108:111], v7 offset:14336
    s_waitcnt lgkmcnt(7)
    v_mfma_f32_16x16x32_bf16 v[16:19], a[16:19], v[80:83], v[16:19]
    v_mfma_f32_16x16x32_bf16 v[20:23], a[88:91], v[80:83], v[20:23]
    ds_read_b128 v[112:115], v8 offset:0
    s_waitcnt lgkmcnt(7)
    v_mfma_f32_16x16x32_bf16 v[24:27], a[16:19], v[84:87], v[24:27]
    v_mfma_f32_16x16x32_bf16 v[28:31], a[88:91], v[84:87], v[28:31]
    ds_read_b128 v[116:119], v8 offset:2048
    s_waitcnt lgkmcnt(7)
    v_mfma_f32_16x16x32_bf16 v[32:35], a[16:19], v[88:91], v[32:35]
    v_mfma_f32_16x16x32_bf16 v[36:39], a[88:91], v[88:91], v[36:39]
    ds_read_b128 v[120:123], v8 offset:4096
    s_waitcnt lgkmcnt(7)
    v_mfma_f32_16x16x32_bf16 v[40:43], a[16:19], v[92:95], v[40:43]
    v_mfma_f32_16x16x32_bf16 v[44:47], a[88:91], v[92:95], v[44:47]
    ds_read_b128 v[124:127], v8 offset:6144
    s_waitcnt lgkmcnt(7)
    v_mfma_f32_16x16x32_bf16 v[48:51], a[16:19], v[96:99], v[48:51]
    v_mfma_f32_16x16x32_bf16 v[52:55], a[88:91], v[96:99], v[52:55]
    ds_read_b128 v[128:131], v8 offset:8192
    s_waitcnt lgkmcnt(7)
    v_mfma_f32_16x16x32_bf16 v[56:59], a[16:19], v[100:103], v[56:59]
    v_mfma_f32_16x16x32_bf16 v[60:63], a[88:91], v[100:103], v[60:63]
    ds_read_b128 v[132:135], v8 offset:10240
    s_waitcnt lgkmcnt(7)
    v_mfma_f32_16x16x32_bf16 v[64:67], a[16:19], v[104:107], v[64:67]
    v_mfma_f32_16x16x32_bf16 v[68:71], a[88:91], v[104:107], v[68:71]
    ds_read_b128 v[136:139], v8 offset:12288
    s_waitcnt lgkmcnt(7)
    v_mfma_f32_16x16x32_bf16 v[72:75], a[16:19], v[108:111], v[72:75]
    v_mfma_f32_16x16x32_bf16 v[76:79], a[88:91], v[108:111], v[76:79]
    ds_read_b128 v[140:143], v8 offset:14336
    s_waitcnt lgkmcnt(7)
    v_mfma_f32_16x16x32_bf16 v[16:19], a[20:23], v[112:115], v[16:19]
    v_mfma_f32_16x16x32_bf16 v[20:23], a[92:95], v[112:115], v[20:23]
    s_waitcnt lgkmcnt(6)
    v_mfma_f32_16x16x32_bf16 v[24:27], a[20:23], v[116:119], v[24:27]
    v_mfma_f32_16x16x32_bf16 v[28:31], a[92:95], v[116:119], v[28:31]
    s_waitcnt lgkmcnt(5)
    v_mfma_f32_16x16x32_bf16 v[32:35], a[20:23], v[120:123], v[32:35]
    v_mfma_f32_16x16x32_bf16 v[36:39], a[92:95], v[120:123], v[36:39]
    s_waitcnt lgkmcnt(4)
    v_mfma_f32_16x16x32_bf16 v[40:43], a[20:23], v[124:127], v[40:43]
    v_mfma_f32_16x16x32_bf16 v[44:47], a[92:95], v[124:127], v[44:47]
    s_waitcnt lgkmcnt(3)
    v_mfma_f32_16x16x32_bf16 v[48:51], a[20:23], v[128:131], v[48:51]
    v_mfma_f32_16x16x32_bf16 v[52:55], a[92:95], v[128:131], v[52:55]
    s_waitcnt lgkmcnt(2)
    v_mfma_f32_16x16x32_bf16 v[56:59], a[20:23], v[132:135], v[56:59]
    v_mfma_f32_16x16x32_bf16 v[60:63], a[92:95], v[132:135], v[60:63]
    s_waitcnt lgkmcnt(1)
    v_mfma_f32_16x16x32_bf16 v[64:67], a[20:23], v[136:139], v[64:67]
    v_mfma_f32_16x16x32_bf16 v[68:71], a[92:95], v[136:139], v[68:71]
    s_waitcnt lgkmcnt(0)
    v_mfma_f32_16x16x32_bf16 v[72:75], a[20:23], v[140:143], v[72:75]
    v_mfma_f32_16x16x32_bf16 v[76:79], a[92:95], v[140:143], v[76:79]
    s_waitcnt vmcnt(28)
    s_barrier
    s_add_u32 s50, s38, 0
    s_add_u32 m0, s39, 0
    s_nop 0
    buffer_load_dwordx4 v1, s[12:15], s50 offen  lds
    s_add_u32 s50, s38, 9216
    s_add_u32 m0, s39, 1024
    s_nop 0
    buffer_load_dwordx4 v2, s[12:15], s50 offen  lds
    s_add_u32 s50, s38, 18432
    s_add_u32 m0, s39, 2048
    s_nop 0
    buffer_load_dwordx4 v1, s[12:15], s50 offen  lds
    s_add_u32 s50, s38, 27648
    s_add_u32 m0, s39, 3072
    s_nop 0
    buffer_load_dwordx4 v2, s[12:15], s50 offen  lds
    s_add_u32 s38, s38, 128
    s_add_u32 s39, s39, 16384
    s_and_b32 s39, s39, 0x1ffff
    v_add_u32 v7, s41, v3
    v_add_u32 v8, s41, v4
    s_add_u32 s41, s41, 16384
    s_and_b32 s41, s41, 0x1ffff
    ds_read_b128 v[80:83], v7 offset:0
    ds_read_b128 v[84:87], v7 offset:2048
    ds_read_b128 v[88:91], v7 offset:4096
    ds_read_b128 v[92:95], v7 offset:6144
    ds_read_b128 v[96:99], v7 offset:8192
    ds_read_b128 v[100:103], v7 offset:10240
    ds_read_b128 v[104:107], v7 offset:12288
    ds_read_b128 v[108:111], v7 offset:14336
    s_waitcnt lgkmcnt(7)
    v_mfma_f32_16x16x32_bf16 v[16:19], a[24:27], v[80:83], v[16:19]
    v_mfma_f32_16x16x32_bf16 v[20:23], a[96:99], v[80:83], v[20:23]
    ds_read_b128 v[112:115], v8 offset:0
    s_waitcnt lgkmcnt(7)
    v_mfma_f32_16x16x32_bf16 v[24:27], a[24:27], v[84:87], v[24:27]
    v_mfma_f32_16x16x32_bf16 v[28:31], a[96:99], v[84:87], v[28:31]
    ds_read_b128 v[116:119], v8 offset:2048
    s_waitcnt lgkmcnt(7)
    v_mfma_f32_16x16x32_bf16 v[32:35], a[24:27], v[88:91], v[32:35]
    v_mfma_f32_16x16x32_bf16 v[36:39], a[96:99], v[88:91], v[36:39]
    ds_read_b128 v[120:123], v8 offset:4096
    s_waitcnt lgkmcnt(7)
    v_mfma_f32_16x16x32_bf16 v[40:43], a[24:27], v[92:95], v[40:43]
    v_mfma_f32_16x16x32_bf16 v[44:47], a[96:99], v[92:95], v[44:47]
    ds_read_b128 v[124:127], v8 offset:6144
    s_waitcnt lgkmcnt(7)
    v_mfma_f32_16x16x32_bf16 v[48:51], a[24:27], v[96:99], v[48:51]
    v_mfma_f32_16x16x32_bf16 v[52:55], a[96:99], v[96:99], v[52:55]
    ds_read_b128 v[128:131], v8 offset:8192
    s_waitcnt lgkmcnt(7)
    v_mfma_f32_16x16x32_bf16 v[56:59], a[24:27], v[100:103], v[56:59]
    v_mfma_f32_16x16x32_bf16 v[60:63], a[96:99], v[100:103], v[60:63]
    ds_read_b128 v[132:135], v8 offset:10240
    s_waitcnt lgkmcnt(7)
    v_mfma_f32_16x16x32_bf16 v[64:67], a[24:27], v[104:107], v[64:67]
    v_mfma_f32_16x16x32_bf16 v[68:71], a[96:99], v[104:107], v[68:71]
    ds_read_b128 v[136:139], v8 offset:12288
    s_waitcnt lgkmcnt(7)
    v_mfma_f32_16x16x32_bf16 v[72:75], a[24:27], v[108:111], v[72:75]
    v_mfma_f32_16x16x32_bf16 v[76:79], a[96:99], v[108:111], v[76:79]
    ds_read_b128 v[140:143], v8 offset:14336
    s_waitcnt lgkmcnt(7)
    v_mfma_f32_16x16x32_bf16 v[16:19], a[28:31], v[112:115], v[16:19]
    v_mfma_f32_16x16x32_bf16 v[20:23], a[100:103], v[112:115], v[20:23]
    s_waitcnt lgkmcnt(6)
    v_mfma_f32_16x16x32_bf16 v[24:27], a[28:31], v[116:119], v[24:27]
    v_mfma_f32_16x16x32_bf16 v[28:31], a[100:103], v[116:119], v[28:31]
    s_waitcnt lgkmcnt(5)
    v_mfma_f32_16x16x32_bf16 v[32:35], a[28:31], v[120:123], v[32:35]
    v_mfma_f32_16x16x32_bf16 v[36:39], a[100:103], v[120:123], v[36:39]
    s_waitcnt lgkmcnt(4)
    v_mfma_f32_16x16x32_bf16 v[40:43], a[28:31], v[124:127], v[40:43]
    v_mfma_f32_16x16x32_bf16 v[44:47], a[100:103], v[124:127], v[44:47]
    s_waitcnt lgkmcnt(3)
    v_mfma_f32_16x16x32_bf16 v[48:51], a[28:31], v[128:131], v[48:51]
    v_mfma_f32_16x16x32_bf16 v[52:55], a[100:103], v[128:131], v[52:55]
    s_waitcnt lgkmcnt(2)
    v_mfma_f32_16x16x32_bf16 v[56:59], a[28:31], v[132:135], v[56:59]
    v_mfma_f32_16x16x32_bf16 v[60:63], a[100:103], v[132:135], v[60:63]
    s_waitcnt lgkmcnt(1)
    v_mfma_f32_16x16x32_bf16 v[64:67], a[28:31], v[136:139], v[64:67]
    v_mfma_f32_16x16x32_bf16 v[68:71], a[100:103], v[136:139], v[68:71]
    s_waitcnt lgkmcnt(0)
    v_mfma_f32_16x16x32_bf16 v[72:75], a[28:31], v[140:143], v[72:75]
    v_mfma_f32_16x16x32_bf16 v[76:79], a[100:103], v[140:143], v[76:79]
    s_waitcnt vmcnt(28)
    s_barrier
    s_add_u32 s50, s38, 0
    s_add_u32 m0, s39, 0
    s_nop 0
    buffer_load_dwordx4 v1, s[12:15], s50 offen  lds
    s_add_u32 s50, s38, 9216
    s_add_u32 m0, s39, 1024
    s_nop 0
    buffer_load_dwordx4 v2, s[12:15], s50 offen  lds
    s_add_u32 s50, s38, 18432
    s_add_u32 m0, s39, 2048
    s_nop 0
    buffer_load_dwordx4 v1, s[12:15], s50 offen  lds
    s_add_u32 s50, s38, 27648
    s_add_u32 m0, s39, 3072
    s_nop 0
    buffer_load_dwordx4 v2, s[12:15], s50 offen  lds
    s_add_u32 s38, s38, 128
    s_add_u32 s39, s39, 16384
    s_and_b32 s39, s39, 0x1ffff
    v_add_u32 v7, s41, v3
    v_add_u32 v8, s41, v4
    s_add_u32 s41, s41, 16384
    s_and_b32 s41, s41, 0x1ffff
    ds_read_b128 v[80:83], v7 offset:0
    ds_read_b128 v[84:87], v7 offset:2048
    ds_read_b128 v[88:91], v7 offset:4096
    ds_read_b128 v[92:95], v7 offset:6144
    ds_read_b128 v[96:99], v7 offset:8192
    ds_read_b128 v[100:103], v7 offset:10240
    ds_read_b128 v[104:107], v7 offset:12288
    ds_read_b128 v[108:111], v7 offset:14336
    s_waitcnt lgkmcnt(7)
    v_mfma_f32_16x16x32_bf16 v[16:19], a[32:35], v[80:83], v[16:19]
    v_mfma_f32_16x16x32_bf16 v[20:23], a[104:107], v[80:83], v[20:23]
    ds_read_b128 v[112:115], v8 offset:0
    s_waitcnt lgkmcnt(7)
    v_mfma_f32_16x16x32_bf16 v[24:27], a[32:35], v[84:87], v[24:27]
    v_mfma_f32_16x16x32_bf16 v[28:31], a[104:107], v[84:87], v[28:31]
    ds_read_b128 v[116:119], v8 offset:2048
    s_waitcnt lgkmcnt(7)
    v_mfma_f32_16x16x32_bf16 v[32:35], a[32:35], v[88:91], v[32:35]
    v_mfma_f32_16x16x32_bf16 v[36:39], a[104:107], v[88:91], v[36:39]
    ds_read_b128 v[120:123], v8 offset:4096
    s_waitcnt lgkmcnt(7)
    v_mfma_f32_16x16x32_bf16 v[40:43], a[32:35], v[92:95], v[40:43]
    v_mfma_f32_16x16x32_bf16 v[44:47], a[104:107], v[92:95], v[44:47]
    ds_read_b128 v[124:127], v8 offset:6144
    s_waitcnt lgkmcnt(7)
    v_mfma_f32_16x16x32_bf16 v[48:51], a[32:35], v[96:99], v[48:51]
    v_mfma_f32_16x16x32_bf16 v[52:55], a[104:107], v[96:99], v[52:55]
    ds_read_b128 v[128:131], v8 offset:8192
    s_waitcnt lgkmcnt(7)
    v_mfma_f32_16x16x32_bf16 v[56:59], a[32:35], v[100:103], v[56:59]
    v_mfma_f32_16x16x32_bf16 v[60:63], a[104:107], v[100:103], v[60:63]
    ds_read_b128 v[132:135], v8 offset:10240
    s_waitcnt lgkmcnt(7)
    v_mfma_f32_16x16x32_bf16 v[64:67], a[32:35], v[104:107], v[64:67]
    v_mfma_f32_16x16x32_bf16 v[68:71], a[104:107], v[104:107], v[68:71]
    ds_read_b128 v[136:139], v8 offset:12288
    s_waitcnt lgkmcnt(7)
    v_mfma_f32_16x16x32_bf16 v[72:75], a[32:35], v[108:111], v[72:75]
    v_mfma_f32_16x16x32_bf16 v[76:79], a[104:107], v[108:111], v[76:79]
    ds_read_b128 v[140:143], v8 offset:14336
    s_waitcnt lgkmcnt(7)
    v_mfma_f32_16x16x32_bf16 v[16:19], a[36:39], v[112:115], v[16:19]
    v_mfma_f32_16x16x32_bf16 v[20:23], a[108:111], v[112:115], v[20:23]
    s_waitcnt lgkmcnt(6)
    v_mfma_f32_16x16x32_bf16 v[24:27], a[36:39], v[116:119], v[24:27]
    v_mfma_f32_16x16x32_bf16 v[28:31], a[108:111], v[116:119], v[28:31]
    s_waitcnt lgkmcnt(5)
    v_mfma_f32_16x16x32_bf16 v[32:35], a[36:39], v[120:123], v[32:35]
    v_mfma_f32_16x16x32_bf16 v[36:39], a[108:111], v[120:123], v[36:39]
    s_waitcnt lgkmcnt(4)
    v_mfma_f32_16x16x32_bf16 v[40:43], a[36:39], v[124:127], v[40:43]
    v_mfma_f32_16x16x32_bf16 v[44:47], a[108:111], v[124:127], v[44:47]
    s_waitcnt lgkmcnt(3)
    v_mfma_f32_16x16x32_bf16 v[48:51], a[36:39], v[128:131], v[48:51]
    v_mfma_f32_16x16x32_bf16 v[52:55], a[108:111], v[128:131], v[52:55]
    s_waitcnt lgkmcnt(2)
    v_mfma_f32_16x16x32_bf16 v[56:59], a[36:39], v[132:135], v[56:59]
    v_mfma_f32_16x16x32_bf16 v[60:63], a[108:111], v[132:135], v[60:63]
    s_waitcnt lgkmcnt(1)
    v_mfma_f32_16x16x32_bf16 v[64:67], a[36:39], v[136:139], v[64:67]
    v_mfma_f32_16x16x32_bf16 v[68:71], a[108:111], v[136:139], v[68:71]
    s_waitcnt lgkmcnt(0)
    v_mfma_f32_16x16x32_bf16 v[72:75], a[36:39], v[140:143], v[72:75]
    v_mfma_f32_16x16x32_bf16 v[76:79], a[108:111], v[140:143], v[76:79]
    s_waitcnt vmcnt(28)
    s_barrier
    s_add_u32 s50, s38, 0
    s_add_u32 m0, s39, 0
    s_nop 0
    buffer_load_dwordx4 v1, s[12:15], s50 offen  lds
    s_add_u32 s50, s38, 9216
    s_add_u32 m0, s39, 1024
    s_nop 0
    buffer_load_dwordx4 v2, s[12:15], s50 offen  lds
    s_add_u32 s50, s38, 18432
    s_add_u32 m0, s39, 2048
    s_nop 0
    buffer_load_dwordx4 v1, s[12:15], s50 offen  lds
    s_add_u32 s50, s38, 27648
    s_add_u32 m0, s39, 3072
    s_nop 0
    buffer_load_dwordx4 v2, s[12:15], s50 offen  lds
    s_add_u32 s38, s38, 128
    s_add_u32 s39, s39, 16384
    s_and_b32 s39, s39, 0x1ffff
    v_add_u32 v7, s41, v3
    v_add_u32 v8, s41, v4
    s_add_u32 s41, s41, 16384
    s_and_b32 s41, s41, 0x1ffff
    ds_read_b128 v[80:83], v7 offset:0
    ds_read_b128 v[84:87], v7 offset:2048
    ds_read_b128 v[88:91], v7 offset:4096
    ds_read_b128 v[92:95], v7 offset:6144
    ds_read_b128 v[96:99], v7 offset:8192
    ds_read_b128 v[100:103], v7 offset:10240
    ds_read_b128 v[104:107], v7 offset:12288
    ds_read_b128 v[108:111], v7 offset:14336
    s_waitcnt lgkmcnt(7)
    v_mfma_f32_16x16x32_bf16 v[16:19], a[40:43], v[80:83], v[16:19]
    v_mfma_f32_16x16x32_bf16 v[20:23], a[112:115], v[80:83], v[20:23]
    ds_read_b128 v[112:115], v8 offset:0
    s_waitcnt lgkmcnt(7)
    v_mfma_f32_16x16x32_bf16 v[24:27], a[40:43], v[84:87], v[24:27]
    v_mfma_f32_16x16x32_bf16 v[28:31], a[112:115], v[84:87], v[28:31]
    ds_read_b128 v[116:119], v8 offset:2048
    s_waitcnt lgkmcnt(7)
    v_mfma_f32_16x16x32_bf16 v[32:35], a[40:43], v[88:91], v[32:35]
    v_mfma_f32_16x16x32_bf16 v[36:39], a[112:115], v[88:91], v[36:39]
    ds_read_b128 v[120:123], v8 offset:4096
    s_waitcnt lgkmcnt(7)
    v_mfma_f32_16x16x32_bf16 v[40:43], a[40:43], v[92:95], v[40:43]
    v_mfma_f32_16x16x32_bf16 v[44:47], a[112:115], v[92:95], v[44:47]
    ds_read_b128 v[124:127], v8 offset:6144
    s_waitcnt lgkmcnt(7)
    v_mfma_f32_16x16x32_bf16 v[48:51], a[40:43], v[96:99], v[48:51]
    v_mfma_f32_16x16x32_bf16 v[52:55], a[112:115], v[96:99], v[52:55]
    ds_read_b128 v[128:131], v8 offset:8192
    s_waitcnt lgkmcnt(7)
    v_mfma_f32_16x16x32_bf16 v[56:59], a[40:43], v[100:103], v[56:59]
    v_mfma_f32_16x16x32_bf16 v[60:63], a[112:115], v[100:103], v[60:63]
    ds_read_b128 v[132:135], v8 offset:10240
    s_waitcnt lgkmcnt(7)
    v_mfma_f32_16x16x32_bf16 v[64:67], a[40:43], v[104:107], v[64:67]
    v_mfma_f32_16x16x32_bf16 v[68:71], a[112:115], v[104:107], v[68:71]
    ds_read_b128 v[136:139], v8 offset:12288
    s_waitcnt lgkmcnt(7)
    v_mfma_f32_16x16x32_bf16 v[72:75], a[40:43], v[108:111], v[72:75]
    v_mfma_f32_16x16x32_bf16 v[76:79], a[112:115], v[108:111], v[76:79]
    ds_read_b128 v[140:143], v8 offset:14336
    s_waitcnt lgkmcnt(7)
    v_mfma_f32_16x16x32_bf16 v[16:19], a[44:47], v[112:115], v[16:19]
    v_mfma_f32_16x16x32_bf16 v[20:23], a[116:119], v[112:115], v[20:23]
    s_waitcnt lgkmcnt(6)
    v_mfma_f32_16x16x32_bf16 v[24:27], a[44:47], v[116:119], v[24:27]
    v_mfma_f32_16x16x32_bf16 v[28:31], a[116:119], v[116:119], v[28:31]
    s_waitcnt lgkmcnt(5)
    v_mfma_f32_16x16x32_bf16 v[32:35], a[44:47], v[120:123], v[32:35]
    v_mfma_f32_16x16x32_bf16 v[36:39], a[116:119], v[120:123], v[36:39]
    s_waitcnt lgkmcnt(4)
    v_mfma_f32_16x16x32_bf16 v[40:43], a[44:47], v[124:127], v[40:43]
    v_mfma_f32_16x16x32_bf16 v[44:47], a[116:119], v[124:127], v[44:47]
    s_waitcnt lgkmcnt(3)
    v_mfma_f32_16x16x32_bf16 v[48:51], a[44:47], v[128:131], v[48:51]
    v_mfma_f32_16x16x32_bf16 v[52:55], a[116:119], v[128:131], v[52:55]
    s_waitcnt lgkmcnt(2)
    v_mfma_f32_16x16x32_bf16 v[56:59], a[44:47], v[132:135], v[56:59]
    v_mfma_f32_16x16x32_bf16 v[60:63], a[116:119], v[132:135], v[60:63]
    s_waitcnt lgkmcnt(1)
    v_mfma_f32_16x16x32_bf16 v[64:67], a[44:47], v[136:139], v[64:67]
    v_mfma_f32_16x16x32_bf16 v[68:71], a[116:119], v[136:139], v[68:71]
    s_waitcnt lgkmcnt(0)
    v_mfma_f32_16x16x32_bf16 v[72:75], a[44:47], v[140:143], v[72:75]
    v_mfma_f32_16x16x32_bf16 v[76:79], a[116:119], v[140:143], v[76:79]
    s_waitcnt vmcnt(20)
    s_barrier
    s_add_u32 s50, s38, 0
    s_add_u32 m0, s39, 0
    s_nop 0
    buffer_load_dwordx4 v1, s[12:15], s50 offen  lds
    s_add_u32 s50, s38, 9216
    s_add_u32 m0, s39, 1024
    s_nop 0
    buffer_load_dwordx4 v2, s[12:15], s50 offen  lds
    s_add_u32 s50, s38, 18432
    s_add_u32 m0, s39, 2048
    s_nop 0
    buffer_load_dwordx4 v1, s[12:15], s50 offen  lds
    s_add_u32 s50, s38, 27648
    s_add_u32 m0, s39, 3072
    s_nop 0
    buffer_load_dwordx4 v2, s[12:15], s50 offen  lds
    s_add_u32 s38, s38, 128
    s_add_u32 s39, s39, 16384
    s_and_b32 s39, s39, 0x1ffff
    v_add_u32 v7, s41, v3
    v_add_u32 v8, s41, v4
    s_add_u32 s41, s41, 16384
    s_and_b32 s41, s41, 0x1ffff
    ds_read_b128 v[80:83], v7 offset:0
    ds_read_b128 v[84:87], v7 offset:2048
    ds_read_b128 v[88:91], v7 offset:4096
    ds_read_b128 v[92:95], v7 offset:6144
    ds_read_b128 v[96:99], v7 offset:8192
    ds_read_b128 v[100:103], v7 offset:10240
    ds_read_b128 v[104:107], v7 offset:12288
    ds_read_b128 v[108:111], v7 offset:14336
    s_waitcnt lgkmcnt(7)
    v_mfma_f32_16x16x32_bf16 v[16:19], a[48:51], v[80:83], v[16:19]
    v_mfma_f32_16x16x32_bf16 v[20:23], a[120:123], v[80:83], v[20:23]
    ds_read_b128 v[112:115], v8 offset:0
    s_waitcnt lgkmcnt(7)
    v_mfma_f32_16x16x32_bf16 v[24:27], a[48:51], v[84:87], v[24:27]
    v_mfma_f32_16x16x32_bf16 v[28:31], a[120:123], v[84:87], v[28:31]
    ds_read_b128 v[116:119], v8 offset:2048
    s_waitcnt lgkmcnt(7)
    v_mfma_f32_16x16x32_bf16 v[32:35], a[48:51], v[88:91], v[32:35]
    v_mfma_f32_16x16x32_bf16 v[36:39], a[120:123], v[88:91], v[36:39]
    ds_read_b128 v[120:123], v8 offset:4096
    s_waitcnt lgkmcnt(7)
    v_mfma_f32_16x16x32_bf16 v[40:43], a[48:51], v[92:95], v[40:43]
    v_mfma_f32_16x16x32_bf16 v[44:47], a[120:123], v[92:95], v[44:47]
    ds_read_b128 v[124:127], v8 offset:6144
    s_waitcnt lgkmcnt(7)
    v_mfma_f32_16x16x32_bf16 v[48:51], a[48:51], v[96:99], v[48:51]
    v_mfma_f32_16x16x32_bf16 v[52:55], a[120:123], v[96:99], v[52:55]
    ds_read_b128 v[128:131], v8 offset:8192
    s_waitcnt lgkmcnt(7)
    v_mfma_f32_16x16x32_bf16 v[56:59], a[48:51], v[100:103], v[56:59]
    v_mfma_f32_16x16x32_bf16 v[60:63], a[120:123], v[100:103], v[60:63]
    ds_read_b128 v[132:135], v8 offset:10240
    s_waitcnt lgkmcnt(7)
    v_mfma_f32_16x16x32_bf16 v[64:67], a[48:51], v[104:107], v[64:67]
    v_mfma_f32_16x16x32_bf16 v[68:71], a[120:123], v[104:107], v[68:71]
    ds_read_b128 v[136:139], v8 offset:12288
    s_waitcnt lgkmcnt(7)
    v_mfma_f32_16x16x32_bf16 v[72:75], a[48:51], v[108:111], v[72:75]
    v_mfma_f32_16x16x32_bf16 v[76:79], a[120:123], v[108:111], v[76:79]
    ds_read_b128 v[140:143], v8 offset:14336
    s_waitcnt lgkmcnt(7)
    v_mfma_f32_16x16x32_bf16 v[16:19], a[52:55], v[112:115], v[16:19]
    v_mfma_f32_16x16x32_bf16 v[20:23], a[124:127], v[112:115], v[20:23]
    s_waitcnt lgkmcnt(6)
    v_mfma_f32_16x16x32_bf16 v[24:27], a[52:55], v[116:119], v[24:27]
    v_mfma_f32_16x16x32_bf16 v[28:31], a[124:127], v[116:119], v[28:31]
    s_waitcnt lgkmcnt(5)
    v_mfma_f32_16x16x32_bf16 v[32:35], a[52:55], v[120:123], v[32:35]
    v_mfma_f32_16x16x32_bf16 v[36:39], a[124:127], v[120:123], v[36:39]
    s_waitcnt lgkmcnt(4)
    v_mfma_f32_16x16x32_bf16 v[40:43], a[52:55], v[124:127], v[40:43]
    v_mfma_f32_16x16x32_bf16 v[44:47], a[124:127], v[124:127], v[44:47]
    s_waitcnt lgkmcnt(3)
    v_mfma_f32_16x16x32_bf16 v[48:51], a[52:55], v[128:131], v[48:51]
    v_mfma_f32_16x16x32_bf16 v[52:55], a[124:127], v[128:131], v[52:55]
    s_waitcnt lgkmcnt(2)
    v_mfma_f32_16x16x32_bf16 v[56:59], a[52:55], v[132:135], v[56:59]
    v_mfma_f32_16x16x32_bf16 v[60:63], a[124:127], v[132:135], v[60:63]
    s_waitcnt lgkmcnt(1)
    v_mfma_f32_16x16x32_bf16 v[64:67], a[52:55], v[136:139], v[64:67]
    v_mfma_f32_16x16x32_bf16 v[68:71], a[124:127], v[136:139], v[68:71]
    s_waitcnt lgkmcnt(0)
    v_mfma_f32_16x16x32_bf16 v[72:75], a[52:55], v[140:143], v[72:75]
    v_mfma_f32_16x16x32_bf16 v[76:79], a[124:127], v[140:143], v[76:79]
    s_waitcnt vmcnt(20)
    s_barrier
    s_add_u32 s50, s38, 0
    s_add_u32 m0, s39, 0
    s_nop 0
    buffer_load_dwordx4 v1, s[12:15], s50 offen  lds
    s_add_u32 s50, s38, 9216
    s_add_u32 m0, s39, 1024
    s_nop 0
    buffer_load_dwordx4 v2, s[12:15], s50 offen  lds
    s_add_u32 s50, s38, 18432
    s_add_u32 m0, s39, 2048
    s_nop 0
    buffer_load_dwordx4 v1, s[12:15], s50 offen  lds
    s_add_u32 s50, s38, 27648
    s_add_u32 m0, s39, 3072
    s_nop 0
    buffer_load_dwordx4 v2, s[12:15], s50 offen  lds
    s_add_u32 s38, s38, 128
    s_add_u32 s39, s39, 16384
    s_and_b32 s39, s39, 0x1ffff
    v_add_u32 v7, s41, v3
    v_add_u32 v8, s41, v4
    s_add_u32 s41, s41, 16384
    s_and_b32 s41, s41, 0x1ffff
    ds_read_b128 v[80:83], v7 offset:0
    ds_read_b128 v[84:87], v7 offset:2048
    ds_read_b128 v[88:91], v7 offset:4096
    ds_read_b128 v[92:95], v7 offset:6144
    ds_read_b128 v[96:99], v7 offset:8192
    ds_read_b128 v[100:103], v7 offset:10240
    ds_read_b128 v[104:107], v7 offset:12288
    ds_read_b128 v[108:111], v7 offset:14336
    s_waitcnt lgkmcnt(7)
    v_mfma_f32_16x16x32_bf16 v[16:19], a[56:59], v[80:83], v[16:19]
    v_mfma_f32_16x16x32_bf16 v[20:23], a[128:131], v[80:83], v[20:23]
    ds_read_b128 v[112:115], v8 offset:0
    s_waitcnt lgkmcnt(7)
    v_mfma_f32_16x16x32_bf16 v[24:27], a[56:59], v[84:87], v[24:27]
    v_mfma_f32_16x16x32_bf16 v[28:31], a[128:131], v[84:87], v[28:31]
    ds_read_b128 v[116:119], v8 offset:2048
    s_waitcnt lgkmcnt(7)
    v_mfma_f32_16x16x32_bf16 v[32:35], a[56:59], v[88:91], v[32:35]
    v_mfma_f32_16x16x32_bf16 v[36:39], a[128:131], v[88:91], v[36:39]
    ds_read_b128 v[120:123], v8 offset:4096
    s_waitcnt lgkmcnt(7)
    v_mfma_f32_16x16x32_bf16 v[40:43], a[56:59], v[92:95], v[40:43]
    v_mfma_f32_16x16x32_bf16 v[44:47], a[128:131], v[92:95], v[44:47]
    ds_read_b128 v[124:127], v8 offset:6144
    s_waitcnt lgkmcnt(7)
    v_mfma_f32_16x16x32_bf16 v[48:51], a[56:59], v[96:99], v[48:51]
    v_mfma_f32_16x16x32_bf16 v[52:55], a[128:131], v[96:99], v[52:55]
    ds_read_b128 v[128:131], v8 offset:8192
    s_waitcnt lgkmcnt(7)
    v_mfma_f32_16x16x32_bf16 v[56:59], a[56:59], v[100:103], v[56:59]
    v_mfma_f32_16x16x32_bf16 v[60:63], a[128:131], v[100:103], v[60:63]
    ds_read_b128 v[132:135], v8 offset:10240
    s_waitcnt lgkmcnt(7)
    v_mfma_f32_16x16x32_bf16 v[64:67], a[56:59], v[104:107], v[64:67]
    v_mfma_f32_16x16x32_bf16 v[68:71], a[128:131], v[104:107], v[68:71]
    ds_read_b128 v[136:139], v8 offset:12288
    s_waitcnt lgkmcnt(7)
    v_mfma_f32_16x16x32_bf16 v[72:75], a[56:59], v[108:111], v[72:75]
    v_mfma_f32_16x16x32_bf16 v[76:79], a[128:131], v[108:111], v[76:79]
    ds_read_b128 v[140:143], v8 offset:14336
    s_waitcnt lgkmcnt(7)
    v_mfma_f32_16x16x32_bf16 v[16:19], a[60:63], v[112:115], v[16:19]
    v_mfma_f32_16x16x32_bf16 v[20:23], a[132:135], v[112:115], v[20:23]
    s_waitcnt lgkmcnt(6)
    v_mfma_f32_16x16x32_bf16 v[24:27], a[60:63], v[116:119], v[24:27]
    v_mfma_f32_16x16x32_bf16 v[28:31], a[132:135], v[116:119], v[28:31]
    s_waitcnt lgkmcnt(5)
    v_mfma_f32_16x16x32_bf16 v[32:35], a[60:63], v[120:123], v[32:35]
    v_mfma_f32_16x16x32_bf16 v[36:39], a[132:135], v[120:123], v[36:39]
    s_waitcnt lgkmcnt(4)
    v_mfma_f32_16x16x32_bf16 v[40:43], a[60:63], v[124:127], v[40:43]
    v_mfma_f32_16x16x32_bf16 v[44:47], a[132:135], v[124:127], v[44:47]
    s_waitcnt lgkmcnt(3)
    v_mfma_f32_16x16x32_bf16 v[48:51], a[60:63], v[128:131], v[48:51]
    v_mfma_f32_16x16x32_bf16 v[52:55], a[132:135], v[128:131], v[52:55]
    s_waitcnt lgkmcnt(2)
    v_mfma_f32_16x16x32_bf16 v[56:59], a[60:63], v[132:135], v[56:59]
    v_mfma_f32_16x16x32_bf16 v[60:63], a[132:135], v[132:135], v[60:63]
    s_waitcnt lgkmcnt(1)
    v_mfma_f32_16x16x32_bf16 v[64:67], a[60:63], v[136:139], v[64:67]
    v_mfma_f32_16x16x32_bf16 v[68:71], a[132:135], v[136:139], v[68:71]
    s_waitcnt lgkmcnt(0)
    v_mfma_f32_16x16x32_bf16 v[72:75], a[60:63], v[140:143], v[72:75]
    v_mfma_f32_16x16x32_bf16 v[76:79], a[132:135], v[140:143], v[76:79]
    s_waitcnt vmcnt(20)
    s_barrier
    s_add_u32 s50, s38, 0
    s_add_u32 m0, s39, 0
    s_nop 0
    buffer_load_dwordx4 v1, s[12:15], s50 offen  lds
    s_add_u32 s50, s38, 9216
    s_add_u32 m0, s39, 1024
    s_nop 0
    buffer_load_dwordx4 v2, s[12:15], s50 offen  lds
    s_add_u32 s50, s38, 18432
    s_add_u32 m0, s39, 2048
    s_nop 0
    buffer_load_dwordx4 v1, s[12:15], s50 offen  lds
    s_add_u32 s50, s38, 27648
    s_add_u32 m0, s39, 3072
    s_nop 0
    buffer_load_dwordx4 v2, s[12:15], s50 offen  lds
    s_add_u32 s38, s38, 128
    s_add_u32 s39, s39, 16384
    s_and_b32 s39, s39, 0x1ffff
    v_add_u32 v7, s41, v3
    v_add_u32 v8, s41, v4
    s_add_u32 s41, s41, 16384
    s_and_b32 s41, s41, 0x1ffff
    ds_read_b128 v[80:83], v7 offset:0
    ds_read_b128 v[84:87], v7 offset:2048
    ds_read_b128 v[88:91], v7 offset:4096
    ds_read_b128 v[92:95], v7 offset:6144
    ds_read_b128 v[96:99], v7 offset:8192
    ds_read_b128 v[100:103], v7 offset:10240
    ds_read_b128 v[104:107], v7 offset:12288
    ds_read_b128 v[108:111], v7 offset:14336
    s_waitcnt lgkmcnt(7)
    v_mfma_f32_16x16x32_bf16 v[16:19], a[64:67], v[80:83], v[16:19]
    v_mfma_f32_16x16x32_bf16 v[20:23], a[136:139], v[80:83], v[20:23]
    ds_read_b128 v[112:115], v8 offset:0
    s_waitcnt lgkmcnt(7)
    v_mfma_f32_16x16x32_bf16 v[24:27], a[64:67], v[84:87], v[24:27]
    v_mfma_f32_16x16x32_bf16 v[28:31], a[136:139], v[84:87], v[28:31]
    ds_read_b128 v[116:119], v8 offset:2048
    s_waitcnt lgkmcnt(7)
    v_mfma_f32_16x16x32_bf16 v[32:35], a[64:67], v[88:91], v[32:35]
    v_mfma_f32_16x16x32_bf16 v[36:39], a[136:139], v[88:91], v[36:39]
    ds_read_b128 v[120:123], v8 offset:4096
    s_waitcnt lgkmcnt(7)
    v_mfma_f32_16x16x32_bf16 v[40:43], a[64:67], v[92:95], v[40:43]
    v_mfma_f32_16x16x32_bf16 v[44:47], a[136:139], v[92:95], v[44:47]
    ds_read_b128 v[124:127], v8 offset:6144
    s_waitcnt lgkmcnt(7)
    v_mfma_f32_16x16x32_bf16 v[48:51], a[64:67], v[96:99], v[48:51]
    v_mfma_f32_16x16x32_bf16 v[52:55], a[136:139], v[96:99], v[52:55]
    ds_read_b128 v[128:131], v8 offset:8192
    s_waitcnt lgkmcnt(7)
    v_mfma_f32_16x16x32_bf16 v[56:59], a[64:67], v[100:103], v[56:59]
    v_mfma_f32_16x16x32_bf16 v[60:63], a[136:139], v[100:103], v[60:63]
    ds_read_b128 v[132:135], v8 offset:10240
    s_waitcnt lgkmcnt(7)
    v_mfma_f32_16x16x32_bf16 v[64:67], a[64:67], v[104:107], v[64:67]
    v_mfma_f32_16x16x32_bf16 v[68:71], a[136:139], v[104:107], v[68:71]
    ds_read_b128 v[136:139], v8 offset:12288
    s_waitcnt lgkmcnt(7)
    v_mfma_f32_16x16x32_bf16 v[72:75], a[64:67], v[108:111], v[72:75]
    v_mfma_f32_16x16x32_bf16 v[76:79], a[136:139], v[108:111], v[76:79]
    ds_read_b128 v[140:143], v8 offset:14336
    s_waitcnt lgkmcnt(7)
    v_mfma_f32_16x16x32_bf16 v[16:19], a[68:71], v[112:115], v[16:19]
    v_mfma_f32_16x16x32_bf16 v[20:23], a[140:143], v[112:115], v[20:23]
    s_waitcnt lgkmcnt(6)
    v_mfma_f32_16x16x32_bf16 v[24:27], a[68:71], v[116:119], v[24:27]
    v_mfma_f32_16x16x32_bf16 v[28:31], a[140:143], v[116:119], v[28:31]
    s_waitcnt lgkmcnt(5)
    v_mfma_f32_16x16x32_bf16 v[32:35], a[68:71], v[120:123], v[32:35]
    v_mfma_f32_16x16x32_bf16 v[36:39], a[140:143], v[120:123], v[36:39]
    s_waitcnt lgkmcnt(4)
    v_mfma_f32_16x16x32_bf16 v[40:43], a[68:71], v[124:127], v[40:43]
    v_mfma_f32_16x16x32_bf16 v[44:47], a[140:143], v[124:127], v[44:47]
    s_waitcnt lgkmcnt(3)
    v_mfma_f32_16x16x32_bf16 v[48:51], a[68:71], v[128:131], v[48:51]
    v_mfma_f32_16x16x32_bf16 v[52:55], a[140:143], v[128:131], v[52:55]
    s_waitcnt lgkmcnt(2)
    v_mfma_f32_16x16x32_bf16 v[56:59], a[68:71], v[132:135], v[56:59]
    v_mfma_f32_16x16x32_bf16 v[60:63], a[140:143], v[132:135], v[60:63]
    s_waitcnt lgkmcnt(1)
    v_mfma_f32_16x16x32_bf16 v[64:67], a[68:71], v[136:139], v[64:67]
    v_mfma_f32_16x16x32_bf16 v[68:71], a[140:143], v[136:139], v[68:71]
    s_waitcnt lgkmcnt(0)
    v_mfma_f32_16x16x32_bf16 v[72:75], a[68:71], v[140:143], v[72:75]
    v_mfma_f32_16x16x32_bf16 v[76:79], a[140:143], v[140:143], v[76:79]
    s_mov_b32 s58, 0x3fb8aa3b
    s_mov_b32 s59, 0x358637bd
    v_cvt_pk_bf16_f32 v160, v16, v17
    v_lshlrev_b32 v161, 16, v160
    v_and_b32 v162, 0xffff0000, v160
    v_mul_f32 v163, s58, v161
    v_mul_f32 v164, s58, v162
    v_exp_f32 v163, v163
    v_exp_f32 v164, v164
    v_add_f32 v165, 1.0, v161
    v_add_f32 v166, 1.0, v162
    v_cmp_lt_f32 vcc, 0, v161
    s_nop 1
    v_cndmask_b32 v163, v163, v165, vcc
    v_cmp_lt_f32 vcc, 0, v162
    s_nop 1
    v_cndmask_b32 v164, v164, v166, vcc
    v_cvt_pk_bf16_f32 v160, v163, v164
    v_lshlrev_b32 v161, 16, v160
    v_and_b32 v162, 0xffff0000, v160
    v_add_f32 v161, s59, v161
    v_add_f32 v162, s59, v162
    v_cvt_pk_bf16_f32 v144, v161, v162
    v_cvt_pk_bf16_f32 v160, v18, v19
    v_lshlrev_b32 v161, 16, v160
    v_and_b32 v162, 0xffff0000, v160
    v_mul_f32 v163, s58, v161
    v_mul_f32 v164, s58, v162
    v_exp_f32 v163, v163
    v_exp_f32 v164, v164
    v_add_f32 v165, 1.0, v161
    v_add_f32 v166, 1.0, v162
    v_cmp_lt_f32 vcc, 0, v161
    s_nop 1
    v_cndmask_b32 v163, v163, v165, vcc
    v_cmp_lt_f32 vcc, 0, v162
    s_nop 1
    v_cndmask_b32 v164, v164, v166, vcc
    v_cvt_pk_bf16_f32 v160, v163, v164
    v_lshlrev_b32 v161, 16, v160
    v_and_b32 v162, 0xffff0000, v160
    v_add_f32 v161, s59, v161
    v_add_f32 v162, s59, v162
    v_cvt_pk_bf16_f32 v145, v161, v162
    v_cvt_pk_bf16_f32 v160, v20, v21
    v_lshlrev_b32 v161, 16, v160
    v_and_b32 v162, 0xffff0000, v160
    v_mul_f32 v163, s58, v161
    v_mul_f32 v164, s58, v162
    v_exp_f32 v163, v163
    v_exp_f32 v164, v164
    v_add_f32 v165, 1.0, v161
    v_add_f32 v166, 1.0, v162
    v_cmp_lt_f32 vcc, 0, v161
    s_nop 1
    v_cndmask_b32 v163, v163, v165, vcc
    v_cmp_lt_f32 vcc, 0, v162
    s_nop 1
    v_cndmask_b32 v164, v164, v166, vcc
    v_cvt_pk_bf16_f32 v160, v163, v164
    v_lshlrev_b32 v161, 16, v160
    v_and_b32 v162, 0xffff0000, v160
    v_add_f32 v161, s59, v161
    v_add_f32 v162, s59, v162
    v_cvt_pk_bf16_f32 v146, v161, v162
    v_cvt_pk_bf16_f32 v160, v22, v23
    v_lshlrev_b32 v161, 16, v160
    v_and_b32 v162, 0xffff0000, v160
    v_mul_f32 v163, s58, v161
    v_mul_f32 v164, s58, v162
    v_exp_f32 v163, v163
    v_exp_f32 v164, v164
    v_add_f32 v165, 1.0, v161
    v_add_f32 v166, 1.0, v162
    v_cmp_lt_f32 vcc, 0, v161
    s_nop 1
    v_cndmask_b32 v163, v163, v165, vcc
    v_cmp_lt_f32 vcc, 0, v162
    s_nop 1
    v_cndmask_b32 v164, v164, v166, vcc
    v_cvt_pk_bf16_f32 v160, v163, v164
    v_lshlrev_b32 v161, 16, v160
    v_and_b32 v162, 0xffff0000, v160
    v_add_f32 v161, s59, v161
    v_add_f32 v162, s59, v162
    v_cvt_pk_bf16_f32 v147, v161, v162
    s_add_u32 s50, s36, 0
    buffer_store_dwordx4 v[144:147], v0, s[4:7], s50 offen sc1
    v_cvt_pk_bf16_f32 v160, v24, v25
    v_lshlrev_b32 v161, 16, v160
    v_and_b32 v162, 0xffff0000, v160
    v_mul_f32 v163, s58, v161
    v_mul_f32 v164, s58, v162
    v_exp_f32 v163, v163
    v_exp_f32 v164, v164
    v_add_f32 v165, 1.0, v161
    v_add_f32 v166, 1.0, v162
    v_cmp_lt_f32 vcc, 0, v161
    s_nop 1
    v_cndmask_b32 v163, v163, v165, vcc
    v_cmp_lt_f32 vcc, 0, v162
    s_nop 1
    v_cndmask_b32 v164, v164, v166, vcc
    v_cvt_pk_bf16_f32 v160, v163, v164
    v_lshlrev_b32 v161, 16, v160
    v_and_b32 v162, 0xffff0000, v160
    v_add_f32 v161, s59, v161
    v_add_f32 v162, s59, v162
    v_cvt_pk_bf16_f32 v148, v161, v162
    v_cvt_pk_bf16_f32 v160, v26, v27
    v_lshlrev_b32 v161, 16, v160
    v_and_b32 v162, 0xffff0000, v160
    v_mul_f32 v163, s58, v161
    v_mul_f32 v164, s58, v162
    v_exp_f32 v163, v163
    v_exp_f32 v164, v164
    v_add_f32 v165, 1.0, v161
    v_add_f32 v166, 1.0, v162
    v_cmp_lt_f32 vcc, 0, v161
    s_nop 1
    v_cndmask_b32 v163, v163, v165, vcc
    v_cmp_lt_f32 vcc, 0, v162
    s_nop 1
    v_cndmask_b32 v164, v164, v166, vcc
    v_cvt_pk_bf16_f32 v160, v163, v164
    v_lshlrev_b32 v161, 16, v160
    v_and_b32 v162, 0xffff0000, v160
    v_add_f32 v161, s59, v161
    v_add_f32 v162, s59, v162
    v_cvt_pk_bf16_f32 v149, v161, v162
    v_cvt_pk_bf16_f32 v160, v28, v29
    v_lshlrev_b32 v161, 16, v160
    v_and_b32 v162, 0xffff0000, v160
    v_mul_f32 v163, s58, v161
    v_mul_f32 v164, s58, v162
    v_exp_f32 v163, v163
    v_exp_f32 v164, v164
    v_add_f32 v165, 1.0, v161
    v_add_f32 v166, 1.0, v162
    v_cmp_lt_f32 vcc, 0, v161
    s_nop 1
    v_cndmask_b32 v163, v163, v165, vcc
    v_cmp_lt_f32 vcc, 0, v162
    s_nop 1
    v_cndmask_b32 v164, v164, v166, vcc
    v_cvt_pk_bf16_f32 v160, v163, v164
    v_lshlrev_b32 v161, 16, v160
    v_and_b32 v162, 0xffff0000, v160
    v_add_f32 v161, s59, v161
    v_add_f32 v162, s59, v162
    v_cvt_pk_bf16_f32 v150, v161, v162
    v_cvt_pk_bf16_f32 v160, v30, v31
    v_lshlrev_b32 v161, 16, v160
    v_and_b32 v162, 0xffff0000, v160
    v_mul_f32 v163, s58, v161
    v_mul_f32 v164, s58, v162
    v_exp_f32 v163, v163
    v_exp_f32 v164, v164
    v_add_f32 v165, 1.0, v161
    v_add_f32 v166, 1.0, v162
    v_cmp_lt_f32 vcc, 0, v161
    s_nop 1
    v_cndmask_b32 v163, v163, v165, vcc
    v_cmp_lt_f32 vcc, 0, v162
    s_nop 1
    v_cndmask_b32 v164, v164, v166, vcc
    v_cvt_pk_bf16_f32 v160, v163, v164
    v_lshlrev_b32 v161, 16, v160
    v_and_b32 v162, 0xffff0000, v160
    v_add_f32 v161, s59, v161
    v_add_f32 v162, s59, v162
    v_cvt_pk_bf16_f32 v151, v161, v162
    s_add_u32 s50, s36, 20480
    buffer_store_dwordx4 v[148:151], v0, s[4:7], s50 offen sc1
    v_cvt_pk_bf16_f32 v160, v32, v33
    v_lshlrev_b32 v161, 16, v160
    v_and_b32 v162, 0xffff0000, v160
    v_mul_f32 v163, s58, v161
    v_mul_f32 v164, s58, v162
    v_exp_f32 v163, v163
    v_exp_f32 v164, v164
    v_add_f32 v165, 1.0, v161
    v_add_f32 v166, 1.0, v162
    v_cmp_lt_f32 vcc, 0, v161
    s_nop 1
    v_cndmask_b32 v163, v163, v165, vcc
    v_cmp_lt_f32 vcc, 0, v162
    s_nop 1
    v_cndmask_b32 v164, v164, v166, vcc
    v_cvt_pk_bf16_f32 v160, v163, v164
    v_lshlrev_b32 v161, 16, v160
    v_and_b32 v162, 0xffff0000, v160
    v_add_f32 v161, s59, v161
    v_add_f32 v162, s59, v162
    v_cvt_pk_bf16_f32 v152, v161, v162
    v_cvt_pk_bf16_f32 v160, v34, v35
    v_lshlrev_b32 v161, 16, v160
    v_and_b32 v162, 0xffff0000, v160
    v_mul_f32 v163, s58, v161
    v_mul_f32 v164, s58, v162
    v_exp_f32 v163, v163
    v_exp_f32 v164, v164
    v_add_f32 v165, 1.0, v161
    v_add_f32 v166, 1.0, v162
    v_cmp_lt_f32 vcc, 0, v161
    s_nop 1
    v_cndmask_b32 v163, v163, v165, vcc
    v_cmp_lt_f32 vcc, 0, v162
    s_nop 1
    v_cndmask_b32 v164, v164, v166, vcc
    v_cvt_pk_bf16_f32 v160, v163, v164
    v_lshlrev_b32 v161, 16, v160
    v_and_b32 v162, 0xffff0000, v160
    v_add_f32 v161, s59, v161
    v_add_f32 v162, s59, v162
    v_cvt_pk_bf16_f32 v153, v161, v162
    v_cvt_pk_bf16_f32 v160, v36, v37
    v_lshlrev_b32 v161, 16, v160
    v_and_b32 v162, 0xffff0000, v160
    v_mul_f32 v163, s58, v161
    v_mul_f32 v164, s58, v162
    v_exp_f32 v163, v163
    v_exp_f32 v164, v164
    v_add_f32 v165, 1.0, v161
    v_add_f32 v166, 1.0, v162
    v_cmp_lt_f32 vcc, 0, v161
    s_nop 1
    v_cndmask_b32 v163, v163, v165, vcc
    v_cmp_lt_f32 vcc, 0, v162
    s_nop 1
    v_cndmask_b32 v164, v164, v166, vcc
    v_cvt_pk_bf16_f32 v160, v163, v164
    v_lshlrev_b32 v161, 16, v160
    v_and_b32 v162, 0xffff0000, v160
    v_add_f32 v161, s59, v161
    v_add_f32 v162, s59, v162
    v_cvt_pk_bf16_f32 v154, v161, v162
    v_cvt_pk_bf16_f32 v160, v38, v39
    v_lshlrev_b32 v161, 16, v160
    v_and_b32 v162, 0xffff0000, v160
    v_mul_f32 v163, s58, v161
    v_mul_f32 v164, s58, v162
    v_exp_f32 v163, v163
    v_exp_f32 v164, v164
    v_add_f32 v165, 1.0, v161
    v_add_f32 v166, 1.0, v162
    v_cmp_lt_f32 vcc, 0, v161
    s_nop 1
    v_cndmask_b32 v163, v163, v165, vcc
    v_cmp_lt_f32 vcc, 0, v162
    s_nop 1
    v_cndmask_b32 v164, v164, v166, vcc
    v_cvt_pk_bf16_f32 v160, v163, v164
    v_lshlrev_b32 v161, 16, v160
    v_and_b32 v162, 0xffff0000, v160
    v_add_f32 v161, s59, v161
    v_add_f32 v162, s59, v162
    v_cvt_pk_bf16_f32 v155, v161, v162
    s_add_u32 s50, s36, 40960
    buffer_store_dwordx4 v[152:155], v0, s[4:7], s50 offen sc1
    v_cvt_pk_bf16_f32 v160, v40, v41
    v_lshlrev_b32 v161, 16, v160
    v_and_b32 v162, 0xffff0000, v160
    v_mul_f32 v163, s58, v161
    v_mul_f32 v164, s58, v162
    v_exp_f32 v163, v163
    v_exp_f32 v164, v164
    v_add_f32 v165, 1.0, v161
    v_add_f32 v166, 1.0, v162
    v_cmp_lt_f32 vcc, 0, v161
    s_nop 1
    v_cndmask_b32 v163, v163, v165, vcc
    v_cmp_lt_f32 vcc, 0, v162
    s_nop 1
    v_cndmask_b32 v164, v164, v166, vcc
    v_cvt_pk_bf16_f32 v160, v163, v164
    v_lshlrev_b32 v161, 16, v160
    v_and_b32 v162, 0xffff0000, v160
    v_add_f32 v161, s59, v161
    v_add_f32 v162, s59, v162
    v_cvt_pk_bf16_f32 v156, v161, v162
    v_cvt_pk_bf16_f32 v160, v42, v43
    v_lshlrev_b32 v161, 16, v160
    v_and_b32 v162, 0xffff0000, v160
    v_mul_f32 v163, s58, v161
    v_mul_f32 v164, s58, v162
    v_exp_f32 v163, v163
    v_exp_f32 v164, v164
    v_add_f32 v165, 1.0, v161
    v_add_f32 v166, 1.0, v162
    v_cmp_lt_f32 vcc, 0, v161
    s_nop 1
    v_cndmask_b32 v163, v163, v165, vcc
    v_cmp_lt_f32 vcc, 0, v162
    s_nop 1
    v_cndmask_b32 v164, v164, v166, vcc
    v_cvt_pk_bf16_f32 v160, v163, v164
    v_lshlrev_b32 v161, 16, v160
    v_and_b32 v162, 0xffff0000, v160
    v_add_f32 v161, s59, v161
    v_add_f32 v162, s59, v162
    v_cvt_pk_bf16_f32 v157, v161, v162
    v_cvt_pk_bf16_f32 v160, v44, v45
    v_lshlrev_b32 v161, 16, v160
    v_and_b32 v162, 0xffff0000, v160
    v_mul_f32 v163, s58, v161
    v_mul_f32 v164, s58, v162
    v_exp_f32 v163, v163
    v_exp_f32 v164, v164
    v_add_f32 v165, 1.0, v161
    v_add_f32 v166, 1.0, v162
    v_cmp_lt_f32 vcc, 0, v161
    s_nop 1
    v_cndmask_b32 v163, v163, v165, vcc
    v_cmp_lt_f32 vcc, 0, v162
    s_nop 1
    v_cndmask_b32 v164, v164, v166, vcc
    v_cvt_pk_bf16_f32 v160, v163, v164
    v_lshlrev_b32 v161, 16, v160
    v_and_b32 v162, 0xffff0000, v160
    v_add_f32 v161, s59, v161
    v_add_f32 v162, s59, v162
    v_cvt_pk_bf16_f32 v158, v161, v162
    v_cvt_pk_bf16_f32 v160, v46, v47
    v_lshlrev_b32 v161, 16, v160
    v_and_b32 v162, 0xffff0000, v160
    v_mul_f32 v163, s58, v161
    v_mul_f32 v164, s58, v162
    v_exp_f32 v163, v163
    v_exp_f32 v164, v164
    v_add_f32 v165, 1.0, v161
    v_add_f32 v166, 1.0, v162
    v_cmp_lt_f32 vcc, 0, v161
    s_nop 1
    v_cndmask_b32 v163, v163, v165, vcc
    v_cmp_lt_f32 vcc, 0, v162
    s_nop 1
    v_cndmask_b32 v164, v164, v166, vcc
    v_cvt_pk_bf16_f32 v160, v163, v164
    v_lshlrev_b32 v161, 16, v160
    v_and_b32 v162, 0xffff0000, v160
    v_add_f32 v161, s59, v161
    v_add_f32 v162, s59, v162
    v_cvt_pk_bf16_f32 v159, v161, v162
    s_add_u32 s50, s36, 61440
    buffer_store_dwordx4 v[156:159], v0, s[4:7], s50 offen sc1
    v_cvt_pk_bf16_f32 v160, v48, v49
    v_lshlrev_b32 v161, 16, v160
    v_and_b32 v162, 0xffff0000, v160
    v_mul_f32 v163, s58, v161
    v_mul_f32 v164, s58, v162
    v_exp_f32 v163, v163
    v_exp_f32 v164, v164
    v_add_f32 v165, 1.0, v161
    v_add_f32 v166, 1.0, v162
    v_cmp_lt_f32 vcc, 0, v161
    s_nop 1
    v_cndmask_b32 v163, v163, v165, vcc
    v_cmp_lt_f32 vcc, 0, v162
    s_nop 1
    v_cndmask_b32 v164, v164, v166, vcc
    v_cvt_pk_bf16_f32 v160, v163, v164
    v_lshlrev_b32 v161, 16, v160
    v_and_b32 v162, 0xffff0000, v160
    v_add_f32 v161, s59, v161
    v_add_f32 v162, s59, v162
    v_cvt_pk_bf16_f32 v144, v161, v162
    v_cvt_pk_bf16_f32 v160, v50, v51
    v_lshlrev_b32 v161, 16, v160
    v_and_b32 v162, 0xffff0000, v160
    v_mul_f32 v163, s58, v161
    v_mul_f32 v164, s58, v162
    v_exp_f32 v163, v163
    v_exp_f32 v164, v164
    v_add_f32 v165, 1.0, v161
    v_add_f32 v166, 1.0, v162
    v_cmp_lt_f32 vcc, 0, v161
    s_nop 1
    v_cndmask_b32 v163, v163, v165, vcc
    v_cmp_lt_f32 vcc, 0, v162
    s_nop 1
    v_cndmask_b32 v164, v164, v166, vcc
    v_cvt_pk_bf16_f32 v160, v163, v164
    v_lshlrev_b32 v161, 16, v160
    v_and_b32 v162, 0xffff0000, v160
    v_add_f32 v161, s59, v161
    v_add_f32 v162, s59, v162
    v_cvt_pk_bf16_f32 v145, v161, v162
    v_cvt_pk_bf16_f32 v160, v52, v53
    v_lshlrev_b32 v161, 16, v160
    v_and_b32 v162, 0xffff0000, v160
    v_mul_f32 v163, s58, v161
    v_mul_f32 v164, s58, v162
    v_exp_f32 v163, v163
    v_exp_f32 v164, v164
    v_add_f32 v165, 1.0, v161
    v_add_f32 v166, 1.0, v162
    v_cmp_lt_f32 vcc, 0, v161
    s_nop 1
    v_cndmask_b32 v163, v163, v165, vcc
    v_cmp_lt_f32 vcc, 0, v162
    s_nop 1
    v_cndmask_b32 v164, v164, v166, vcc
    v_cvt_pk_bf16_f32 v160, v163, v164
    v_lshlrev_b32 v161, 16, v160
    v_and_b32 v162, 0xffff0000, v160
    v_add_f32 v161, s59, v161
    v_add_f32 v162, s59, v162
    v_cvt_pk_bf16_f32 v146, v161, v162
    v_cvt_pk_bf16_f32 v160, v54, v55
    v_lshlrev_b32 v161, 16, v160
    v_and_b32 v162, 0xffff0000, v160
    v_mul_f32 v163, s58, v161
    v_mul_f32 v164, s58, v162
    v_exp_f32 v163, v163
    v_exp_f32 v164, v164
    v_add_f32 v165, 1.0, v161
    v_add_f32 v166, 1.0, v162
    v_cmp_lt_f32 vcc, 0, v161
    s_nop 1
    v_cndmask_b32 v163, v163, v165, vcc
    v_cmp_lt_f32 vcc, 0, v162
    s_nop 1
    v_cndmask_b32 v164, v164, v166, vcc
    v_cvt_pk_bf16_f32 v160, v163, v164
    v_lshlrev_b32 v161, 16, v160
    v_and_b32 v162, 0xffff0000, v160
    v_add_f32 v161, s59, v161
    v_add_f32 v162, s59, v162
    v_cvt_pk_bf16_f32 v147, v161, v162
    s_add_u32 s50, s36, 81920
    buffer_store_dwordx4 v[144:147], v0, s[4:7], s50 offen sc1
    v_cvt_pk_bf16_f32 v160, v56, v57
    v_lshlrev_b32 v161, 16, v160
    v_and_b32 v162, 0xffff0000, v160
    v_mul_f32 v163, s58, v161
    v_mul_f32 v164, s58, v162
    v_exp_f32 v163, v163
    v_exp_f32 v164, v164
    v_add_f32 v165, 1.0, v161
    v_add_f32 v166, 1.0, v162
    v_cmp_lt_f32 vcc, 0, v161
    s_nop 1
    v_cndmask_b32 v163, v163, v165, vcc
    v_cmp_lt_f32 vcc, 0, v162
    s_nop 1
    v_cndmask_b32 v164, v164, v166, vcc
    v_cvt_pk_bf16_f32 v160, v163, v164
    v_lshlrev_b32 v161, 16, v160
    v_and_b32 v162, 0xffff0000, v160
    v_add_f32 v161, s59, v161
    v_add_f32 v162, s59, v162
    v_cvt_pk_bf16_f32 v148, v161, v162
    v_cvt_pk_bf16_f32 v160, v58, v59
    v_lshlrev_b32 v161, 16, v160
    v_and_b32 v162, 0xffff0000, v160
    v_mul_f32 v163, s58, v161
    v_mul_f32 v164, s58, v162
    v_exp_f32 v163, v163
    v_exp_f32 v164, v164
    v_add_f32 v165, 1.0, v161
    v_add_f32 v166, 1.0, v162
    v_cmp_lt_f32 vcc, 0, v161
    s_nop 1
    v_cndmask_b32 v163, v163, v165, vcc
    v_cmp_lt_f32 vcc, 0, v162
    s_nop 1
    v_cndmask_b32 v164, v164, v166, vcc
    v_cvt_pk_bf16_f32 v160, v163, v164
    v_lshlrev_b32 v161, 16, v160
    v_and_b32 v162, 0xffff0000, v160
    v_add_f32 v161, s59, v161
    v_add_f32 v162, s59, v162
    v_cvt_pk_bf16_f32 v149, v161, v162
    v_cvt_pk_bf16_f32 v160, v60, v61
    v_lshlrev_b32 v161, 16, v160
    v_and_b32 v162, 0xffff0000, v160
    v_mul_f32 v163, s58, v161
    v_mul_f32 v164, s58, v162
    v_exp_f32 v163, v163
    v_exp_f32 v164, v164
    v_add_f32 v165, 1.0, v161
    v_add_f32 v166, 1.0, v162
    v_cmp_lt_f32 vcc, 0, v161
    s_nop 1
    v_cndmask_b32 v163, v163, v165, vcc
    v_cmp_lt_f32 vcc, 0, v162
    s_nop 1
    v_cndmask_b32 v164, v164, v166, vcc
    v_cvt_pk_bf16_f32 v160, v163, v164
    v_lshlrev_b32 v161, 16, v160
    v_and_b32 v162, 0xffff0000, v160
    v_add_f32 v161, s59, v161
    v_add_f32 v162, s59, v162
    v_cvt_pk_bf16_f32 v150, v161, v162
    v_cvt_pk_bf16_f32 v160, v62, v63
    v_lshlrev_b32 v161, 16, v160
    v_and_b32 v162, 0xffff0000, v160
    v_mul_f32 v163, s58, v161
    v_mul_f32 v164, s58, v162
    v_exp_f32 v163, v163
    v_exp_f32 v164, v164
    v_add_f32 v165, 1.0, v161
    v_add_f32 v166, 1.0, v162
    v_cmp_lt_f32 vcc, 0, v161
    s_nop 1
    v_cndmask_b32 v163, v163, v165, vcc
    v_cmp_lt_f32 vcc, 0, v162
    s_nop 1
    v_cndmask_b32 v164, v164, v166, vcc
    v_cvt_pk_bf16_f32 v160, v163, v164
    v_lshlrev_b32 v161, 16, v160
    v_and_b32 v162, 0xffff0000, v160
    v_add_f32 v161, s59, v161
    v_add_f32 v162, s59, v162
    v_cvt_pk_bf16_f32 v151, v161, v162
    s_add_u32 s50, s36, 102400
    buffer_store_dwordx4 v[148:151], v0, s[4:7], s50 offen sc1
    v_cvt_pk_bf16_f32 v160, v64, v65
    v_lshlrev_b32 v161, 16, v160
    v_and_b32 v162, 0xffff0000, v160
    v_mul_f32 v163, s58, v161
    v_mul_f32 v164, s58, v162
    v_exp_f32 v163, v163
    v_exp_f32 v164, v164
    v_add_f32 v165, 1.0, v161
    v_add_f32 v166, 1.0, v162
    v_cmp_lt_f32 vcc, 0, v161
    s_nop 1
    v_cndmask_b32 v163, v163, v165, vcc
    v_cmp_lt_f32 vcc, 0, v162
    s_nop 1
    v_cndmask_b32 v164, v164, v166, vcc
    v_cvt_pk_bf16_f32 v160, v163, v164
    v_lshlrev_b32 v161, 16, v160
    v_and_b32 v162, 0xffff0000, v160
    v_add_f32 v161, s59, v161
    v_add_f32 v162, s59, v162
    v_cvt_pk_bf16_f32 v152, v161, v162
    v_cvt_pk_bf16_f32 v160, v66, v67
    v_lshlrev_b32 v161, 16, v160
    v_and_b32 v162, 0xffff0000, v160
    v_mul_f32 v163, s58, v161
    v_mul_f32 v164, s58, v162
    v_exp_f32 v163, v163
    v_exp_f32 v164, v164
    v_add_f32 v165, 1.0, v161
    v_add_f32 v166, 1.0, v162
    v_cmp_lt_f32 vcc, 0, v161
    s_nop 1
    v_cndmask_b32 v163, v163, v165, vcc
    v_cmp_lt_f32 vcc, 0, v162
    s_nop 1
    v_cndmask_b32 v164, v164, v166, vcc
    v_cvt_pk_bf16_f32 v160, v163, v164
    v_lshlrev_b32 v161, 16, v160
    v_and_b32 v162, 0xffff0000, v160
    v_add_f32 v161, s59, v161
    v_add_f32 v162, s59, v162
    v_cvt_pk_bf16_f32 v153, v161, v162
    v_cvt_pk_bf16_f32 v160, v68, v69
    v_lshlrev_b32 v161, 16, v160
    v_and_b32 v162, 0xffff0000, v160
    v_mul_f32 v163, s58, v161
    v_mul_f32 v164, s58, v162
    v_exp_f32 v163, v163
    v_exp_f32 v164, v164
    v_add_f32 v165, 1.0, v161
    v_add_f32 v166, 1.0, v162
    v_cmp_lt_f32 vcc, 0, v161
    s_nop 1
    v_cndmask_b32 v163, v163, v165, vcc
    v_cmp_lt_f32 vcc, 0, v162
    s_nop 1
    v_cndmask_b32 v164, v164, v166, vcc
    v_cvt_pk_bf16_f32 v160, v163, v164
    v_lshlrev_b32 v161, 16, v160
    v_and_b32 v162, 0xffff0000, v160
    v_add_f32 v161, s59, v161
    v_add_f32 v162, s59, v162
    v_cvt_pk_bf16_f32 v154, v161, v162
    v_cvt_pk_bf16_f32 v160, v70, v71
    v_lshlrev_b32 v161, 16, v160
    v_and_b32 v162, 0xffff0000, v160
    v_mul_f32 v163, s58, v161
    v_mul_f32 v164, s58, v162
    v_exp_f32 v163, v163
    v_exp_f32 v164, v164
    v_add_f32 v165, 1.0, v161
    v_add_f32 v166, 1.0, v162
    v_cmp_lt_f32 vcc, 0, v161
    s_nop 1
    v_cndmask_b32 v163, v163, v165, vcc
    v_cmp_lt_f32 vcc, 0, v162
    s_nop 1
    v_cndmask_b32 v164, v164, v166, vcc
    v_cvt_pk_bf16_f32 v160, v163, v164
    v_lshlrev_b32 v161, 16, v160
    v_and_b32 v162, 0xffff0000, v160
    v_add_f32 v161, s59, v161
    v_add_f32 v162, s59, v162
    v_cvt_pk_bf16_f32 v155, v161, v162
    s_add_u32 s50, s36, 122880
    buffer_store_dwordx4 v[152:155], v0, s[4:7], s50 offen sc1
    v_cvt_pk_bf16_f32 v160, v72, v73
    v_lshlrev_b32 v161, 16, v160
    v_and_b32 v162, 0xffff0000, v160
    v_mul_f32 v163, s58, v161
    v_mul_f32 v164, s58, v162
    v_exp_f32 v163, v163
    v_exp_f32 v164, v164
    v_add_f32 v165, 1.0, v161
    v_add_f32 v166, 1.0, v162
    v_cmp_lt_f32 vcc, 0, v161
    s_nop 1
    v_cndmask_b32 v163, v163, v165, vcc
    v_cmp_lt_f32 vcc, 0, v162
    s_nop 1
    v_cndmask_b32 v164, v164, v166, vcc
    v_cvt_pk_bf16_f32 v160, v163, v164
    v_lshlrev_b32 v161, 16, v160
    v_and_b32 v162, 0xffff0000, v160
    v_add_f32 v161, s59, v161
    v_add_f32 v162, s59, v162
    v_cvt_pk_bf16_f32 v156, v161, v162
    v_cvt_pk_bf16_f32 v160, v74, v75
    v_lshlrev_b32 v161, 16, v160
    v_and_b32 v162, 0xffff0000, v160
    v_mul_f32 v163, s58, v161
    v_mul_f32 v164, s58, v162
    v_exp_f32 v163, v163
    v_exp_f32 v164, v164
    v_add_f32 v165, 1.0, v161
    v_add_f32 v166, 1.0, v162
    v_cmp_lt_f32 vcc, 0, v161
    s_nop 1
    v_cndmask_b32 v163, v163, v165, vcc
    v_cmp_lt_f32 vcc, 0, v162
    s_nop 1
    v_cndmask_b32 v164, v164, v166, vcc
    v_cvt_pk_bf16_f32 v160, v163, v164
    v_lshlrev_b32 v161, 16, v160
    v_and_b32 v162, 0xffff0000, v160
    v_add_f32 v161, s59, v161
    v_add_f32 v162, s59, v162
    v_cvt_pk_bf16_f32 v157, v161, v162
    v_cvt_pk_bf16_f32 v160, v76, v77
    v_lshlrev_b32 v161, 16, v160
    v_and_b32 v162, 0xffff0000, v160
    v_mul_f32 v163, s58, v161
    v_mul_f32 v164, s58, v162
    v_exp_f32 v163, v163
    v_exp_f32 v164, v164
    v_add_f32 v165, 1.0, v161
    v_add_f32 v166, 1.0, v162
    v_cmp_lt_f32 vcc, 0, v161
    s_nop 1
    v_cndmask_b32 v163, v163, v165, vcc
    v_cmp_lt_f32 vcc, 0, v162
    s_nop 1
    v_cndmask_b32 v164, v164, v166, vcc
    v_cvt_pk_bf16_f32 v160, v163, v164
    v_lshlrev_b32 v161, 16, v160
    v_and_b32 v162, 0xffff0000, v160
    v_add_f32 v161, s59, v161
    v_add_f32 v162, s59, v162
    v_cvt_pk_bf16_f32 v158, v161, v162
    v_cvt_pk_bf16_f32 v160, v78, v79
    v_lshlrev_b32 v161, 16, v160
    v_and_b32 v162, 0xffff0000, v160
    v_mul_f32 v163, s58, v161
    v_mul_f32 v164, s58, v162
    v_exp_f32 v163, v163
    v_exp_f32 v164, v164
    v_add_f32 v165, 1.0, v161
    v_add_f32 v166, 1.0, v162
    v_cmp_lt_f32 vcc, 0, v161
    s_nop 1
    v_cndmask_b32 v163, v163, v165, vcc
    v_cmp_lt_f32 vcc, 0, v162
    s_nop 1
    v_cndmask_b32 v164, v164, v166, vcc
    v_cvt_pk_bf16_f32 v160, v163, v164
    v_lshlrev_b32 v161, 16, v160
    v_and_b32 v162, 0xffff0000, v160
    v_add_f32 v161, s59, v161
    v_add_f32 v162, s59, v162
    v_cvt_pk_bf16_f32 v159, v161, v162
    s_add_u32 s50, s36, 143360
    buffer_store_dwordx4 v[156:159], v0, s[4:7], s50 offen sc1
    s_add_u32 s34, s34, 1
    s_add_u32 s36, s36, s37
    s_cmp_lt_u32 s34, s35
    s_cbranch_scc1 BL1Q_BLK
    s_waitcnt vmcnt(0)
    s_barrier
    s_branch BL1_END
BL1_N:
    s_lshl_b32 s64, s63, 3
    s_lshl_b32 s65, s31, 1
    s_add_u32 s64, s64, s65
    s_lshl_b32 s36, s64, 16
    s_lshl_b32 s64, s34, 12
    s_add_u32 s36, s36, s64
    s_mov_b32 s37, 4096
    s_cmp_eq_u32 s62, 1
    s_cbranch_scc0 BL1_V
    s_add_u32 s36, s36, 83886080
    s_mul_i32 s38, s34, 147456
    s_mul_i32 s50, s31, 36864
    s_add_u32 s38, s38, s50
    s_lshl_b32 s39, s31, 12
    s_mov_b32 s41, 0
    s_add_u32 s50, s38, 0
    s_add_u32 m0, s39, 0
    s_nop 0
    buffer_load_dwordx4 v1, s[12:15], s50 offen  lds
    s_add_u32 s50, s38, 9216
    s_add_u32 m0, s39, 1024
    s_nop 0
    buffer_load_dwordx4 v2, s[12:15], s50 offen  lds
    s_add_u32 s50, s38, 18432
    s_add_u32 m0, s39, 2048
    s_nop 0
    buffer_load_dwordx4 v1, s[12:15], s50 offen  lds
    s_add_u32 s50, s38, 27648
    s_add_u32 m0, s39, 3072
    s_nop 0
    buffer_load_dwordx4 v2, s[12:15], s50 offen  lds
    s_add_u32 s38, s38, 128
    s_add_u32 s39, s39, 16384
    s_and_b32 s39, s39, 0x1ffff
    s_add_u32 s50, s38, 0
    s_add_u32 m0, s39, 0
    s_nop 0
    buffer_load_dwordx4 v1, s[12:15], s50 offen  lds
    s_add_u32 s50, s38, 9216
    s_add_u32 m0, s39, 1024
    s_nop 0
    buffer_load_dwordx4 v2, s[12:15], s50 offen  lds
    s_add_u32 s50, s38, 18432
    s_add_u32 m0, s39, 2048
    s_nop 0
    buffer_load_dwordx4 v1, s[12:15], s50 offen  lds
    s_add_u32 s50, s38, 27648
    s_add_u32 m0, s39, 3072
    s_nop 0
    buffer_load_dwordx4 v2, s[12:15], s50 offen  lds
    s_add_u32 s38, s38, 128
    s_add_u32 s39, s39, 16384
    s_and_b32 s39, s39, 0x1ffff
    s_add_u32 s50, s38, 0
    s_add_u32 m0, s39, 0
    s_nop 0
    buffer_load_dwordx4 v1, s[12:15], s50 offen  lds
    s_add_u32 s50, s38, 9216
    s_add_u32 m0, s39, 1024
    s_nop 0
    buffer_load_dwordx4 v2, s[12:15], s50 offen  lds
    s_add_u32 s50, s38, 18432
    s_add_u32 m0, s39, 2048
    s_nop 0
    buffer_load_dwordx4 v1, s[12:15], s50 offen  lds
    s_add_u32 s50, s38, 27648
    s_add_u32 m0, s39, 3072
    s_nop 0
    buffer_load_dwordx4 v2, s[12:15], s50 offen  lds
    s_add_u32 s38, s38, 128
    s_add_u32 s39, s39, 16384
    s_and_b32 s39, s39, 0x1ffff
    s_add_u32 s50, s38, 0
    s_add_u32 m0, s39, 0
    s_nop 0
    buffer_load_dwordx4 v1, s[12:15], s50 offen  lds
    s_add_u32 s50, s38, 9216
    s_add_u32 m0, s39, 1024
    s_nop 0
    buffer_load_dwordx4 v2, s[12:15], s50 offen  lds
    s_add_u32 s50, s38, 18432
    s_add_u32 m0, s39, 2048
    s_nop 0
    buffer_load_dwordx4 v1, s[12:15], s50 offen  lds
    s_add_u32 s50, s38, 27648
    s_add_u32 m0, s39, 3072
    s_nop 0
    buffer_load_dwordx4 v2, s[12:15], s50 offen  lds
    s_add_u32 s38, s38, 128
    s_add_u32 s39, s39, 16384
    s_and_b32 s39, s39, 0x1ffff
    s_add_u32 s50, s38, 0
    s_add_u32 m0, s39, 0
    s_nop 0
    buffer_load_dwordx4 v1, s[12:15], s50 offen  lds
    s_add_u32 s50, s38, 9216
    s_add_u32 m0, s39, 1024
    s_nop 0
    buffer_load_dwordx4 v2, s[12:15], s50 offen  lds
    s_add_u32 s50, s38, 18432
    s_add_u32 m0, s39, 2048
    s_nop 0
    buffer_load_dwordx4 v1, s[12:15], s50 offen  lds
    s_add_u32 s50, s38, 27648
    s_add_u32 m0, s39, 3072
    s_nop 0
    buffer_load_dwordx4 v2, s[12:15], s50 offen  lds
    s_add_u32 s38, s38, 128
    s_add_u32 s39, s39, 16384
    s_and_b32 s39, s39, 0x1ffff
    s_add_u32 s50, s38, 0
    s_add_u32 m0, s39, 0
    s_nop 0
    buffer_load_dwordx4 v1, s[12:15], s50 offen  lds
    s_add_u32 s50, s38, 9216
    s_add_u32 m0, s39, 1024
    s_nop 0
    buffer_load_dwordx4 v2, s[12:15], s50 offen  lds
    s_add_u32 s50, s38, 18432
    s_add_u32 m0, s39, 2048
    s_nop 0
    buffer_load_dwordx4 v1, s[12:15], s50 offen  lds
    s_add_u32 s50, s38, 27648
    s_add_u32 m0, s39, 3072
    s_nop 0
    buffer_load_dwordx4 v2, s[12:15], s50 offen  lds
    s_add_u32 s38, s38, 128
    s_add_u32 s39, s39, 16384
    s_and_b32 s39, s39, 0x1ffff
    s_waitcnt vmcnt(0)
BL1K_BLK:
    s_waitcnt vmcnt(28)
    s_barrier
    s_add_u32 s50, s38, 0
    s_add_u32 m0, s39, 0
    s_nop 0
    buffer_load_dwordx4 v1, s[12:15], s50 offen  lds
    s_add_u32 s50, s38, 9216
    s_add_u32 m0, s39, 1024
    s_nop 0
    buffer_load_dwordx4 v2, s[12:15], s50 offen  lds
    s_add_u32 s50, s38, 18432
    s_add_u32 m0, s39, 2048
    s_nop 0
    buffer_load_dwordx4 v1, s[12:15], s50 offen  lds
    s_add_u32 s50, s38, 27648
    s_add_u32 m0, s39, 3072
    s_nop 0
    buffer_load_dwordx4 v2, s[12:15], s50 offen  lds
    s_add_u32 s38, s38, 128
    s_add_u32 s39, s39, 16384
    s_and_b32 s39, s39, 0x1ffff
    v_add_u32 v7, s41, v3
    v_add_u32 v8, s41, v4
    s_add_u32 s41, s41, 16384
    s_and_b32 s41, s41, 0x1ffff
    ds_read_b128 v[80:83], v7 offset:0
    ds_read_b128 v[84:87], v7 offset:2048
    ds_read_b128 v[88:91], v7 offset:4096
    ds_read_b128 v[92:95], v7 offset:6144
    ds_read_b128 v[96:99], v7 offset:8192
    ds_read_b128 v[100:103], v7 offset:10240
    ds_read_b128 v[104:107], v7 offset:12288
    ds_read_b128 v[108:111], v7 offset:14336
    s_waitcnt lgkmcnt(7)
    v_mfma_f32_16x16x32_bf16 v[16:19], v[80:83], a[0:3], 0
    v_mfma_f32_16x16x32_bf16 v[20:23], v[80:83], a[72:75], 0
    ds_read_b128 v[112:115], v8 offset:0
    s_waitcnt lgkmcnt(7)
    v_mfma_f32_16x16x32_bf16 v[24:27], v[84:87], a[0:3], 0
    v_mfma_f32_16x16x32_bf16 v[28:31], v[84:87], a[72:75], 0
    ds_read_b128 v[116:119], v8 offset:2048
    s_waitcnt lgkmcnt(7)
    v_mfma_f32_16x16x32_bf16 v[32:35], v[88:91], a[0:3], 0
    v_mfma_f32_16x16x32_bf16 v[36:39], v[88:91], a[72:75], 0
    ds_read_b128 v[120:123], v8 offset:4096
    s_waitcnt lgkmcnt(7)
    v_mfma_f32_16x16x32_bf16 v[40:43], v[92:95], a[0:3], 0
    v_mfma_f32_16x16x32_bf16 v[44:47], v[92:95], a[72:75], 0
    ds_read_b128 v[124:127], v8 offset:6144
    s_waitcnt lgkmcnt(7)
    v_mfma_f32_16x16x32_bf16 v[48:51], v[96:99], a[0:3], 0
    v_mfma_f32_16x16x32_bf16 v[52:55], v[96:99], a[72:75], 0
    ds_read_b128 v[128:131], v8 offset:8192
    s_waitcnt lgkmcnt(7)
    v_mfma_f32_16x16x32_bf16 v[56:59], v[100:103], a[0:3], 0
    v_mfma_f32_16x16x32_bf16 v[60:63], v[100:103], a[72:75], 0
    ds_read_b128 v[132:135], v8 offset:10240
    s_waitcnt lgkmcnt(7)
    v_mfma_f32_16x16x32_bf16 v[64:67], v[104:107], a[0:3], 0
    v_mfma_f32_16x16x32_bf16 v[68:71], v[104:107], a[72:75], 0
    ds_read_b128 v[136:139], v8 offset:12288
    s_waitcnt lgkmcnt(7)
    v_mfma_f32_16x16x32_bf16 v[72:75], v[108:111], a[0:3], 0
    v_mfma_f32_16x16x32_bf16 v[76:79], v[108:111], a[72:75], 0
    ds_read_b128 v[140:143], v8 offset:14336
    s_waitcnt lgkmcnt(7)
    v_mfma_f32_16x16x32_bf16 v[16:19], v[112:115], a[4:7], v[16:19]
    v_mfma_f32_16x16x32_bf16 v[20:23], v[112:115], a[76:79], v[20:23]
    s_waitcnt lgkmcnt(6)
    v_mfma_f32_16x16x32_bf16 v[24:27], v[116:119], a[4:7], v[24:27]
    v_mfma_f32_16x16x32_bf16 v[28:31], v[116:119], a[76:79], v[28:31]
    s_waitcnt lgkmcnt(5)
    v_mfma_f32_16x16x32_bf16 v[32:35], v[120:123], a[4:7], v[32:35]
    v_mfma_f32_16x16x32_bf16 v[36:39], v[120:123], a[76:79], v[36:39]
    s_waitcnt lgkmcnt(4)
    v_mfma_f32_16x16x32_bf16 v[40:43], v[124:127], a[4:7], v[40:43]
    v_mfma_f32_16x16x32_bf16 v[44:47], v[124:127], a[76:79], v[44:47]
    s_waitcnt lgkmcnt(3)
    v_mfma_f32_16x16x32_bf16 v[48:51], v[128:131], a[4:7], v[48:51]
    v_mfma_f32_16x16x32_bf16 v[52:55], v[128:131], a[76:79], v[52:55]
    s_waitcnt lgkmcnt(2)
    v_mfma_f32_16x16x32_bf16 v[56:59], v[132:135], a[4:7], v[56:59]
    v_mfma_f32_16x16x32_bf16 v[60:63], v[132:135], a[76:79], v[60:63]
    s_waitcnt lgkmcnt(1)
    v_mfma_f32_16x16x32_bf16 v[64:67], v[136:139], a[4:7], v[64:67]
    v_mfma_f32_16x16x32_bf16 v[68:71], v[136:139], a[76:79], v[68:71]
    s_waitcnt lgkmcnt(0)
    v_mfma_f32_16x16x32_bf16 v[72:75], v[140:143], a[4:7], v[72:75]
    v_mfma_f32_16x16x32_bf16 v[76:79], v[140:143], a[76:79], v[76:79]
    s_waitcnt vmcnt(28)
    s_barrier
    s_add_u32 s50, s38, 0
    s_add_u32 m0, s39, 0
    s_nop 0
    buffer_load_dwordx4 v1, s[12:15], s50 offen  lds
    s_add_u32 s50, s38, 9216
    s_add_u32 m0, s39, 1024
    s_nop 0
    buffer_load_dwordx4 v2, s[12:15], s50 offen  lds
    s_add_u32 s50, s38, 18432
    s_add_u32 m0, s39, 2048
    s_nop 0
    buffer_load_dwordx4 v1, s[12:15], s50 offen  lds
    s_add_u32 s50, s38, 27648
    s_add_u32 m0, s39, 3072
    s_nop 0
    buffer_load_dwordx4 v2, s[12:15], s50 offen  lds
    s_add_u32 s38, s38, 128
    s_add_u32 s39, s39, 16384
    s_and_b32 s39, s39, 0x1ffff
    v_add_u32 v7, s41, v3
    v_add_u32 v8, s41, v4
    s_add_u32 s41, s41, 16384
    s_and_b32 s41, s41, 0x1ffff
    ds_read_b128 v[80:83], v7 offset:0
    ds_read_b128 v[84:87], v7 offset:2048
    ds_read_b128 v[88:91], v7 offset:4096
    ds_read_b128 v[92:95], v7 offset:6144
    ds_read_b128 v[96:99], v7 offset:8192
    ds_read_b128 v[100:103], v7 offset:10240
    ds_read_b128 v[104:107], v7 offset:12288
    ds_read_b128 v[108:111], v7 offset:14336
    s_waitcnt lgkmcnt(7)
    v_mfma_f32_16x16x32_bf16 v[16:19], v[80:83], a[8:11], v[16:19]
    v_mfma_f32_16x16x32_bf16 v[20:23], v[80:83], a[80:83], v[20:23]
    ds_read_b128 v[112:115], v8 offset:0
    s_waitcnt lgkmcnt(7)
    v_mfma_f32_16x16x32_bf16 v[24:27], v[84:87], a[8:11], v[24:27]
    v_mfma_f32_16x16x32_bf16 v[28:31], v[84:87], a[80:83], v[28:31]
    ds_read_b128 v[116:119], v8 offset:2048
    s_waitcnt lgkmcnt(7)
    v_mfma_f32_16x16x32_bf16 v[32:35], v[88:91], a[8:11], v[32:35]
    v_mfma_f32_16x16x32_bf16 v[36:39], v[88:91], a[80:83], v[36:39]
    ds_read_b128 v[120:123], v8 offset:4096
    s_waitcnt lgkmcnt(7)
    v_mfma_f32_16x16x32_bf16 v[40:43], v[92:95], a[8:11], v[40:43]
    v_mfma_f32_16x16x32_bf16 v[44:47], v[92:95], a[80:83], v[44:47]
    ds_read_b128 v[124:127], v8 offset:6144
    s_waitcnt lgkmcnt(7)
    v_mfma_f32_16x16x32_bf16 v[48:51], v[96:99], a[8:11], v[48:51]
    v_mfma_f32_16x16x32_bf16 v[52:55], v[96:99], a[80:83], v[52:55]
    ds_read_b128 v[128:131], v8 offset:8192
    s_waitcnt lgkmcnt(7)
    v_mfma_f32_16x16x32_bf16 v[56:59], v[100:103], a[8:11], v[56:59]
    v_mfma_f32_16x16x32_bf16 v[60:63], v[100:103], a[80:83], v[60:63]
    ds_read_b128 v[132:135], v8 offset:10240
    s_waitcnt lgkmcnt(7)
    v_mfma_f32_16x16x32_bf16 v[64:67], v[104:107], a[8:11], v[64:67]
    v_mfma_f32_16x16x32_bf16 v[68:71], v[104:107], a[80:83], v[68:71]
    ds_read_b128 v[136:139], v8 offset:12288
    s_waitcnt lgkmcnt(7)
    v_mfma_f32_16x16x32_bf16 v[72:75], v[108:111], a[8:11], v[72:75]
    v_mfma_f32_16x16x32_bf16 v[76:79], v[108:111], a[80:83], v[76:79]
    ds_read_b128 v[140:143], v8 offset:14336
    s_waitcnt lgkmcnt(7)
    v_mfma_f32_16x16x32_bf16 v[16:19], v[112:115], a[12:15], v[16:19]
    v_mfma_f32_16x16x32_bf16 v[20:23], v[112:115], a[84:87], v[20:23]
    s_waitcnt lgkmcnt(6)
    v_mfma_f32_16x16x32_bf16 v[24:27], v[116:119], a[12:15], v[24:27]
    v_mfma_f32_16x16x32_bf16 v[28:31], v[116:119], a[84:87], v[28:31]
    s_waitcnt lgkmcnt(5)
    v_mfma_f32_16x16x32_bf16 v[32:35], v[120:123], a[12:15], v[32:35]
    v_mfma_f32_16x16x32_bf16 v[36:39], v[120:123], a[84:87], v[36:39]
    s_waitcnt lgkmcnt(4)
    v_mfma_f32_16x16x32_bf16 v[40:43], v[124:127], a[12:15], v[40:43]
    v_mfma_f32_16x16x32_bf16 v[44:47], v[124:127], a[84:87], v[44:47]
    s_waitcnt lgkmcnt(3)
    v_mfma_f32_16x16x32_bf16 v[48:51], v[128:131], a[12:15], v[48:51]
    v_mfma_f32_16x16x32_bf16 v[52:55], v[128:131], a[84:87], v[52:55]
    s_waitcnt lgkmcnt(2)
    v_mfma_f32_16x16x32_bf16 v[56:59], v[132:135], a[12:15], v[56:59]
    v_mfma_f32_16x16x32_bf16 v[60:63], v[132:135], a[84:87], v[60:63]
    s_waitcnt lgkmcnt(1)
    v_mfma_f32_16x16x32_bf16 v[64:67], v[136:139], a[12:15], v[64:67]
    v_mfma_f32_16x16x32_bf16 v[68:71], v[136:139], a[84:87], v[68:71]
    s_waitcnt lgkmcnt(0)
    v_mfma_f32_16x16x32_bf16 v[72:75], v[140:143], a[12:15], v[72:75]
    v_mfma_f32_16x16x32_bf16 v[76:79], v[140:143], a[84:87], v[76:79]
    s_waitcnt vmcnt(28)
    s_barrier
    s_add_u32 s50, s38, 0
    s_add_u32 m0, s39, 0
    s_nop 0
    buffer_load_dwordx4 v1, s[12:15], s50 offen  lds
    s_add_u32 s50, s38, 9216
    s_add_u32 m0, s39, 1024
    s_nop 0
    buffer_load_dwordx4 v2, s[12:15], s50 offen  lds
    s_add_u32 s50, s38, 18432
    s_add_u32 m0, s39, 2048
    s_nop 0
    buffer_load_dwordx4 v1, s[12:15], s50 offen  lds
    s_add_u32 s50, s38, 27648
    s_add_u32 m0, s39, 3072
    s_nop 0
    buffer_load_dwordx4 v2, s[12:15], s50 offen  lds
    s_add_u32 s38, s38, 146432
    s_add_u32 s39, s39, 16384
    s_and_b32 s39, s39, 0x1ffff
    v_add_u32 v7, s41, v3
    v_add_u32 v8, s41, v4
    s_add_u32 s41, s41, 16384
    s_and_b32 s41, s41, 0x1ffff
    ds_read_b128 v[80:83], v7 offset:0
    ds_read_b128 v[84:87], v7 offset:2048
    ds_read_b128 v[88:91], v7 offset:4096
    ds_read_b128 v[92:95], v7 offset:6144
    ds_read_b128 v[96:99], v7 offset:8192
    ds_read_b128 v[100:103], v7 offset:10240
    ds_read_b128 v[104:107], v7 offset:12288
    ds_read_b128 v[108:111], v7 offset:14336
    s_waitcnt lgkmcnt(7)
    v_mfma_f32_16x16x32_bf16 v[16:19], v[80:83], a[16:19], v[16:19]
    v_mfma_f32_16x16x32_bf16 v[20:23], v[80:83], a[88:91], v[20:23]
    ds_read_b128 v[112:115], v8 offset:0
    s_waitcnt lgkmcnt(7)
    v_mfma_f32_16x16x32_bf16 v[24:27], v[84:87], a[16:19], v[24:27]
    v_mfma_f32_16x16x32_bf16 v[28:31], v[84:87], a[88:91], v[28:31]
    ds_read_b128 v[116:119], v8 offset:2048
    s_waitcnt lgkmcnt(7)
    v_mfma_f32_16x16x32_bf16 v[32:35], v[88:91], a[16:19], v[32:35]
    v_mfma_f32_16x16x32_bf16 v[36:39], v[88:91], a[88:91], v[36:39]
    ds_read_b128 v[120:123], v8 offset:4096
    s_waitcnt lgkmcnt(7)
    v_mfma_f32_16x16x32_bf16 v[40:43], v[92:95], a[16:19], v[40:43]
    v_mfma_f32_16x16x32_bf16 v[44:47], v[92:95], a[88:91], v[44:47]
    ds_read_b128 v[124:127], v8 offset:6144
    s_waitcnt lgkmcnt(7)
    v_mfma_f32_16x16x32_bf16 v[48:51], v[96:99], a[16:19], v[48:51]
    v_mfma_f32_16x16x32_bf16 v[52:55], v[96:99], a[88:91], v[52:55]
    ds_read_b128 v[128:131], v8 offset:8192
    s_waitcnt lgkmcnt(7)
    v_mfma_f32_16x16x32_bf16 v[56:59], v[100:103], a[16:19], v[56:59]
    v_mfma_f32_16x16x32_bf16 v[60:63], v[100:103], a[88:91], v[60:63]
    ds_read_b128 v[132:135], v8 offset:10240
    s_waitcnt lgkmcnt(7)
    v_mfma_f32_16x16x32_bf16 v[64:67], v[104:107], a[16:19], v[64:67]
    v_mfma_f32_16x16x32_bf16 v[68:71], v[104:107], a[88:91], v[68:71]
    ds_read_b128 v[136:139], v8 offset:12288
    s_waitcnt lgkmcnt(7)
    v_mfma_f32_16x16x32_bf16 v[72:75], v[108:111], a[16:19], v[72:75]
    v_mfma_f32_16x16x32_bf16 v[76:79], v[108:111], a[88:91], v[76:79]
    ds_read_b128 v[140:143], v8 offset:14336
    s_waitcnt lgkmcnt(7)
    v_mfma_f32_16x16x32_bf16 v[16:19], v[112:115], a[20:23], v[16:19]
    v_mfma_f32_16x16x32_bf16 v[20:23], v[112:115], a[92:95], v[20:23]
    s_waitcnt lgkmcnt(6)
    v_mfma_f32_16x16x32_bf16 v[24:27], v[116:119], a[20:23], v[24:27]
    v_mfma_f32_16x16x32_bf16 v[28:31], v[116:119], a[92:95], v[28:31]
    s_waitcnt lgkmcnt(5)
    v_mfma_f32_16x16x32_bf16 v[32:35], v[120:123], a[20:23], v[32:35]
    v_mfma_f32_16x16x32_bf16 v[36:39], v[120:123], a[92:95], v[36:39]
    s_waitcnt lgkmcnt(4)
    v_mfma_f32_16x16x32_bf16 v[40:43], v[124:127], a[20:23], v[40:43]
    v_mfma_f32_16x16x32_bf16 v[44:47], v[124:127], a[92:95], v[44:47]
    s_waitcnt lgkmcnt(3)
    v_mfma_f32_16x16x32_bf16 v[48:51], v[128:131], a[20:23], v[48:51]
    v_mfma_f32_16x16x32_bf16 v[52:55], v[128:131], a[92:95], v[52:55]
    s_waitcnt lgkmcnt(2)
    v_mfma_f32_16x16x32_bf16 v[56:59], v[132:135], a[20:23], v[56:59]
    v_mfma_f32_16x16x32_bf16 v[60:63], v[132:135], a[92:95], v[60:63]
    s_waitcnt lgkmcnt(1)
    v_mfma_f32_16x16x32_bf16 v[64:67], v[136:139], a[20:23], v[64:67]
    v_mfma_f32_16x16x32_bf16 v[68:71], v[136:139], a[92:95], v[68:71]
    s_waitcnt lgkmcnt(0)
    v_mfma_f32_16x16x32_bf16 v[72:75], v[140:143], a[20:23], v[72:75]
    v_mfma_f32_16x16x32_bf16 v[76:79], v[140:143], a[92:95], v[76:79]
    s_waitcnt vmcnt(28)
    s_barrier
    s_add_u32 s50, s38, 0
    s_add_u32 m0, s39, 0
    s_nop 0
    buffer_load_dwordx4 v1, s[12:15], s50 offen  lds
    s_add_u32 s50, s38, 9216
    s_add_u32 m0, s39, 1024
    s_nop 0
    buffer_load_dwordx4 v2, s[12:15], s50 offen  lds
    s_add_u32 s50, s38, 18432
    s_add_u32 m0, s39, 2048
    s_nop 0
    buffer_load_dwordx4 v1, s[12:15], s50 offen  lds
    s_add_u32 s50, s38, 27648
    s_add_u32 m0, s39, 3072
    s_nop 0
    buffer_load_dwordx4 v2, s[12:15], s50 offen  lds
    s_add_u32 s38, s38, 128
    s_add_u32 s39, s39, 16384
    s_and_b32 s39, s39, 0x1ffff
    v_add_u32 v7, s41, v3
    v_add_u32 v8, s41, v4
    s_add_u32 s41, s41, 16384
    s_and_b32 s41, s41, 0x1ffff
    ds_read_b128 v[80:83], v7 offset:0
    ds_read_b128 v[84:87], v7 offset:2048
    ds_read_b128 v[88:91], v7 offset:4096
    ds_read_b128 v[92:95], v7 offset:6144
    ds_read_b128 v[96:99], v7 offset:8192
    ds_read_b128 v[100:103], v7 offset:10240
    ds_read_b128 v[104:107], v7 offset:12288
    ds_read_b128 v[108:111], v7 offset:14336
    s_waitcnt lgkmcnt(7)
    v_mfma_f32_16x16x32_bf16 v[16:19], v[80:83], a[24:27], v[16:19]
    v_mfma_f32_16x16x32_bf16 v[20:23], v[80:83], a[96:99], v[20:23]
    ds_read_b128 v[112:115], v8 offset:0
    s_waitcnt lgkmcnt(7)
    v_mfma_f32_16x16x32_bf16 v[24:27], v[84:87], a[24:27], v[24:27]
    v_mfma_f32_16x16x32_bf16 v[28:31], v[84:87], a[96:99], v[28:31]
    ds_read_b128 v[116:119], v8 offset:2048
    s_waitcnt lgkmcnt(7)
    v_mfma_f32_16x16x32_bf16 v[32:35], v[88:91], a[24:27], v[32:35]
    v_mfma_f32_16x16x32_bf16 v[36:39], v[88:91], a[96:99], v[36:39]
    ds_read_b128 v[120:123], v8 offset:4096
    s_waitcnt lgkmcnt(7)
    v_mfma_f32_16x16x32_bf16 v[40:43], v[92:95], a[24:27], v[40:43]
    v_mfma_f32_16x16x32_bf16 v[44:47], v[92:95], a[96:99], v[44:47]
    ds_read_b128 v[124:127], v8 offset:6144
    s_waitcnt lgkmcnt(7)
    v_mfma_f32_16x16x32_bf16 v[48:51], v[96:99], a[24:27], v[48:51]
    v_mfma_f32_16x16x32_bf16 v[52:55], v[96:99], a[96:99], v[52:55]
    ds_read_b128 v[128:131], v8 offset:8192
    s_waitcnt lgkmcnt(7)
    v_mfma_f32_16x16x32_bf16 v[56:59], v[100:103], a[24:27], v[56:59]
    v_mfma_f32_16x16x32_bf16 v[60:63], v[100:103], a[96:99], v[60:63]
    ds_read_b128 v[132:135], v8 offset:10240
    s_waitcnt lgkmcnt(7)
    v_mfma_f32_16x16x32_bf16 v[64:67], v[104:107], a[24:27], v[64:67]
    v_mfma_f32_16x16x32_bf16 v[68:71], v[104:107], a[96:99], v[68:71]
    ds_read_b128 v[136:139], v8 offset:12288
    s_waitcnt lgkmcnt(7)
    v_mfma_f32_16x16x32_bf16 v[72:75], v[108:111], a[24:27], v[72:75]
    v_mfma_f32_16x16x32_bf16 v[76:79], v[108:111], a[96:99], v[76:79]
    ds_read_b128 v[140:143], v8 offset:14336
    s_waitcnt lgkmcnt(7)
    v_mfma_f32_16x16x32_bf16 v[16:19], v[112:115], a[28:31], v[16:19]
    v_mfma_f32_16x16x32_bf16 v[20:23], v[112:115], a[100:103], v[20:23]
    s_waitcnt lgkmcnt(6)
    v_mfma_f32_16x16x32_bf16 v[24:27], v[116:119], a[28:31], v[24:27]
    v_mfma_f32_16x16x32_bf16 v[28:31], v[116:119], a[100:103], v[28:31]
    s_waitcnt lgkmcnt(5)
    v_mfma_f32_16x16x32_bf16 v[32:35], v[120:123], a[28:31], v[32:35]
    v_mfma_f32_16x16x32_bf16 v[36:39], v[120:123], a[100:103], v[36:39]
    s_waitcnt lgkmcnt(4)
    v_mfma_f32_16x16x32_bf16 v[40:43], v[124:127], a[28:31], v[40:43]
    v_mfma_f32_16x16x32_bf16 v[44:47], v[124:127], a[100:103], v[44:47]
    s_waitcnt lgkmcnt(3)
    v_mfma_f32_16x16x32_bf16 v[48:51], v[128:131], a[28:31], v[48:51]
    v_mfma_f32_16x16x32_bf16 v[52:55], v[128:131], a[100:103], v[52:55]
    s_waitcnt lgkmcnt(2)
    v_mfma_f32_16x16x32_bf16 v[56:59], v[132:135], a[28:31], v[56:59]
    v_mfma_f32_16x16x32_bf16 v[60:63], v[132:135], a[100:103], v[60:63]
    s_waitcnt lgkmcnt(1)
    v_mfma_f32_16x16x32_bf16 v[64:67], v[136:139], a[28:31], v[64:67]
    v_mfma_f32_16x16x32_bf16 v[68:71], v[136:139], a[100:103], v[68:71]
    s_waitcnt lgkmcnt(0)
    v_mfma_f32_16x16x32_bf16 v[72:75], v[140:143], a[28:31], v[72:75]
    v_mfma_f32_16x16x32_bf16 v[76:79], v[140:143], a[100:103], v[76:79]
    s_waitcnt vmcnt(28)
    s_barrier
    s_add_u32 s50, s38, 0
    s_add_u32 m0, s39, 0
    s_nop 0
    buffer_load_dwordx4 v1, s[12:15], s50 offen  lds
    s_add_u32 s50, s38, 9216
    s_add_u32 m0, s39, 1024
    s_nop 0
    buffer_load_dwordx4 v2, s[12:15], s50 offen  lds
    s_add_u32 s50, s38, 18432
    s_add_u32 m0, s39, 2048
    s_nop 0
    buffer_load_dwordx4 v1, s[12:15], s50 offen  lds
    s_add_u32 s50, s38, 27648
    s_add_u32 m0, s39, 3072
    s_nop 0
    buffer_load_dwordx4 v2, s[12:15], s50 offen  lds
    s_add_u32 s38, s38, 128
    s_add_u32 s39, s39, 16384
    s_and_b32 s39, s39, 0x1ffff
    v_add_u32 v7, s41, v3
    v_add_u32 v8, s41, v4
    s_add_u32 s41, s41, 16384
    s_and_b32 s41, s41, 0x1ffff
    ds_read_b128 v[80:83], v7 offset:0
    ds_read_b128 v[84:87], v7 offset:2048
    ds_read_b128 v[88:91], v7 offset:4096
    ds_read_b128 v[92:95], v7 offset:6144
    ds_read_b128 v[96:99], v7 offset:8192
    ds_read_b128 v[100:103], v7 offset:10240
    ds_read_b128 v[104:107], v7 offset:12288
    ds_read_b128 v[108:111], v7 offset:14336
    s_waitcnt lgkmcnt(7)
    v_mfma_f32_16x16x32_bf16 v[16:19], v[80:83], a[32:35], v[16:19]
    v_mfma_f32_16x16x32_bf16 v[20:23], v[80:83], a[104:107], v[20:23]
    ds_read_b128 v[112:115], v8 offset:0
    s_waitcnt lgkmcnt(7)
    v_mfma_f32_16x16x32_bf16 v[24:27], v[84:87], a[32:35], v[24:27]
    v_mfma_f32_16x16x32_bf16 v[28:31], v[84:87], a[104:107], v[28:31]
    ds_read_b128 v[116:119], v8 offset:2048
    s_waitcnt lgkmcnt(7)
    v_mfma_f32_16x16x32_bf16 v[32:35], v[88:91], a[32:35], v[32:35]
    v_mfma_f32_16x16x32_bf16 v[36:39], v[88:91], a[104:107], v[36:39]
    ds_read_b128 v[120:123], v8 offset:4096
    s_waitcnt lgkmcnt(7)
    v_mfma_f32_16x16x32_bf16 v[40:43], v[92:95], a[32:35], v[40:43]
    v_mfma_f32_16x16x32_bf16 v[44:47], v[92:95], a[104:107], v[44:47]
    ds_read_b128 v[124:127], v8 offset:6144
    s_waitcnt lgkmcnt(7)
    v_mfma_f32_16x16x32_bf16 v[48:51], v[96:99], a[32:35], v[48:51]
    v_mfma_f32_16x16x32_bf16 v[52:55], v[96:99], a[104:107], v[52:55]
    ds_read_b128 v[128:131], v8 offset:8192
    s_waitcnt lgkmcnt(7)
    v_mfma_f32_16x16x32_bf16 v[56:59], v[100:103], a[32:35], v[56:59]
    v_mfma_f32_16x16x32_bf16 v[60:63], v[100:103], a[104:107], v[60:63]
    ds_read_b128 v[132:135], v8 offset:10240
    s_waitcnt lgkmcnt(7)
    v_mfma_f32_16x16x32_bf16 v[64:67], v[104:107], a[32:35], v[64:67]
    v_mfma_f32_16x16x32_bf16 v[68:71], v[104:107], a[104:107], v[68:71]
    ds_read_b128 v[136:139], v8 offset:12288
    s_waitcnt lgkmcnt(7)
    v_mfma_f32_16x16x32_bf16 v[72:75], v[108:111], a[32:35], v[72:75]
    v_mfma_f32_16x16x32_bf16 v[76:79], v[108:111], a[104:107], v[76:79]
    ds_read_b128 v[140:143], v8 offset:14336
    s_waitcnt lgkmcnt(7)
    v_mfma_f32_16x16x32_bf16 v[16:19], v[112:115], a[36:39], v[16:19]
    v_mfma_f32_16x16x32_bf16 v[20:23], v[112:115], a[108:111], v[20:23]
    s_waitcnt lgkmcnt(6)
    v_mfma_f32_16x16x32_bf16 v[24:27], v[116:119], a[36:39], v[24:27]
    v_mfma_f32_16x16x32_bf16 v[28:31], v[116:119], a[108:111], v[28:31]
    s_waitcnt lgkmcnt(5)
    v_mfma_f32_16x16x32_bf16 v[32:35], v[120:123], a[36:39], v[32:35]
    v_mfma_f32_16x16x32_bf16 v[36:39], v[120:123], a[108:111], v[36:39]
    s_waitcnt lgkmcnt(4)
    v_mfma_f32_16x16x32_bf16 v[40:43], v[124:127], a[36:39], v[40:43]
    v_mfma_f32_16x16x32_bf16 v[44:47], v[124:127], a[108:111], v[44:47]
    s_waitcnt lgkmcnt(3)
    v_mfma_f32_16x16x32_bf16 v[48:51], v[128:131], a[36:39], v[48:51]
    v_mfma_f32_16x16x32_bf16 v[52:55], v[128:131], a[108:111], v[52:55]
    s_waitcnt lgkmcnt(2)
    v_mfma_f32_16x16x32_bf16 v[56:59], v[132:135], a[36:39], v[56:59]
    v_mfma_f32_16x16x32_bf16 v[60:63], v[132:135], a[108:111], v[60:63]
    s_waitcnt lgkmcnt(1)
    v_mfma_f32_16x16x32_bf16 v[64:67], v[136:139], a[36:39], v[64:67]
    v_mfma_f32_16x16x32_bf16 v[68:71], v[136:139], a[108:111], v[68:71]
    s_waitcnt lgkmcnt(0)
    v_mfma_f32_16x16x32_bf16 v[72:75], v[140:143], a[36:39], v[72:75]
    v_mfma_f32_16x16x32_bf16 v[76:79], v[140:143], a[108:111], v[76:79]
    s_waitcnt vmcnt(28)
    s_barrier
    s_add_u32 s50, s38, 0
    s_add_u32 m0, s39, 0
    s_nop 0
    buffer_load_dwordx4 v1, s[12:15], s50 offen  lds
    s_add_u32 s50, s38, 9216
    s_add_u32 m0, s39, 1024
    s_nop 0
    buffer_load_dwordx4 v2, s[12:15], s50 offen  lds
    s_add_u32 s50, s38, 18432
    s_add_u32 m0, s39, 2048
    s_nop 0
    buffer_load_dwordx4 v1, s[12:15], s50 offen  lds
    s_add_u32 s50, s38, 27648
    s_add_u32 m0, s39, 3072
    s_nop 0
    buffer_load_dwordx4 v2, s[12:15], s50 offen  lds
    s_add_u32 s38, s38, 128
    s_add_u32 s39, s39, 16384
    s_and_b32 s39, s39, 0x1ffff
    v_add_u32 v7, s41, v3
    v_add_u32 v8, s41, v4
    s_add_u32 s41, s41, 16384
    s_and_b32 s41, s41, 0x1ffff
    ds_read_b128 v[80:83], v7 offset:0
    ds_read_b128 v[84:87], v7 offset:2048
    ds_read_b128 v[88:91], v7 offset:4096
    ds_read_b128 v[92:95], v7 offset:6144
    ds_read_b128 v[96:99], v7 offset:8192
    ds_read_b128 v[100:103], v7 offset:10240
    ds_read_b128 v[104:107], v7 offset:12288
    ds_read_b128 v[108:111], v7 offset:14336
    s_waitcnt lgkmcnt(7)
    v_mfma_f32_16x16x32_bf16 v[16:19], v[80:83], a[40:43], v[16:19]
    v_mfma_f32_16x16x32_bf16 v[20:23], v[80:83], a[112:115], v[20:23]
    ds_read_b128 v[112:115], v8 offset:0
    s_waitcnt lgkmcnt(7)
    v_mfma_f32_16x16x32_bf16 v[24:27], v[84:87], a[40:43], v[24:27]
    v_mfma_f32_16x16x32_bf16 v[28:31], v[84:87], a[112:115], v[28:31]
    ds_read_b128 v[116:119], v8 offset:2048
    s_waitcnt lgkmcnt(7)
    v_mfma_f32_16x16x32_bf16 v[32:35], v[88:91], a[40:43], v[32:35]
    v_mfma_f32_16x16x32_bf16 v[36:39], v[88:91], a[112:115], v[36:39]
    ds_read_b128 v[120:123], v8 offset:4096
    s_waitcnt lgkmcnt(7)
    v_mfma_f32_16x16x32_bf16 v[40:43], v[92:95], a[40:43], v[40:43]
    v_mfma_f32_16x16x32_bf16 v[44:47], v[92:95], a[112:115], v[44:47]
    ds_read_b128 v[124:127], v8 offset:6144
    s_waitcnt lgkmcnt(7)
    v_mfma_f32_16x16x32_bf16 v[48:51], v[96:99], a[40:43], v[48:51]
    v_mfma_f32_16x16x32_bf16 v[52:55], v[96:99], a[112:115], v[52:55]
    ds_read_b128 v[128:131], v8 offset:8192
    s_waitcnt lgkmcnt(7)
    v_mfma_f32_16x16x32_bf16 v[56:59], v[100:103], a[40:43], v[56:59]
    v_mfma_f32_16x16x32_bf16 v[60:63], v[100:103], a[112:115], v[60:63]
    ds_read_b128 v[132:135], v8 offset:10240
    s_waitcnt lgkmcnt(7)
    v_mfma_f32_16x16x32_bf16 v[64:67], v[104:107], a[40:43], v[64:67]
    v_mfma_f32_16x16x32_bf16 v[68:71], v[104:107], a[112:115], v[68:71]
    ds_read_b128 v[136:139], v8 offset:12288
    s_waitcnt lgkmcnt(7)
    v_mfma_f32_16x16x32_bf16 v[72:75], v[108:111], a[40:43], v[72:75]
    v_mfma_f32_16x16x32_bf16 v[76:79], v[108:111], a[112:115], v[76:79]
    ds_read_b128 v[140:143], v8 offset:14336
    s_waitcnt lgkmcnt(7)
    v_mfma_f32_16x16x32_bf16 v[16:19], v[112:115], a[44:47], v[16:19]
    v_mfma_f32_16x16x32_bf16 v[20:23], v[112:115], a[116:119], v[20:23]
    s_waitcnt lgkmcnt(6)
    v_mfma_f32_16x16x32_bf16 v[24:27], v[116:119], a[44:47], v[24:27]
    v_mfma_f32_16x16x32_bf16 v[28:31], v[116:119], a[116:119], v[28:31]
    s_waitcnt lgkmcnt(5)
    v_mfma_f32_16x16x32_bf16 v[32:35], v[120:123], a[44:47], v[32:35]
    v_mfma_f32_16x16x32_bf16 v[36:39], v[120:123], a[116:119], v[36:39]
    s_waitcnt lgkmcnt(4)
    v_mfma_f32_16x16x32_bf16 v[40:43], v[124:127], a[44:47], v[40:43]
    v_mfma_f32_16x16x32_bf16 v[44:47], v[124:127], a[116:119], v[44:47]
    s_waitcnt lgkmcnt(3)
    v_mfma_f32_16x16x32_bf16 v[48:51], v[128:131], a[44:47], v[48:51]
    v_mfma_f32_16x16x32_bf16 v[52:55], v[128:131], a[116:119], v[52:55]
    s_waitcnt lgkmcnt(2)
    v_mfma_f32_16x16x32_bf16 v[56:59], v[132:135], a[44:47], v[56:59]
    v_mfma_f32_16x16x32_bf16 v[60:63], v[132:135], a[116:119], v[60:63]
    s_waitcnt lgkmcnt(1)
    v_mfma_f32_16x16x32_bf16 v[64:67], v[136:139], a[44:47], v[64:67]
    v_mfma_f32_16x16x32_bf16 v[68:71], v[136:139], a[116:119], v[68:71]
    s_waitcnt lgkmcnt(0)
    v_mfma_f32_16x16x32_bf16 v[72:75], v[140:143], a[44:47], v[72:75]
    v_mfma_f32_16x16x32_bf16 v[76:79], v[140:143], a[116:119], v[76:79]
    s_waitcnt vmcnt(20)
    s_barrier
    s_add_u32 s50, s38, 0
    s_add_u32 m0, s39, 0
    s_nop 0
    buffer_load_dwordx4 v1, s[12:15], s50 offen  lds
    s_add_u32 s50, s38, 9216
    s_add_u32 m0, s39, 1024
    s_nop 0
    buffer_load_dwordx4 v2, s[12:15], s50 offen  lds
    s_add_u32 s50, s38, 18432
    s_add_u32 m0, s39, 2048
    s_nop 0
    buffer_load_dwordx4 v1, s[12:15], s50 offen  lds
    s_add_u32 s50, s38, 27648
    s_add_u32 m0, s39, 3072
    s_nop 0
    buffer_load_dwordx4 v2, s[12:15], s50 offen  lds
    s_add_u32 s38, s38, 128
    s_add_u32 s39, s39, 16384
    s_and_b32 s39, s39, 0x1ffff
    v_add_u32 v7, s41, v3
    v_add_u32 v8, s41, v4
    s_add_u32 s41, s41, 16384
    s_and_b32 s41, s41, 0x1ffff
    ds_read_b128 v[80:83], v7 offset:0
    ds_read_b128 v[84:87], v7 offset:2048
    ds_read_b128 v[88:91], v7 offset:4096
    ds_read_b128 v[92:95], v7 offset:6144
    ds_read_b128 v[96:99], v7 offset:8192
    ds_read_b128 v[100:103], v7 offset:10240
    ds_read_b128 v[104:107], v7 offset:12288
    ds_read_b128 v[108:111], v7 offset:14336
    s_waitcnt lgkmcnt(7)
    v_mfma_f32_16x16x32_bf16 v[16:19], v[80:83], a[48:51], v[16:19]
    v_mfma_f32_16x16x32_bf16 v[20:23], v[80:83], a[120:123], v[20:23]
    ds_read_b128 v[112:115], v8 offset:0
    s_waitcnt lgkmcnt(7)
    v_mfma_f32_16x16x32_bf16 v[24:27], v[84:87], a[48:51], v[24:27]
    v_mfma_f32_16x16x32_bf16 v[28:31], v[84:87], a[120:123], v[28:31]
    ds_read_b128 v[116:119], v8 offset:2048
    s_waitcnt lgkmcnt(7)
    v_mfma_f32_16x16x32_bf16 v[32:35], v[88:91], a[48:51], v[32:35]
    v_mfma_f32_16x16x32_bf16 v[36:39], v[88:91], a[120:123], v[36:39]
    ds_read_b128 v[120:123], v8 offset:4096
    s_waitcnt lgkmcnt(7)
    v_mfma_f32_16x16x32_bf16 v[40:43], v[92:95], a[48:51], v[40:43]
    v_mfma_f32_16x16x32_bf16 v[44:47], v[92:95], a[120:123], v[44:47]
    ds_read_b128 v[124:127], v8 offset:6144
    s_waitcnt lgkmcnt(7)
    v_mfma_f32_16x16x32_bf16 v[48:51], v[96:99], a[48:51], v[48:51]
    v_mfma_f32_16x16x32_bf16 v[52:55], v[96:99], a[120:123], v[52:55]
    ds_read_b128 v[128:131], v8 offset:8192
    s_waitcnt lgkmcnt(7)
    v_mfma_f32_16x16x32_bf16 v[56:59], v[100:103], a[48:51], v[56:59]
    v_mfma_f32_16x16x32_bf16 v[60:63], v[100:103], a[120:123], v[60:63]
    ds_read_b128 v[132:135], v8 offset:10240
    s_waitcnt lgkmcnt(7)
    v_mfma_f32_16x16x32_bf16 v[64:67], v[104:107], a[48:51], v[64:67]
    v_mfma_f32_16x16x32_bf16 v[68:71], v[104:107], a[120:123], v[68:71]
    ds_read_b128 v[136:139], v8 offset:12288
    s_waitcnt lgkmcnt(7)
    v_mfma_f32_16x16x32_bf16 v[72:75], v[108:111], a[48:51], v[72:75]
    v_mfma_f32_16x16x32_bf16 v[76:79], v[108:111], a[120:123], v[76:79]
    ds_read_b128 v[140:143], v8 offset:14336
    s_waitcnt lgkmcnt(7)
    v_mfma_f32_16x16x32_bf16 v[16:19], v[112:115], a[52:55], v[16:19]
    v_mfma_f32_16x16x32_bf16 v[20:23], v[112:115], a[124:127], v[20:23]
    s_waitcnt lgkmcnt(6)
    v_mfma_f32_16x16x32_bf16 v[24:27], v[116:119], a[52:55], v[24:27]
    v_mfma_f32_16x16x32_bf16 v[28:31], v[116:119], a[124:127], v[28:31]
    s_waitcnt lgkmcnt(5)
    v_mfma_f32_16x16x32_bf16 v[32:35], v[120:123], a[52:55], v[32:35]
    v_mfma_f32_16x16x32_bf16 v[36:39], v[120:123], a[124:127], v[36:39]
    s_waitcnt lgkmcnt(4)
    v_mfma_f32_16x16x32_bf16 v[40:43], v[124:127], a[52:55], v[40:43]
    v_mfma_f32_16x16x32_bf16 v[44:47], v[124:127], a[124:127], v[44:47]
    s_waitcnt lgkmcnt(3)
    v_mfma_f32_16x16x32_bf16 v[48:51], v[128:131], a[52:55], v[48:51]
    v_mfma_f32_16x16x32_bf16 v[52:55], v[128:131], a[124:127], v[52:55]
    s_waitcnt lgkmcnt(2)
    v_mfma_f32_16x16x32_bf16 v[56:59], v[132:135], a[52:55], v[56:59]
    v_mfma_f32_16x16x32_bf16 v[60:63], v[132:135], a[124:127], v[60:63]
    s_waitcnt lgkmcnt(1)
    v_mfma_f32_16x16x32_bf16 v[64:67], v[136:139], a[52:55], v[64:67]
    v_mfma_f32_16x16x32_bf16 v[68:71], v[136:139], a[124:127], v[68:71]
    s_waitcnt lgkmcnt(0)
    v_mfma_f32_16x16x32_bf16 v[72:75], v[140:143], a[52:55], v[72:75]
    v_mfma_f32_16x16x32_bf16 v[76:79], v[140:143], a[124:127], v[76:79]
    s_waitcnt vmcnt(20)
    s_barrier
    s_add_u32 s50, s38, 0
    s_add_u32 m0, s39, 0
    s_nop 0
    buffer_load_dwordx4 v1, s[12:15], s50 offen  lds
    s_add_u32 s50, s38, 9216
    s_add_u32 m0, s39, 1024
    s_nop 0
    buffer_load_dwordx4 v2, s[12:15], s50 offen  lds
    s_add_u32 s50, s38, 18432
    s_add_u32 m0, s39, 2048
    s_nop 0
    buffer_load_dwordx4 v1, s[12:15], s50 offen  lds
    s_add_u32 s50, s38, 27648
    s_add_u32 m0, s39, 3072
    s_nop 0
    buffer_load_dwordx4 v2, s[12:15], s50 offen  lds
    s_add_u32 s38, s38, 128
    s_add_u32 s39, s39, 16384
    s_and_b32 s39, s39, 0x1ffff
    v_add_u32 v7, s41, v3
    v_add_u32 v8, s41, v4
    s_add_u32 s41, s41, 16384
    s_and_b32 s41, s41, 0x1ffff
    ds_read_b128 v[80:83], v7 offset:0
    ds_read_b128 v[84:87], v7 offset:2048
    ds_read_b128 v[88:91], v7 offset:4096
    ds_read_b128 v[92:95], v7 offset:6144
    ds_read_b128 v[96:99], v7 offset:8192
    ds_read_b128 v[100:103], v7 offset:10240
    ds_read_b128 v[104:107], v7 offset:12288
    ds_read_b128 v[108:111], v7 offset:14336
    s_waitcnt lgkmcnt(7)
    v_mfma_f32_16x16x32_bf16 v[16:19], v[80:83], a[56:59], v[16:19]
    v_mfma_f32_16x16x32_bf16 v[20:23], v[80:83], a[128:131], v[20:23]
    ds_read_b128 v[112:115], v8 offset:0
    s_waitcnt lgkmcnt(7)
    v_mfma_f32_16x16x32_bf16 v[24:27], v[84:87], a[56:59], v[24:27]
    v_mfma_f32_16x16x32_bf16 v[28:31], v[84:87], a[128:131], v[28:31]
    ds_read_b128 v[116:119], v8 offset:2048
    s_waitcnt lgkmcnt(7)
    v_mfma_f32_16x16x32_bf16 v[32:35], v[88:91], a[56:59], v[32:35]
    v_mfma_f32_16x16x32_bf16 v[36:39], v[88:91], a[128:131], v[36:39]
    ds_read_b128 v[120:123], v8 offset:4096
    s_waitcnt lgkmcnt(7)
    v_mfma_f32_16x16x32_bf16 v[40:43], v[92:95], a[56:59], v[40:43]
    v_mfma_f32_16x16x32_bf16 v[44:47], v[92:95], a[128:131], v[44:47]
    ds_read_b128 v[124:127], v8 offset:6144
    s_waitcnt lgkmcnt(7)
    v_mfma_f32_16x16x32_bf16 v[48:51], v[96:99], a[56:59], v[48:51]
    v_mfma_f32_16x16x32_bf16 v[52:55], v[96:99], a[128:131], v[52:55]
    ds_read_b128 v[128:131], v8 offset:8192
    s_waitcnt lgkmcnt(7)
    v_mfma_f32_16x16x32_bf16 v[56:59], v[100:103], a[56:59], v[56:59]
    v_mfma_f32_16x16x32_bf16 v[60:63], v[100:103], a[128:131], v[60:63]
    ds_read_b128 v[132:135], v8 offset:10240
    s_waitcnt lgkmcnt(7)
    v_mfma_f32_16x16x32_bf16 v[64:67], v[104:107], a[56:59], v[64:67]
    v_mfma_f32_16x16x32_bf16 v[68:71], v[104:107], a[128:131], v[68:71]
    ds_read_b128 v[136:139], v8 offset:12288
    s_waitcnt lgkmcnt(7)
    v_mfma_f32_16x16x32_bf16 v[72:75], v[108:111], a[56:59], v[72:75]
    v_mfma_f32_16x16x32_bf16 v[76:79], v[108:111], a[128:131], v[76:79]
    ds_read_b128 v[140:143], v8 offset:14336
    s_waitcnt lgkmcnt(7)
    v_mfma_f32_16x16x32_bf16 v[16:19], v[112:115], a[60:63], v[16:19]
    v_mfma_f32_16x16x32_bf16 v[20:23], v[112:115], a[132:135], v[20:23]
    s_waitcnt lgkmcnt(6)
    v_mfma_f32_16x16x32_bf16 v[24:27], v[116:119], a[60:63], v[24:27]
    v_mfma_f32_16x16x32_bf16 v[28:31], v[116:119], a[132:135], v[28:31]
    s_waitcnt lgkmcnt(5)
    v_mfma_f32_16x16x32_bf16 v[32:35], v[120:123], a[60:63], v[32:35]
    v_mfma_f32_16x16x32_bf16 v[36:39], v[120:123], a[132:135], v[36:39]
    s_waitcnt lgkmcnt(4)
    v_mfma_f32_16x16x32_bf16 v[40:43], v[124:127], a[60:63], v[40:43]
    v_mfma_f32_16x16x32_bf16 v[44:47], v[124:127], a[132:135], v[44:47]
    s_waitcnt lgkmcnt(3)
    v_mfma_f32_16x16x32_bf16 v[48:51], v[128:131], a[60:63], v[48:51]
    v_mfma_f32_16x16x32_bf16 v[52:55], v[128:131], a[132:135], v[52:55]
    s_waitcnt lgkmcnt(2)
    v_mfma_f32_16x16x32_bf16 v[56:59], v[132:135], a[60:63], v[56:59]
    v_mfma_f32_16x16x32_bf16 v[60:63], v[132:135], a[132:135], v[60:63]
    s_waitcnt lgkmcnt(1)
    v_mfma_f32_16x16x32_bf16 v[64:67], v[136:139], a[60:63], v[64:67]
    v_mfma_f32_16x16x32_bf16 v[68:71], v[136:139], a[132:135], v[68:71]
    s_waitcnt lgkmcnt(0)
    v_mfma_f32_16x16x32_bf16 v[72:75], v[140:143], a[60:63], v[72:75]
    v_mfma_f32_16x16x32_bf16 v[76:79], v[140:143], a[132:135], v[76:79]
    s_waitcnt vmcnt(20)
    s_barrier
    s_add_u32 s50, s38, 0
    s_add_u32 m0, s39, 0
    s_nop 0
    buffer_load_dwordx4 v1, s[12:15], s50 offen  lds
    s_add_u32 s50, s38, 9216
    s_add_u32 m0, s39, 1024
    s_nop 0
    buffer_load_dwordx4 v2, s[12:15], s50 offen  lds
    s_add_u32 s50, s38, 18432
    s_add_u32 m0, s39, 2048
    s_nop 0
    buffer_load_dwordx4 v1, s[12:15], s50 offen  lds
    s_add_u32 s50, s38, 27648
    s_add_u32 m0, s39, 3072
    s_nop 0
    buffer_load_dwordx4 v2, s[12:15], s50 offen  lds
    s_add_u32 s38, s38, 128
    s_add_u32 s39, s39, 16384
    s_and_b32 s39, s39, 0x1ffff
    v_add_u32 v7, s41, v3
    v_add_u32 v8, s41, v4
    s_add_u32 s41, s41, 16384
    s_and_b32 s41, s41, 0x1ffff
    ds_read_b128 v[80:83], v7 offset:0
    ds_read_b128 v[84:87], v7 offset:2048
    ds_read_b128 v[88:91], v7 offset:4096
    ds_read_b128 v[92:95], v7 offset:6144
    ds_read_b128 v[96:99], v7 offset:8192
    ds_read_b128 v[100:103], v7 offset:10240
    ds_read_b128 v[104:107], v7 offset:12288
    ds_read_b128 v[108:111], v7 offset:14336
    s_waitcnt lgkmcnt(7)
    v_mfma_f32_16x16x32_bf16 v[16:19], v[80:83], a[64:67], v[16:19]
    v_mfma_f32_16x16x32_bf16 v[20:23], v[80:83], a[136:139], v[20:23]
    ds_read_b128 v[112:115], v8 offset:0
    s_waitcnt lgkmcnt(7)
    v_mfma_f32_16x16x32_bf16 v[24:27], v[84:87], a[64:67], v[24:27]
    v_mfma_f32_16x16x32_bf16 v[28:31], v[84:87], a[136:139], v[28:31]
    ds_read_b128 v[116:119], v8 offset:2048
    s_waitcnt lgkmcnt(7)
    v_mfma_f32_16x16x32_bf16 v[32:35], v[88:91], a[64:67], v[32:35]
    v_mfma_f32_16x16x32_bf16 v[36:39], v[88:91], a[136:139], v[36:39]
    ds_read_b128 v[120:123], v8 offset:4096
    s_waitcnt lgkmcnt(7)
    v_mfma_f32_16x16x32_bf16 v[40:43], v[92:95], a[64:67], v[40:43]
    v_mfma_f32_16x16x32_bf16 v[44:47], v[92:95], a[136:139], v[44:47]
    ds_read_b128 v[124:127], v8 offset:6144
    s_waitcnt lgkmcnt(7)
    v_mfma_f32_16x16x32_bf16 v[48:51], v[96:99], a[64:67], v[48:51]
    v_mfma_f32_16x16x32_bf16 v[52:55], v[96:99], a[136:139], v[52:55]
    ds_read_b128 v[128:131], v8 offset:8192
    s_waitcnt lgkmcnt(7)
    v_mfma_f32_16x16x32_bf16 v[56:59], v[100:103], a[64:67], v[56:59]
    v_mfma_f32_16x16x32_bf16 v[60:63], v[100:103], a[136:139], v[60:63]
    ds_read_b128 v[132:135], v8 offset:10240
    s_waitcnt lgkmcnt(7)
    v_mfma_f32_16x16x32_bf16 v[64:67], v[104:107], a[64:67], v[64:67]
    v_mfma_f32_16x16x32_bf16 v[68:71], v[104:107], a[136:139], v[68:71]
    ds_read_b128 v[136:139], v8 offset:12288
    s_waitcnt lgkmcnt(7)
    v_mfma_f32_16x16x32_bf16 v[72:75], v[108:111], a[64:67], v[72:75]
    v_mfma_f32_16x16x32_bf16 v[76:79], v[108:111], a[136:139], v[76:79]
    ds_read_b128 v[140:143], v8 offset:14336
    s_waitcnt lgkmcnt(7)
    v_mfma_f32_16x16x32_bf16 v[16:19], v[112:115], a[68:71], v[16:19]
    v_mfma_f32_16x16x32_bf16 v[20:23], v[112:115], a[140:143], v[20:23]
    s_waitcnt lgkmcnt(6)
    v_mfma_f32_16x16x32_bf16 v[24:27], v[116:119], a[68:71], v[24:27]
    v_mfma_f32_16x16x32_bf16 v[28:31], v[116:119], a[140:143], v[28:31]
    s_waitcnt lgkmcnt(5)
    v_mfma_f32_16x16x32_bf16 v[32:35], v[120:123], a[68:71], v[32:35]
    v_mfma_f32_16x16x32_bf16 v[36:39], v[120:123], a[140:143], v[36:39]
    s_waitcnt lgkmcnt(4)
    v_mfma_f32_16x16x32_bf16 v[40:43], v[124:127], a[68:71], v[40:43]
    v_mfma_f32_16x16x32_bf16 v[44:47], v[124:127], a[140:143], v[44:47]
    s_waitcnt lgkmcnt(3)
    v_mfma_f32_16x16x32_bf16 v[48:51], v[128:131], a[68:71], v[48:51]
    v_mfma_f32_16x16x32_bf16 v[52:55], v[128:131], a[140:143], v[52:55]
    s_waitcnt lgkmcnt(2)
    v_mfma_f32_16x16x32_bf16 v[56:59], v[132:135], a[68:71], v[56:59]
    v_mfma_f32_16x16x32_bf16 v[60:63], v[132:135], a[140:143], v[60:63]
    s_waitcnt lgkmcnt(1)
    v_mfma_f32_16x16x32_bf16 v[64:67], v[136:139], a[68:71], v[64:67]
    v_mfma_f32_16x16x32_bf16 v[68:71], v[136:139], a[140:143], v[68:71]
    s_waitcnt lgkmcnt(0)
    v_mfma_f32_16x16x32_bf16 v[72:75], v[140:143], a[68:71], v[72:75]
    v_mfma_f32_16x16x32_bf16 v[76:79], v[140:143], a[140:143], v[76:79]
    s_mov_b32 s58, 0x3fb8aa3b
    s_mov_b32 s59, 0x358637bd
    v_cvt_pk_bf16_f32 v160, v16, v17
    v_lshlrev_b32 v161, 16, v160
    v_and_b32 v162, 0xffff0000, v160
    v_mul_f32 v163, s58, v161
    v_mul_f32 v164, s58, v162
    v_exp_f32 v163, v163
    v_exp_f32 v164, v164
    v_add_f32 v165, 1.0, v161
    v_add_f32 v166, 1.0, v162
    v_cmp_lt_f32 vcc, 0, v161
    s_nop 1
    v_cndmask_b32 v163, v163, v165, vcc
    v_cmp_lt_f32 vcc, 0, v162
    s_nop 1
    v_cndmask_b32 v164, v164, v166, vcc
    v_cvt_pk_bf16_f32 v160, v163, v164
    v_lshlrev_b32 v161, 16, v160
    v_and_b32 v162, 0xffff0000, v160
    v_add_f32 v161, s59, v161
    v_add_f32 v162, s59, v162
    v_cvt_pk_bf16_f32 v144, v161, v162
    v_cvt_pk_bf16_f32 v160, v18, v19
    v_lshlrev_b32 v161, 16, v160
    v_and_b32 v162, 0xffff0000, v160
    v_mul_f32 v163, s58, v161
    v_mul_f32 v164, s58, v162
    v_exp_f32 v163, v163
    v_exp_f32 v164, v164
    v_add_f32 v165, 1.0, v161
    v_add_f32 v166, 1.0, v162
    v_cmp_lt_f32 vcc, 0, v161
    s_nop 1
    v_cndmask_b32 v163, v163, v165, vcc
    v_cmp_lt_f32 vcc, 0, v162
    s_nop 1
    v_cndmask_b32 v164, v164, v166, vcc
    v_cvt_pk_bf16_f32 v160, v163, v164
    v_lshlrev_b32 v161, 16, v160
    v_and_b32 v162, 0xffff0000, v160
    v_add_f32 v161, s59, v161
    v_add_f32 v162, s59, v162
    v_cvt_pk_bf16_f32 v145, v161, v162
    v_cvt_pk_bf16_f32 v160, v24, v25
    v_lshlrev_b32 v161, 16, v160
    v_and_b32 v162, 0xffff0000, v160
    v_mul_f32 v163, s58, v161
    v_mul_f32 v164, s58, v162
    v_exp_f32 v163, v163
    v_exp_f32 v164, v164
    v_add_f32 v165, 1.0, v161
    v_add_f32 v166, 1.0, v162
    v_cmp_lt_f32 vcc, 0, v161
    s_nop 1
    v_cndmask_b32 v163, v163, v165, vcc
    v_cmp_lt_f32 vcc, 0, v162
    s_nop 1
    v_cndmask_b32 v164, v164, v166, vcc
    v_cvt_pk_bf16_f32 v160, v163, v164
    v_lshlrev_b32 v161, 16, v160
    v_and_b32 v162, 0xffff0000, v160
    v_add_f32 v161, s59, v161
    v_add_f32 v162, s59, v162
    v_cvt_pk_bf16_f32 v146, v161, v162
    v_cvt_pk_bf16_f32 v160, v26, v27
    v_lshlrev_b32 v161, 16, v160
    v_and_b32 v162, 0xffff0000, v160
    v_mul_f32 v163, s58, v161
    v_mul_f32 v164, s58, v162
    v_exp_f32 v163, v163
    v_exp_f32 v164, v164
    v_add_f32 v165, 1.0, v161
    v_add_f32 v166, 1.0, v162
    v_cmp_lt_f32 vcc, 0, v161
    s_nop 1
    v_cndmask_b32 v163, v163, v165, vcc
    v_cmp_lt_f32 vcc, 0, v162
    s_nop 1
    v_cndmask_b32 v164, v164, v166, vcc
    v_cvt_pk_bf16_f32 v160, v163, v164
    v_lshlrev_b32 v161, 16, v160
    v_and_b32 v162, 0xffff0000, v160
    v_add_f32 v161, s59, v161
    v_add_f32 v162, s59, v162
    v_cvt_pk_bf16_f32 v147, v161, v162
    s_add_u32 s50, s36, 0
    buffer_store_dwordx4 v[144:147], v0, s[4:7], s50 offen sc1
    v_cvt_pk_bf16_f32 v160, v20, v21
    v_lshlrev_b32 v161, 16, v160
    v_and_b32 v162, 0xffff0000, v160
    v_mul_f32 v163, s58, v161
    v_mul_f32 v164, s58, v162
    v_exp_f32 v163, v163
    v_exp_f32 v164, v164
    v_add_f32 v165, 1.0, v161
    v_add_f32 v166, 1.0, v162
    v_cmp_lt_f32 vcc, 0, v161
    s_nop 1
    v_cndmask_b32 v163, v163, v165, vcc
    v_cmp_lt_f32 vcc, 0, v162
    s_nop 1
    v_cndmask_b32 v164, v164, v166, vcc
    v_cvt_pk_bf16_f32 v160, v163, v164
    v_lshlrev_b32 v161, 16, v160
    v_and_b32 v162, 0xffff0000, v160
    v_add_f32 v161, s59, v161
    v_add_f32 v162, s59, v162
    v_cvt_pk_bf16_f32 v148, v161, v162
    v_cvt_pk_bf16_f32 v160, v22, v23
    v_lshlrev_b32 v161, 16, v160
    v_and_b32 v162, 0xffff0000, v160
    v_mul_f32 v163, s58, v161
    v_mul_f32 v164, s58, v162
    v_exp_f32 v163, v163
    v_exp_f32 v164, v164
    v_add_f32 v165, 1.0, v161
    v_add_f32 v166, 1.0, v162
    v_cmp_lt_f32 vcc, 0, v161
    s_nop 1
    v_cndmask_b32 v163, v163, v165, vcc
    v_cmp_lt_f32 vcc, 0, v162
    s_nop 1
    v_cndmask_b32 v164, v164, v166, vcc
    v_cvt_pk_bf16_f32 v160, v163, v164
    v_lshlrev_b32 v161, 16, v160
    v_and_b32 v162, 0xffff0000, v160
    v_add_f32 v161, s59, v161
    v_add_f32 v162, s59, v162
    v_cvt_pk_bf16_f32 v149, v161, v162
    v_cvt_pk_bf16_f32 v160, v28, v29
    v_lshlrev_b32 v161, 16, v160
    v_and_b32 v162, 0xffff0000, v160
    v_mul_f32 v163, s58, v161
    v_mul_f32 v164, s58, v162
    v_exp_f32 v163, v163
    v_exp_f32 v164, v164
    v_add_f32 v165, 1.0, v161
    v_add_f32 v166, 1.0, v162
    v_cmp_lt_f32 vcc, 0, v161
    s_nop 1
    v_cndmask_b32 v163, v163, v165, vcc
    v_cmp_lt_f32 vcc, 0, v162
    s_nop 1
    v_cndmask_b32 v164, v164, v166, vcc
    v_cvt_pk_bf16_f32 v160, v163, v164
    v_lshlrev_b32 v161, 16, v160
    v_and_b32 v162, 0xffff0000, v160
    v_add_f32 v161, s59, v161
    v_add_f32 v162, s59, v162
    v_cvt_pk_bf16_f32 v150, v161, v162
    v_cvt_pk_bf16_f32 v160, v30, v31
    v_lshlrev_b32 v161, 16, v160
    v_and_b32 v162, 0xffff0000, v160
    v_mul_f32 v163, s58, v161
    v_mul_f32 v164, s58, v162
    v_exp_f32 v163, v163
    v_exp_f32 v164, v164
    v_add_f32 v165, 1.0, v161
    v_add_f32 v166, 1.0, v162
    v_cmp_lt_f32 vcc, 0, v161
    s_nop 1
    v_cndmask_b32 v163, v163, v165, vcc
    v_cmp_lt_f32 vcc, 0, v162
    s_nop 1
    v_cndmask_b32 v164, v164, v166, vcc
    v_cvt_pk_bf16_f32 v160, v163, v164
    v_lshlrev_b32 v161, 16, v160
    v_and_b32 v162, 0xffff0000, v160
    v_add_f32 v161, s59, v161
    v_add_f32 v162, s59, v162
    v_cvt_pk_bf16_f32 v151, v161, v162
    s_add_u32 s50, s36, 65536
    buffer_store_dwordx4 v[148:151], v0, s[4:7], s50 offen sc1
    v_cvt_pk_bf16_f32 v160, v32, v33
    v_lshlrev_b32 v161, 16, v160
    v_and_b32 v162, 0xffff0000, v160
    v_mul_f32 v163, s58, v161
    v_mul_f32 v164, s58, v162
    v_exp_f32 v163, v163
    v_exp_f32 v164, v164
    v_add_f32 v165, 1.0, v161
    v_add_f32 v166, 1.0, v162
    v_cmp_lt_f32 vcc, 0, v161
    s_nop 1
    v_cndmask_b32 v163, v163, v165, vcc
    v_cmp_lt_f32 vcc, 0, v162
    s_nop 1
    v_cndmask_b32 v164, v164, v166, vcc
    v_cvt_pk_bf16_f32 v160, v163, v164
    v_lshlrev_b32 v161, 16, v160
    v_and_b32 v162, 0xffff0000, v160
    v_add_f32 v161, s59, v161
    v_add_f32 v162, s59, v162
    v_cvt_pk_bf16_f32 v152, v161, v162
    v_cvt_pk_bf16_f32 v160, v34, v35
    v_lshlrev_b32 v161, 16, v160
    v_and_b32 v162, 0xffff0000, v160
    v_mul_f32 v163, s58, v161
    v_mul_f32 v164, s58, v162
    v_exp_f32 v163, v163
    v_exp_f32 v164, v164
    v_add_f32 v165, 1.0, v161
    v_add_f32 v166, 1.0, v162
    v_cmp_lt_f32 vcc, 0, v161
    s_nop 1
    v_cndmask_b32 v163, v163, v165, vcc
    v_cmp_lt_f32 vcc, 0, v162
    s_nop 1
    v_cndmask_b32 v164, v164, v166, vcc
    v_cvt_pk_bf16_f32 v160, v163, v164
    v_lshlrev_b32 v161, 16, v160
    v_and_b32 v162, 0xffff0000, v160
    v_add_f32 v161, s59, v161
    v_add_f32 v162, s59, v162
    v_cvt_pk_bf16_f32 v153, v161, v162
    v_cvt_pk_bf16_f32 v160, v40, v41
    v_lshlrev_b32 v161, 16, v160
    v_and_b32 v162, 0xffff0000, v160
    v_mul_f32 v163, s58, v161
    v_mul_f32 v164, s58, v162
    v_exp_f32 v163, v163
    v_exp_f32 v164, v164
    v_add_f32 v165, 1.0, v161
    v_add_f32 v166, 1.0, v162
    v_cmp_lt_f32 vcc, 0, v161
    s_nop 1
    v_cndmask_b32 v163, v163, v165, vcc
    v_cmp_lt_f32 vcc, 0, v162
    s_nop 1
    v_cndmask_b32 v164, v164, v166, vcc
    v_cvt_pk_bf16_f32 v160, v163, v164
    v_lshlrev_b32 v161, 16, v160
    v_and_b32 v162, 0xffff0000, v160
    v_add_f32 v161, s59, v161
    v_add_f32 v162, s59, v162
    v_cvt_pk_bf16_f32 v154, v161, v162
    v_cvt_pk_bf16_f32 v160, v42, v43
    v_lshlrev_b32 v161, 16, v160
    v_and_b32 v162, 0xffff0000, v160
    v_mul_f32 v163, s58, v161
    v_mul_f32 v164, s58, v162
    v_exp_f32 v163, v163
    v_exp_f32 v164, v164
    v_add_f32 v165, 1.0, v161
    v_add_f32 v166, 1.0, v162
    v_cmp_lt_f32 vcc, 0, v161
    s_nop 1
    v_cndmask_b32 v163, v163, v165, vcc
    v_cmp_lt_f32 vcc, 0, v162
    s_nop 1
    v_cndmask_b32 v164, v164, v166, vcc
    v_cvt_pk_bf16_f32 v160, v163, v164
    v_lshlrev_b32 v161, 16, v160
    v_and_b32 v162, 0xffff0000, v160
    v_add_f32 v161, s59, v161
    v_add_f32 v162, s59, v162
    v_cvt_pk_bf16_f32 v155, v161, v162
    s_add_u32 s50, s36, 1024
    buffer_store_dwordx4 v[152:155], v0, s[4:7], s50 offen sc1
    v_cvt_pk_bf16_f32 v160, v36, v37
    v_lshlrev_b32 v161, 16, v160
    v_and_b32 v162, 0xffff0000, v160
    v_mul_f32 v163, s58, v161
    v_mul_f32 v164, s58, v162
    v_exp_f32 v163, v163
    v_exp_f32 v164, v164
    v_add_f32 v165, 1.0, v161
    v_add_f32 v166, 1.0, v162
    v_cmp_lt_f32 vcc, 0, v161
    s_nop 1
    v_cndmask_b32 v163, v163, v165, vcc
    v_cmp_lt_f32 vcc, 0, v162
    s_nop 1
    v_cndmask_b32 v164, v164, v166, vcc
    v_cvt_pk_bf16_f32 v160, v163, v164
    v_lshlrev_b32 v161, 16, v160
    v_and_b32 v162, 0xffff0000, v160
    v_add_f32 v161, s59, v161
    v_add_f32 v162, s59, v162
    v_cvt_pk_bf16_f32 v156, v161, v162
    v_cvt_pk_bf16_f32 v160, v38, v39
    v_lshlrev_b32 v161, 16, v160
    v_and_b32 v162, 0xffff0000, v160
    v_mul_f32 v163, s58, v161
    v_mul_f32 v164, s58, v162
    v_exp_f32 v163, v163
    v_exp_f32 v164, v164
    v_add_f32 v165, 1.0, v161
    v_add_f32 v166, 1.0, v162
    v_cmp_lt_f32 vcc, 0, v161
    s_nop 1
    v_cndmask_b32 v163, v163, v165, vcc
    v_cmp_lt_f32 vcc, 0, v162
    s_nop 1
    v_cndmask_b32 v164, v164, v166, vcc
    v_cvt_pk_bf16_f32 v160, v163, v164
    v_lshlrev_b32 v161, 16, v160
    v_and_b32 v162, 0xffff0000, v160
    v_add_f32 v161, s59, v161
    v_add_f32 v162, s59, v162
    v_cvt_pk_bf16_f32 v157, v161, v162
    v_cvt_pk_bf16_f32 v160, v44, v45
    v_lshlrev_b32 v161, 16, v160
    v_and_b32 v162, 0xffff0000, v160
    v_mul_f32 v163, s58, v161
    v_mul_f32 v164, s58, v162
    v_exp_f32 v163, v163
    v_exp_f32 v164, v164
    v_add_f32 v165, 1.0, v161
    v_add_f32 v166, 1.0, v162
    v_cmp_lt_f32 vcc, 0, v161
    s_nop 1
    v_cndmask_b32 v163, v163, v165, vcc
    v_cmp_lt_f32 vcc, 0, v162
    s_nop 1
    v_cndmask_b32 v164, v164, v166, vcc
    v_cvt_pk_bf16_f32 v160, v163, v164
    v_lshlrev_b32 v161, 16, v160
    v_and_b32 v162, 0xffff0000, v160
    v_add_f32 v161, s59, v161
    v_add_f32 v162, s59, v162
    v_cvt_pk_bf16_f32 v158, v161, v162
    v_cvt_pk_bf16_f32 v160, v46, v47
    v_lshlrev_b32 v161, 16, v160
    v_and_b32 v162, 0xffff0000, v160
    v_mul_f32 v163, s58, v161
    v_mul_f32 v164, s58, v162
    v_exp_f32 v163, v163
    v_exp_f32 v164, v164
    v_add_f32 v165, 1.0, v161
    v_add_f32 v166, 1.0, v162
    v_cmp_lt_f32 vcc, 0, v161
    s_nop 1
    v_cndmask_b32 v163, v163, v165, vcc
    v_cmp_lt_f32 vcc, 0, v162
    s_nop 1
    v_cndmask_b32 v164, v164, v166, vcc
    v_cvt_pk_bf16_f32 v160, v163, v164
    v_lshlrev_b32 v161, 16, v160
    v_and_b32 v162, 0xffff0000, v160
    v_add_f32 v161, s59, v161
    v_add_f32 v162, s59, v162
    v_cvt_pk_bf16_f32 v159, v161, v162
    s_add_u32 s50, s36, 66560
    buffer_store_dwordx4 v[156:159], v0, s[4:7], s50 offen sc1
    v_cvt_pk_bf16_f32 v160, v48, v49
    v_lshlrev_b32 v161, 16, v160
    v_and_b32 v162, 0xffff0000, v160
    v_mul_f32 v163, s58, v161
    v_mul_f32 v164, s58, v162
    v_exp_f32 v163, v163
    v_exp_f32 v164, v164
    v_add_f32 v165, 1.0, v161
    v_add_f32 v166, 1.0, v162
    v_cmp_lt_f32 vcc, 0, v161
    s_nop 1
    v_cndmask_b32 v163, v163, v165, vcc
    v_cmp_lt_f32 vcc, 0, v162
    s_nop 1
    v_cndmask_b32 v164, v164, v166, vcc
    v_cvt_pk_bf16_f32 v160, v163, v164
    v_lshlrev_b32 v161, 16, v160
    v_and_b32 v162, 0xffff0000, v160
    v_add_f32 v161, s59, v161
    v_add_f32 v162, s59, v162
    v_cvt_pk_bf16_f32 v144, v161, v162
    v_cvt_pk_bf16_f32 v160, v50, v51
    v_lshlrev_b32 v161, 16, v160
    v_and_b32 v162, 0xffff0000, v160
    v_mul_f32 v163, s58, v161
    v_mul_f32 v164, s58, v162
    v_exp_f32 v163, v163
    v_exp_f32 v164, v164
    v_add_f32 v165, 1.0, v161
    v_add_f32 v166, 1.0, v162
    v_cmp_lt_f32 vcc, 0, v161
    s_nop 1
    v_cndmask_b32 v163, v163, v165, vcc
    v_cmp_lt_f32 vcc, 0, v162
    s_nop 1
    v_cndmask_b32 v164, v164, v166, vcc
    v_cvt_pk_bf16_f32 v160, v163, v164
    v_lshlrev_b32 v161, 16, v160
    v_and_b32 v162, 0xffff0000, v160
    v_add_f32 v161, s59, v161
    v_add_f32 v162, s59, v162
    v_cvt_pk_bf16_f32 v145, v161, v162
    v_cvt_pk_bf16_f32 v160, v56, v57
    v_lshlrev_b32 v161, 16, v160
    v_and_b32 v162, 0xffff0000, v160
    v_mul_f32 v163, s58, v161
    v_mul_f32 v164, s58, v162
    v_exp_f32 v163, v163
    v_exp_f32 v164, v164
    v_add_f32 v165, 1.0, v161
    v_add_f32 v166, 1.0, v162
    v_cmp_lt_f32 vcc, 0, v161
    s_nop 1
    v_cndmask_b32 v163, v163, v165, vcc
    v_cmp_lt_f32 vcc, 0, v162
    s_nop 1
    v_cndmask_b32 v164, v164, v166, vcc
    v_cvt_pk_bf16_f32 v160, v163, v164
    v_lshlrev_b32 v161, 16, v160
    v_and_b32 v162, 0xffff0000, v160
    v_add_f32 v161, s59, v161
    v_add_f32 v162, s59, v162
    v_cvt_pk_bf16_f32 v146, v161, v162
    v_cvt_pk_bf16_f32 v160, v58, v59
    v_lshlrev_b32 v161, 16, v160
    v_and_b32 v162, 0xffff0000, v160
    v_mul_f32 v163, s58, v161
    v_mul_f32 v164, s58, v162
    v_exp_f32 v163, v163
    v_exp_f32 v164, v164
    v_add_f32 v165, 1.0, v161
    v_add_f32 v166, 1.0, v162
    v_cmp_lt_f32 vcc, 0, v161
    s_nop 1
    v_cndmask_b32 v163, v163, v165, vcc
    v_cmp_lt_f32 vcc, 0, v162
    s_nop 1
    v_cndmask_b32 v164, v164, v166, vcc
    v_cvt_pk_bf16_f32 v160, v163, v164
    v_lshlrev_b32 v161, 16, v160
    v_and_b32 v162, 0xffff0000, v160
    v_add_f32 v161, s59, v161
    v_add_f32 v162, s59, v162
    v_cvt_pk_bf16_f32 v147, v161, v162
    s_add_u32 s50, s36, 2048
    buffer_store_dwordx4 v[144:147], v0, s[4:7], s50 offen sc1
    v_cvt_pk_bf16_f32 v160, v52, v53
    v_lshlrev_b32 v161, 16, v160
    v_and_b32 v162, 0xffff0000, v160
    v_mul_f32 v163, s58, v161
    v_mul_f32 v164, s58, v162
    v_exp_f32 v163, v163
    v_exp_f32 v164, v164
    v_add_f32 v165, 1.0, v161
    v_add_f32 v166, 1.0, v162
    v_cmp_lt_f32 vcc, 0, v161
    s_nop 1
    v_cndmask_b32 v163, v163, v165, vcc
    v_cmp_lt_f32 vcc, 0, v162
    s_nop 1
    v_cndmask_b32 v164, v164, v166, vcc
    v_cvt_pk_bf16_f32 v160, v163, v164
    v_lshlrev_b32 v161, 16, v160
    v_and_b32 v162, 0xffff0000, v160
    v_add_f32 v161, s59, v161
    v_add_f32 v162, s59, v162
    v_cvt_pk_bf16_f32 v148, v161, v162
    v_cvt_pk_bf16_f32 v160, v54, v55
    v_lshlrev_b32 v161, 16, v160
    v_and_b32 v162, 0xffff0000, v160
    v_mul_f32 v163, s58, v161
    v_mul_f32 v164, s58, v162
    v_exp_f32 v163, v163
    v_exp_f32 v164, v164
    v_add_f32 v165, 1.0, v161
    v_add_f32 v166, 1.0, v162
    v_cmp_lt_f32 vcc, 0, v161
    s_nop 1
    v_cndmask_b32 v163, v163, v165, vcc
    v_cmp_lt_f32 vcc, 0, v162
    s_nop 1
    v_cndmask_b32 v164, v164, v166, vcc
    v_cvt_pk_bf16_f32 v160, v163, v164
    v_lshlrev_b32 v161, 16, v160
    v_and_b32 v162, 0xffff0000, v160
    v_add_f32 v161, s59, v161
    v_add_f32 v162, s59, v162
    v_cvt_pk_bf16_f32 v149, v161, v162
    v_cvt_pk_bf16_f32 v160, v60, v61
    v_lshlrev_b32 v161, 16, v160
    v_and_b32 v162, 0xffff0000, v160
    v_mul_f32 v163, s58, v161
    v_mul_f32 v164, s58, v162
    v_exp_f32 v163, v163
    v_exp_f32 v164, v164
    v_add_f32 v165, 1.0, v161
    v_add_f32 v166, 1.0, v162
    v_cmp_lt_f32 vcc, 0, v161
    s_nop 1
    v_cndmask_b32 v163, v163, v165, vcc
    v_cmp_lt_f32 vcc, 0, v162
    s_nop 1
    v_cndmask_b32 v164, v164, v166, vcc
    v_cvt_pk_bf16_f32 v160, v163, v164
    v_lshlrev_b32 v161, 16, v160
    v_and_b32 v162, 0xffff0000, v160
    v_add_f32 v161, s59, v161
    v_add_f32 v162, s59, v162
    v_cvt_pk_bf16_f32 v150, v161, v162
    v_cvt_pk_bf16_f32 v160, v62, v63
    v_lshlrev_b32 v161, 16, v160
    v_and_b32 v162, 0xffff0000, v160
    v_mul_f32 v163, s58, v161
    v_mul_f32 v164, s58, v162
    v_exp_f32 v163, v163
    v_exp_f32 v164, v164
    v_add_f32 v165, 1.0, v161
    v_add_f32 v166, 1.0, v162
    v_cmp_lt_f32 vcc, 0, v161
    s_nop 1
    v_cndmask_b32 v163, v163, v165, vcc
    v_cmp_lt_f32 vcc, 0, v162
    s_nop 1
    v_cndmask_b32 v164, v164, v166, vcc
    v_cvt_pk_bf16_f32 v160, v163, v164
    v_lshlrev_b32 v161, 16, v160
    v_and_b32 v162, 0xffff0000, v160
    v_add_f32 v161, s59, v161
    v_add_f32 v162, s59, v162
    v_cvt_pk_bf16_f32 v151, v161, v162
    s_add_u32 s50, s36, 67584
    buffer_store_dwordx4 v[148:151], v0, s[4:7], s50 offen sc1
    v_cvt_pk_bf16_f32 v160, v64, v65
    v_lshlrev_b32 v161, 16, v160
    v_and_b32 v162, 0xffff0000, v160
    v_mul_f32 v163, s58, v161
    v_mul_f32 v164, s58, v162
    v_exp_f32 v163, v163
    v_exp_f32 v164, v164
    v_add_f32 v165, 1.0, v161
    v_add_f32 v166, 1.0, v162
    v_cmp_lt_f32 vcc, 0, v161
    s_nop 1
    v_cndmask_b32 v163, v163, v165, vcc
    v_cmp_lt_f32 vcc, 0, v162
    s_nop 1
    v_cndmask_b32 v164, v164, v166, vcc
    v_cvt_pk_bf16_f32 v160, v163, v164
    v_lshlrev_b32 v161, 16, v160
    v_and_b32 v162, 0xffff0000, v160
    v_add_f32 v161, s59, v161
    v_add_f32 v162, s59, v162
    v_cvt_pk_bf16_f32 v152, v161, v162
    v_cvt_pk_bf16_f32 v160, v66, v67
    v_lshlrev_b32 v161, 16, v160
    v_and_b32 v162, 0xffff0000, v160
    v_mul_f32 v163, s58, v161
    v_mul_f32 v164, s58, v162
    v_exp_f32 v163, v163
    v_exp_f32 v164, v164
    v_add_f32 v165, 1.0, v161
    v_add_f32 v166, 1.0, v162
    v_cmp_lt_f32 vcc, 0, v161
    s_nop 1
    v_cndmask_b32 v163, v163, v165, vcc
    v_cmp_lt_f32 vcc, 0, v162
    s_nop 1
    v_cndmask_b32 v164, v164, v166, vcc
    v_cvt_pk_bf16_f32 v160, v163, v164
    v_lshlrev_b32 v161, 16, v160
    v_and_b32 v162, 0xffff0000, v160
    v_add_f32 v161, s59, v161
    v_add_f32 v162, s59, v162
    v_cvt_pk_bf16_f32 v153, v161, v162
    v_cvt_pk_bf16_f32 v160, v72, v73
    v_lshlrev_b32 v161, 16, v160
    v_and_b32 v162, 0xffff0000, v160
    v_mul_f32 v163, s58, v161
    v_mul_f32 v164, s58, v162
    v_exp_f32 v163, v163
    v_exp_f32 v164, v164
    v_add_f32 v165, 1.0, v161
    v_add_f32 v166, 1.0, v162
    v_cmp_lt_f32 vcc, 0, v161
    s_nop 1
    v_cndmask_b32 v163, v163, v165, vcc
    v_cmp_lt_f32 vcc, 0, v162
    s_nop 1
    v_cndmask_b32 v164, v164, v166, vcc
    v_cvt_pk_bf16_f32 v160, v163, v164
    v_lshlrev_b32 v161, 16, v160
    v_and_b32 v162, 0xffff0000, v160
    v_add_f32 v161, s59, v161
    v_add_f32 v162, s59, v162
    v_cvt_pk_bf16_f32 v154, v161, v162
    v_cvt_pk_bf16_f32 v160, v74, v75
    v_lshlrev_b32 v161, 16, v160
    v_and_b32 v162, 0xffff0000, v160
    v_mul_f32 v163, s58, v161
    v_mul_f32 v164, s58, v162
    v_exp_f32 v163, v163
    v_exp_f32 v164, v164
    v_add_f32 v165, 1.0, v161
    v_add_f32 v166, 1.0, v162
    v_cmp_lt_f32 vcc, 0, v161
    s_nop 1
    v_cndmask_b32 v163, v163, v165, vcc
    v_cmp_lt_f32 vcc, 0, v162
    s_nop 1
    v_cndmask_b32 v164, v164, v166, vcc
    v_cvt_pk_bf16_f32 v160, v163, v164
    v_lshlrev_b32 v161, 16, v160
    v_and_b32 v162, 0xffff0000, v160
    v_add_f32 v161, s59, v161
    v_add_f32 v162, s59, v162
    v_cvt_pk_bf16_f32 v155, v161, v162
    s_add_u32 s50, s36, 3072
    buffer_store_dwordx4 v[152:155], v0, s[4:7], s50 offen sc1
    v_cvt_pk_bf16_f32 v160, v68, v69
    v_lshlrev_b32 v161, 16, v160
    v_and_b32 v162, 0xffff0000, v160
    v_mul_f32 v163, s58, v161
    v_mul_f32 v164, s58, v162
    v_exp_f32 v163, v163
    v_exp_f32 v164, v164
    v_add_f32 v165, 1.0, v161
    v_add_f32 v166, 1.0, v162
    v_cmp_lt_f32 vcc, 0, v161
    s_nop 1
    v_cndmask_b32 v163, v163, v165, vcc
    v_cmp_lt_f32 vcc, 0, v162
    s_nop 1
    v_cndmask_b32 v164, v164, v166, vcc
    v_cvt_pk_bf16_f32 v160, v163, v164
    v_lshlrev_b32 v161, 16, v160
    v_and_b32 v162, 0xffff0000, v160
    v_add_f32 v161, s59, v161
    v_add_f32 v162, s59, v162
    v_cvt_pk_bf16_f32 v156, v161, v162
    v_cvt_pk_bf16_f32 v160, v70, v71
    v_lshlrev_b32 v161, 16, v160
    v_and_b32 v162, 0xffff0000, v160
    v_mul_f32 v163, s58, v161
    v_mul_f32 v164, s58, v162
    v_exp_f32 v163, v163
    v_exp_f32 v164, v164
    v_add_f32 v165, 1.0, v161
    v_add_f32 v166, 1.0, v162
    v_cmp_lt_f32 vcc, 0, v161
    s_nop 1
    v_cndmask_b32 v163, v163, v165, vcc
    v_cmp_lt_f32 vcc, 0, v162
    s_nop 1
    v_cndmask_b32 v164, v164, v166, vcc
    v_cvt_pk_bf16_f32 v160, v163, v164
    v_lshlrev_b32 v161, 16, v160
    v_and_b32 v162, 0xffff0000, v160
    v_add_f32 v161, s59, v161
    v_add_f32 v162, s59, v162
    v_cvt_pk_bf16_f32 v157, v161, v162
    v_cvt_pk_bf16_f32 v160, v76, v77
    v_lshlrev_b32 v161, 16, v160
    v_and_b32 v162, 0xffff0000, v160
    v_mul_f32 v163, s58, v161
    v_mul_f32 v164, s58, v162
    v_exp_f32 v163, v163
    v_exp_f32 v164, v164
    v_add_f32 v165, 1.0, v161
    v_add_f32 v166, 1.0, v162
    v_cmp_lt_f32 vcc, 0, v161
    s_nop 1
    v_cndmask_b32 v163, v163, v165, vcc
    v_cmp_lt_f32 vcc, 0, v162
    s_nop 1
    v_cndmask_b32 v164, v164, v166, vcc
    v_cvt_pk_bf16_f32 v160, v163, v164
    v_lshlrev_b32 v161, 16, v160
    v_and_b32 v162, 0xffff0000, v160
    v_add_f32 v161, s59, v161
    v_add_f32 v162, s59, v162
    v_cvt_pk_bf16_f32 v158, v161, v162
    v_cvt_pk_bf16_f32 v160, v78, v79
    v_lshlrev_b32 v161, 16, v160
    v_and_b32 v162, 0xffff0000, v160
    v_mul_f32 v163, s58, v161
    v_mul_f32 v164, s58, v162
    v_exp_f32 v163, v163
    v_exp_f32 v164, v164
    v_add_f32 v165, 1.0, v161
    v_add_f32 v166, 1.0, v162
    v_cmp_lt_f32 vcc, 0, v161
    s_nop 1
    v_cndmask_b32 v163, v163, v165, vcc
    v_cmp_lt_f32 vcc, 0, v162
    s_nop 1
    v_cndmask_b32 v164, v164, v166, vcc
    v_cvt_pk_bf16_f32 v160, v163, v164
    v_lshlrev_b32 v161, 16, v160
    v_and_b32 v162, 0xffff0000, v160
    v_add_f32 v161, s59, v161
    v_add_f32 v162, s59, v162
    v_cvt_pk_bf16_f32 v159, v161, v162
    s_add_u32 s50, s36, 68608
    buffer_store_dwordx4 v[156:159], v0, s[4:7], s50 offen sc1
    s_add_u32 s34, s34, 1
    s_add_u32 s36, s36, s37
    s_cmp_lt_u32 s34, s35
    s_cbranch_scc1 BL1K_BLK
    s_waitcnt vmcnt(0)
    s_barrier
    s_branch BL1_END
BL1_V:
    s_add_u32 s36, s36, 88080384
    s_mul_i32 s38, s34, 147456
    s_mul_i32 s50, s31, 36864
    s_add_u32 s38, s38, s50
    s_lshl_b32 s39, s31, 12
    s_mov_b32 s41, 0
    s_add_u32 s50, s38, 0
    s_add_u32 m0, s39, 0
    s_nop 0
    buffer_load_dwordx4 v1, s[12:15], s50 offen  lds
    s_add_u32 s50, s38, 9216
    s_add_u32 m0, s39, 1024
    s_nop 0
    buffer_load_dwordx4 v2, s[12:15], s50 offen  lds
    s_add_u32 s50, s38, 18432
    s_add_u32 m0, s39, 2048
    s_nop 0
    buffer_load_dwordx4 v1, s[12:15], s50 offen  lds
    s_add_u32 s50, s38, 27648
    s_add_u32 m0, s39, 3072
    s_nop 0
    buffer_load_dwordx4 v2, s[12:15], s50 offen  lds
    s_add_u32 s38, s38, 128
    s_add_u32 s39, s39, 16384
    s_and_b32 s39, s39, 0x1ffff
    s_add_u32 s50, s38, 0
    s_add_u32 m0, s39, 0
    s_nop 0
    buffer_load_dwordx4 v1, s[12:15], s50 offen  lds
    s_add_u32 s50, s38, 9216
    s_add_u32 m0, s39, 1024
    s_nop 0
    buffer_load_dwordx4 v2, s[12:15], s50 offen  lds
    s_add_u32 s50, s38, 18432
    s_add_u32 m0, s39, 2048
    s_nop 0
    buffer_load_dwordx4 v1, s[12:15], s50 offen  lds
    s_add_u32 s50, s38, 27648
    s_add_u32 m0, s39, 3072
    s_nop 0
    buffer_load_dwordx4 v2, s[12:15], s50 offen  lds
    s_add_u32 s38, s38, 128
    s_add_u32 s39, s39, 16384
    s_and_b32 s39, s39, 0x1ffff
    s_add_u32 s50, s38, 0
    s_add_u32 m0, s39, 0
    s_nop 0
    buffer_load_dwordx4 v1, s[12:15], s50 offen  lds
    s_add_u32 s50, s38, 9216
    s_add_u32 m0, s39, 1024
    s_nop 0
    buffer_load_dwordx4 v2, s[12:15], s50 offen  lds
    s_add_u32 s50, s38, 18432
    s_add_u32 m0, s39, 2048
    s_nop 0
    buffer_load_dwordx4 v1, s[12:15], s50 offen  lds
    s_add_u32 s50, s38, 27648
    s_add_u32 m0, s39, 3072
    s_nop 0
    buffer_load_dwordx4 v2, s[12:15], s50 offen  lds
    s_add_u32 s38, s38, 128
    s_add_u32 s39, s39, 16384
    s_and_b32 s39, s39, 0x1ffff
    s_add_u32 s50, s38, 0
    s_add_u32 m0, s39, 0
    s_nop 0
    buffer_load_dwordx4 v1, s[12:15], s50 offen  lds
    s_add_u32 s50, s38, 9216
    s_add_u32 m0, s39, 1024
    s_nop 0
    buffer_load_dwordx4 v2, s[12:15], s50 offen  lds
    s_add_u32 s50, s38, 18432
    s_add_u32 m0, s39, 2048
    s_nop 0
    buffer_load_dwordx4 v1, s[12:15], s50 offen  lds
    s_add_u32 s50, s38, 27648
    s_add_u32 m0, s39, 3072
    s_nop 0
    buffer_load_dwordx4 v2, s[12:15], s50 offen  lds
    s_add_u32 s38, s38, 128
    s_add_u32 s39, s39, 16384
    s_and_b32 s39, s39, 0x1ffff
    s_add_u32 s50, s38, 0
    s_add_u32 m0, s39, 0
    s_nop 0
    buffer_load_dwordx4 v1, s[12:15], s50 offen  lds
    s_add_u32 s50, s38, 9216
    s_add_u32 m0, s39, 1024
    s_nop 0
    buffer_load_dwordx4 v2, s[12:15], s50 offen  lds
    s_add_u32 s50, s38, 18432
    s_add_u32 m0, s39, 2048
    s_nop 0
    buffer_load_dwordx4 v1, s[12:15], s50 offen  lds
    s_add_u32 s50, s38, 27648
    s_add_u32 m0, s39, 3072
    s_nop 0
    buffer_load_dwordx4 v2, s[12:15], s50 offen  lds
    s_add_u32 s38, s38, 128
    s_add_u32 s39, s39, 16384
    s_and_b32 s39, s39, 0x1ffff
    s_add_u32 s50, s38, 0
    s_add_u32 m0, s39, 0
    s_nop 0
    buffer_load_dwordx4 v1, s[12:15], s50 offen  lds
    s_add_u32 s50, s38, 9216
    s_add_u32 m0, s39, 1024
    s_nop 0
    buffer_load_dwordx4 v2, s[12:15], s50 offen  lds
    s_add_u32 s50, s38, 18432
    s_add_u32 m0, s39, 2048
    s_nop 0
    buffer_load_dwordx4 v1, s[12:15], s50 offen  lds
    s_add_u32 s50, s38, 27648
    s_add_u32 m0, s39, 3072
    s_nop 0
    buffer_load_dwordx4 v2, s[12:15], s50 offen  lds
    s_add_u32 s38, s38, 128
    s_add_u32 s39, s39, 16384
    s_and_b32 s39, s39, 0x1ffff
    s_waitcnt vmcnt(0)
BL1V_BLK:
    s_waitcnt vmcnt(28)
    s_barrier
    s_add_u32 s50, s38, 0
    s_add_u32 m0, s39, 0
    s_nop 0
    buffer_load_dwordx4 v1, s[12:15], s50 offen  lds
    s_add_u32 s50, s38, 9216
    s_add_u32 m0, s39, 1024
    s_nop 0
    buffer_load_dwordx4 v2, s[12:15], s50 offen  lds
    s_add_u32 s50, s38, 18432
    s_add_u32 m0, s39, 2048
    s_nop 0
    buffer_load_dwordx4 v1, s[12:15], s50 offen  lds
    s_add_u32 s50, s38, 27648
    s_add_u32 m0, s39, 3072
    s_nop 0
    buffer_load_dwordx4 v2, s[12:15], s50 offen  lds
    s_add_u32 s38, s38, 128
    s_add_u32 s39, s39, 16384
    s_and_b32 s39, s39, 0x1ffff
    v_add_u32 v7, s41, v3
    v_add_u32 v8, s41, v4
    s_add_u32 s41, s41, 16384
    s_and_b32 s41, s41, 0x1ffff
    ds_read_b128 v[80:83], v7 offset:0
    ds_read_b128 v[84:87], v7 offset:2048
    ds_read_b128 v[88:91], v7 offset:4096
    ds_read_b128 v[92:95], v7 offset:6144
    ds_read_b128 v[96:99], v7 offset:8192
    ds_read_b128 v[100:103], v7 offset:10240
    ds_read_b128 v[104:107], v7 offset:12288
    ds_read_b128 v[108:111], v7 offset:14336
    s_waitcnt lgkmcnt(7)
    v_mfma_f32_16x16x32_bf16 v[16:19], v[80:83], a[0:3], 0
    v_mfma_f32_16x16x32_bf16 v[20:23], v[80:83], a[72:75], 0
    ds_read_b128 v[112:115], v8 offset:0
    s_waitcnt lgkmcnt(7)
    v_mfma_f32_16x16x32_bf16 v[24:27], v[84:87], a[0:3], 0
    v_mfma_f32_16x16x32_bf16 v[28:31], v[84:87], a[72:75], 0
    ds_read_b128 v[116:119], v8 offset:2048
    s_waitcnt lgkmcnt(7)
    v_mfma_f32_16x16x32_bf16 v[32:35], v[88:91], a[0:3], 0
    v_mfma_f32_16x16x32_bf16 v[36:39], v[88:91], a[72:75], 0
    ds_read_b128 v[120:123], v8 offset:4096
    s_waitcnt lgkmcnt(7)
    v_mfma_f32_16x16x32_bf16 v[40:43], v[92:95], a[0:3], 0
    v_mfma_f32_16x16x32_bf16 v[44:47], v[92:95], a[72:75], 0
    ds_read_b128 v[124:127], v8 offset:6144
    s_waitcnt lgkmcnt(7)
    v_mfma_f32_16x16x32_bf16 v[48:51], v[96:99], a[0:3], 0
    v_mfma_f32_16x16x32_bf16 v[52:55], v[96:99], a[72:75], 0
    ds_read_b128 v[128:131], v8 offset:8192
    s_waitcnt lgkmcnt(7)
    v_mfma_f32_16x16x32_bf16 v[56:59], v[100:103], a[0:3], 0
    v_mfma_f32_16x16x32_bf16 v[60:63], v[100:103], a[72:75], 0
    ds_read_b128 v[132:135], v8 offset:10240
    s_waitcnt lgkmcnt(7)
    v_mfma_f32_16x16x32_bf16 v[64:67], v[104:107], a[0:3], 0
    v_mfma_f32_16x16x32_bf16 v[68:71], v[104:107], a[72:75], 0
    ds_read_b128 v[136:139], v8 offset:12288
    s_waitcnt lgkmcnt(7)
    v_mfma_f32_16x16x32_bf16 v[72:75], v[108:111], a[0:3], 0
    v_mfma_f32_16x16x32_bf16 v[76:79], v[108:111], a[72:75], 0
    ds_read_b128 v[140:143], v8 offset:14336
    s_waitcnt lgkmcnt(7)
    v_mfma_f32_16x16x32_bf16 v[16:19], v[112:115], a[4:7], v[16:19]
    v_mfma_f32_16x16x32_bf16 v[20:23], v[112:115], a[76:79], v[20:23]
    s_waitcnt lgkmcnt(6)
    v_mfma_f32_16x16x32_bf16 v[24:27], v[116:119], a[4:7], v[24:27]
    v_mfma_f32_16x16x32_bf16 v[28:31], v[116:119], a[76:79], v[28:31]
    s_waitcnt lgkmcnt(5)
    v_mfma_f32_16x16x32_bf16 v[32:35], v[120:123], a[4:7], v[32:35]
    v_mfma_f32_16x16x32_bf16 v[36:39], v[120:123], a[76:79], v[36:39]
    s_waitcnt lgkmcnt(4)
    v_mfma_f32_16x16x32_bf16 v[40:43], v[124:127], a[4:7], v[40:43]
    v_mfma_f32_16x16x32_bf16 v[44:47], v[124:127], a[76:79], v[44:47]
    s_waitcnt lgkmcnt(3)
    v_mfma_f32_16x16x32_bf16 v[48:51], v[128:131], a[4:7], v[48:51]
    v_mfma_f32_16x16x32_bf16 v[52:55], v[128:131], a[76:79], v[52:55]
    s_waitcnt lgkmcnt(2)
    v_mfma_f32_16x16x32_bf16 v[56:59], v[132:135], a[4:7], v[56:59]
    v_mfma_f32_16x16x32_bf16 v[60:63], v[132:135], a[76:79], v[60:63]
    s_waitcnt lgkmcnt(1)
    v_mfma_f32_16x16x32_bf16 v[64:67], v[136:139], a[4:7], v[64:67]
    v_mfma_f32_16x16x32_bf16 v[68:71], v[136:139], a[76:79], v[68:71]
    s_waitcnt lgkmcnt(0)
    v_mfma_f32_16x16x32_bf16 v[72:75], v[140:143], a[4:7], v[72:75]
    v_mfma_f32_16x16x32_bf16 v[76:79], v[140:143], a[76:79], v[76:79]
    s_waitcnt vmcnt(28)
    s_barrier
    s_add_u32 s50, s38, 0
    s_add_u32 m0, s39, 0
    s_nop 0
    buffer_load_dwordx4 v1, s[12:15], s50 offen  lds
    s_add_u32 s50, s38, 9216
    s_add_u32 m0, s39, 1024
    s_nop 0
    buffer_load_dwordx4 v2, s[12:15], s50 offen  lds
    s_add_u32 s50, s38, 18432
    s_add_u32 m0, s39, 2048
    s_nop 0
    buffer_load_dwordx4 v1, s[12:15], s50 offen  lds
    s_add_u32 s50, s38, 27648
    s_add_u32 m0, s39, 3072
    s_nop 0
    buffer_load_dwordx4 v2, s[12:15], s50 offen  lds
    s_add_u32 s38, s38, 128
    s_add_u32 s39, s39, 16384
    s_and_b32 s39, s39, 0x1ffff
    v_add_u32 v7, s41, v3
    v_add_u32 v8, s41, v4
    s_add_u32 s41, s41, 16384
    s_and_b32 s41, s41, 0x1ffff
    ds_read_b128 v[80:83], v7 offset:0
    ds_read_b128 v[84:87], v7 offset:2048
    ds_read_b128 v[88:91], v7 offset:4096
    ds_read_b128 v[92:95], v7 offset:6144
    ds_read_b128 v[96:99], v7 offset:8192
    ds_read_b128 v[100:103], v7 offset:10240
    ds_read_b128 v[104:107], v7 offset:12288
    ds_read_b128 v[108:111], v7 offset:14336
    s_waitcnt lgkmcnt(7)
    v_mfma_f32_16x16x32_bf16 v[16:19], v[80:83], a[8:11], v[16:19]
    v_mfma_f32_16x16x32_bf16 v[20:23], v[80:83], a[80:83], v[20:23]
    ds_read_b128 v[112:115], v8 offset:0
    s_waitcnt lgkmcnt(7)
    v_mfma_f32_16x16x32_bf16 v[24:27], v[84:87], a[8:11], v[24:27]
    v_mfma_f32_16x16x32_bf16 v[28:31], v[84:87], a[80:83], v[28:31]
    ds_read_b128 v[116:119], v8 offset:2048
    s_waitcnt lgkmcnt(7)
    v_mfma_f32_16x16x32_bf16 v[32:35], v[88:91], a[8:11], v[32:35]
    v_mfma_f32_16x16x32_bf16 v[36:39], v[88:91], a[80:83], v[36:39]
    ds_read_b128 v[120:123], v8 offset:4096
    s_waitcnt lgkmcnt(7)
    v_mfma_f32_16x16x32_bf16 v[40:43], v[92:95], a[8:11], v[40:43]
    v_mfma_f32_16x16x32_bf16 v[44:47], v[92:95], a[80:83], v[44:47]
    ds_read_b128 v[124:127], v8 offset:6144
    s_waitcnt lgkmcnt(7)
    v_mfma_f32_16x16x32_bf16 v[48:51], v[96:99], a[8:11], v[48:51]
    v_mfma_f32_16x16x32_bf16 v[52:55], v[96:99], a[80:83], v[52:55]
    ds_read_b128 v[128:131], v8 offset:8192
    s_waitcnt lgkmcnt(7)
    v_mfma_f32_16x16x32_bf16 v[56:59], v[100:103], a[8:11], v[56:59]
    v_mfma_f32_16x16x32_bf16 v[60:63], v[100:103], a[80:83], v[60:63]
    ds_read_b128 v[132:135], v8 offset:10240
    s_waitcnt lgkmcnt(7)
    v_mfma_f32_16x16x32_bf16 v[64:67], v[104:107], a[8:11], v[64:67]
    v_mfma_f32_16x16x32_bf16 v[68:71], v[104:107], a[80:83], v[68:71]
    ds_read_b128 v[136:139], v8 offset:12288
    s_waitcnt lgkmcnt(7)
    v_mfma_f32_16x16x32_bf16 v[72:75], v[108:111], a[8:11], v[72:75]
    v_mfma_f32_16x16x32_bf16 v[76:79], v[108:111], a[80:83], v[76:79]
    ds_read_b128 v[140:143], v8 offset:14336
    s_waitcnt lgkmcnt(7)
    v_mfma_f32_16x16x32_bf16 v[16:19], v[112:115], a[12:15], v[16:19]
    v_mfma_f32_16x16x32_bf16 v[20:23], v[112:115], a[84:87], v[20:23]
    s_waitcnt lgkmcnt(6)
    v_mfma_f32_16x16x32_bf16 v[24:27], v[116:119], a[12:15], v[24:27]
    v_mfma_f32_16x16x32_bf16 v[28:31], v[116:119], a[84:87], v[28:31]
    s_waitcnt lgkmcnt(5)
    v_mfma_f32_16x16x32_bf16 v[32:35], v[120:123], a[12:15], v[32:35]
    v_mfma_f32_16x16x32_bf16 v[36:39], v[120:123], a[84:87], v[36:39]
    s_waitcnt lgkmcnt(4)
    v_mfma_f32_16x16x32_bf16 v[40:43], v[124:127], a[12:15], v[40:43]
    v_mfma_f32_16x16x32_bf16 v[44:47], v[124:127], a[84:87], v[44:47]
    s_waitcnt lgkmcnt(3)
    v_mfma_f32_16x16x32_bf16 v[48:51], v[128:131], a[12:15], v[48:51]
    v_mfma_f32_16x16x32_bf16 v[52:55], v[128:131], a[84:87], v[52:55]
    s_waitcnt lgkmcnt(2)
    v_mfma_f32_16x16x32_bf16 v[56:59], v[132:135], a[12:15], v[56:59]
    v_mfma_f32_16x16x32_bf16 v[60:63], v[132:135], a[84:87], v[60:63]
    s_waitcnt lgkmcnt(1)
    v_mfma_f32_16x16x32_bf16 v[64:67], v[136:139], a[12:15], v[64:67]
    v_mfma_f32_16x16x32_bf16 v[68:71], v[136:139], a[84:87], v[68:71]
    s_waitcnt lgkmcnt(0)
    v_mfma_f32_16x16x32_bf16 v[72:75], v[140:143], a[12:15], v[72:75]
    v_mfma_f32_16x16x32_bf16 v[76:79], v[140:143], a[84:87], v[76:79]
    s_waitcnt vmcnt(28)
    s_barrier
    s_add_u32 s50, s38, 0
    s_add_u32 m0, s39, 0
    s_nop 0
    buffer_load_dwordx4 v1, s[12:15], s50 offen  lds
    s_add_u32 s50, s38, 9216
    s_add_u32 m0, s39, 1024
    s_nop 0
    buffer_load_dwordx4 v2, s[12:15], s50 offen  lds
    s_add_u32 s50, s38, 18432
    s_add_u32 m0, s39, 2048
    s_nop 0
    buffer_load_dwordx4 v1, s[12:15], s50 offen  lds
    s_add_u32 s50, s38, 27648
    s_add_u32 m0, s39, 3072
    s_nop 0
    buffer_load_dwordx4 v2, s[12:15], s50 offen  lds
    s_add_u32 s38, s38, 146432
    s_add_u32 s39, s39, 16384
    s_and_b32 s39, s39, 0x1ffff
    v_add_u32 v7, s41, v3
    v_add_u32 v8, s41, v4
    s_add_u32 s41, s41, 16384
    s_and_b32 s41, s41, 0x1ffff
    ds_read_b128 v[80:83], v7 offset:0
    ds_read_b128 v[84:87], v7 offset:2048
    ds_read_b128 v[88:91], v7 offset:4096
    ds_read_b128 v[92:95], v7 offset:6144
    ds_read_b128 v[96:99], v7 offset:8192
    ds_read_b128 v[100:103], v7 offset:10240
    ds_read_b128 v[104:107], v7 offset:12288
    ds_read_b128 v[108:111], v7 offset:14336
    s_waitcnt lgkmcnt(7)
    v_mfma_f32_16x16x32_bf16 v[16:19], v[80:83], a[16:19], v[16:19]
    v_mfma_f32_16x16x32_bf16 v[20:23], v[80:83], a[88:91], v[20:23]
    ds_read_b128 v[112:115], v8 offset:0
    s_waitcnt lgkmcnt(7)
    v_mfma_f32_16x16x32_bf16 v[24:27], v[84:87], a[16:19], v[24:27]
    v_mfma_f32_16x16x32_bf16 v[28:31], v[84:87], a[88:91], v[28:31]
    ds_read_b128 v[116:119], v8 offset:2048
    s_waitcnt lgkmcnt(7)
    v_mfma_f32_16x16x32_bf16 v[32:35], v[88:91], a[16:19], v[32:35]
    v_mfma_f32_16x16x32_bf16 v[36:39], v[88:91], a[88:91], v[36:39]
    ds_read_b128 v[120:123], v8 offset:4096
    s_waitcnt lgkmcnt(7)
    v_mfma_f32_16x16x32_bf16 v[40:43], v[92:95], a[16:19], v[40:43]
    v_mfma_f32_16x16x32_bf16 v[44:47], v[92:95], a[88:91], v[44:47]
    ds_read_b128 v[124:127], v8 offset:6144
    s_waitcnt lgkmcnt(7)
    v_mfma_f32_16x16x32_bf16 v[48:51], v[96:99], a[16:19], v[48:51]
    v_mfma_f32_16x16x32_bf16 v[52:55], v[96:99], a[88:91], v[52:55]
    ds_read_b128 v[128:131], v8 offset:8192
    s_waitcnt lgkmcnt(7)
    v_mfma_f32_16x16x32_bf16 v[56:59], v[100:103], a[16:19], v[56:59]
    v_mfma_f32_16x16x32_bf16 v[60:63], v[100:103], a[88:91], v[60:63]
    ds_read_b128 v[132:135], v8 offset:10240
    s_waitcnt lgkmcnt(7)
    v_mfma_f32_16x16x32_bf16 v[64:67], v[104:107], a[16:19], v[64:67]
    v_mfma_f32_16x16x32_bf16 v[68:71], v[104:107], a[88:91], v[68:71]
    ds_read_b128 v[136:139], v8 offset:12288
    s_waitcnt lgkmcnt(7)
    v_mfma_f32_16x16x32_bf16 v[72:75], v[108:111], a[16:19], v[72:75]
    v_mfma_f32_16x16x32_bf16 v[76:79], v[108:111], a[88:91], v[76:79]
    ds_read_b128 v[140:143], v8 offset:14336
    s_waitcnt lgkmcnt(7)
    v_mfma_f32_16x16x32_bf16 v[16:19], v[112:115], a[20:23], v[16:19]
    v_mfma_f32_16x16x32_bf16 v[20:23], v[112:115], a[92:95], v[20:23]
    s_waitcnt lgkmcnt(6)
    v_mfma_f32_16x16x32_bf16 v[24:27], v[116:119], a[20:23], v[24:27]
    v_mfma_f32_16x16x32_bf16 v[28:31], v[116:119], a[92:95], v[28:31]
    s_waitcnt lgkmcnt(5)
    v_mfma_f32_16x16x32_bf16 v[32:35], v[120:123], a[20:23], v[32:35]
    v_mfma_f32_16x16x32_bf16 v[36:39], v[120:123], a[92:95], v[36:39]
    s_waitcnt lgkmcnt(4)
    v_mfma_f32_16x16x32_bf16 v[40:43], v[124:127], a[20:23], v[40:43]
    v_mfma_f32_16x16x32_bf16 v[44:47], v[124:127], a[92:95], v[44:47]
    s_waitcnt lgkmcnt(3)
    v_mfma_f32_16x16x32_bf16 v[48:51], v[128:131], a[20:23], v[48:51]
    v_mfma_f32_16x16x32_bf16 v[52:55], v[128:131], a[92:95], v[52:55]
    s_waitcnt lgkmcnt(2)
    v_mfma_f32_16x16x32_bf16 v[56:59], v[132:135], a[20:23], v[56:59]
    v_mfma_f32_16x16x32_bf16 v[60:63], v[132:135], a[92:95], v[60:63]
    s_waitcnt lgkmcnt(1)
    v_mfma_f32_16x16x32_bf16 v[64:67], v[136:139], a[20:23], v[64:67]
    v_mfma_f32_16x16x32_bf16 v[68:71], v[136:139], a[92:95], v[68:71]
    s_waitcnt lgkmcnt(0)
    v_mfma_f32_16x16x32_bf16 v[72:75], v[140:143], a[20:23], v[72:75]
    v_mfma_f32_16x16x32_bf16 v[76:79], v[140:143], a[92:95], v[76:79]
    s_waitcnt vmcnt(28)
    s_barrier
    s_add_u32 s50, s38, 0
    s_add_u32 m0, s39, 0
    s_nop 0
    buffer_load_dwordx4 v1, s[12:15], s50 offen  lds
    s_add_u32 s50, s38, 9216
    s_add_u32 m0, s39, 1024
    s_nop 0
    buffer_load_dwordx4 v2, s[12:15], s50 offen  lds
    s_add_u32 s50, s38, 18432
    s_add_u32 m0, s39, 2048
    s_nop 0
    buffer_load_dwordx4 v1, s[12:15], s50 offen  lds
    s_add_u32 s50, s38, 27648
    s_add_u32 m0, s39, 3072
    s_nop 0
    buffer_load_dwordx4 v2, s[12:15], s50 offen  lds
    s_add_u32 s38, s38, 128
    s_add_u32 s39, s39, 16384
    s_and_b32 s39, s39, 0x1ffff
    v_add_u32 v7, s41, v3
    v_add_u32 v8, s41, v4
    s_add_u32 s41, s41, 16384
    s_and_b32 s41, s41, 0x1ffff
    ds_read_b128 v[80:83], v7 offset:0
    ds_read_b128 v[84:87], v7 offset:2048
    ds_read_b128 v[88:91], v7 offset:4096
    ds_read_b128 v[92:95], v7 offset:6144
    ds_read_b128 v[96:99], v7 offset:8192
    ds_read_b128 v[100:103], v7 offset:10240
    ds_read_b128 v[104:107], v7 offset:12288
    ds_read_b128 v[108:111], v7 offset:14336
    s_waitcnt lgkmcnt(7)
    v_mfma_f32_16x16x32_bf16 v[16:19], v[80:83], a[24:27], v[16:19]
    v_mfma_f32_16x16x32_bf16 v[20:23], v[80:83], a[96:99], v[20:23]
    ds_read_b128 v[112:115], v8 offset:0
    s_waitcnt lgkmcnt(7)
    v_mfma_f32_16x16x32_bf16 v[24:27], v[84:87], a[24:27], v[24:27]
    v_mfma_f32_16x16x32_bf16 v[28:31], v[84:87], a[96:99], v[28:31]
    ds_read_b128 v[116:119], v8 offset:2048
    s_waitcnt lgkmcnt(7)
    v_mfma_f32_16x16x32_bf16 v[32:35], v[88:91], a[24:27], v[32:35]
    v_mfma_f32_16x16x32_bf16 v[36:39], v[88:91], a[96:99], v[36:39]
    ds_read_b128 v[120:123], v8 offset:4096
    s_waitcnt lgkmcnt(7)
    v_mfma_f32_16x16x32_bf16 v[40:43], v[92:95], a[24:27], v[40:43]
    v_mfma_f32_16x16x32_bf16 v[44:47], v[92:95], a[96:99], v[44:47]
    ds_read_b128 v[124:127], v8 offset:6144
    s_waitcnt lgkmcnt(7)
    v_mfma_f32_16x16x32_bf16 v[48:51], v[96:99], a[24:27], v[48:51]
    v_mfma_f32_16x16x32_bf16 v[52:55], v[96:99], a[96:99], v[52:55]
    ds_read_b128 v[128:131], v8 offset:8192
    s_waitcnt lgkmcnt(7)
    v_mfma_f32_16x16x32_bf16 v[56:59], v[100:103], a[24:27], v[56:59]
    v_mfma_f32_16x16x32_bf16 v[60:63], v[100:103], a[96:99], v[60:63]
    ds_read_b128 v[132:135], v8 offset:10240
    s_waitcnt lgkmcnt(7)
    v_mfma_f32_16x16x32_bf16 v[64:67], v[104:107], a[24:27], v[64:67]
    v_mfma_f32_16x16x32_bf16 v[68:71], v[104:107], a[96:99], v[68:71]
    ds_read_b128 v[136:139], v8 offset:12288
    s_waitcnt lgkmcnt(7)
    v_mfma_f32_16x16x32_bf16 v[72:75], v[108:111], a[24:27], v[72:75]
    v_mfma_f32_16x16x32_bf16 v[76:79], v[108:111], a[96:99], v[76:79]
    ds_read_b128 v[140:143], v8 offset:14336
    s_waitcnt lgkmcnt(7)
    v_mfma_f32_16x16x32_bf16 v[16:19], v[112:115], a[28:31], v[16:19]
    v_mfma_f32_16x16x32_bf16 v[20:23], v[112:115], a[100:103], v[20:23]
    s_waitcnt lgkmcnt(6)
    v_mfma_f32_16x16x32_bf16 v[24:27], v[116:119], a[28:31], v[24:27]
    v_mfma_f32_16x16x32_bf16 v[28:31], v[116:119], a[100:103], v[28:31]
    s_waitcnt lgkmcnt(5)
    v_mfma_f32_16x16x32_bf16 v[32:35], v[120:123], a[28:31], v[32:35]
    v_mfma_f32_16x16x32_bf16 v[36:39], v[120:123], a[100:103], v[36:39]
    s_waitcnt lgkmcnt(4)
    v_mfma_f32_16x16x32_bf16 v[40:43], v[124:127], a[28:31], v[40:43]
    v_mfma_f32_16x16x32_bf16 v[44:47], v[124:127], a[100:103], v[44:47]
    s_waitcnt lgkmcnt(3)
    v_mfma_f32_16x16x32_bf16 v[48:51], v[128:131], a[28:31], v[48:51]
    v_mfma_f32_16x16x32_bf16 v[52:55], v[128:131], a[100:103], v[52:55]
    s_waitcnt lgkmcnt(2)
    v_mfma_f32_16x16x32_bf16 v[56:59], v[132:135], a[28:31], v[56:59]
    v_mfma_f32_16x16x32_bf16 v[60:63], v[132:135], a[100:103], v[60:63]
    s_waitcnt lgkmcnt(1)
    v_mfma_f32_16x16x32_bf16 v[64:67], v[136:139], a[28:31], v[64:67]
    v_mfma_f32_16x16x32_bf16 v[68:71], v[136:139], a[100:103], v[68:71]
    s_waitcnt lgkmcnt(0)
    v_mfma_f32_16x16x32_bf16 v[72:75], v[140:143], a[28:31], v[72:75]
    v_mfma_f32_16x16x32_bf16 v[76:79], v[140:143], a[100:103], v[76:79]
    s_waitcnt vmcnt(28)
    s_barrier
    s_add_u32 s50, s38, 0
    s_add_u32 m0, s39, 0
    s_nop 0
    buffer_load_dwordx4 v1, s[12:15], s50 offen  lds
    s_add_u32 s50, s38, 9216
    s_add_u32 m0, s39, 1024
    s_nop 0
    buffer_load_dwordx4 v2, s[12:15], s50 offen  lds
    s_add_u32 s50, s38, 18432
    s_add_u32 m0, s39, 2048
    s_nop 0
    buffer_load_dwordx4 v1, s[12:15], s50 offen  lds
    s_add_u32 s50, s38, 27648
    s_add_u32 m0, s39, 3072
    s_nop 0
    buffer_load_dwordx4 v2, s[12:15], s50 offen  lds
    s_add_u32 s38, s38, 128
    s_add_u32 s39, s39, 16384
    s_and_b32 s39, s39, 0x1ffff
    v_add_u32 v7, s41, v3
    v_add_u32 v8, s41, v4
    s_add_u32 s41, s41, 16384
    s_and_b32 s41, s41, 0x1ffff
    ds_read_b128 v[80:83], v7 offset:0
    ds_read_b128 v[84:87], v7 offset:2048
    ds_read_b128 v[88:91], v7 offset:4096
    ds_read_b128 v[92:95], v7 offset:6144
    ds_read_b128 v[96:99], v7 offset:8192
    ds_read_b128 v[100:103], v7 offset:10240
    ds_read_b128 v[104:107], v7 offset:12288
    ds_read_b128 v[108:111], v7 offset:14336
    s_waitcnt lgkmcnt(7)
    v_mfma_f32_16x16x32_bf16 v[16:19], v[80:83], a[32:35], v[16:19]
    v_mfma_f32_16x16x32_bf16 v[20:23], v[80:83], a[104:107], v[20:23]
    ds_read_b128 v[112:115], v8 offset:0
    s_waitcnt lgkmcnt(7)
    v_mfma_f32_16x16x32_bf16 v[24:27], v[84:87], a[32:35], v[24:27]
    v_mfma_f32_16x16x32_bf16 v[28:31], v[84:87], a[104:107], v[28:31]
    ds_read_b128 v[116:119], v8 offset:2048
    s_waitcnt lgkmcnt(7)
    v_mfma_f32_16x16x32_bf16 v[32:35], v[88:91], a[32:35], v[32:35]
    v_mfma_f32_16x16x32_bf16 v[36:39], v[88:91], a[104:107], v[36:39]
    ds_read_b128 v[120:123], v8 offset:4096
    s_waitcnt lgkmcnt(7)
    v_mfma_f32_16x16x32_bf16 v[40:43], v[92:95], a[32:35], v[40:43]
    v_mfma_f32_16x16x32_bf16 v[44:47], v[92:95], a[104:107], v[44:47]
    ds_read_b128 v[124:127], v8 offset:6144
    s_waitcnt lgkmcnt(7)
    v_mfma_f32_16x16x32_bf16 v[48:51], v[96:99], a[32:35], v[48:51]
    v_mfma_f32_16x16x32_bf16 v[52:55], v[96:99], a[104:107], v[52:55]
    ds_read_b128 v[128:131], v8 offset:8192
    s_waitcnt lgkmcnt(7)
    v_mfma_f32_16x16x32_bf16 v[56:59], v[100:103], a[32:35], v[56:59]
    v_mfma_f32_16x16x32_bf16 v[60:63], v[100:103], a[104:107], v[60:63]
    ds_read_b128 v[132:135], v8 offset:10240
    s_waitcnt lgkmcnt(7)
    v_mfma_f32_16x16x32_bf16 v[64:67], v[104:107], a[32:35], v[64:67]
    v_mfma_f32_16x16x32_bf16 v[68:71], v[104:107], a[104:107], v[68:71]
    ds_read_b128 v[136:139], v8 offset:12288
    s_waitcnt lgkmcnt(7)
    v_mfma_f32_16x16x32_bf16 v[72:75], v[108:111], a[32:35], v[72:75]
    v_mfma_f32_16x16x32_bf16 v[76:79], v[108:111], a[104:107], v[76:79]
    ds_read_b128 v[140:143], v8 offset:14336
    s_waitcnt lgkmcnt(7)
    v_mfma_f32_16x16x32_bf16 v[16:19], v[112:115], a[36:39], v[16:19]
    v_mfma_f32_16x16x32_bf16 v[20:23], v[112:115], a[108:111], v[20:23]
    s_waitcnt lgkmcnt(6)
    v_mfma_f32_16x16x32_bf16 v[24:27], v[116:119], a[36:39], v[24:27]
    v_mfma_f32_16x16x32_bf16 v[28:31], v[116:119], a[108:111], v[28:31]
    s_waitcnt lgkmcnt(5)
    v_mfma_f32_16x16x32_bf16 v[32:35], v[120:123], a[36:39], v[32:35]
    v_mfma_f32_16x16x32_bf16 v[36:39], v[120:123], a[108:111], v[36:39]
    s_waitcnt lgkmcnt(4)
    v_mfma_f32_16x16x32_bf16 v[40:43], v[124:127], a[36:39], v[40:43]
    v_mfma_f32_16x16x32_bf16 v[44:47], v[124:127], a[108:111], v[44:47]
    s_waitcnt lgkmcnt(3)
    v_mfma_f32_16x16x32_bf16 v[48:51], v[128:131], a[36:39], v[48:51]
    v_mfma_f32_16x16x32_bf16 v[52:55], v[128:131], a[108:111], v[52:55]
    s_waitcnt lgkmcnt(2)
    v_mfma_f32_16x16x32_bf16 v[56:59], v[132:135], a[36:39], v[56:59]
    v_mfma_f32_16x16x32_bf16 v[60:63], v[132:135], a[108:111], v[60:63]
    s_waitcnt lgkmcnt(1)
    v_mfma_f32_16x16x32_bf16 v[64:67], v[136:139], a[36:39], v[64:67]
    v_mfma_f32_16x16x32_bf16 v[68:71], v[136:139], a[108:111], v[68:71]
    s_waitcnt lgkmcnt(0)
    v_mfma_f32_16x16x32_bf16 v[72:75], v[140:143], a[36:39], v[72:75]
    v_mfma_f32_16x16x32_bf16 v[76:79], v[140:143], a[108:111], v[76:79]
    s_waitcnt vmcnt(28)
    s_barrier
    s_add_u32 s50, s38, 0
    s_add_u32 m0, s39, 0
    s_nop 0
    buffer_load_dwordx4 v1, s[12:15], s50 offen  lds
    s_add_u32 s50, s38, 9216
    s_add_u32 m0, s39, 1024
    s_nop 0
    buffer_load_dwordx4 v2, s[12:15], s50 offen  lds
    s_add_u32 s50, s38, 18432
    s_add_u32 m0, s39, 2048
    s_nop 0
    buffer_load_dwordx4 v1, s[12:15], s50 offen  lds
    s_add_u32 s50, s38, 27648
    s_add_u32 m0, s39, 3072
    s_nop 0
    buffer_load_dwordx4 v2, s[12:15], s50 offen  lds
    s_add_u32 s38, s38, 128
    s_add_u32 s39, s39, 16384
    s_and_b32 s39, s39, 0x1ffff
    v_add_u32 v7, s41, v3
    v_add_u32 v8, s41, v4
    s_add_u32 s41, s41, 16384
    s_and_b32 s41, s41, 0x1ffff
    ds_read_b128 v[80:83], v7 offset:0
    ds_read_b128 v[84:87], v7 offset:2048
    ds_read_b128 v[88:91], v7 offset:4096
    ds_read_b128 v[92:95], v7 offset:6144
    ds_read_b128 v[96:99], v7 offset:8192
    ds_read_b128 v[100:103], v7 offset:10240
    ds_read_b128 v[104:107], v7 offset:12288
    ds_read_b128 v[108:111], v7 offset:14336
    s_waitcnt lgkmcnt(7)
    v_mfma_f32_16x16x32_bf16 v[16:19], v[80:83], a[40:43], v[16:19]
    v_mfma_f32_16x16x32_bf16 v[20:23], v[80:83], a[112:115], v[20:23]
    ds_read_b128 v[112:115], v8 offset:0
    s_waitcnt lgkmcnt(7)
    v_mfma_f32_16x16x32_bf16 v[24:27], v[84:87], a[40:43], v[24:27]
    v_mfma_f32_16x16x32_bf16 v[28:31], v[84:87], a[112:115], v[28:31]
    ds_read_b128 v[116:119], v8 offset:2048
    s_waitcnt lgkmcnt(7)
    v_mfma_f32_16x16x32_bf16 v[32:35], v[88:91], a[40:43], v[32:35]
    v_mfma_f32_16x16x32_bf16 v[36:39], v[88:91], a[112:115], v[36:39]
    ds_read_b128 v[120:123], v8 offset:4096
    s_waitcnt lgkmcnt(7)
    v_mfma_f32_16x16x32_bf16 v[40:43], v[92:95], a[40:43], v[40:43]
    v_mfma_f32_16x16x32_bf16 v[44:47], v[92:95], a[112:115], v[44:47]
    ds_read_b128 v[124:127], v8 offset:6144
    s_waitcnt lgkmcnt(7)
    v_mfma_f32_16x16x32_bf16 v[48:51], v[96:99], a[40:43], v[48:51]
    v_mfma_f32_16x16x32_bf16 v[52:55], v[96:99], a[112:115], v[52:55]
    ds_read_b128 v[128:131], v8 offset:8192
    s_waitcnt lgkmcnt(7)
    v_mfma_f32_16x16x32_bf16 v[56:59], v[100:103], a[40:43], v[56:59]
    v_mfma_f32_16x16x32_bf16 v[60:63], v[100:103], a[112:115], v[60:63]
    ds_read_b128 v[132:135], v8 offset:10240
    s_waitcnt lgkmcnt(7)
    v_mfma_f32_16x16x32_bf16 v[64:67], v[104:107], a[40:43], v[64:67]
    v_mfma_f32_16x16x32_bf16 v[68:71], v[104:107], a[112:115], v[68:71]
    ds_read_b128 v[136:139], v8 offset:12288
    s_waitcnt lgkmcnt(7)
    v_mfma_f32_16x16x32_bf16 v[72:75], v[108:111], a[40:43], v[72:75]
    v_mfma_f32_16x16x32_bf16 v[76:79], v[108:111], a[112:115], v[76:79]
    ds_read_b128 v[140:143], v8 offset:14336
    s_waitcnt lgkmcnt(7)
    v_mfma_f32_16x16x32_bf16 v[16:19], v[112:115], a[44:47], v[16:19]
    v_mfma_f32_16x16x32_bf16 v[20:23], v[112:115], a[116:119], v[20:23]
    s_waitcnt lgkmcnt(6)
    v_mfma_f32_16x16x32_bf16 v[24:27], v[116:119], a[44:47], v[24:27]
    v_mfma_f32_16x16x32_bf16 v[28:31], v[116:119], a[116:119], v[28:31]
    s_waitcnt lgkmcnt(5)
    v_mfma_f32_16x16x32_bf16 v[32:35], v[120:123], a[44:47], v[32:35]
    v_mfma_f32_16x16x32_bf16 v[36:39], v[120:123], a[116:119], v[36:39]
    s_waitcnt lgkmcnt(4)
    v_mfma_f32_16x16x32_bf16 v[40:43], v[124:127], a[44:47], v[40:43]
    v_mfma_f32_16x16x32_bf16 v[44:47], v[124:127], a[116:119], v[44:47]
    s_waitcnt lgkmcnt(3)
    v_mfma_f32_16x16x32_bf16 v[48:51], v[128:131], a[44:47], v[48:51]
    v_mfma_f32_16x16x32_bf16 v[52:55], v[128:131], a[116:119], v[52:55]
    s_waitcnt lgkmcnt(2)
    v_mfma_f32_16x16x32_bf16 v[56:59], v[132:135], a[44:47], v[56:59]
    v_mfma_f32_16x16x32_bf16 v[60:63], v[132:135], a[116:119], v[60:63]
    s_waitcnt lgkmcnt(1)
    v_mfma_f32_16x16x32_bf16 v[64:67], v[136:139], a[44:47], v[64:67]
    v_mfma_f32_16x16x32_bf16 v[68:71], v[136:139], a[116:119], v[68:71]
    s_waitcnt lgkmcnt(0)
    v_mfma_f32_16x16x32_bf16 v[72:75], v[140:143], a[44:47], v[72:75]
    v_mfma_f32_16x16x32_bf16 v[76:79], v[140:143], a[116:119], v[76:79]
    s_waitcnt vmcnt(20)
    s_barrier
    s_add_u32 s50, s38, 0
    s_add_u32 m0, s39, 0
    s_nop 0
    buffer_load_dwordx4 v1, s[12:15], s50 offen  lds
    s_add_u32 s50, s38, 9216
    s_add_u32 m0, s39, 1024
    s_nop 0
    buffer_load_dwordx4 v2, s[12:15], s50 offen  lds
    s_add_u32 s50, s38, 18432
    s_add_u32 m0, s39, 2048
    s_nop 0
    buffer_load_dwordx4 v1, s[12:15], s50 offen  lds
    s_add_u32 s50, s38, 27648
    s_add_u32 m0, s39, 3072
    s_nop 0
    buffer_load_dwordx4 v2, s[12:15], s50 offen  lds
    s_add_u32 s38, s38, 128
    s_add_u32 s39, s39, 16384
    s_and_b32 s39, s39, 0x1ffff
    v_add_u32 v7, s41, v3
    v_add_u32 v8, s41, v4
    s_add_u32 s41, s41, 16384
    s_and_b32 s41, s41, 0x1ffff
    ds_read_b128 v[80:83], v7 offset:0
    ds_read_b128 v[84:87], v7 offset:2048
    ds_read_b128 v[88:91], v7 offset:4096
    ds_read_b128 v[92:95], v7 offset:6144
    ds_read_b128 v[96:99], v7 offset:8192
    ds_read_b128 v[100:103], v7 offset:10240
    ds_read_b128 v[104:107], v7 offset:12288
    ds_read_b128 v[108:111], v7 offset:14336
    s_waitcnt lgkmcnt(7)
    v_mfma_f32_16x16x32_bf16 v[16:19], v[80:83], a[48:51], v[16:19]
    v_mfma_f32_16x16x32_bf16 v[20:23], v[80:83], a[120:123], v[20:23]
    ds_read_b128 v[112:115], v8 offset:0
    s_waitcnt lgkmcnt(7)
    v_mfma_f32_16x16x32_bf16 v[24:27], v[84:87], a[48:51], v[24:27]
    v_mfma_f32_16x16x32_bf16 v[28:31], v[84:87], a[120:123], v[28:31]
    ds_read_b128 v[116:119], v8 offset:2048
    s_waitcnt lgkmcnt(7)
    v_mfma_f32_16x16x32_bf16 v[32:35], v[88:91], a[48:51], v[32:35]
    v_mfma_f32_16x16x32_bf16 v[36:39], v[88:91], a[120:123], v[36:39]
    ds_read_b128 v[120:123], v8 offset:4096
    s_waitcnt lgkmcnt(7)
    v_mfma_f32_16x16x32_bf16 v[40:43], v[92:95], a[48:51], v[40:43]
    v_mfma_f32_16x16x32_bf16 v[44:47], v[92:95], a[120:123], v[44:47]
    ds_read_b128 v[124:127], v8 offset:6144
    s_waitcnt lgkmcnt(7)
    v_mfma_f32_16x16x32_bf16 v[48:51], v[96:99], a[48:51], v[48:51]
    v_mfma_f32_16x16x32_bf16 v[52:55], v[96:99], a[120:123], v[52:55]
    ds_read_b128 v[128:131], v8 offset:8192
    s_waitcnt lgkmcnt(7)
    v_mfma_f32_16x16x32_bf16 v[56:59], v[100:103], a[48:51], v[56:59]
    v_mfma_f32_16x16x32_bf16 v[60:63], v[100:103], a[120:123], v[60:63]
    ds_read_b128 v[132:135], v8 offset:10240
    s_waitcnt lgkmcnt(7)
    v_mfma_f32_16x16x32_bf16 v[64:67], v[104:107], a[48:51], v[64:67]
    v_mfma_f32_16x16x32_bf16 v[68:71], v[104:107], a[120:123], v[68:71]
    ds_read_b128 v[136:139], v8 offset:12288
    s_waitcnt lgkmcnt(7)
    v_mfma_f32_16x16x32_bf16 v[72:75], v[108:111], a[48:51], v[72:75]
    v_mfma_f32_16x16x32_bf16 v[76:79], v[108:111], a[120:123], v[76:79]
    ds_read_b128 v[140:143], v8 offset:14336
    s_waitcnt lgkmcnt(7)
    v_mfma_f32_16x16x32_bf16 v[16:19], v[112:115], a[52:55], v[16:19]
    v_mfma_f32_16x16x32_bf16 v[20:23], v[112:115], a[124:127], v[20:23]
    s_waitcnt lgkmcnt(6)
    v_mfma_f32_16x16x32_bf16 v[24:27], v[116:119], a[52:55], v[24:27]
    v_mfma_f32_16x16x32_bf16 v[28:31], v[116:119], a[124:127], v[28:31]
    s_waitcnt lgkmcnt(5)
    v_mfma_f32_16x16x32_bf16 v[32:35], v[120:123], a[52:55], v[32:35]
    v_mfma_f32_16x16x32_bf16 v[36:39], v[120:123], a[124:127], v[36:39]
    s_waitcnt lgkmcnt(4)
    v_mfma_f32_16x16x32_bf16 v[40:43], v[124:127], a[52:55], v[40:43]
    v_mfma_f32_16x16x32_bf16 v[44:47], v[124:127], a[124:127], v[44:47]
    s_waitcnt lgkmcnt(3)
    v_mfma_f32_16x16x32_bf16 v[48:51], v[128:131], a[52:55], v[48:51]
    v_mfma_f32_16x16x32_bf16 v[52:55], v[128:131], a[124:127], v[52:55]
    s_waitcnt lgkmcnt(2)
    v_mfma_f32_16x16x32_bf16 v[56:59], v[132:135], a[52:55], v[56:59]
    v_mfma_f32_16x16x32_bf16 v[60:63], v[132:135], a[124:127], v[60:63]
    s_waitcnt lgkmcnt(1)
    v_mfma_f32_16x16x32_bf16 v[64:67], v[136:139], a[52:55], v[64:67]
    v_mfma_f32_16x16x32_bf16 v[68:71], v[136:139], a[124:127], v[68:71]
    s_waitcnt lgkmcnt(0)
    v_mfma_f32_16x16x32_bf16 v[72:75], v[140:143], a[52:55], v[72:75]
    v_mfma_f32_16x16x32_bf16 v[76:79], v[140:143], a[124:127], v[76:79]
    s_waitcnt vmcnt(20)
    s_barrier
    s_add_u32 s50, s38, 0
    s_add_u32 m0, s39, 0
    s_nop 0
    buffer_load_dwordx4 v1, s[12:15], s50 offen  lds
    s_add_u32 s50, s38, 9216
    s_add_u32 m0, s39, 1024
    s_nop 0
    buffer_load_dwordx4 v2, s[12:15], s50 offen  lds
    s_add_u32 s50, s38, 18432
    s_add_u32 m0, s39, 2048
    s_nop 0
    buffer_load_dwordx4 v1, s[12:15], s50 offen  lds
    s_add_u32 s50, s38, 27648
    s_add_u32 m0, s39, 3072
    s_nop 0
    buffer_load_dwordx4 v2, s[12:15], s50 offen  lds
    s_add_u32 s38, s38, 128
    s_add_u32 s39, s39, 16384
    s_and_b32 s39, s39, 0x1ffff
    v_add_u32 v7, s41, v3
    v_add_u32 v8, s41, v4
    s_add_u32 s41, s41, 16384
    s_and_b32 s41, s41, 0x1ffff
    ds_read_b128 v[80:83], v7 offset:0
    ds_read_b128 v[84:87], v7 offset:2048
    ds_read_b128 v[88:91], v7 offset:4096
    ds_read_b128 v[92:95], v7 offset:6144
    ds_read_b128 v[96:99], v7 offset:8192
    ds_read_b128 v[100:103], v7 offset:10240
    ds_read_b128 v[104:107], v7 offset:12288
    ds_read_b128 v[108:111], v7 offset:14336
    s_waitcnt lgkmcnt(7)
    v_mfma_f32_16x16x32_bf16 v[16:19], v[80:83], a[56:59], v[16:19]
    v_mfma_f32_16x16x32_bf16 v[20:23], v[80:83], a[128:131], v[20:23]
    ds_read_b128 v[112:115], v8 offset:0
    s_waitcnt lgkmcnt(7)
    v_mfma_f32_16x16x32_bf16 v[24:27], v[84:87], a[56:59], v[24:27]
    v_mfma_f32_16x16x32_bf16 v[28:31], v[84:87], a[128:131], v[28:31]
    ds_read_b128 v[116:119], v8 offset:2048
    s_waitcnt lgkmcnt(7)
    v_mfma_f32_16x16x32_bf16 v[32:35], v[88:91], a[56:59], v[32:35]
    v_mfma_f32_16x16x32_bf16 v[36:39], v[88:91], a[128:131], v[36:39]
    ds_read_b128 v[120:123], v8 offset:4096
    s_waitcnt lgkmcnt(7)
    v_mfma_f32_16x16x32_bf16 v[40:43], v[92:95], a[56:59], v[40:43]
    v_mfma_f32_16x16x32_bf16 v[44:47], v[92:95], a[128:131], v[44:47]
    ds_read_b128 v[124:127], v8 offset:6144
    s_waitcnt lgkmcnt(7)
    v_mfma_f32_16x16x32_bf16 v[48:51], v[96:99], a[56:59], v[48:51]
    v_mfma_f32_16x16x32_bf16 v[52:55], v[96:99], a[128:131], v[52:55]
    ds_read_b128 v[128:131], v8 offset:8192
    s_waitcnt lgkmcnt(7)
    v_mfma_f32_16x16x32_bf16 v[56:59], v[100:103], a[56:59], v[56:59]
    v_mfma_f32_16x16x32_bf16 v[60:63], v[100:103], a[128:131], v[60:63]
    ds_read_b128 v[132:135], v8 offset:10240
    s_waitcnt lgkmcnt(7)
    v_mfma_f32_16x16x32_bf16 v[64:67], v[104:107], a[56:59], v[64:67]
    v_mfma_f32_16x16x32_bf16 v[68:71], v[104:107], a[128:131], v[68:71]
    ds_read_b128 v[136:139], v8 offset:12288
    s_waitcnt lgkmcnt(7)
    v_mfma_f32_16x16x32_bf16 v[72:75], v[108:111], a[56:59], v[72:75]
    v_mfma_f32_16x16x32_bf16 v[76:79], v[108:111], a[128:131], v[76:79]
    ds_read_b128 v[140:143], v8 offset:14336
    s_waitcnt lgkmcnt(7)
    v_mfma_f32_16x16x32_bf16 v[16:19], v[112:115], a[60:63], v[16:19]
    v_mfma_f32_16x16x32_bf16 v[20:23], v[112:115], a[132:135], v[20:23]
    s_waitcnt lgkmcnt(6)
    v_mfma_f32_16x16x32_bf16 v[24:27], v[116:119], a[60:63], v[24:27]
    v_mfma_f32_16x16x32_bf16 v[28:31], v[116:119], a[132:135], v[28:31]
    s_waitcnt lgkmcnt(5)
    v_mfma_f32_16x16x32_bf16 v[32:35], v[120:123], a[60:63], v[32:35]
    v_mfma_f32_16x16x32_bf16 v[36:39], v[120:123], a[132:135], v[36:39]
    s_waitcnt lgkmcnt(4)
    v_mfma_f32_16x16x32_bf16 v[40:43], v[124:127], a[60:63], v[40:43]
    v_mfma_f32_16x16x32_bf16 v[44:47], v[124:127], a[132:135], v[44:47]
    s_waitcnt lgkmcnt(3)
    v_mfma_f32_16x16x32_bf16 v[48:51], v[128:131], a[60:63], v[48:51]
    v_mfma_f32_16x16x32_bf16 v[52:55], v[128:131], a[132:135], v[52:55]
    s_waitcnt lgkmcnt(2)
    v_mfma_f32_16x16x32_bf16 v[56:59], v[132:135], a[60:63], v[56:59]
    v_mfma_f32_16x16x32_bf16 v[60:63], v[132:135], a[132:135], v[60:63]
    s_waitcnt lgkmcnt(1)
    v_mfma_f32_16x16x32_bf16 v[64:67], v[136:139], a[60:63], v[64:67]
    v_mfma_f32_16x16x32_bf16 v[68:71], v[136:139], a[132:135], v[68:71]
    s_waitcnt lgkmcnt(0)
    v_mfma_f32_16x16x32_bf16 v[72:75], v[140:143], a[60:63], v[72:75]
    v_mfma_f32_16x16x32_bf16 v[76:79], v[140:143], a[132:135], v[76:79]
    s_waitcnt vmcnt(20)
    s_barrier
    s_add_u32 s50, s38, 0
    s_add_u32 m0, s39, 0
    s_nop 0
    buffer_load_dwordx4 v1, s[12:15], s50 offen  lds
    s_add_u32 s50, s38, 9216
    s_add_u32 m0, s39, 1024
    s_nop 0
    buffer_load_dwordx4 v2, s[12:15], s50 offen  lds
    s_add_u32 s50, s38, 18432
    s_add_u32 m0, s39, 2048
    s_nop 0
    buffer_load_dwordx4 v1, s[12:15], s50 offen  lds
    s_add_u32 s50, s38, 27648
    s_add_u32 m0, s39, 3072
    s_nop 0
    buffer_load_dwordx4 v2, s[12:15], s50 offen  lds
    s_add_u32 s38, s38, 128
    s_add_u32 s39, s39, 16384
    s_and_b32 s39, s39, 0x1ffff
    v_add_u32 v7, s41, v3
    v_add_u32 v8, s41, v4
    s_add_u32 s41, s41, 16384
    s_and_b32 s41, s41, 0x1ffff
    ds_read_b128 v[80:83], v7 offset:0
    ds_read_b128 v[84:87], v7 offset:2048
    ds_read_b128 v[88:91], v7 offset:4096
    ds_read_b128 v[92:95], v7 offset:6144
    ds_read_b128 v[96:99], v7 offset:8192
    ds_read_b128 v[100:103], v7 offset:10240
    ds_read_b128 v[104:107], v7 offset:12288
    ds_read_b128 v[108:111], v7 offset:14336
    s_waitcnt lgkmcnt(7)
    v_mfma_f32_16x16x32_bf16 v[16:19], v[80:83], a[64:67], v[16:19]
    v_mfma_f32_16x16x32_bf16 v[20:23], v[80:83], a[136:139], v[20:23]
    ds_read_b128 v[112:115], v8 offset:0
    s_waitcnt lgkmcnt(7)
    v_mfma_f32_16x16x32_bf16 v[24:27], v[84:87], a[64:67], v[24:27]
    v_mfma_f32_16x16x32_bf16 v[28:31], v[84:87], a[136:139], v[28:31]
    ds_read_b128 v[116:119], v8 offset:2048
    s_waitcnt lgkmcnt(7)
    v_mfma_f32_16x16x32_bf16 v[32:35], v[88:91], a[64:67], v[32:35]
    v_mfma_f32_16x16x32_bf16 v[36:39], v[88:91], a[136:139], v[36:39]
    ds_read_b128 v[120:123], v8 offset:4096
    s_waitcnt lgkmcnt(7)
    v_mfma_f32_16x16x32_bf16 v[40:43], v[92:95], a[64:67], v[40:43]
    v_mfma_f32_16x16x32_bf16 v[44:47], v[92:95], a[136:139], v[44:47]
    ds_read_b128 v[124:127], v8 offset:6144
    s_waitcnt lgkmcnt(7)
    v_mfma_f32_16x16x32_bf16 v[48:51], v[96:99], a[64:67], v[48:51]
    v_mfma_f32_16x16x32_bf16 v[52:55], v[96:99], a[136:139], v[52:55]
    ds_read_b128 v[128:131], v8 offset:8192
    s_waitcnt lgkmcnt(7)
    v_mfma_f32_16x16x32_bf16 v[56:59], v[100:103], a[64:67], v[56:59]
    v_mfma_f32_16x16x32_bf16 v[60:63], v[100:103], a[136:139], v[60:63]
    ds_read_b128 v[132:135], v8 offset:10240
    s_waitcnt lgkmcnt(7)
    v_mfma_f32_16x16x32_bf16 v[64:67], v[104:107], a[64:67], v[64:67]
    v_mfma_f32_16x16x32_bf16 v[68:71], v[104:107], a[136:139], v[68:71]
    ds_read_b128 v[136:139], v8 offset:12288
    s_waitcnt lgkmcnt(7)
    v_mfma_f32_16x16x32_bf16 v[72:75], v[108:111], a[64:67], v[72:75]
    v_mfma_f32_16x16x32_bf16 v[76:79], v[108:111], a[136:139], v[76:79]
    ds_read_b128 v[140:143], v8 offset:14336
    s_waitcnt lgkmcnt(7)
    v_mfma_f32_16x16x32_bf16 v[16:19], v[112:115], a[68:71], v[16:19]
    v_mfma_f32_16x16x32_bf16 v[20:23], v[112:115], a[140:143], v[20:23]
    s_waitcnt lgkmcnt(6)
    v_mfma_f32_16x16x32_bf16 v[24:27], v[116:119], a[68:71], v[24:27]
    v_mfma_f32_16x16x32_bf16 v[28:31], v[116:119], a[140:143], v[28:31]
    s_waitcnt lgkmcnt(5)
    v_mfma_f32_16x16x32_bf16 v[32:35], v[120:123], a[68:71], v[32:35]
    v_mfma_f32_16x16x32_bf16 v[36:39], v[120:123], a[140:143], v[36:39]
    s_waitcnt lgkmcnt(4)
    v_mfma_f32_16x16x32_bf16 v[40:43], v[124:127], a[68:71], v[40:43]
    v_mfma_f32_16x16x32_bf16 v[44:47], v[124:127], a[140:143], v[44:47]
    s_waitcnt lgkmcnt(3)
    v_mfma_f32_16x16x32_bf16 v[48:51], v[128:131], a[68:71], v[48:51]
    v_mfma_f32_16x16x32_bf16 v[52:55], v[128:131], a[140:143], v[52:55]
    s_waitcnt lgkmcnt(2)
    v_mfma_f32_16x16x32_bf16 v[56:59], v[132:135], a[68:71], v[56:59]
    v_mfma_f32_16x16x32_bf16 v[60:63], v[132:135], a[140:143], v[60:63]
    s_waitcnt lgkmcnt(1)
    v_mfma_f32_16x16x32_bf16 v[64:67], v[136:139], a[68:71], v[64:67]
    v_mfma_f32_16x16x32_bf16 v[68:71], v[136:139], a[140:143], v[68:71]
    s_waitcnt lgkmcnt(0)
    v_mfma_f32_16x16x32_bf16 v[72:75], v[140:143], a[68:71], v[72:75]
    v_mfma_f32_16x16x32_bf16 v[76:79], v[140:143], a[140:143], v[76:79]
    v_cvt_pk_bf16_f32 v144, v16, v17
    v_cvt_pk_bf16_f32 v145, v18, v19
    v_cvt_pk_bf16_f32 v146, v24, v25
    v_cvt_pk_bf16_f32 v147, v26, v27
    s_add_u32 s50, s36, 0
    buffer_store_dwordx4 v[144:147], v0, s[4:7], s50 offen sc1
    v_cvt_pk_bf16_f32 v148, v20, v21
    v_cvt_pk_bf16_f32 v149, v22, v23
    v_cvt_pk_bf16_f32 v150, v28, v29
    v_cvt_pk_bf16_f32 v151, v30, v31
    s_add_u32 s50, s36, 65536
    buffer_store_dwordx4 v[148:151], v0, s[4:7], s50 offen sc1
    v_cvt_pk_bf16_f32 v152, v32, v33
    v_cvt_pk_bf16_f32 v153, v34, v35
    v_cvt_pk_bf16_f32 v154, v40, v41
    v_cvt_pk_bf16_f32 v155, v42, v43
    s_add_u32 s50, s36, 1024
    buffer_store_dwordx4 v[152:155], v0, s[4:7], s50 offen sc1
    v_cvt_pk_bf16_f32 v156, v36, v37
    v_cvt_pk_bf16_f32 v157, v38, v39
    v_cvt_pk_bf16_f32 v158, v44, v45
    v_cvt_pk_bf16_f32 v159, v46, v47
    s_add_u32 s50, s36, 66560
    buffer_store_dwordx4 v[156:159], v0, s[4:7], s50 offen sc1
    v_cvt_pk_bf16_f32 v144, v48, v49
    v_cvt_pk_bf16_f32 v145, v50, v51
    v_cvt_pk_bf16_f32 v146, v56, v57
    v_cvt_pk_bf16_f32 v147, v58, v59
    s_add_u32 s50, s36, 2048
    buffer_store_dwordx4 v[144:147], v0, s[4:7], s50 offen sc1
    v_cvt_pk_bf16_f32 v148, v52, v53
    v_cvt_pk_bf16_f32 v149, v54, v55
    v_cvt_pk_bf16_f32 v150, v60, v61
    v_cvt_pk_bf16_f32 v151, v62, v63
    s_add_u32 s50, s36, 67584
    buffer_store_dwordx4 v[148:151], v0, s[4:7], s50 offen sc1
    v_cvt_pk_bf16_f32 v152, v64, v65
    v_cvt_pk_bf16_f32 v153, v66, v67
    v_cvt_pk_bf16_f32 v154, v72, v73
    v_cvt_pk_bf16_f32 v155, v74, v75
    s_add_u32 s50, s36, 3072
    buffer_store_dwordx4 v[152:155], v0, s[4:7], s50 offen sc1
    v_cvt_pk_bf16_f32 v156, v68, v69
    v_cvt_pk_bf16_f32 v157, v70, v71
    v_cvt_pk_bf16_f32 v158, v76, v77
    v_cvt_pk_bf16_f32 v159, v78, v79
    s_add_u32 s50, s36, 68608
    buffer_store_dwordx4 v[156:159], v0, s[4:7], s50 offen sc1
    s_add_u32 s34, s34, 1
    s_add_u32 s36, s36, s37
    s_cmp_lt_u32 s34, s35
    s_cbranch_scc1 BL1V_BLK
    s_waitcnt vmcnt(0)
    s_barrier
BL1_END:
    s_cmp_eq_u32 s31, 0
    s_cbranch_scc0 BL_a1
    v_mov_b32 v13, 48
    v_mov_b32 v14, 1
    s_mov_b64 exec, 1
    global_atomic_add v13, v14, s[90:91]
    s_mov_b64 exec, -1
BL_a1:
BL_B1SKIP:
    v_mov_b32 v13, 48
    s_mov_b64 exec, 1
    s_mov_b32 s57, 0x40000
BL_w1:
    global_load_dword v14, v13, s[90:91] sc1
    s_waitcnt vmcnt(0)
    v_readfirstlane_b32 s56, v14
    s_sub_u32 s57, s57, 1
    s_cbranch_scc1 BL_w1_o
    s_cmp_lt_u32 s56, 30
    s_cbranch_scc0 BL_w1_o
    s_sleep 8
    s_branch BL_w1
BL_w1_o:
    s_mov_b64 exec, -1
    s_barrier
    s_mov_b32 s32, s70
BL_KVT:
    s_lshl_b32 s50, s31, 14
    s_lshl_b32 s51, s32, 16
    s_add_u32 s51, s51, s50
    s_add_u32 s52, s51, 88080384
    s_add_u32 s54, s51, 83886080
    s_add_u32 s55, s54, 65536
    s_sub_u32 s53, s54, 65536
    s_cmp_eq_u32 s32, 0
    s_cselect_b32 s53, s54, s53
    v_mov_b32 v4, 0x3f803f80
    v_mov_b32 v5, 0x3f803f80
    v_mov_b32 v6, 0x3f803f80
    v_mov_b32 v7, 0x3f803f80
    v_mov_b32 v8, 0
    v_mov_b32 v9, 0
    v_mov_b32 v10, 0
    v_mov_b32 v11, 0
    v_mov_b32 v12, 0
    v_mov_b32 v13, 0
    v_mov_b32 v14, 0
    v_mov_b32 v15, 0
    v_mov_b32 v16, 0
    v_mov_b32 v17, 0
    v_mov_b32 v18, 0
    v_mov_b32 v19, 0
    v_mov_b32 v20, 0
    v_mov_b32 v21, 0
    v_mov_b32 v22, 0
    v_mov_b32 v23, 0
    v_mov_b32 v24, 0
    v_mov_b32 v25, 0
    v_mov_b32 v26, 0
    v_mov_b32 v27, 0
    v_mov_b32 v28, 0
    v_mov_b32 v29, 0
    v_mov_b32 v30, 0
    v_mov_b32 v31, 0
    buffer_load_dwordx4 v[32:35], v0, s[4:7], s52 offen offset:0 sc1
    buffer_load_dwordx4 v[36:39], v0, s[4:7], s53 offen offset:0 sc1
    buffer_load_dwordx4 v[40:43], v0, s[4:7], s54 offen offset:0 sc1
    buffer_load_dwordx4 v[44:47], v0, s[4:7], s55 offen offset:0 sc1
    buffer_load_dwordx4 v[48:51], v0, s[4:7], s52 offen offset:1024 sc1
    buffer_load_dwordx4 v[52:55], v0, s[4:7], s53 offen offset:1024 sc1
    buffer_load_dwordx4 v[56:59], v0, s[4:7], s54 offen offset:1024 sc1
    buffer_load_dwordx4 v[60:63], v0, s[4:7], s55 offen offset:1024 sc1
    buffer_load_dwordx4 v[64:67], v0, s[4:7], s52 offen offset:2048 sc1
    buffer_load_dwordx4 v[68:71], v0, s[4:7], s53 offen offset:2048 sc1
    buffer_load_dwordx4 v[72:75], v0, s[4:7], s54 offen offset:2048 sc1
    buffer_load_dwordx4 v[76:79], v0, s[4:7], s55 offen offset:2048 sc1
    buffer_load_dwordx4 v[80:83], v0, s[4:7], s52 offen offset:3072 sc1
    buffer_load_dwordx4 v[84:87], v0, s[4:7], s53 offen offset:3072 sc1
    buffer_load_dwordx4 v[88:91], v0, s[4:7], s54 offen offset:3072 sc1
    buffer_load_dwordx4 v[92:95], v0, s[4:7], s55 offen offset:3072 sc1
    s_add_u32 s52, s52, 4096
    s_add_u32 s53, s53, 4096
    s_add_u32 s54, s54, 4096
    s_add_u32 s55, s55, 4096
    s_waitcnt vmcnt(14)
    v_mfma_f32_16x16x32_bf16 v[8:11], v[36:39], v[32:35], v[8:11]
    v_mfma_f32_16x16x32_bf16 v[20:23], v[36:39], v[4:7], v[20:23]
    s_waitcnt vmcnt(13)
    v_mfma_f32_16x16x32_bf16 v[12:15], v[40:43], v[32:35], v[12:15]
    v_mfma_f32_16x16x32_bf16 v[24:27], v[40:43], v[4:7], v[24:27]
    s_waitcnt vmcnt(12)
    v_mfma_f32_16x16x32_bf16 v[16:19], v[44:47], v[32:35], v[16:19]
    v_mfma_f32_16x16x32_bf16 v[28:31], v[44:47], v[4:7], v[28:31]
    s_waitcnt vmcnt(10)
    v_mfma_f32_16x16x32_bf16 v[8:11], v[52:55], v[48:51], v[8:11]
    v_mfma_f32_16x16x32_bf16 v[20:23], v[52:55], v[4:7], v[20:23]
    s_waitcnt vmcnt(9)
    v_mfma_f32_16x16x32_bf16 v[12:15], v[56:59], v[48:51], v[12:15]
    v_mfma_f32_16x16x32_bf16 v[24:27], v[56:59], v[4:7], v[24:27]
    s_waitcnt vmcnt(8)
    v_mfma_f32_16x16x32_bf16 v[16:19], v[60:63], v[48:51], v[16:19]
    v_mfma_f32_16x16x32_bf16 v[28:31], v[60:63], v[4:7], v[28:31]
    s_waitcnt vmcnt(6)
    v_mfma_f32_16x16x32_bf16 v[8:11], v[68:71], v[64:67], v[8:11]
    v_mfma_f32_16x16x32_bf16 v[20:23], v[68:71], v[4:7], v[20:23]
    s_waitcnt vmcnt(5)
    v_mfma_f32_16x16x32_bf16 v[12:15], v[72:75], v[64:67], v[12:15]
    v_mfma_f32_16x16x32_bf16 v[24:27], v[72:75], v[4:7], v[24:27]
    s_waitcnt vmcnt(4)
    v_mfma_f32_16x16x32_bf16 v[16:19], v[76:79], v[64:67], v[16:19]
    v_mfma_f32_16x16x32_bf16 v[28:31], v[76:79], v[4:7], v[28:31]
    s_waitcnt vmcnt(2)
    v_mfma_f32_16x16x32_bf16 v[8:11], v[84:87], v[80:83], v[8:11]
    v_mfma_f32_16x16x32_bf16 v[20:23], v[84:87], v[4:7], v[20:23]
    s_waitcnt vmcnt(1)
    v_mfma_f32_16x16x32_bf16 v[12:15], v[88:91], v[80:83], v[12:15]
    v_mfma_f32_16x16x32_bf16 v[24:27], v[88:91], v[4:7], v[24:27]
    s_waitcnt vmcnt(0)
    v_mfma_f32_16x16x32_bf16 v[16:19], v[92:95], v[80:83], v[16:19]
    v_mfma_f32_16x16x32_bf16 v[28:31], v[92:95], v[4:7], v[28:31]
    buffer_load_dwordx4 v[32:35], v0, s[4:7], s52 offen offset:0 sc1
    buffer_load_dwordx4 v[36:39], v0, s[4:7], s53 offen offset:0 sc1
    buffer_load_dwordx4 v[40:43], v0, s[4:7], s54 offen offset:0 sc1
    buffer_load_dwordx4 v[44:47], v0, s[4:7], s55 offen offset:0 sc1
    buffer_load_dwordx4 v[48:51], v0, s[4:7], s52 offen offset:1024 sc1
    buffer_load_dwordx4 v[52:55], v0, s[4:7], s53 offen offset:1024 sc1
    buffer_load_dwordx4 v[56:59], v0, s[4:7], s54 offen offset:1024 sc1
    buffer_load_dwordx4 v[60:63], v0, s[4:7], s55 offen offset:1024 sc1
    buffer_load_dwordx4 v[64:67], v0, s[4:7], s52 offen offset:2048 sc1
    buffer_load_dwordx4 v[68:71], v0, s[4:7], s53 offen offset:2048 sc1
    buffer_load_dwordx4 v[72:75], v0, s[4:7], s54 offen offset:2048 sc1
    buffer_load_dwordx4 v[76:79], v0, s[4:7], s55 offen offset:2048 sc1
    buffer_load_dwordx4 v[80:83], v0, s[4:7], s52 offen offset:3072 sc1
    buffer_load_dwordx4 v[84:87], v0, s[4:7], s53 offen offset:3072 sc1
    buffer_load_dwordx4 v[88:91], v0, s[4:7], s54 offen offset:3072 sc1
    buffer_load_dwordx4 v[92:95], v0, s[4:7], s55 offen offset:3072 sc1
    s_add_u32 s52, s52, 4096
    s_add_u32 s53, s53, 4096
    s_add_u32 s54, s54, 4096
    s_add_u32 s55, s55, 4096
    s_waitcnt vmcnt(14)
    v_mfma_f32_16x16x32_bf16 v[8:11], v[36:39], v[32:35], v[8:11]
    v_mfma_f32_16x16x32_bf16 v[20:23], v[36:39], v[4:7], v[20:23]
    s_waitcnt vmcnt(13)
    v_mfma_f32_16x16x32_bf16 v[12:15], v[40:43], v[32:35], v[12:15]
    v_mfma_f32_16x16x32_bf16 v[24:27], v[40:43], v[4:7], v[24:27]
    s_waitcnt vmcnt(12)
    v_mfma_f32_16x16x32_bf16 v[16:19], v[44:47], v[32:35], v[16:19]
    v_mfma_f32_16x16x32_bf16 v[28:31], v[44:47], v[4:7], v[28:31]
    s_waitcnt vmcnt(10)
    v_mfma_f32_16x16x32_bf16 v[8:11], v[52:55], v[48:51], v[8:11]
    v_mfma_f32_16x16x32_bf16 v[20:23], v[52:55], v[4:7], v[20:23]
    s_waitcnt vmcnt(9)
    v_mfma_f32_16x16x32_bf16 v[12:15], v[56:59], v[48:51], v[12:15]
    v_mfma_f32_16x16x32_bf16 v[24:27], v[56:59], v[4:7], v[24:27]
    s_waitcnt vmcnt(8)
    v_mfma_f32_16x16x32_bf16 v[16:19], v[60:63], v[48:51], v[16:19]
    v_mfma_f32_16x16x32_bf16 v[28:31], v[60:63], v[4:7], v[28:31]
    s_waitcnt vmcnt(6)
    v_mfma_f32_16x16x32_bf16 v[8:11], v[68:71], v[64:67], v[8:11]
    v_mfma_f32_16x16x32_bf16 v[20:23], v[68:71], v[4:7], v[20:23]
    s_waitcnt vmcnt(5)
    v_mfma_f32_16x16x32_bf16 v[12:15], v[72:75], v[64:67], v[12:15]
    v_mfma_f32_16x16x32_bf16 v[24:27], v[72:75], v[4:7], v[24:27]
    s_waitcnt vmcnt(4)
    v_mfma_f32_16x16x32_bf16 v[16:19], v[76:79], v[64:67], v[16:19]
    v_mfma_f32_16x16x32_bf16 v[28:31], v[76:79], v[4:7], v[28:31]
    s_waitcnt vmcnt(2)
    v_mfma_f32_16x16x32_bf16 v[8:11], v[84:87], v[80:83], v[8:11]
    v_mfma_f32_16x16x32_bf16 v[20:23], v[84:87], v[4:7], v[20:23]
    s_waitcnt vmcnt(1)
    v_mfma_f32_16x16x32_bf16 v[12:15], v[88:91], v[80:83], v[12:15]
    v_mfma_f32_16x16x32_bf16 v[24:27], v[88:91], v[4:7], v[24:27]
    s_waitcnt vmcnt(0)
    v_mfma_f32_16x16x32_bf16 v[16:19], v[92:95], v[80:83], v[16:19]
    v_mfma_f32_16x16x32_bf16 v[28:31], v[92:95], v[4:7], v[28:31]
    buffer_load_dwordx4 v[32:35], v0, s[4:7], s52 offen offset:0 sc1
    buffer_load_dwordx4 v[36:39], v0, s[4:7], s53 offen offset:0 sc1
    buffer_load_dwordx4 v[40:43], v0, s[4:7], s54 offen offset:0 sc1
    buffer_load_dwordx4 v[44:47], v0, s[4:7], s55 offen offset:0 sc1
    buffer_load_dwordx4 v[48:51], v0, s[4:7], s52 offen offset:1024 sc1
    buffer_load_dwordx4 v[52:55], v0, s[4:7], s53 offen offset:1024 sc1
    buffer_load_dwordx4 v[56:59], v0, s[4:7], s54 offen offset:1024 sc1
    buffer_load_dwordx4 v[60:63], v0, s[4:7], s55 offen offset:1024 sc1
    buffer_load_dwordx4 v[64:67], v0, s[4:7], s52 offen offset:2048 sc1
    buffer_load_dwordx4 v[68:71], v0, s[4:7], s53 offen offset:2048 sc1
    buffer_load_dwordx4 v[72:75], v0, s[4:7], s54 offen offset:2048 sc1
    buffer_load_dwordx4 v[76:79], v0, s[4:7], s55 offen offset:2048 sc1
    buffer_load_dwordx4 v[80:83], v0, s[4:7], s52 offen offset:3072 sc1
    buffer_load_dwordx4 v[84:87], v0, s[4:7], s53 offen offset:3072 sc1
    buffer_load_dwordx4 v[88:91], v0, s[4:7], s54 offen offset:3072 sc1
    buffer_load_dwordx4 v[92:95], v0, s[4:7], s55 offen offset:3072 sc1
    s_add_u32 s52, s52, 4096
    s_add_u32 s53, s53, 4096
    s_add_u32 s54, s54, 4096
    s_add_u32 s55, s55, 4096
    s_waitcnt vmcnt(14)
    v_mfma_f32_16x16x32_bf16 v[8:11], v[36:39], v[32:35], v[8:11]
    v_mfma_f32_16x16x32_bf16 v[20:23], v[36:39], v[4:7], v[20:23]
    s_waitcnt vmcnt(13)
    v_mfma_f32_16x16x32_bf16 v[12:15], v[40:43], v[32:35], v[12:15]
    v_mfma_f32_16x16x32_bf16 v[24:27], v[40:43], v[4:7], v[24:27]
    s_waitcnt vmcnt(12)
    v_mfma_f32_16x16x32_bf16 v[16:19], v[44:47], v[32:35], v[16:19]
    v_mfma_f32_16x16x32_bf16 v[28:31], v[44:47], v[4:7], v[28:31]
    s_waitcnt vmcnt(10)
    v_mfma_f32_16x16x32_bf16 v[8:11], v[52:55], v[48:51], v[8:11]
    v_mfma_f32_16x16x32_bf16 v[20:23], v[52:55], v[4:7], v[20:23]
    s_waitcnt vmcnt(9)
    v_mfma_f32_16x16x32_bf16 v[12:15], v[56:59], v[48:51], v[12:15]
    v_mfma_f32_16x16x32_bf16 v[24:27], v[56:59], v[4:7], v[24:27]
    s_waitcnt vmcnt(8)
    v_mfma_f32_16x16x32_bf16 v[16:19], v[60:63], v[48:51], v[16:19]
    v_mfma_f32_16x16x32_bf16 v[28:31], v[60:63], v[4:7], v[28:31]
    s_waitcnt vmcnt(6)
    v_mfma_f32_16x16x32_bf16 v[8:11], v[68:71], v[64:67], v[8:11]
    v_mfma_f32_16x16x32_bf16 v[20:23], v[68:71], v[4:7], v[20:23]
    s_waitcnt vmcnt(5)
    v_mfma_f32_16x16x32_bf16 v[12:15], v[72:75], v[64:67], v[12:15]
    v_mfma_f32_16x16x32_bf16 v[24:27], v[72:75], v[4:7], v[24:27]
    s_waitcnt vmcnt(4)
    v_mfma_f32_16x16x32_bf16 v[16:19], v[76:79], v[64:67], v[16:19]
    v_mfma_f32_16x16x32_bf16 v[28:31], v[76:79], v[4:7], v[28:31]
    s_waitcnt vmcnt(2)
    v_mfma_f32_16x16x32_bf16 v[8:11], v[84:87], v[80:83], v[8:11]
    v_mfma_f32_16x16x32_bf16 v[20:23], v[84:87], v[4:7], v[20:23]
    s_waitcnt vmcnt(1)
    v_mfma_f32_16x16x32_bf16 v[12:15], v[88:91], v[80:83], v[12:15]
    v_mfma_f32_16x16x32_bf16 v[24:27], v[88:91], v[4:7], v[24:27]
    s_waitcnt vmcnt(0)
    v_mfma_f32_16x16x32_bf16 v[16:19], v[92:95], v[80:83], v[16:19]
    v_mfma_f32_16x16x32_bf16 v[28:31], v[92:95], v[4:7], v[28:31]
    buffer_load_dwordx4 v[32:35], v0, s[4:7], s52 offen offset:0 sc1
    buffer_load_dwordx4 v[36:39], v0, s[4:7], s53 offen offset:0 sc1
    buffer_load_dwordx4 v[40:43], v0, s[4:7], s54 offen offset:0 sc1
    buffer_load_dwordx4 v[44:47], v0, s[4:7], s55 offen offset:0 sc1
    buffer_load_dwordx4 v[48:51], v0, s[4:7], s52 offen offset:1024 sc1
    buffer_load_dwordx4 v[52:55], v0, s[4:7], s53 offen offset:1024 sc1
    buffer_load_dwordx4 v[56:59], v0, s[4:7], s54 offen offset:1024 sc1
    buffer_load_dwordx4 v[60:63], v0, s[4:7], s55 offen offset:1024 sc1
    buffer_load_dwordx4 v[64:67], v0, s[4:7], s52 offen offset:2048 sc1
    buffer_load_dwordx4 v[68:71], v0, s[4:7], s53 offen offset:2048 sc1
    buffer_load_dwordx4 v[72:75], v0, s[4:7], s54 offen offset:2048 sc1
    buffer_load_dwordx4 v[76:79], v0, s[4:7], s55 offen offset:2048 sc1
    buffer_load_dwordx4 v[80:83], v0, s[4:7], s52 offen offset:3072 sc1
    buffer_load_dwordx4 v[84:87], v0, s[4:7], s53 offen offset:3072 sc1
    buffer_load_dwordx4 v[88:91], v0, s[4:7], s54 offen offset:3072 sc1
    buffer_load_dwordx4 v[92:95], v0, s[4:7], s55 offen offset:3072 sc1
    s_add_u32 s52, s52, 4096
    s_add_u32 s53, s53, 4096
    s_add_u32 s54, s54, 4096
    s_add_u32 s55, s55, 4096
    s_waitcnt vmcnt(14)
    v_mfma_f32_16x16x32_bf16 v[8:11], v[36:39], v[32:35], v[8:11]
    v_mfma_f32_16x16x32_bf16 v[20:23], v[36:39], v[4:7], v[20:23]
    s_waitcnt vmcnt(13)
    v_mfma_f32_16x16x32_bf16 v[12:15], v[40:43], v[32:35], v[12:15]
    v_mfma_f32_16x16x32_bf16 v[24:27], v[40:43], v[4:7], v[24:27]
    s_waitcnt vmcnt(12)
    v_mfma_f32_16x16x32_bf16 v[16:19], v[44:47], v[32:35], v[16:19]
    v_mfma_f32_16x16x32_bf16 v[28:31], v[44:47], v[4:7], v[28:31]
    s_waitcnt vmcnt(10)
    v_mfma_f32_16x16x32_bf16 v[8:11], v[52:55], v[48:51], v[8:11]
    v_mfma_f32_16x16x32_bf16 v[20:23], v[52:55], v[4:7], v[20:23]
    s_waitcnt vmcnt(9)
    v_mfma_f32_16x16x32_bf16 v[12:15], v[56:59], v[48:51], v[12:15]
    v_mfma_f32_16x16x32_bf16 v[24:27], v[56:59], v[4:7], v[24:27]
    s_waitcnt vmcnt(8)
    v_mfma_f32_16x16x32_bf16 v[16:19], v[60:63], v[48:51], v[16:19]
    v_mfma_f32_16x16x32_bf16 v[28:31], v[60:63], v[4:7], v[28:31]
    s_waitcnt vmcnt(6)
    v_mfma_f32_16x16x32_bf16 v[8:11], v[68:71], v[64:67], v[8:11]
    v_mfma_f32_16x16x32_bf16 v[20:23], v[68:71], v[4:7], v[20:23]
    s_waitcnt vmcnt(5)
    v_mfma_f32_16x16x32_bf16 v[12:15], v[72:75], v[64:67], v[12:15]
    v_mfma_f32_16x16x32_bf16 v[24:27], v[72:75], v[4:7], v[24:27]
    s_waitcnt vmcnt(4)
    v_mfma_f32_16x16x32_bf16 v[16:19], v[76:79], v[64:67], v[16:19]
    v_mfma_f32_16x16x32_bf16 v[28:31], v[76:79], v[4:7], v[28:31]
    s_waitcnt vmcnt(2)
    v_mfma_f32_16x16x32_bf16 v[8:11], v[84:87], v[80:83], v[8:11]
    v_mfma_f32_16x16x32_bf16 v[20:23], v[84:87], v[4:7], v[20:23]
    s_waitcnt vmcnt(1)
    v_mfma_f32_16x16x32_bf16 v[12:15], v[88:91], v[80:83], v[12:15]
    v_mfma_f32_16x16x32_bf16 v[24:27], v[88:91], v[4:7], v[24:27]
    s_waitcnt vmcnt(0)
    v_mfma_f32_16x16x32_bf16 v[16:19], v[92:95], v[80:83], v[16:19]
    v_mfma_f32_16x16x32_bf16 v[28:31], v[92:95], v[4:7], v[28:31]
    s_mul_i32 s50, s31, 6144
    v_add_u32 v1, s50, v0
    ds_write_b128 v1, v[8:11] offset:0
    ds_write_b128 v1, v[12:15] offset:1024
    ds_write_b128 v1, v[16:19] offset:2048
    ds_write_b128 v1, v[20:23] offset:3072
    ds_write_b128 v1, v[24:27] offset:4096
    s_nop 0
    ds_write_b128 v1, v[28:31] offset:5120
    s_waitcnt lgkmcnt(0)
    s_barrier
    s_cmp_eq_u32 s31, 0
    s_cbranch_scc0 BL2_done
    ds_read_b128 v[32:35], v0 offset:6144
    ds_read_b128 v[36:39], v0 offset:12288
    ds_read_b128 v[40:43], v0 offset:18432
    s_waitcnt lgkmcnt(2)
    v_pk_add_f32 v[8:9], v[8:9], v[32:33]
    v_pk_add_f32 v[10:11], v[10:11], v[34:35]
    s_waitcnt lgkmcnt(1)
    v_pk_add_f32 v[8:9], v[8:9], v[36:37]
    v_pk_add_f32 v[10:11], v[10:11], v[38:39]
    s_waitcnt lgkmcnt(0)
    v_pk_add_f32 v[8:9], v[8:9], v[40:41]
    v_pk_add_f32 v[10:11], v[10:11], v[42:43]
    ds_read_b128 v[32:35], v0 offset:7168
    ds_read_b128 v[36:39], v0 offset:13312
    ds_read_b128 v[40:43], v0 offset:19456
    s_waitcnt lgkmcnt(2)
    v_pk_add_f32 v[12:13], v[12:13], v[32:33]
    v_pk_add_f32 v[14:15], v[14:15], v[34:35]
    s_waitcnt lgkmcnt(1)
    v_pk_add_f32 v[12:13], v[12:13], v[36:37]
    v_pk_add_f32 v[14:15], v[14:15], v[38:39]
    s_waitcnt lgkmcnt(0)
    v_pk_add_f32 v[12:13], v[12:13], v[40:41]
    v_pk_add_f32 v[14:15], v[14:15], v[42:43]
    ds_read_b128 v[32:35], v0 offset:8192
    ds_read_b128 v[36:39], v0 offset:14336
    ds_read_b128 v[40:43], v0 offset:20480
    s_waitcnt lgkmcnt(2)
    v_pk_add_f32 v[16:17], v[16:17], v[32:33]
    v_pk_add_f32 v[18:19], v[18:19], v[34:35]
    s_waitcnt lgkmcnt(1)
    v_pk_add_f32 v[16:17], v[16:17], v[36:37]
    v_pk_add_f32 v[18:19], v[18:19], v[38:39]
    s_waitcnt lgkmcnt(0)
    v_pk_add_f32 v[16:17], v[16:17], v[40:41]
    v_pk_add_f32 v[18:19], v[18:19], v[42:43]
    ds_read_b128 v[32:35], v0 offset:9216
    ds_read_b128 v[36:39], v0 offset:15360
    ds_read_b128 v[40:43], v0 offset:21504
    s_waitcnt lgkmcnt(2)
    v_pk_add_f32 v[20:21], v[20:21], v[32:33]
    v_pk_add_f32 v[22:23], v[22:23], v[34:35]
    s_waitcnt lgkmcnt(1)
    v_pk_add_f32 v[20:21], v[20:21], v[36:37]
    v_pk_add_f32 v[22:23], v[22:23], v[38:39]
    s_waitcnt lgkmcnt(0)
    v_pk_add_f32 v[20:21], v[20:21], v[40:41]
    v_pk_add_f32 v[22:23], v[22:23], v[42:43]
    ds_read_b128 v[32:35], v0 offset:10240
    ds_read_b128 v[36:39], v0 offset:16384
    ds_read_b128 v[40:43], v0 offset:22528
    s_waitcnt lgkmcnt(2)
    v_pk_add_f32 v[24:25], v[24:25], v[32:33]
    v_pk_add_f32 v[26:27], v[26:27], v[34:35]
    s_waitcnt lgkmcnt(1)
    v_pk_add_f32 v[24:25], v[24:25], v[36:37]
    v_pk_add_f32 v[26:27], v[26:27], v[38:39]
    s_waitcnt lgkmcnt(0)
    v_pk_add_f32 v[24:25], v[24:25], v[40:41]
    v_pk_add_f32 v[26:27], v[26:27], v[42:43]
    ds_read_b128 v[32:35], v0 offset:11264
    ds_read_b128 v[36:39], v0 offset:17408
    ds_read_b128 v[40:43], v0 offset:23552
    s_waitcnt lgkmcnt(2)
    v_pk_add_f32 v[28:29], v[28:29], v[32:33]
    v_pk_add_f32 v[30:31], v[30:31], v[34:35]
    s_waitcnt lgkmcnt(1)
    v_pk_add_f32 v[28:29], v[28:29], v[36:37]
    v_pk_add_f32 v[30:31], v[30:31], v[38:39]
    s_waitcnt lgkmcnt(0)
    v_pk_add_f32 v[28:29], v[28:29], v[40:41]
    v_pk_add_f32 v[30:31], v[30:31], v[42:43]
    v_lshrrev_b32 v1, 4, v0
    v_and_b32 v2, 15, v1
    v_lshrrev_b32 v1, 4, v1
    s_lshl_b32 s50, s32, 4
    v_add_u32 v2, s50, v2
    s_mov_b32 s51, 3641
    v_mul_u32_u24 v2, s51, v2
    v_lshrrev_b32 v2, 16, v2
    v_add_u32 v2, 1, v2
    v_lshlrev_b32 v1, 2, v1
    s_add_u32 s50, s50, 2
    v_add_u32 v1, s50, v1
    v_add_u32 v3, 0, v1
    v_mul_u32_u24 v3, s51, v3
    v_lshrrev_b32 v3, 16, v3
    v_cmp_eq_u32 vcc, v3, v2
    s_nop 1
    v_cndmask_b32 v8, 0, v8, vcc
    v_cndmask_b32 v20, 0, v20, vcc
    v_add_u32 v3, 1, v1
    v_mul_u32_u24 v3, s51, v3
    v_lshrrev_b32 v3, 16, v3
    v_cmp_eq_u32 vcc, v3, v2
    s_nop 1
    v_cndmask_b32 v9, 0, v9, vcc
    v_cndmask_b32 v21, 0, v21, vcc
    v_add_u32 v3, 2, v1
    v_mul_u32_u24 v3, s51, v3
    v_lshrrev_b32 v3, 16, v3
    v_cmp_eq_u32 vcc, v3, v2
    s_nop 1
    v_cndmask_b32 v10, 0, v10, vcc
    v_cndmask_b32 v22, 0, v22, vcc
    v_add_u32 v3, 3, v1
    v_mul_u32_u24 v3, s51, v3
    v_lshrrev_b32 v3, 16, v3
    v_cmp_eq_u32 vcc, v3, v2
    s_nop 1
    v_cndmask_b32 v11, 0, v11, vcc
    v_cndmask_b32 v23, 0, v23, vcc
    v_add_u32 v3, 16, v1
    v_mul_u32_u24 v3, s51, v3
    v_lshrrev_b32 v3, 16, v3
    v_cmp_eq_u32 vcc, v3, v2
    s_nop 1
    v_cndmask_b32 v12, 0, v12, vcc
    v_cndmask_b32 v24, 0, v24, vcc
    v_add_u32 v3, 17, v1
    v_mul_u32_u24 v3, s51, v3
    v_lshrrev_b32 v3, 16, v3
    v_cmp_eq_u32 vcc, v3, v2
    s_nop 1
    v_cndmask_b32 v13, 0, v13, vcc
    v_cndmask_b32 v25, 0, v25, vcc
    v_add_u32 v3, 18, v1
    v_mul_u32_u24 v3, s51, v3
    v_lshrrev_b32 v3, 16, v3
    v_cmp_eq_u32 vcc, v3, v2
    s_nop 1
    v_cndmask_b32 v14, 0, v14, vcc
    v_cndmask_b32 v26, 0, v26, vcc
    v_add_u32 v3, 19, v1
    v_mul_u32_u24 v3, s51, v3
    v_lshrrev_b32 v3, 16, v3
    v_cmp_eq_u32 vcc, v3, v2
    s_nop 1
    v_cndmask_b32 v15, 0, v15, vcc
    v_cndmask_b32 v27, 0, v27, vcc
    v_add_u32 v3, 32, v1
    v_mul_u32_u24 v3, s51, v3
    v_lshrrev_b32 v3, 16, v3
    v_cmp_eq_u32 vcc, v3, v2
    s_nop 1
    v_cndmask_b32 v16, 0, v16, vcc
    v_cndmask_b32 v28, 0, v28, vcc
    v_add_u32 v3, 33, v1
    v_mul_u32_u24 v3, s51, v3
    v_lshrrev_b32 v3, 16, v3
    v_cmp_eq_u32 vcc, v3, v2
    s_nop 1
    v_cndmask_b32 v17, 0, v17, vcc
    v_cndmask_b32 v29, 0, v29, vcc
    v_add_u32 v3, 34, v1
    v_mul_u32_u24 v3, s51, v3
    v_lshrrev_b32 v3, 16, v3
    v_cmp_eq_u32 vcc, v3, v2
    s_nop 1
    v_cndmask_b32 v18, 0, v18, vcc
    v_cndmask_b32 v30, 0, v30, vcc
    v_add_u32 v3, 35, v1
    v_mul_u32_u24 v3, s51, v3
    v_lshrrev_b32 v3, 16, v3
    v_cmp_eq_u32 vcc, v3, v2
    s_nop 1
    v_cndmask_b32 v19, 0, v19, vcc
    v_cndmask_b32 v31, 0, v31, vcc
    v_cvt_pk_bf16_f32 v40, v8, v9
    v_cvt_pk_bf16_f32 v41, v10, v11
    v_cvt_pk_bf16_f32 v48, v20, v21
    v_cvt_pk_bf16_f32 v49, v22, v23
    v_cvt_pk_bf16_f32 v42, v12, v13
    v_cvt_pk_bf16_f32 v43, v14, v15
    v_cvt_pk_bf16_f32 v50, v24, v25
    v_cvt_pk_bf16_f32 v51, v26, v27
    v_cvt_pk_bf16_f32 v44, v16, v17
    v_cvt_pk_bf16_f32 v45, v18, v19
    v_cvt_pk_bf16_f32 v52, v28, v29
    v_cvt_pk_bf16_f32 v53, v30, v31
    s_lshl_b32 s50, s32, 12
    s_add_u32 s50, s50, 96468992
    s_bitcmp1_b32 s32, 0
    s_cbranch_scc1 BL2_odd
    v_mov_b32 v60, 0
    v_mov_b32 v61, 0
    v_mov_b32 v62, v40
    v_mov_b32 v63, v41
    v_mov_b32 v64, v42
    v_mov_b32 v65, v43
    v_mov_b32 v66, v44
    v_mov_b32 v67, v45
    buffer_store_dwordx4 v[60:63], v0, s[4:7], s50 offen sc1
    buffer_store_dwordx4 v[64:67], v0, s[4:7], s50 offen offset:1024 sc1
    s_nop 1
    v_mov_b32 v60, 0
    v_mov_b32 v61, 0
    v_mov_b32 v62, v48
    v_mov_b32 v63, v49
    v_mov_b32 v64, v50
    v_mov_b32 v65, v51
    v_mov_b32 v66, v52
    v_mov_b32 v67, v53
    buffer_store_dwordx4 v[60:63], v0, s[4:7], s50 offen offset:2048 sc1
    buffer_store_dwordx4 v[64:67], v0, s[4:7], s50 offen offset:3072 sc1
    s_branch BL2_done
BL2_odd:
    v_mov_b32 v60, v40
    v_mov_b32 v61, v41
    v_mov_b32 v62, v42
    v_mov_b32 v63, v43
    v_mov_b32 v64, v44
    v_mov_b32 v65, v45
    v_mov_b32 v66, 0
    v_mov_b32 v67, 0
    buffer_store_dwordx4 v[60:63], v0, s[4:7], s50 offen sc1
    buffer_store_dwordx4 v[64:67], v0, s[4:7], s50 offen offset:1024 sc1
    s_nop 1
    v_mov_b32 v60, v48
    v_mov_b32 v61, v49
    v_mov_b32 v62, v50
    v_mov_b32 v63, v51
    v_mov_b32 v64, v52
    v_mov_b32 v65, v53
    v_mov_b32 v66, 0
    v_mov_b32 v67, 0
    buffer_store_dwordx4 v[60:63], v0, s[4:7], s50 offen offset:2048 sc1
    buffer_store_dwordx4 v[64:67], v0, s[4:7], s50 offen offset:3072 sc1
BL2_done:
    s_waitcnt vmcnt(0)
    s_barrier
    s_cmp_eq_u32 s31, 0
    s_cbranch_scc0 BL_a2
    v_mov_b32 v13, 52
    v_mov_b32 v14, 1
    s_mov_b64 exec, 1
    global_atomic_add v13, v14, s[90:91]
    s_mov_b64 exec, -1
BL_a2:
    s_add_u32 s32, s32, 32
    s_cmp_lt_u32 s32, 36
    s_cbranch_scc1 BL_KVT
    v_mov_b32 v13, 52
    s_mov_b64 exec, 1
    s_mov_b32 s57, 0x40000
BL_w2:
    global_load_dword v14, v13, s[90:91] sc1
    s_waitcnt vmcnt(0)
    v_readfirstlane_b32 s56, v14
    s_sub_u32 s57, s57, 1
    s_cbranch_scc1 BL_w2_o
    s_cmp_lt_u32 s56, 36
    s_cbranch_scc0 BL_w2_o
    s_sleep 8
    s_branch BL_w2
BL_w2_o:
    s_mov_b64 exec, -1
    s_barrier
    s_lshl_b32 s32, s70, 2
    s_add_u32 s33, s32, 4
    s_lshr_b32 s50, s31, 1
    s_mul_i32 s54, s50, 18
    s_and_b32 s50, s31, 1
    s_mul_i32 s51, s50, 10
    s_add_u32 s54, s54, s51
    s_lshl_b32 s50, s50, 1
    s_sub_u32 s55, 10, s50
    s_lshl_b32 s50, s54, 12
    s_add_u32 s50, s50, 96468992
    buffer_load_dwordx4 a[0:3], v0, s[4:7], s50 offen offset:0 sc1
    buffer_load_dwordx4 a[4:7], v0, s[4:7], s50 offen offset:1024 sc1
    buffer_load_dwordx4 a[8:11], v0, s[4:7], s50 offen offset:2048 sc1
    buffer_load_dwordx4 a[12:15], v0, s[4:7], s50 offen offset:3072 sc1
    s_add_u32 s50, s50, 4096
    buffer_load_dwordx4 a[16:19], v0, s[4:7], s50 offen offset:0 sc1
    buffer_load_dwordx4 a[20:23], v0, s[4:7], s50 offen offset:1024 sc1
    buffer_load_dwordx4 a[24:27], v0, s[4:7], s50 offen offset:2048 sc1
    buffer_load_dwordx4 a[28:31], v0, s[4:7], s50 offen offset:3072 sc1
    s_add_u32 s50, s50, 4096
    buffer_load_dwordx4 a[32:35], v0, s[4:7], s50 offen offset:0 sc1
    buffer_load_dwordx4 a[36:39], v0, s[4:7], s50 offen offset:1024 sc1
    buffer_load_dwordx4 a[40:43], v0, s[4:7], s50 offen offset:2048 sc1
    buffer_load_dwordx4 a[44:47], v0, s[4:7], s50 offen offset:3072 sc1
    s_add_u32 s50, s50, 4096
    s_waitcnt vmcnt(0)
    buffer_load_dwordx4 a[48:51], v0, s[4:7], s50 offen offset:0 sc1
    buffer_load_dwordx4 a[52:55], v0, s[4:7], s50 offen offset:1024 sc1
    buffer_load_dwordx4 a[56:59], v0, s[4:7], s50 offen offset:2048 sc1
    buffer_load_dwordx4 a[60:63], v0, s[4:7], s50 offen offset:3072 sc1
    s_add_u32 s50, s50, 4096
    buffer_load_dwordx4 a[64:67], v0, s[4:7], s50 offen offset:0 sc1
    buffer_load_dwordx4 a[68:71], v0, s[4:7], s50 offen offset:1024 sc1
    buffer_load_dwordx4 a[72:75], v0, s[4:7], s50 offen offset:2048 sc1
    buffer_load_dwordx4 a[76:79], v0, s[4:7], s50 offen offset:3072 sc1
    s_add_u32 s50, s50, 4096
    buffer_load_dwordx4 a[80:83], v0, s[4:7], s50 offen offset:0 sc1
    buffer_load_dwordx4 a[84:87], v0, s[4:7], s50 offen offset:1024 sc1
    buffer_load_dwordx4 a[88:91], v0, s[4:7], s50 offen offset:2048 sc1
    buffer_load_dwordx4 a[92:95], v0, s[4:7], s50 offen offset:3072 sc1
    s_add_u32 s50, s50, 4096
    s_waitcnt vmcnt(0)
    buffer_load_dwordx4 a[96:99], v0, s[4:7], s50 offen offset:0 sc1
    buffer_load_dwordx4 a[100:103], v0, s[4:7], s50 offen offset:1024 sc1
    buffer_load_dwordx4 a[104:107], v0, s[4:7], s50 offen offset:2048 sc1
    buffer_load_dwordx4 a[108:111], v0, s[4:7], s50 offen offset:3072 sc1
    s_add_u32 s50, s50, 4096
    buffer_load_dwordx4 a[112:115], v0, s[4:7], s50 offen offset:0 sc1
    buffer_load_dwordx4 a[116:119], v0, s[4:7], s50 offen offset:1024 sc1
    buffer_load_dwordx4 a[120:123], v0, s[4:7], s50 offen offset:2048 sc1
    buffer_load_dwordx4 a[124:127], v0, s[4:7], s50 offen offset:3072 sc1
    s_add_u32 s50, s50, 4096
    buffer_load_dwordx4 a[128:131], v0, s[4:7], s50 offen offset:0 sc1
    buffer_load_dwordx4 a[132:135], v0, s[4:7], s50 offen offset:1024 sc1
    buffer_load_dwordx4 a[136:139], v0, s[4:7], s50 offen offset:2048 sc1
    buffer_load_dwordx4 a[140:143], v0, s[4:7], s50 offen offset:3072 sc1
    s_add_u32 s50, s50, 4096
    s_waitcnt vmcnt(0)
    buffer_load_dwordx4 a[144:147], v0, s[4:7], s50 offen offset:0 sc1
    buffer_load_dwordx4 a[148:151], v0, s[4:7], s50 offen offset:1024 sc1
    buffer_load_dwordx4 a[152:155], v0, s[4:7], s50 offen offset:2048 sc1
    buffer_load_dwordx4 a[156:159], v0, s[4:7], s50 offen offset:3072 sc1
    s_add_u32 s50, s50, 4096
    s_lshr_b32 s50, s54, 1
    s_lshl_b32 s50, s50, 10
    s_mul_i32 s57, s32, 20480
    s_add_u32 s57, s57, s50
    s_add_u32 s57, s57, 92274688
    s_mul_i32 s58, s32, 18432
    s_lshl_b32 s50, s54, 5
    s_add_u32 s58, s58, s50
    s_add_u32 s58, s58, 97517568
    v_lshrrev_b32 v1, 4, v0
    v_and_b32 v2, 15, v1
    v_lshrrev_b32 v1, 4, v1
    v_mul_u32_u24 v2, 1152, v2
    v_lshl_add_u32 v1, v1, 3, v2
    s_mov_b32 s59, 0x358637bd
    s_waitcnt vmcnt(0)
BL3_loop:
    s_sub_u32 s56, s57, 1024
    s_cmp_eq_u32 s31, 0
    s_cselect_b32 s56, s57, s56
    buffer_load_dwordx4 v[8:11], v0, s[4:7], s56 offen sc1
    buffer_load_dwordx4 v[12:15], v0, s[4:7], s57 offen offset:0 sc1
    buffer_load_dwordx4 v[16:19], v0, s[4:7], s57 offen offset:1024 sc1
    buffer_load_dwordx4 v[20:23], v0, s[4:7], s57 offen offset:2048 sc1
    buffer_load_dwordx4 v[24:27], v0, s[4:7], s57 offen offset:3072 sc1
    s_add_u32 s50, s57, 4096
    buffer_load_dwordx4 v[28:31], v0, s[4:7], s50 offen offset:0 sc1
    s_add_u32 s50, s57, 4096
    buffer_load_dwordx4 v[32:35], v0, s[4:7], s50 offen offset:1024 sc1
    s_waitcnt vmcnt(6)
    v_mfma_f32_16x16x32_bf16 v[40:43], a[0:3], v[8:11], 0
    v_mfma_f32_16x16x32_bf16 v[44:47], a[8:11], v[8:11], 0
    s_waitcnt vmcnt(5)
    v_mfma_f32_16x16x32_bf16 v[40:43], a[4:7], v[12:15], v[40:43]
    v_mfma_f32_16x16x32_bf16 v[44:47], a[12:15], v[12:15], v[44:47]
    s_nop 3
    v_cvt_pk_bf16_f32 v48, v40, v41
    s_nop 2
    v_cvt_pk_bf16_f32 v49, v44, v45
    v_lshlrev_b32 v50, 16, v49
    v_and_b32 v51, 0xffff0000, v49
    v_add_f32 v50, s59, v50
    v_add_f32 v51, s59, v51
    v_cvt_pk_bf16_f32 v49, v50, v51
    v_lshlrev_b32 v50, 16, v49
    v_and_b32 v51, 0xffff0000, v49
    v_rcp_f32 v50, v50
    v_rcp_f32 v51, v51
    v_lshlrev_b32 v52, 16, v48
    v_and_b32 v53, 0xffff0000, v48
    v_mul_f32 v52, v52, v50
    v_mul_f32 v53, v53, v51
    v_cvt_pk_bf16_f32 v54, v52, v53
    v_cvt_pk_bf16_f32 v48, v42, v43
    v_cvt_pk_bf16_f32 v49, v46, v47
    v_lshlrev_b32 v50, 16, v49
    v_and_b32 v51, 0xffff0000, v49
    v_add_f32 v50, s59, v50
    v_add_f32 v51, s59, v51
    v_cvt_pk_bf16_f32 v49, v50, v51
    v_lshlrev_b32 v50, 16, v49
    v_and_b32 v51, 0xffff0000, v49
    v_rcp_f32 v50, v50
    v_rcp_f32 v51, v51
    v_lshlrev_b32 v52, 16, v48
    v_and_b32 v53, 0xffff0000, v48
    v_mul_f32 v52, v52, v50
    v_mul_f32 v53, v53, v51
    v_cvt_pk_bf16_f32 v55, v52, v53
    buffer_store_dwordx2 v[54:55], v1, s[4:7], s58 offen offset:0 sc1
    s_nop 1
    v_mfma_f32_16x16x32_bf16 v[40:43], a[16:19], v[12:15], 0
    v_mfma_f32_16x16x32_bf16 v[44:47], a[24:27], v[12:15], 0
    s_waitcnt vmcnt(5)
    v_mfma_f32_16x16x32_bf16 v[40:43], a[20:23], v[16:19], v[40:43]
    v_mfma_f32_16x16x32_bf16 v[44:47], a[28:31], v[16:19], v[44:47]
    s_nop 3
    v_cvt_pk_bf16_f32 v48, v40, v41
    s_nop 2
    v_cvt_pk_bf16_f32 v49, v44, v45
    v_lshlrev_b32 v50, 16, v49
    v_and_b32 v51, 0xffff0000, v49
    v_add_f32 v50, s59, v50
    v_add_f32 v51, s59, v51
    v_cvt_pk_bf16_f32 v49, v50, v51
    v_lshlrev_b32 v50, 16, v49
    v_and_b32 v51, 0xffff0000, v49
    v_rcp_f32 v50, v50
    v_rcp_f32 v51, v51
    v_lshlrev_b32 v52, 16, v48
    v_and_b32 v53, 0xffff0000, v48
    v_mul_f32 v52, v52, v50
    v_mul_f32 v53, v53, v51
    v_cvt_pk_bf16_f32 v54, v52, v53
    v_cvt_pk_bf16_f32 v48, v42, v43
    v_cvt_pk_bf16_f32 v49, v46, v47
    v_lshlrev_b32 v50, 16, v49
    v_and_b32 v51, 0xffff0000, v49
    v_add_f32 v50, s59, v50
    v_add_f32 v51, s59, v51
    v_cvt_pk_bf16_f32 v49, v50, v51
    v_lshlrev_b32 v50, 16, v49
    v_and_b32 v51, 0xffff0000, v49
    v_rcp_f32 v50, v50
    v_rcp_f32 v51, v51
    v_lshlrev_b32 v52, 16, v48
    v_and_b32 v53, 0xffff0000, v48
    v_mul_f32 v52, v52, v50
    v_mul_f32 v53, v53, v51
    v_cvt_pk_bf16_f32 v55, v52, v53
    buffer_store_dwordx2 v[54:55], v1, s[4:7], s58 offen offset:32 sc1
    s_nop 1
    v_mfma_f32_16x16x32_bf16 v[40:43], a[32:35], v[12:15], 0
    v_mfma_f32_16x16x32_bf16 v[44:47], a[40:43], v[12:15], 0
    v_mfma_f32_16x16x32_bf16 v[40:43], a[36:39], v[16:19], v[40:43]
    v_mfma_f32_16x16x32_bf16 v[44:47], a[44:47], v[16:19], v[44:47]
    s_nop 3
    v_cvt_pk_bf16_f32 v48, v40, v41
    s_nop 2
    v_cvt_pk_bf16_f32 v49, v44, v45
    v_lshlrev_b32 v50, 16, v49
    v_and_b32 v51, 0xffff0000, v49
    v_add_f32 v50, s59, v50
    v_add_f32 v51, s59, v51
    v_cvt_pk_bf16_f32 v49, v50, v51
    v_lshlrev_b32 v50, 16, v49
    v_and_b32 v51, 0xffff0000, v49
    v_rcp_f32 v50, v50
    v_rcp_f32 v51, v51
    v_lshlrev_b32 v52, 16, v48
    v_and_b32 v53, 0xffff0000, v48
    v_mul_f32 v52, v52, v50
    v_mul_f32 v53, v53, v51
    v_cvt_pk_bf16_f32 v54, v52, v53
    v_cvt_pk_bf16_f32 v48, v42, v43
    v_cvt_pk_bf16_f32 v49, v46, v47
    v_lshlrev_b32 v50, 16, v49
    v_and_b32 v51, 0xffff0000, v49
    v_add_f32 v50, s59, v50
    v_add_f32 v51, s59, v51
    v_cvt_pk_bf16_f32 v49, v50, v51
    v_lshlrev_b32 v50, 16, v49
    v_and_b32 v51, 0xffff0000, v49
    v_rcp_f32 v50, v50
    v_rcp_f32 v51, v51
    v_lshlrev_b32 v52, 16, v48
    v_and_b32 v53, 0xffff0000, v48
    v_mul_f32 v52, v52, v50
    v_mul_f32 v53, v53, v51
    v_cvt_pk_bf16_f32 v55, v52, v53
    buffer_store_dwordx2 v[54:55], v1, s[4:7], s58 offen offset:64 sc1
    s_nop 1
    v_mfma_f32_16x16x32_bf16 v[40:43], a[48:51], v[16:19], 0
    v_mfma_f32_16x16x32_bf16 v[44:47], a[56:59], v[16:19], 0
    s_waitcnt vmcnt(6)
    v_mfma_f32_16x16x32_bf16 v[40:43], a[52:55], v[20:23], v[40:43]
    v_mfma_f32_16x16x32_bf16 v[44:47], a[60:63], v[20:23], v[44:47]
    s_nop 3
    v_cvt_pk_bf16_f32 v48, v40, v41
    s_nop 2
    v_cvt_pk_bf16_f32 v49, v44, v45
    v_lshlrev_b32 v50, 16, v49
    v_and_b32 v51, 0xffff0000, v49
    v_add_f32 v50, s59, v50
    v_add_f32 v51, s59, v51
    v_cvt_pk_bf16_f32 v49, v50, v51
    v_lshlrev_b32 v50, 16, v49
    v_and_b32 v51, 0xffff0000, v49
    v_rcp_f32 v50, v50
    v_rcp_f32 v51, v51
    v_lshlrev_b32 v52, 16, v48
    v_and_b32 v53, 0xffff0000, v48
    v_mul_f32 v52, v52, v50
    v_mul_f32 v53, v53, v51
    v_cvt_pk_bf16_f32 v54, v52, v53
    v_cvt_pk_bf16_f32 v48, v42, v43
    v_cvt_pk_bf16_f32 v49, v46, v47
    v_lshlrev_b32 v50, 16, v49
    v_and_b32 v51, 0xffff0000, v49
    v_add_f32 v50, s59, v50
    v_add_f32 v51, s59, v51
    v_cvt_pk_bf16_f32 v49, v50, v51
    v_lshlrev_b32 v50, 16, v49
    v_and_b32 v51, 0xffff0000, v49
    v_rcp_f32 v50, v50
    v_rcp_f32 v51, v51
    v_lshlrev_b32 v52, 16, v48
    v_and_b32 v53, 0xffff0000, v48
    v_mul_f32 v52, v52, v50
    v_mul_f32 v53, v53, v51
    v_cvt_pk_bf16_f32 v55, v52, v53
    buffer_store_dwordx2 v[54:55], v1, s[4:7], s58 offen offset:96 sc1
    s_nop 1
    v_mfma_f32_16x16x32_bf16 v[40:43], a[64:67], v[16:19], 0
    v_mfma_f32_16x16x32_bf16 v[44:47], a[72:75], v[16:19], 0
    v_mfma_f32_16x16x32_bf16 v[40:43], a[68:71], v[20:23], v[40:43]
    v_mfma_f32_16x16x32_bf16 v[44:47], a[76:79], v[20:23], v[44:47]
    s_nop 3
    v_cvt_pk_bf16_f32 v48, v40, v41
    s_nop 2
    v_cvt_pk_bf16_f32 v49, v44, v45
    v_lshlrev_b32 v50, 16, v49
    v_and_b32 v51, 0xffff0000, v49
    v_add_f32 v50, s59, v50
    v_add_f32 v51, s59, v51
    v_cvt_pk_bf16_f32 v49, v50, v51
    v_lshlrev_b32 v50, 16, v49
    v_and_b32 v51, 0xffff0000, v49
    v_rcp_f32 v50, v50
    v_rcp_f32 v51, v51
    v_lshlrev_b32 v52, 16, v48
    v_and_b32 v53, 0xffff0000, v48
    v_mul_f32 v52, v52, v50
    v_mul_f32 v53, v53, v51
    v_cvt_pk_bf16_f32 v54, v52, v53
    v_cvt_pk_bf16_f32 v48, v42, v43
    v_cvt_pk_bf16_f32 v49, v46, v47
    v_lshlrev_b32 v50, 16, v49
    v_and_b32 v51, 0xffff0000, v49
    v_add_f32 v50, s59, v50
    v_add_f32 v51, s59, v51
    v_cvt_pk_bf16_f32 v49, v50, v51
    v_lshlrev_b32 v50, 16, v49
    v_and_b32 v51, 0xffff0000, v49
    v_rcp_f32 v50, v50
    v_rcp_f32 v51, v51
    v_lshlrev_b32 v52, 16, v48
    v_and_b32 v53, 0xffff0000, v48
    v_mul_f32 v52, v52, v50
    v_mul_f32 v53, v53, v51
    v_cvt_pk_bf16_f32 v55, v52, v53
    buffer_store_dwordx2 v[54:55], v1, s[4:7], s58 offen offset:128 sc1
    s_nop 1
    v_mfma_f32_16x16x32_bf16 v[40:43], a[80:83], v[20:23], 0
    v_mfma_f32_16x16x32_bf16 v[44:47], a[88:91], v[20:23], 0
    s_waitcnt vmcnt(7)
    v_mfma_f32_16x16x32_bf16 v[40:43], a[84:87], v[24:27], v[40:43]
    v_mfma_f32_16x16x32_bf16 v[44:47], a[92:95], v[24:27], v[44:47]
    s_nop 3
    v_cvt_pk_bf16_f32 v48, v40, v41
    s_nop 2
    v_cvt_pk_bf16_f32 v49, v44, v45
    v_lshlrev_b32 v50, 16, v49
    v_and_b32 v51, 0xffff0000, v49
    v_add_f32 v50, s59, v50
    v_add_f32 v51, s59, v51
    v_cvt_pk_bf16_f32 v49, v50, v51
    v_lshlrev_b32 v50, 16, v49
    v_and_b32 v51, 0xffff0000, v49
    v_rcp_f32 v50, v50
    v_rcp_f32 v51, v51
    v_lshlrev_b32 v52, 16, v48
    v_and_b32 v53, 0xffff0000, v48
    v_mul_f32 v52, v52, v50
    v_mul_f32 v53, v53, v51
    v_cvt_pk_bf16_f32 v54, v52, v53
    v_cvt_pk_bf16_f32 v48, v42, v43
    v_cvt_pk_bf16_f32 v49, v46, v47
    v_lshlrev_b32 v50, 16, v49
    v_and_b32 v51, 0xffff0000, v49
    v_add_f32 v50, s59, v50
    v_add_f32 v51, s59, v51
    v_cvt_pk_bf16_f32 v49, v50, v51
    v_lshlrev_b32 v50, 16, v49
    v_and_b32 v51, 0xffff0000, v49
    v_rcp_f32 v50, v50
    v_rcp_f32 v51, v51
    v_lshlrev_b32 v52, 16, v48
    v_and_b32 v53, 0xffff0000, v48
    v_mul_f32 v52, v52, v50
    v_mul_f32 v53, v53, v51
    v_cvt_pk_bf16_f32 v55, v52, v53
    buffer_store_dwordx2 v[54:55], v1, s[4:7], s58 offen offset:160 sc1
    s_nop 1
    v_mfma_f32_16x16x32_bf16 v[40:43], a[96:99], v[20:23], 0
    v_mfma_f32_16x16x32_bf16 v[44:47], a[104:107], v[20:23], 0
    v_mfma_f32_16x16x32_bf16 v[40:43], a[100:103], v[24:27], v[40:43]
    v_mfma_f32_16x16x32_bf16 v[44:47], a[108:111], v[24:27], v[44:47]
    s_nop 3
    v_cvt_pk_bf16_f32 v48, v40, v41
    s_nop 2
    v_cvt_pk_bf16_f32 v49, v44, v45
    v_lshlrev_b32 v50, 16, v49
    v_and_b32 v51, 0xffff0000, v49
    v_add_f32 v50, s59, v50
    v_add_f32 v51, s59, v51
    v_cvt_pk_bf16_f32 v49, v50, v51
    v_lshlrev_b32 v50, 16, v49
    v_and_b32 v51, 0xffff0000, v49
    v_rcp_f32 v50, v50
    v_rcp_f32 v51, v51
    v_lshlrev_b32 v52, 16, v48
    v_and_b32 v53, 0xffff0000, v48
    v_mul_f32 v52, v52, v50
    v_mul_f32 v53, v53, v51
    v_cvt_pk_bf16_f32 v54, v52, v53
    v_cvt_pk_bf16_f32 v48, v42, v43
    v_cvt_pk_bf16_f32 v49, v46, v47
    v_lshlrev_b32 v50, 16, v49
    v_and_b32 v51, 0xffff0000, v49
    v_add_f32 v50, s59, v50
    v_add_f32 v51, s59, v51
    v_cvt_pk_bf16_f32 v49, v50, v51
    v_lshlrev_b32 v50, 16, v49
    v_and_b32 v51, 0xffff0000, v49
    v_rcp_f32 v50, v50
    v_rcp_f32 v51, v51
    v_lshlrev_b32 v52, 16, v48
    v_and_b32 v53, 0xffff0000, v48
    v_mul_f32 v52, v52, v50
    v_mul_f32 v53, v53, v51
    v_cvt_pk_bf16_f32 v55, v52, v53
    buffer_store_dwordx2 v[54:55], v1, s[4:7], s58 offen offset:192 sc1
    s_nop 1
    v_mfma_f32_16x16x32_bf16 v[40:43], a[112:115], v[24:27], 0
    v_mfma_f32_16x16x32_bf16 v[44:47], a[120:123], v[24:27], 0
    s_waitcnt vmcnt(8)
    v_mfma_f32_16x16x32_bf16 v[40:43], a[116:119], v[28:31], v[40:43]
    v_mfma_f32_16x16x32_bf16 v[44:47], a[124:127], v[28:31], v[44:47]
    s_nop 3
    v_cvt_pk_bf16_f32 v48, v40, v41
    s_nop 2
    v_cvt_pk_bf16_f32 v49, v44, v45
    v_lshlrev_b32 v50, 16, v49
    v_and_b32 v51, 0xffff0000, v49
    v_add_f32 v50, s59, v50
    v_add_f32 v51, s59, v51
    v_cvt_pk_bf16_f32 v49, v50, v51
    v_lshlrev_b32 v50, 16, v49
    v_and_b32 v51, 0xffff0000, v49
    v_rcp_f32 v50, v50
    v_rcp_f32 v51, v51
    v_lshlrev_b32 v52, 16, v48
    v_and_b32 v53, 0xffff0000, v48
    v_mul_f32 v52, v52, v50
    v_mul_f32 v53, v53, v51
    v_cvt_pk_bf16_f32 v54, v52, v53
    v_cvt_pk_bf16_f32 v48, v42, v43
    v_cvt_pk_bf16_f32 v49, v46, v47
    v_lshlrev_b32 v50, 16, v49
    v_and_b32 v51, 0xffff0000, v49
    v_add_f32 v50, s59, v50
    v_add_f32 v51, s59, v51
    v_cvt_pk_bf16_f32 v49, v50, v51
    v_lshlrev_b32 v50, 16, v49
    v_and_b32 v51, 0xffff0000, v49
    v_rcp_f32 v50, v50
    v_rcp_f32 v51, v51
    v_lshlrev_b32 v52, 16, v48
    v_and_b32 v53, 0xffff0000, v48
    v_mul_f32 v52, v52, v50
    v_mul_f32 v53, v53, v51
    v_cvt_pk_bf16_f32 v55, v52, v53
    buffer_store_dwordx2 v[54:55], v1, s[4:7], s58 offen offset:224 sc1
    s_nop 1
    s_cmp_lt_u32 s55, 10
    s_cbranch_scc1 BL3_skip
    v_mfma_f32_16x16x32_bf16 v[40:43], a[128:131], v[24:27], 0
    v_mfma_f32_16x16x32_bf16 v[44:47], a[136:139], v[24:27], 0
    v_mfma_f32_16x16x32_bf16 v[40:43], a[132:135], v[28:31], v[40:43]
    v_mfma_f32_16x16x32_bf16 v[44:47], a[140:143], v[28:31], v[44:47]
    s_nop 3
    v_cvt_pk_bf16_f32 v48, v40, v41
    s_nop 2
    v_cvt_pk_bf16_f32 v49, v44, v45
    v_lshlrev_b32 v50, 16, v49
    v_and_b32 v51, 0xffff0000, v49
    v_add_f32 v50, s59, v50
    v_add_f32 v51, s59, v51
    v_cvt_pk_bf16_f32 v49, v50, v51
    v_lshlrev_b32 v50, 16, v49
    v_and_b32 v51, 0xffff0000, v49
    v_rcp_f32 v50, v50
    v_rcp_f32 v51, v51
    v_lshlrev_b32 v52, 16, v48
    v_and_b32 v53, 0xffff0000, v48
    v_mul_f32 v52, v52, v50
    v_mul_f32 v53, v53, v51
    v_cvt_pk_bf16_f32 v54, v52, v53
    v_cvt_pk_bf16_f32 v48, v42, v43
    v_cvt_pk_bf16_f32 v49, v46, v47
    v_lshlrev_b32 v50, 16, v49
    v_and_b32 v51, 0xffff0000, v49
    v_add_f32 v50, s59, v50
    v_add_f32 v51, s59, v51
    v_cvt_pk_bf16_f32 v49, v50, v51
    v_lshlrev_b32 v50, 16, v49
    v_and_b32 v51, 0xffff0000, v49
    v_rcp_f32 v50, v50
    v_rcp_f32 v51, v51
    v_lshlrev_b32 v52, 16, v48
    v_and_b32 v53, 0xffff0000, v48
    v_mul_f32 v52, v52, v50
    v_mul_f32 v53, v53, v51
    v_cvt_pk_bf16_f32 v55, v52, v53
    buffer_store_dwordx2 v[54:55], v1, s[4:7], s58 offen offset:256 sc1
    s_nop 1
    v_mfma_f32_16x16x32_bf16 v[40:43], a[144:147], v[28:31], 0
    v_mfma_f32_16x16x32_bf16 v[44:47], a[152:155], v[28:31], 0
    s_waitcnt vmcnt(9)
    v_mfma_f32_16x16x32_bf16 v[40:43], a[148:151], v[32:35], v[40:43]
    v_mfma_f32_16x16x32_bf16 v[44:47], a[156:159], v[32:35], v[44:47]
    s_nop 3
    v_cvt_pk_bf16_f32 v48, v40, v41
    s_nop 2
    v_cvt_pk_bf16_f32 v49, v44, v45
    v_lshlrev_b32 v50, 16, v49
    v_and_b32 v51, 0xffff0000, v49
    v_add_f32 v50, s59, v50
    v_add_f32 v51, s59, v51
    v_cvt_pk_bf16_f32 v49, v50, v51
    v_lshlrev_b32 v50, 16, v49
    v_and_b32 v51, 0xffff0000, v49
    v_rcp_f32 v50, v50
    v_rcp_f32 v51, v51
    v_lshlrev_b32 v52, 16, v48
    v_and_b32 v53, 0xffff0000, v48
    v_mul_f32 v52, v52, v50
    v_mul_f32 v53, v53, v51
    v_cvt_pk_bf16_f32 v54, v52, v53
    v_cvt_pk_bf16_f32 v48, v42, v43
    v_cvt_pk_bf16_f32 v49, v46, v47
    v_lshlrev_b32 v50, 16, v49
    v_and_b32 v51, 0xffff0000, v49
    v_add_f32 v50, s59, v50
    v_add_f32 v51, s59, v51
    v_cvt_pk_bf16_f32 v49, v50, v51
    v_lshlrev_b32 v50, 16, v49
    v_and_b32 v51, 0xffff0000, v49
    v_rcp_f32 v50, v50
    v_rcp_f32 v51, v51
    v_lshlrev_b32 v52, 16, v48
    v_and_b32 v53, 0xffff0000, v48
    v_mul_f32 v52, v52, v50
    v_mul_f32 v53, v53, v51
    v_cvt_pk_bf16_f32 v55, v52, v53
    buffer_store_dwordx2 v[54:55], v1, s[4:7], s58 offen offset:288 sc1
    s_nop 1
BL3_skip:
    s_add_u32 s57, s57, 20480
    s_add_u32 s58, s58, 18432
    s_add_u32 s32, s32, 1
    s_cmp_lt_u32 s32, s33
    s_cbranch_scc1 BL3_loop
    s_waitcnt vmcnt(0)
    s_barrier
    s_lshr_b32 s71, s70, 3
    s_lshl_b32 s71, s71, 2
    s_add_u32 s71, s71, 56
    s_cmp_eq_u32 s31, 0
    s_cbranch_scc0 BL_a3
    v_mov_b32 v13, s71
    v_mov_b32 v14, 1
    s_mov_b64 exec, 1
    global_atomic_add v13, v14, s[90:91]
    s_mov_b64 exec, -1
BL_a3:
    s_cmp_ge_u32 s70, 20
    s_cbranch_scc1 KEND
    s_mul_i32 s60, s70, 13
    s_lshr_b32 s60, s60, 6
    s_mul_i32 s63, s60, 5
    s_sub_u32 s63, s70, s63
    s_lshl_b32 s71, s60, 2
    s_add_u32 s71, s71, 56
    v_mov_b32 v13, s71
    s_mov_b64 exec, 1
    s_mov_b32 s57, 0x40000
BL_w3:
    global_load_dword v14, v13, s[90:91] sc1
    s_waitcnt vmcnt(0)
    v_readfirstlane_b32 s56, v14
    s_sub_u32 s57, s57, 1
    s_cbranch_scc1 BL_w3_o
    s_cmp_lt_u32 s56, 8
    s_cbranch_scc0 BL_w3_o
    s_sleep 8
    s_branch BL_w3
BL_w3_o:
    s_mov_b64 exec, -1
    s_barrier
    s_add_u32 s80, s92, 97517568
    s_addc_u32 s81, s93, 0
    s_mov_b32 s12, s80
    s_and_b32 s13, s81, 0xffff
    s_mov_b32 s14, 2359296
    s_mov_b32 s15, 0x00020000
    s_mov_b32 s8, s66
    s_and_b32 s9, s67, 0xffff
    s_mov_b32 s10, 663552
    s_mov_b32 s11, 0x00020000
    s_mov_b32 s16, s94
    s_and_b32 s17, s95, 0xffff
    s_mov_b32 s18, 4718592
    s_mov_b32 s19, 0x00020000
    s_add_u32 s14, s60, 1
    s_mul_i32 s14, s14, 589824
    v_lshrrev_b32 v11, 4, v0
    v_lshrrev_b32 v12, 3, v11
    v_mul_u32_u24 v12, 1152, v12
    v_and_b32 v13, 7, v11
    v_lshrrev_b32 v14, 4, v11
    v_xor_b32 v13, v13, v14
    v_lshl_add_u32 v1, v13, 4, v12
    v_xor_b32 v13, 4, v13
    v_lshl_add_u32 v2, v13, 4, v12
    v_and_b32 v12, 15, v11
    v_lshrrev_b32 v13, 4, v11
    v_lshrrev_b32 v14, 1, v12
    v_xor_b32 v13, v13, v14
    v_lshlrev_b32 v13, 4, v13
    v_lshl_add_u32 v3, v12, 7, v13
    v_xor_b32 v4, 64, v3
    s_mov_b32 s32, 1152
    s_lshl_b32 s33, s63, 8
    s_lshl_b32 s34, s60, 2
    s_add_u32 s35, s34, 4
    s_mul_i32 s36, s34, 294912
    s_lshl_b32 s64, s63, 8
    s_add_u32 s36, s36, s64
    s_lshl_b32 s64, s31, 6
    s_add_u32 s36, s36, s64
    s_add_u32 s36, s36, 1152
    s_mov_b32 s37, 294912
    v_lshrrev_b32 v12, 4, v0
    v_and_b32 v13, 15, v12
    v_lshrrev_b32 v12, 4, v12
    v_mul_u32_u24 v13, 2304, v13
    v_lshl_add_u32 v15, v12, 4, v13
    s_cmp_eq_u32 s63, 4
    s_cselect_b32 s64, 2, 99
    s_cmp_ge_u32 s31, s64
    s_cselect_b32 s64, 0x7f000000, 0
    v_add_u32 v15, s64, v15
    v_lshrrev_b32 v20, 4, v0
    v_lshrrev_b32 v21, 4, v20
    v_and_b32 v22, 15, v20
    v_lshlrev_b32 v23, 1, v21
    v_xor_b32 v22, v22, v23
    v_lshlrev_b32 v22, 4, v22
    v_mul_lo_u32 v21, v21, s32
    v_add_u32 v10, v21, v22
    v_add_u32 v11, v21, v22
    v_xor_b32 v22, 128, v22
    v_add_u32 v11, v21, v22
    s_mul_i32 s50, s31, 144
    s_mul_i32 s50, s50, s32
    s_add_u32 s50, s50, s33
    s_lshl_b32 s51, s32, 2
    s_mul_i32 s52, s31, 36864
    s_add_u32 m0, s52, 0
    s_nop 0
    buffer_load_dwordx4 v10, s[8:11], s50 offen lds
    s_add_u32 s50, s50, s51
    s_add_u32 m0, s52, 1024
    s_nop 0
    buffer_load_dwordx4 v10, s[8:11], s50 offen lds
    s_add_u32 s50, s50, s51
    s_add_u32 m0, s52, 2048
    s_nop 0
    buffer_load_dwordx4 v11, s[8:11], s50 offen lds
    s_add_u32 s50, s50, s51
    s_add_u32 m0, s52, 3072
    s_nop 0
    buffer_load_dwordx4 v11, s[8:11], s50 offen lds
    s_add_u32 s50, s50, s51
    s_add_u32 m0, s52, 4096
    s_nop 0
    buffer_load_dwordx4 v10, s[8:11], s50 offen lds
    s_add_u32 s50, s50, s51
    s_add_u32 m0, s52, 5120
    s_nop 0
    buffer_load_dwordx4 v10, s[8:11], s50 offen lds
    s_add_u32 s50, s50, s51
    s_add_u32 m0, s52, 6144
    s_nop 0
    buffer_load_dwordx4 v11, s[8:11], s50 offen lds
    s_add_u32 s50, s50, s51
    s_add_u32 m0, s52, 7168
    s_nop 0
    buffer_load_dwordx4 v11, s[8:11], s50 offen lds
    s_add_u32 s50, s50, s51
    s_add_u32 m0, s52, 8192
    s_nop 0
    buffer_load_dwordx4 v10, s[8:11], s50 offen lds
    s_add_u32 s50, s50, s51
    s_add_u32 m0, s52, 9216
    s_nop 0
    buffer_load_dwordx4 v10, s[8:11], s50 offen lds
    s_add_u32 s50, s50, s51
    s_add_u32 m0, s52, 10240
    s_nop 0
    buffer_load_dwordx4 v11, s[8:11], s50 offen lds
    s_add_u32 s50, s50, s51
    s_add_u32 m0, s52, 11264
    s_nop 0
    buffer_load_dwordx4 v11, s[8:11], s50 offen lds
    s_add_u32 s50, s50, s51
    s_add_u32 m0, s52, 12288
    s_nop 0
    buffer_load_dwordx4 v10, s[8:11], s50 offen lds
    s_add_u32 s50, s50, s51
    s_add_u32 m0, s52, 13312
    s_nop 0
    buffer_load_dwordx4 v10, s[8:11], s50 offen lds
    s_add_u32 s50, s50, s51
    s_add_u32 m0, s52, 14336
    s_nop 0
    buffer_load_dwordx4 v11, s[8:11], s50 offen lds
    s_add_u32 s50, s50, s51
    s_add_u32 m0, s52, 15360
    s_nop 0
    buffer_load_dwordx4 v11, s[8:11], s50 offen lds
    s_add_u32 s50, s50, s51
    s_add_u32 m0, s52, 16384
    s_nop 0
    buffer_load_dwordx4 v10, s[8:11], s50 offen lds
    s_add_u32 s50, s50, s51
    s_add_u32 m0, s52, 17408
    s_nop 0
    buffer_load_dwordx4 v10, s[8:11], s50 offen lds
    s_add_u32 s50, s50, s51
    s_add_u32 m0, s52, 18432
    s_nop 0
    buffer_load_dwordx4 v11, s[8:11], s50 offen lds
    s_add_u32 s50, s50, s51
    s_add_u32 m0, s52, 19456
    s_nop 0
    buffer_load_dwordx4 v11, s[8:11], s50 offen lds
    s_add_u32 s50, s50, s51
    s_add_u32 m0, s52, 20480
    s_nop 0
    buffer_load_dwordx4 v10, s[8:11], s50 offen lds
    s_add_u32 s50, s50, s51
    s_add_u32 m0, s52, 21504
    s_nop 0
    buffer_load_dwordx4 v10, s[8:11], s50 offen lds
    s_add_u32 s50, s50, s51
    s_add_u32 m0, s52, 22528
    s_nop 0
    buffer_load_dwordx4 v11, s[8:11], s50 offen lds
    s_add_u32 s50, s50, s51
    s_add_u32 m0, s52, 23552
    s_nop 0
    buffer_load_dwordx4 v11, s[8:11], s50 offen lds
    s_add_u32 s50, s50, s51
    s_add_u32 m0, s52, 24576
    s_nop 0
    buffer_load_dwordx4 v10, s[8:11], s50 offen lds
    s_add_u32 s50, s50, s51
    s_add_u32 m0, s52, 25600
    s_nop 0
    buffer_load_dwordx4 v10, s[8:11], s50 offen lds
    s_add_u32 s50, s50, s51
    s_add_u32 m0, s52, 26624
    s_nop 0
    buffer_load_dwordx4 v11, s[8:11], s50 offen lds
    s_add_u32 s50, s50, s51
    s_add_u32 m0, s52, 27648
    s_nop 0
    buffer_load_dwordx4 v11, s[8:11], s50 offen lds
    s_add_u32 s50, s50, s51
    s_add_u32 m0, s52, 28672
    s_nop 0
    buffer_load_dwordx4 v10, s[8:11], s50 offen lds
    s_add_u32 s50, s50, s51
    s_add_u32 m0, s52, 29696
    s_nop 0
    buffer_load_dwordx4 v10, s[8:11], s50 offen lds
    s_add_u32 s50, s50, s51
    s_add_u32 m0, s52, 30720
    s_nop 0
    buffer_load_dwordx4 v11, s[8:11], s50 offen lds
    s_add_u32 s50, s50, s51
    s_add_u32 m0, s52, 31744
    s_nop 0
    buffer_load_dwordx4 v11, s[8:11], s50 offen lds
    s_add_u32 s50, s50, s51
    s_add_u32 m0, s52, 32768
    s_nop 0
    buffer_load_dwordx4 v10, s[8:11], s50 offen lds
    s_add_u32 s50, s50, s51
    s_add_u32 m0, s52, 33792
    s_nop 0
    buffer_load_dwordx4 v10, s[8:11], s50 offen lds
    s_add_u32 s50, s50, s51
    s_add_u32 m0, s52, 34816
    s_nop 0
    buffer_load_dwordx4 v11, s[8:11], s50 offen lds
    s_add_u32 s50, s50, s51
    s_add_u32 m0, s52, 35840
    s_nop 0
    buffer_load_dwordx4 v11, s[8:11], s50 offen lds
    s_add_u32 s50, s50, s51
    v_lshrrev_b32 v21, 4, v20
    v_lshrrev_b32 v22, 2, v20
    v_and_b32 v22, 3, v22
    v_and_b32 v23, 3, v20
    v_lshl_add_u32 v24, v21, 3, v22
    v_lshlrev_b32 v24, 8, v24
    v_and_b32 v25, 1, v21
    v_lshl_or_b32 v25, v25, 2, v22
    s_lshl_b32 s50, s31, 1
    v_lshrrev_b32 v26, 1, v23
    v_add_u32 v26, s50, v26
    v_xor_b32 v25, v26, v25
    v_lshlrev_b32 v25, 5, v25
    v_and_b32 v23, 1, v23
    v_lshlrev_b32 v23, 4, v23
    v_add3_u32 v5, v24, v25, v23
    v_add_u32 v6, 8, v5
    v_add_u32 v26, 0x10000, v5
    v_add_u32 v27, 0x10000, v6
    v_add_u32 v28, 0x20000, v5
    v_add_u32 v29, 0x20000, v6
    s_waitcnt vmcnt(0)
    s_barrier
    ds_read_b64_tr_b16 a[0:1], v5 offset:0
    ds_read_b64_tr_b16 a[2:3], v5 offset:1024
    ds_read_b64_tr_b16 a[72:73], v6 offset:0
    ds_read_b64_tr_b16 a[74:75], v6 offset:1024
    ds_read_b64_tr_b16 a[4:5], v5 offset:8192
    ds_read_b64_tr_b16 a[6:7], v5 offset:9216
    ds_read_b64_tr_b16 a[76:77], v6 offset:8192
    ds_read_b64_tr_b16 a[78:79], v6 offset:9216
    ds_read_b64_tr_b16 a[8:9], v5 offset:16384
    ds_read_b64_tr_b16 a[10:11], v5 offset:17408
    ds_read_b64_tr_b16 a[80:81], v6 offset:16384
    ds_read_b64_tr_b16 a[82:83], v6 offset:17408
    s_waitcnt lgkmcnt(0)
    ds_read_b64_tr_b16 a[12:13], v5 offset:24576
    ds_read_b64_tr_b16 a[14:15], v5 offset:25600
    ds_read_b64_tr_b16 a[84:85], v6 offset:24576
    ds_read_b64_tr_b16 a[86:87], v6 offset:25600
    ds_read_b64_tr_b16 a[16:17], v5 offset:32768
    ds_read_b64_tr_b16 a[18:19], v5 offset:33792
    ds_read_b64_tr_b16 a[88:89], v6 offset:32768
    ds_read_b64_tr_b16 a[90:91], v6 offset:33792
    ds_read_b64_tr_b16 a[20:21], v5 offset:40960
    ds_read_b64_tr_b16 a[22:23], v5 offset:41984
    ds_read_b64_tr_b16 a[92:93], v6 offset:40960
    ds_read_b64_tr_b16 a[94:95], v6 offset:41984
    s_waitcnt lgkmcnt(0)
    ds_read_b64_tr_b16 a[24:25], v5 offset:49152
    ds_read_b64_tr_b16 a[26:27], v5 offset:50176
    ds_read_b64_tr_b16 a[96:97], v6 offset:49152
    ds_read_b64_tr_b16 a[98:99], v6 offset:50176
    ds_read_b64_tr_b16 a[28:29], v5 offset:57344
    ds_read_b64_tr_b16 a[30:31], v5 offset:58368
    ds_read_b64_tr_b16 a[100:101], v6 offset:57344
    ds_read_b64_tr_b16 a[102:103], v6 offset:58368
    ds_read_b64_tr_b16 a[32:33], v26 offset:0
    ds_read_b64_tr_b16 a[34:35], v26 offset:1024
    ds_read_b64_tr_b16 a[104:105], v27 offset:0
    ds_read_b64_tr_b16 a[106:107], v27 offset:1024
    s_waitcnt lgkmcnt(0)
    ds_read_b64_tr_b16 a[36:37], v26 offset:8192
    ds_read_b64_tr_b16 a[38:39], v26 offset:9216
    ds_read_b64_tr_b16 a[108:109], v27 offset:8192
    ds_read_b64_tr_b16 a[110:111], v27 offset:9216
    ds_read_b64_tr_b16 a[40:41], v26 offset:16384
    ds_read_b64_tr_b16 a[42:43], v26 offset:17408
    ds_read_b64_tr_b16 a[112:113], v27 offset:16384
    ds_read_b64_tr_b16 a[114:115], v27 offset:17408
    ds_read_b64_tr_b16 a[44:45], v26 offset:24576
    ds_read_b64_tr_b16 a[46:47], v26 offset:25600
    ds_read_b64_tr_b16 a[116:117], v27 offset:24576
    ds_read_b64_tr_b16 a[118:119], v27 offset:25600
    s_waitcnt lgkmcnt(0)
    ds_read_b64_tr_b16 a[48:49], v26 offset:32768
    ds_read_b64_tr_b16 a[50:51], v26 offset:33792
    ds_read_b64_tr_b16 a[120:121], v27 offset:32768
    ds_read_b64_tr_b16 a[122:123], v27 offset:33792
    ds_read_b64_tr_b16 a[52:53], v26 offset:40960
    ds_read_b64_tr_b16 a[54:55], v26 offset:41984
    ds_read_b64_tr_b16 a[124:125], v27 offset:40960
    ds_read_b64_tr_b16 a[126:127], v27 offset:41984
    ds_read_b64_tr_b16 a[56:57], v26 offset:49152
    ds_read_b64_tr_b16 a[58:59], v26 offset:50176
    ds_read_b64_tr_b16 a[128:129], v27 offset:49152
    ds_read_b64_tr_b16 a[130:131], v27 offset:50176
    s_waitcnt lgkmcnt(0)
    ds_read_b64_tr_b16 a[60:61], v26 offset:57344
    ds_read_b64_tr_b16 a[62:63], v26 offset:58368
    ds_read_b64_tr_b16 a[132:133], v27 offset:57344
    ds_read_b64_tr_b16 a[134:135], v27 offset:58368
    ds_read_b64_tr_b16 a[64:65], v28 offset:0
    ds_read_b64_tr_b16 a[66:67], v28 offset:1024
    ds_read_b64_tr_b16 a[136:137], v29 offset:0
    ds_read_b64_tr_b16 a[138:139], v29 offset:1024
    ds_read_b64_tr_b16 a[68:69], v28 offset:8192
    ds_read_b64_tr_b16 a[70:71], v28 offset:9216
    ds_read_b64_tr_b16 a[140:141], v29 offset:8192
    ds_read_b64_tr_b16 a[142:143], v29 offset:9216
    s_waitcnt lgkmcnt(0)
    s_barrier
    s_mul_i32 s38, s34, 147456
    s_mul_i32 s50, s31, 36864
    s_add_u32 s38, s38, s50
    s_lshl_b32 s39, s31, 12
    s_mov_b32 s41, 0
    s_add_u32 s50, s38, 0
    s_add_u32 m0, s39, 0
    s_nop 0
    buffer_load_dwordx4 v1, s[12:15], s50 offen sc1 lds
    s_add_u32 s50, s38, 9216
    s_add_u32 m0, s39, 1024
    s_nop 0
    buffer_load_dwordx4 v2, s[12:15], s50 offen sc1 lds
    s_add_u32 s50, s38, 18432
    s_add_u32 m0, s39, 2048
    s_nop 0
    buffer_load_dwordx4 v1, s[12:15], s50 offen sc1 lds
    s_add_u32 s50, s38, 27648
    s_add_u32 m0, s39, 3072
    s_nop 0
    buffer_load_dwordx4 v2, s[12:15], s50 offen sc1 lds
    s_add_u32 s38, s38, 128
    s_add_u32 s39, s39, 16384
    s_and_b32 s39, s39, 0x1ffff
    s_add_u32 s50, s38, 0
    s_add_u32 m0, s39, 0
    s_nop 0
    buffer_load_dwordx4 v1, s[12:15], s50 offen sc1 lds
    s_add_u32 s50, s38, 9216
    s_add_u32 m0, s39, 1024
    s_nop 0
    buffer_load_dwordx4 v2, s[12:15], s50 offen sc1 lds
    s_add_u32 s50, s38, 18432
    s_add_u32 m0, s39, 2048
    s_nop 0
    buffer_load_dwordx4 v1, s[12:15], s50 offen sc1 lds
    s_add_u32 s50, s38, 27648
    s_add_u32 m0, s39, 3072
    s_nop 0
    buffer_load_dwordx4 v2, s[12:15], s50 offen sc1 lds
    s_add_u32 s38, s38, 128
    s_add_u32 s39, s39, 16384
    s_and_b32 s39, s39, 0x1ffff
    s_add_u32 s50, s38, 0
    s_add_u32 m0, s39, 0
    s_nop 0
    buffer_load_dwordx4 v1, s[12:15], s50 offen sc1 lds
    s_add_u32 s50, s38, 9216
    s_add_u32 m0, s39, 1024
    s_nop 0
    buffer_load_dwordx4 v2, s[12:15], s50 offen sc1 lds
    s_add_u32 s50, s38, 18432
    s_add_u32 m0, s39, 2048
    s_nop 0
    buffer_load_dwordx4 v1, s[12:15], s50 offen sc1 lds
    s_add_u32 s50, s38, 27648
    s_add_u32 m0, s39, 3072
    s_nop 0
    buffer_load_dwordx4 v2, s[12:15], s50 offen sc1 lds
    s_add_u32 s38, s38, 128
    s_add_u32 s39, s39, 16384
    s_and_b32 s39, s39, 0x1ffff
    s_add_u32 s50, s38, 0
    s_add_u32 m0, s39, 0
    s_nop 0
    buffer_load_dwordx4 v1, s[12:15], s50 offen sc1 lds
    s_add_u32 s50, s38, 9216
    s_add_u32 m0, s39, 1024
    s_nop 0
    buffer_load_dwordx4 v2, s[12:15], s50 offen sc1 lds
    s_add_u32 s50, s38, 18432
    s_add_u32 m0, s39, 2048
    s_nop 0
    buffer_load_dwordx4 v1, s[12:15], s50 offen sc1 lds
    s_add_u32 s50, s38, 27648
    s_add_u32 m0, s39, 3072
    s_nop 0
    buffer_load_dwordx4 v2, s[12:15], s50 offen sc1 lds
    s_add_u32 s38, s38, 128
    s_add_u32 s39, s39, 16384
    s_and_b32 s39, s39, 0x1ffff
    s_add_u32 s50, s38, 0
    s_add_u32 m0, s39, 0
    s_nop 0
    buffer_load_dwordx4 v1, s[12:15], s50 offen sc1 lds
    s_add_u32 s50, s38, 9216
    s_add_u32 m0, s39, 1024
    s_nop 0
    buffer_load_dwordx4 v2, s[12:15], s50 offen sc1 lds
    s_add_u32 s50, s38, 18432
    s_add_u32 m0, s39, 2048
    s_nop 0
    buffer_load_dwordx4 v1, s[12:15], s50 offen sc1 lds
    s_add_u32 s50, s38, 27648
    s_add_u32 m0, s39, 3072
    s_nop 0
    buffer_load_dwordx4 v2, s[12:15], s50 offen sc1 lds
    s_add_u32 s38, s38, 128
    s_add_u32 s39, s39, 16384
    s_and_b32 s39, s39, 0x1ffff
    s_add_u32 s50, s38, 0
    s_add_u32 m0, s39, 0
    s_nop 0
    buffer_load_dwordx4 v1, s[12:15], s50 offen sc1 lds
    s_add_u32 s50, s38, 9216
    s_add_u32 m0, s39, 1024
    s_nop 0
    buffer_load_dwordx4 v2, s[12:15], s50 offen sc1 lds
    s_add_u32 s50, s38, 18432
    s_add_u32 m0, s39, 2048
    s_nop 0
    buffer_load_dwordx4 v1, s[12:15], s50 offen sc1 lds
    s_add_u32 s50, s38, 27648
    s_add_u32 m0, s39, 3072
    s_nop 0
    buffer_load_dwordx4 v2, s[12:15], s50 offen sc1 lds
    s_add_u32 s38, s38, 128
    s_add_u32 s39, s39, 16384
    s_and_b32 s39, s39, 0x1ffff
    s_waitcnt vmcnt(0)
BL4_BLK:
    s_waitcnt vmcnt(28)
    s_barrier
    s_add_u32 s50, s38, 0
    s_add_u32 m0, s39, 0
    s_nop 0
    buffer_load_dwordx4 v1, s[12:15], s50 offen sc1 lds
    s_add_u32 s50, s38, 9216
    s_add_u32 m0, s39, 1024
    s_nop 0
    buffer_load_dwordx4 v2, s[12:15], s50 offen sc1 lds
    s_add_u32 s50, s38, 18432
    s_add_u32 m0, s39, 2048
    s_nop 0
    buffer_load_dwordx4 v1, s[12:15], s50 offen sc1 lds
    s_add_u32 s50, s38, 27648
    s_add_u32 m0, s39, 3072
    s_nop 0
    buffer_load_dwordx4 v2, s[12:15], s50 offen sc1 lds
    s_add_u32 s38, s38, 128
    s_add_u32 s39, s39, 16384
    s_and_b32 s39, s39, 0x1ffff
    v_add_u32 v7, s41, v3
    v_add_u32 v8, s41, v4
    s_add_u32 s41, s41, 16384
    s_and_b32 s41, s41, 0x1ffff
    ds_read_b128 v[80:83], v7 offset:0
    ds_read_b128 v[84:87], v7 offset:2048
    ds_read_b128 v[88:91], v7 offset:4096
    ds_read_b128 v[92:95], v7 offset:6144
    ds_read_b128 v[96:99], v7 offset:8192
    ds_read_b128 v[100:103], v7 offset:10240
    ds_read_b128 v[104:107], v7 offset:12288
    ds_read_b128 v[108:111], v7 offset:14336
    s_waitcnt lgkmcnt(7)
    v_mfma_f32_16x16x32_bf16 v[16:19], a[0:3], v[80:83], 0
    v_mfma_f32_16x16x32_bf16 v[20:23], a[72:75], v[80:83], 0
    ds_read_b128 v[112:115], v8 offset:0
    s_waitcnt lgkmcnt(7)
    v_mfma_f32_16x16x32_bf16 v[24:27], a[0:3], v[84:87], 0
    v_mfma_f32_16x16x32_bf16 v[28:31], a[72:75], v[84:87], 0
    ds_read_b128 v[116:119], v8 offset:2048
    s_waitcnt lgkmcnt(7)
    v_mfma_f32_16x16x32_bf16 v[32:35], a[0:3], v[88:91], 0
    v_mfma_f32_16x16x32_bf16 v[36:39], a[72:75], v[88:91], 0
    ds_read_b128 v[120:123], v8 offset:4096
    s_waitcnt lgkmcnt(7)
    v_mfma_f32_16x16x32_bf16 v[40:43], a[0:3], v[92:95], 0
    v_mfma_f32_16x16x32_bf16 v[44:47], a[72:75], v[92:95], 0
    ds_read_b128 v[124:127], v8 offset:6144
    s_waitcnt lgkmcnt(7)
    v_mfma_f32_16x16x32_bf16 v[48:51], a[0:3], v[96:99], 0
    v_mfma_f32_16x16x32_bf16 v[52:55], a[72:75], v[96:99], 0
    ds_read_b128 v[128:131], v8 offset:8192
    s_waitcnt lgkmcnt(7)
    v_mfma_f32_16x16x32_bf16 v[56:59], a[0:3], v[100:103], 0
    v_mfma_f32_16x16x32_bf16 v[60:63], a[72:75], v[100:103], 0
    ds_read_b128 v[132:135], v8 offset:10240
    s_waitcnt lgkmcnt(7)
    v_mfma_f32_16x16x32_bf16 v[64:67], a[0:3], v[104:107], 0
    v_mfma_f32_16x16x32_bf16 v[68:71], a[72:75], v[104:107], 0
    ds_read_b128 v[136:139], v8 offset:12288
    s_waitcnt lgkmcnt(7)
    v_mfma_f32_16x16x32_bf16 v[72:75], a[0:3], v[108:111], 0
    v_mfma_f32_16x16x32_bf16 v[76:79], a[72:75], v[108:111], 0
    ds_read_b128 v[140:143], v8 offset:14336
    s_waitcnt lgkmcnt(7)
    v_mfma_f32_16x16x32_bf16 v[16:19], a[4:7], v[112:115], v[16:19]
    v_mfma_f32_16x16x32_bf16 v[20:23], a[76:79], v[112:115], v[20:23]
    s_waitcnt lgkmcnt(6)
    v_mfma_f32_16x16x32_bf16 v[24:27], a[4:7], v[116:119], v[24:27]
    v_mfma_f32_16x16x32_bf16 v[28:31], a[76:79], v[116:119], v[28:31]
    s_waitcnt lgkmcnt(5)
    v_mfma_f32_16x16x32_bf16 v[32:35], a[4:7], v[120:123], v[32:35]
    v_mfma_f32_16x16x32_bf16 v[36:39], a[76:79], v[120:123], v[36:39]
    s_waitcnt lgkmcnt(4)
    v_mfma_f32_16x16x32_bf16 v[40:43], a[4:7], v[124:127], v[40:43]
    v_mfma_f32_16x16x32_bf16 v[44:47], a[76:79], v[124:127], v[44:47]
    s_waitcnt lgkmcnt(3)
    v_mfma_f32_16x16x32_bf16 v[48:51], a[4:7], v[128:131], v[48:51]
    v_mfma_f32_16x16x32_bf16 v[52:55], a[76:79], v[128:131], v[52:55]
    s_waitcnt lgkmcnt(2)
    v_mfma_f32_16x16x32_bf16 v[56:59], a[4:7], v[132:135], v[56:59]
    v_mfma_f32_16x16x32_bf16 v[60:63], a[76:79], v[132:135], v[60:63]
    s_waitcnt lgkmcnt(1)
    v_mfma_f32_16x16x32_bf16 v[64:67], a[4:7], v[136:139], v[64:67]
    v_mfma_f32_16x16x32_bf16 v[68:71], a[76:79], v[136:139], v[68:71]
    s_waitcnt lgkmcnt(0)
    v_mfma_f32_16x16x32_bf16 v[72:75], a[4:7], v[140:143], v[72:75]
    v_mfma_f32_16x16x32_bf16 v[76:79], a[76:79], v[140:143], v[76:79]
    s_waitcnt vmcnt(28)
    s_barrier
    s_add_u32 s50, s38, 0
    s_add_u32 m0, s39, 0
    s_nop 0
    buffer_load_dwordx4 v1, s[12:15], s50 offen sc1 lds
    s_add_u32 s50, s38, 9216
    s_add_u32 m0, s39, 1024
    s_nop 0
    buffer_load_dwordx4 v2, s[12:15], s50 offen sc1 lds
    s_add_u32 s50, s38, 18432
    s_add_u32 m0, s39, 2048
    s_nop 0
    buffer_load_dwordx4 v1, s[12:15], s50 offen sc1 lds
    s_add_u32 s50, s38, 27648
    s_add_u32 m0, s39, 3072
    s_nop 0
    buffer_load_dwordx4 v2, s[12:15], s50 offen sc1 lds
    s_add_u32 s38, s38, 128
    s_add_u32 s39, s39, 16384
    s_and_b32 s39, s39, 0x1ffff
    v_add_u32 v7, s41, v3
    v_add_u32 v8, s41, v4
    s_add_u32 s41, s41, 16384
    s_and_b32 s41, s41, 0x1ffff
    ds_read_b128 v[80:83], v7 offset:0
    ds_read_b128 v[84:87], v7 offset:2048
    ds_read_b128 v[88:91], v7 offset:4096
    ds_read_b128 v[92:95], v7 offset:6144
    ds_read_b128 v[96:99], v7 offset:8192
    ds_read_b128 v[100:103], v7 offset:10240
    ds_read_b128 v[104:107], v7 offset:12288
    ds_read_b128 v[108:111], v7 offset:14336
    s_waitcnt lgkmcnt(7)
    v_mfma_f32_16x16x32_bf16 v[16:19], a[8:11], v[80:83], v[16:19]
    v_mfma_f32_16x16x32_bf16 v[20:23], a[80:83], v[80:83], v[20:23]
    ds_read_b128 v[112:115], v8 offset:0
    s_waitcnt lgkmcnt(7)
    v_mfma_f32_16x16x32_bf16 v[24:27], a[8:11], v[84:87], v[24:27]
    v_mfma_f32_16x16x32_bf16 v[28:31], a[80:83], v[84:87], v[28:31]
    ds_read_b128 v[116:119], v8 offset:2048
    s_waitcnt lgkmcnt(7)
    v_mfma_f32_16x16x32_bf16 v[32:35], a[8:11], v[88:91], v[32:35]
    v_mfma_f32_16x16x32_bf16 v[36:39], a[80:83], v[88:91], v[36:39]
    ds_read_b128 v[120:123], v8 offset:4096
    s_waitcnt lgkmcnt(7)
    v_mfma_f32_16x16x32_bf16 v[40:43], a[8:11], v[92:95], v[40:43]
    v_mfma_f32_16x16x32_bf16 v[44:47], a[80:83], v[92:95], v[44:47]
    ds_read_b128 v[124:127], v8 offset:6144
    s_waitcnt lgkmcnt(7)
    v_mfma_f32_16x16x32_bf16 v[48:51], a[8:11], v[96:99], v[48:51]
    v_mfma_f32_16x16x32_bf16 v[52:55], a[80:83], v[96:99], v[52:55]
    ds_read_b128 v[128:131], v8 offset:8192
    s_waitcnt lgkmcnt(7)
    v_mfma_f32_16x16x32_bf16 v[56:59], a[8:11], v[100:103], v[56:59]
    v_mfma_f32_16x16x32_bf16 v[60:63], a[80:83], v[100:103], v[60:63]
    ds_read_b128 v[132:135], v8 offset:10240
    s_waitcnt lgkmcnt(7)
    v_mfma_f32_16x16x32_bf16 v[64:67], a[8:11], v[104:107], v[64:67]
    v_mfma_f32_16x16x32_bf16 v[68:71], a[80:83], v[104:107], v[68:71]
    ds_read_b128 v[136:139], v8 offset:12288
    s_waitcnt lgkmcnt(7)
    v_mfma_f32_16x16x32_bf16 v[72:75], a[8:11], v[108:111], v[72:75]
    v_mfma_f32_16x16x32_bf16 v[76:79], a[80:83], v[108:111], v[76:79]
    ds_read_b128 v[140:143], v8 offset:14336
    s_waitcnt lgkmcnt(7)
    v_mfma_f32_16x16x32_bf16 v[16:19], a[12:15], v[112:115], v[16:19]
    v_mfma_f32_16x16x32_bf16 v[20:23], a[84:87], v[112:115], v[20:23]
    s_waitcnt lgkmcnt(6)
    v_mfma_f32_16x16x32_bf16 v[24:27], a[12:15], v[116:119], v[24:27]
    v_mfma_f32_16x16x32_bf16 v[28:31], a[84:87], v[116:119], v[28:31]
    s_waitcnt lgkmcnt(5)
    v_mfma_f32_16x16x32_bf16 v[32:35], a[12:15], v[120:123], v[32:35]
    v_mfma_f32_16x16x32_bf16 v[36:39], a[84:87], v[120:123], v[36:39]
    s_waitcnt lgkmcnt(4)
    v_mfma_f32_16x16x32_bf16 v[40:43], a[12:15], v[124:127], v[40:43]
    v_mfma_f32_16x16x32_bf16 v[44:47], a[84:87], v[124:127], v[44:47]
    s_waitcnt lgkmcnt(3)
    v_mfma_f32_16x16x32_bf16 v[48:51], a[12:15], v[128:131], v[48:51]
    v_mfma_f32_16x16x32_bf16 v[52:55], a[84:87], v[128:131], v[52:55]
    s_waitcnt lgkmcnt(2)
    v_mfma_f32_16x16x32_bf16 v[56:59], a[12:15], v[132:135], v[56:59]
    v_mfma_f32_16x16x32_bf16 v[60:63], a[84:87], v[132:135], v[60:63]
    s_waitcnt lgkmcnt(1)
    v_mfma_f32_16x16x32_bf16 v[64:67], a[12:15], v[136:139], v[64:67]
    v_mfma_f32_16x16x32_bf16 v[68:71], a[84:87], v[136:139], v[68:71]
    s_waitcnt lgkmcnt(0)
    v_mfma_f32_16x16x32_bf16 v[72:75], a[12:15], v[140:143], v[72:75]
    v_mfma_f32_16x16x32_bf16 v[76:79], a[84:87], v[140:143], v[76:79]
    s_waitcnt vmcnt(28)
    s_barrier
    s_add_u32 s50, s38, 0
    s_add_u32 m0, s39, 0
    s_nop 0
    buffer_load_dwordx4 v1, s[12:15], s50 offen sc1 lds
    s_add_u32 s50, s38, 9216
    s_add_u32 m0, s39, 1024
    s_nop 0
    buffer_load_dwordx4 v2, s[12:15], s50 offen sc1 lds
    s_add_u32 s50, s38, 18432
    s_add_u32 m0, s39, 2048
    s_nop 0
    buffer_load_dwordx4 v1, s[12:15], s50 offen sc1 lds
    s_add_u32 s50, s38, 27648
    s_add_u32 m0, s39, 3072
    s_nop 0
    buffer_load_dwordx4 v2, s[12:15], s50 offen sc1 lds
    s_add_u32 s38, s38, 146432
    s_add_u32 s39, s39, 16384
    s_and_b32 s39, s39, 0x1ffff
    v_add_u32 v7, s41, v3
    v_add_u32 v8, s41, v4
    s_add_u32 s41, s41, 16384
    s_and_b32 s41, s41, 0x1ffff
    ds_read_b128 v[80:83], v7 offset:0
    ds_read_b128 v[84:87], v7 offset:2048
    ds_read_b128 v[88:91], v7 offset:4096
    ds_read_b128 v[92:95], v7 offset:6144
    ds_read_b128 v[96:99], v7 offset:8192
    ds_read_b128 v[100:103], v7 offset:10240
    ds_read_b128 v[104:107], v7 offset:12288
    ds_read_b128 v[108:111], v7 offset:14336
    s_waitcnt lgkmcnt(7)
    v_mfma_f32_16x16x32_bf16 v[16:19], a[16:19], v[80:83], v[16:19]
    v_mfma_f32_16x16x32_bf16 v[20:23], a[88:91], v[80:83], v[20:23]
    ds_read_b128 v[112:115], v8 offset:0
    s_waitcnt lgkmcnt(7)
    v_mfma_f32_16x16x32_bf16 v[24:27], a[16:19], v[84:87], v[24:27]
    v_mfma_f32_16x16x32_bf16 v[28:31], a[88:91], v[84:87], v[28:31]
    ds_read_b128 v[116:119], v8 offset:2048
    s_waitcnt lgkmcnt(7)
    v_mfma_f32_16x16x32_bf16 v[32:35], a[16:19], v[88:91], v[32:35]
    v_mfma_f32_16x16x32_bf16 v[36:39], a[88:91], v[88:91], v[36:39]
    ds_read_b128 v[120:123], v8 offset:4096
    s_waitcnt lgkmcnt(7)
    v_mfma_f32_16x16x32_bf16 v[40:43], a[16:19], v[92:95], v[40:43]
    v_mfma_f32_16x16x32_bf16 v[44:47], a[88:91], v[92:95], v[44:47]
    ds_read_b128 v[124:127], v8 offset:6144
    s_waitcnt lgkmcnt(7)
    v_mfma_f32_16x16x32_bf16 v[48:51], a[16:19], v[96:99], v[48:51]
    v_mfma_f32_16x16x32_bf16 v[52:55], a[88:91], v[96:99], v[52:55]
    ds_read_b128 v[128:131], v8 offset:8192
    s_waitcnt lgkmcnt(7)
    v_mfma_f32_16x16x32_bf16 v[56:59], a[16:19], v[100:103], v[56:59]
    v_mfma_f32_16x16x32_bf16 v[60:63], a[88:91], v[100:103], v[60:63]
    ds_read_b128 v[132:135], v8 offset:10240
    s_waitcnt lgkmcnt(7)
    v_mfma_f32_16x16x32_bf16 v[64:67], a[16:19], v[104:107], v[64:67]
    v_mfma_f32_16x16x32_bf16 v[68:71], a[88:91], v[104:107], v[68:71]
    ds_read_b128 v[136:139], v8 offset:12288
    s_waitcnt lgkmcnt(7)
    v_mfma_f32_16x16x32_bf16 v[72:75], a[16:19], v[108:111], v[72:75]
    v_mfma_f32_16x16x32_bf16 v[76:79], a[88:91], v[108:111], v[76:79]
    ds_read_b128 v[140:143], v8 offset:14336
    s_waitcnt lgkmcnt(7)
    v_mfma_f32_16x16x32_bf16 v[16:19], a[20:23], v[112:115], v[16:19]
    v_mfma_f32_16x16x32_bf16 v[20:23], a[92:95], v[112:115], v[20:23]
    s_waitcnt lgkmcnt(6)
    v_mfma_f32_16x16x32_bf16 v[24:27], a[20:23], v[116:119], v[24:27]
    v_mfma_f32_16x16x32_bf16 v[28:31], a[92:95], v[116:119], v[28:31]
    s_waitcnt lgkmcnt(5)
    v_mfma_f32_16x16x32_bf16 v[32:35], a[20:23], v[120:123], v[32:35]
    v_mfma_f32_16x16x32_bf16 v[36:39], a[92:95], v[120:123], v[36:39]
    s_waitcnt lgkmcnt(4)
    v_mfma_f32_16x16x32_bf16 v[40:43], a[20:23], v[124:127], v[40:43]
    v_mfma_f32_16x16x32_bf16 v[44:47], a[92:95], v[124:127], v[44:47]
    s_waitcnt lgkmcnt(3)
    v_mfma_f32_16x16x32_bf16 v[48:51], a[20:23], v[128:131], v[48:51]
    v_mfma_f32_16x16x32_bf16 v[52:55], a[92:95], v[128:131], v[52:55]
    s_waitcnt lgkmcnt(2)
    v_mfma_f32_16x16x32_bf16 v[56:59], a[20:23], v[132:135], v[56:59]
    v_mfma_f32_16x16x32_bf16 v[60:63], a[92:95], v[132:135], v[60:63]
    s_waitcnt lgkmcnt(1)
    v_mfma_f32_16x16x32_bf16 v[64:67], a[20:23], v[136:139], v[64:67]
    v_mfma_f32_16x16x32_bf16 v[68:71], a[92:95], v[136:139], v[68:71]
    s_waitcnt lgkmcnt(0)
    v_mfma_f32_16x16x32_bf16 v[72:75], a[20:23], v[140:143], v[72:75]
    v_mfma_f32_16x16x32_bf16 v[76:79], a[92:95], v[140:143], v[76:79]
    s_waitcnt vmcnt(28)
    s_barrier
    s_add_u32 s50, s38, 0
    s_add_u32 m0, s39, 0
    s_nop 0
    buffer_load_dwordx4 v1, s[12:15], s50 offen sc1 lds
    s_add_u32 s50, s38, 9216
    s_add_u32 m0, s39, 1024
    s_nop 0
    buffer_load_dwordx4 v2, s[12:15], s50 offen sc1 lds
    s_add_u32 s50, s38, 18432
    s_add_u32 m0, s39, 2048
    s_nop 0
    buffer_load_dwordx4 v1, s[12:15], s50 offen sc1 lds
    s_add_u32 s50, s38, 27648
    s_add_u32 m0, s39, 3072
    s_nop 0
    buffer_load_dwordx4 v2, s[12:15], s50 offen sc1 lds
    s_add_u32 s38, s38, 128
    s_add_u32 s39, s39, 16384
    s_and_b32 s39, s39, 0x1ffff
    v_add_u32 v7, s41, v3
    v_add_u32 v8, s41, v4
    s_add_u32 s41, s41, 16384
    s_and_b32 s41, s41, 0x1ffff
    ds_read_b128 v[80:83], v7 offset:0
    ds_read_b128 v[84:87], v7 offset:2048
    ds_read_b128 v[88:91], v7 offset:4096
    ds_read_b128 v[92:95], v7 offset:6144
    ds_read_b128 v[96:99], v7 offset:8192
    ds_read_b128 v[100:103], v7 offset:10240
    ds_read_b128 v[104:107], v7 offset:12288
    ds_read_b128 v[108:111], v7 offset:14336
    s_waitcnt lgkmcnt(7)
    v_mfma_f32_16x16x32_bf16 v[16:19], a[24:27], v[80:83], v[16:19]
    v_mfma_f32_16x16x32_bf16 v[20:23], a[96:99], v[80:83], v[20:23]
    ds_read_b128 v[112:115], v8 offset:0
    s_waitcnt lgkmcnt(7)
    v_mfma_f32_16x16x32_bf16 v[24:27], a[24:27], v[84:87], v[24:27]
    v_mfma_f32_16x16x32_bf16 v[28:31], a[96:99], v[84:87], v[28:31]
    ds_read_b128 v[116:119], v8 offset:2048
    s_waitcnt lgkmcnt(7)
    v_mfma_f32_16x16x32_bf16 v[32:35], a[24:27], v[88:91], v[32:35]
    v_mfma_f32_16x16x32_bf16 v[36:39], a[96:99], v[88:91], v[36:39]
    ds_read_b128 v[120:123], v8 offset:4096
    s_waitcnt lgkmcnt(7)
    v_mfma_f32_16x16x32_bf16 v[40:43], a[24:27], v[92:95], v[40:43]
    v_mfma_f32_16x16x32_bf16 v[44:47], a[96:99], v[92:95], v[44:47]
    ds_read_b128 v[124:127], v8 offset:6144
    s_waitcnt lgkmcnt(7)
    v_mfma_f32_16x16x32_bf16 v[48:51], a[24:27], v[96:99], v[48:51]
    v_mfma_f32_16x16x32_bf16 v[52:55], a[96:99], v[96:99], v[52:55]
    ds_read_b128 v[128:131], v8 offset:8192
    s_waitcnt lgkmcnt(7)
    v_mfma_f32_16x16x32_bf16 v[56:59], a[24:27], v[100:103], v[56:59]
    v_mfma_f32_16x16x32_bf16 v[60:63], a[96:99], v[100:103], v[60:63]
    ds_read_b128 v[132:135], v8 offset:10240
    s_waitcnt lgkmcnt(7)
    v_mfma_f32_16x16x32_bf16 v[64:67], a[24:27], v[104:107], v[64:67]
    v_mfma_f32_16x16x32_bf16 v[68:71], a[96:99], v[104:107], v[68:71]
    ds_read_b128 v[136:139], v8 offset:12288
    s_waitcnt lgkmcnt(7)
    v_mfma_f32_16x16x32_bf16 v[72:75], a[24:27], v[108:111], v[72:75]
    v_mfma_f32_16x16x32_bf16 v[76:79], a[96:99], v[108:111], v[76:79]
    ds_read_b128 v[140:143], v8 offset:14336
    s_waitcnt lgkmcnt(7)
    v_mfma_f32_16x16x32_bf16 v[16:19], a[28:31], v[112:115], v[16:19]
    v_mfma_f32_16x16x32_bf16 v[20:23], a[100:103], v[112:115], v[20:23]
    s_waitcnt lgkmcnt(6)
    v_mfma_f32_16x16x32_bf16 v[24:27], a[28:31], v[116:119], v[24:27]
    v_mfma_f32_16x16x32_bf16 v[28:31], a[100:103], v[116:119], v[28:31]
    s_waitcnt lgkmcnt(5)
    v_mfma_f32_16x16x32_bf16 v[32:35], a[28:31], v[120:123], v[32:35]
    v_mfma_f32_16x16x32_bf16 v[36:39], a[100:103], v[120:123], v[36:39]
    s_waitcnt lgkmcnt(4)
    v_mfma_f32_16x16x32_bf16 v[40:43], a[28:31], v[124:127], v[40:43]
    v_mfma_f32_16x16x32_bf16 v[44:47], a[100:103], v[124:127], v[44:47]
    s_waitcnt lgkmcnt(3)
    v_mfma_f32_16x16x32_bf16 v[48:51], a[28:31], v[128:131], v[48:51]
    v_mfma_f32_16x16x32_bf16 v[52:55], a[100:103], v[128:131], v[52:55]
    s_waitcnt lgkmcnt(2)
    v_mfma_f32_16x16x32_bf16 v[56:59], a[28:31], v[132:135], v[56:59]
    v_mfma_f32_16x16x32_bf16 v[60:63], a[100:103], v[132:135], v[60:63]
    s_waitcnt lgkmcnt(1)
    v_mfma_f32_16x16x32_bf16 v[64:67], a[28:31], v[136:139], v[64:67]
    v_mfma_f32_16x16x32_bf16 v[68:71], a[100:103], v[136:139], v[68:71]
    s_waitcnt lgkmcnt(0)
    v_mfma_f32_16x16x32_bf16 v[72:75], a[28:31], v[140:143], v[72:75]
    v_mfma_f32_16x16x32_bf16 v[76:79], a[100:103], v[140:143], v[76:79]
    s_waitcnt vmcnt(28)
    s_barrier
    s_add_u32 s50, s38, 0
    s_add_u32 m0, s39, 0
    s_nop 0
    buffer_load_dwordx4 v1, s[12:15], s50 offen sc1 lds
    s_add_u32 s50, s38, 9216
    s_add_u32 m0, s39, 1024
    s_nop 0
    buffer_load_dwordx4 v2, s[12:15], s50 offen sc1 lds
    s_add_u32 s50, s38, 18432
    s_add_u32 m0, s39, 2048
    s_nop 0
    buffer_load_dwordx4 v1, s[12:15], s50 offen sc1 lds
    s_add_u32 s50, s38, 27648
    s_add_u32 m0, s39, 3072
    s_nop 0
    buffer_load_dwordx4 v2, s[12:15], s50 offen sc1 lds
    s_add_u32 s38, s38, 128
    s_add_u32 s39, s39, 16384
    s_and_b32 s39, s39, 0x1ffff
    v_add_u32 v7, s41, v3
    v_add_u32 v8, s41, v4
    s_add_u32 s41, s41, 16384
    s_and_b32 s41, s41, 0x1ffff
    ds_read_b128 v[80:83], v7 offset:0
    ds_read_b128 v[84:87], v7 offset:2048
    ds_read_b128 v[88:91], v7 offset:4096
    ds_read_b128 v[92:95], v7 offset:6144
    ds_read_b128 v[96:99], v7 offset:8192
    ds_read_b128 v[100:103], v7 offset:10240
    ds_read_b128 v[104:107], v7 offset:12288
    ds_read_b128 v[108:111], v7 offset:14336
    s_waitcnt lgkmcnt(7)
    v_mfma_f32_16x16x32_bf16 v[16:19], a[32:35], v[80:83], v[16:19]
    v_mfma_f32_16x16x32_bf16 v[20:23], a[104:107], v[80:83], v[20:23]
    ds_read_b128 v[112:115], v8 offset:0
    s_waitcnt lgkmcnt(7)
    v_mfma_f32_16x16x32_bf16 v[24:27], a[32:35], v[84:87], v[24:27]
    v_mfma_f32_16x16x32_bf16 v[28:31], a[104:107], v[84:87], v[28:31]
    ds_read_b128 v[116:119], v8 offset:2048
    s_waitcnt lgkmcnt(7)
    v_mfma_f32_16x16x32_bf16 v[32:35], a[32:35], v[88:91], v[32:35]
    v_mfma_f32_16x16x32_bf16 v[36:39], a[104:107], v[88:91], v[36:39]
    ds_read_b128 v[120:123], v8 offset:4096
    s_waitcnt lgkmcnt(7)
    v_mfma_f32_16x16x32_bf16 v[40:43], a[32:35], v[92:95], v[40:43]
    v_mfma_f32_16x16x32_bf16 v[44:47], a[104:107], v[92:95], v[44:47]
    ds_read_b128 v[124:127], v8 offset:6144
    s_waitcnt lgkmcnt(7)
    v_mfma_f32_16x16x32_bf16 v[48:51], a[32:35], v[96:99], v[48:51]
    v_mfma_f32_16x16x32_bf16 v[52:55], a[104:107], v[96:99], v[52:55]
    ds_read_b128 v[128:131], v8 offset:8192
    s_waitcnt lgkmcnt(7)
    v_mfma_f32_16x16x32_bf16 v[56:59], a[32:35], v[100:103], v[56:59]
    v_mfma_f32_16x16x32_bf16 v[60:63], a[104:107], v[100:103], v[60:63]
    ds_read_b128 v[132:135], v8 offset:10240
    s_waitcnt lgkmcnt(7)
    v_mfma_f32_16x16x32_bf16 v[64:67], a[32:35], v[104:107], v[64:67]
    v_mfma_f32_16x16x32_bf16 v[68:71], a[104:107], v[104:107], v[68:71]
    ds_read_b128 v[136:139], v8 offset:12288
    s_waitcnt lgkmcnt(7)
    v_mfma_f32_16x16x32_bf16 v[72:75], a[32:35], v[108:111], v[72:75]
    v_mfma_f32_16x16x32_bf16 v[76:79], a[104:107], v[108:111], v[76:79]
    ds_read_b128 v[140:143], v8 offset:14336
    s_waitcnt lgkmcnt(7)
    v_mfma_f32_16x16x32_bf16 v[16:19], a[36:39], v[112:115], v[16:19]
    v_mfma_f32_16x16x32_bf16 v[20:23], a[108:111], v[112:115], v[20:23]
    s_waitcnt lgkmcnt(6)
    v_mfma_f32_16x16x32_bf16 v[24:27], a[36:39], v[116:119], v[24:27]
    v_mfma_f32_16x16x32_bf16 v[28:31], a[108:111], v[116:119], v[28:31]
    s_waitcnt lgkmcnt(5)
    v_mfma_f32_16x16x32_bf16 v[32:35], a[36:39], v[120:123], v[32:35]
    v_mfma_f32_16x16x32_bf16 v[36:39], a[108:111], v[120:123], v[36:39]
    s_waitcnt lgkmcnt(4)
    v_mfma_f32_16x16x32_bf16 v[40:43], a[36:39], v[124:127], v[40:43]
    v_mfma_f32_16x16x32_bf16 v[44:47], a[108:111], v[124:127], v[44:47]
    s_waitcnt lgkmcnt(3)
    v_mfma_f32_16x16x32_bf16 v[48:51], a[36:39], v[128:131], v[48:51]
    v_mfma_f32_16x16x32_bf16 v[52:55], a[108:111], v[128:131], v[52:55]
    s_waitcnt lgkmcnt(2)
    v_mfma_f32_16x16x32_bf16 v[56:59], a[36:39], v[132:135], v[56:59]
    v_mfma_f32_16x16x32_bf16 v[60:63], a[108:111], v[132:135], v[60:63]
    s_waitcnt lgkmcnt(1)
    v_mfma_f32_16x16x32_bf16 v[64:67], a[36:39], v[136:139], v[64:67]
    v_mfma_f32_16x16x32_bf16 v[68:71], a[108:111], v[136:139], v[68:71]
    s_waitcnt lgkmcnt(0)
    v_mfma_f32_16x16x32_bf16 v[72:75], a[36:39], v[140:143], v[72:75]
    v_mfma_f32_16x16x32_bf16 v[76:79], a[108:111], v[140:143], v[76:79]
    s_waitcnt vmcnt(28)
    s_barrier
    s_add_u32 s50, s38, 0
    s_add_u32 m0, s39, 0
    s_nop 0
    buffer_load_dwordx4 v1, s[12:15], s50 offen sc1 lds
    s_add_u32 s50, s38, 9216
    s_add_u32 m0, s39, 1024
    s_nop 0
    buffer_load_dwordx4 v2, s[12:15], s50 offen sc1 lds
    s_add_u32 s50, s38, 18432
    s_add_u32 m0, s39, 2048
    s_nop 0
    buffer_load_dwordx4 v1, s[12:15], s50 offen sc1 lds
    s_add_u32 s50, s38, 27648
    s_add_u32 m0, s39, 3072
    s_nop 0
    buffer_load_dwordx4 v2, s[12:15], s50 offen sc1 lds
    s_add_u32 s38, s38, 128
    s_add_u32 s39, s39, 16384
    s_and_b32 s39, s39, 0x1ffff
    v_add_u32 v7, s41, v3
    v_add_u32 v8, s41, v4
    s_add_u32 s41, s41, 16384
    s_and_b32 s41, s41, 0x1ffff
    ds_read_b128 v[80:83], v7 offset:0
    ds_read_b128 v[84:87], v7 offset:2048
    ds_read_b128 v[88:91], v7 offset:4096
    ds_read_b128 v[92:95], v7 offset:6144
    ds_read_b128 v[96:99], v7 offset:8192
    ds_read_b128 v[100:103], v7 offset:10240
    ds_read_b128 v[104:107], v7 offset:12288
    ds_read_b128 v[108:111], v7 offset:14336
    s_waitcnt lgkmcnt(7)
    v_mfma_f32_16x16x32_bf16 v[16:19], a[40:43], v[80:83], v[16:19]
    v_mfma_f32_16x16x32_bf16 v[20:23], a[112:115], v[80:83], v[20:23]
    ds_read_b128 v[112:115], v8 offset:0
    s_waitcnt lgkmcnt(7)
    v_mfma_f32_16x16x32_bf16 v[24:27], a[40:43], v[84:87], v[24:27]
    v_mfma_f32_16x16x32_bf16 v[28:31], a[112:115], v[84:87], v[28:31]
    ds_read_b128 v[116:119], v8 offset:2048
    s_waitcnt lgkmcnt(7)
    v_mfma_f32_16x16x32_bf16 v[32:35], a[40:43], v[88:91], v[32:35]
    v_mfma_f32_16x16x32_bf16 v[36:39], a[112:115], v[88:91], v[36:39]
    ds_read_b128 v[120:123], v8 offset:4096
    s_waitcnt lgkmcnt(7)
    v_mfma_f32_16x16x32_bf16 v[40:43], a[40:43], v[92:95], v[40:43]
    v_mfma_f32_16x16x32_bf16 v[44:47], a[112:115], v[92:95], v[44:47]
    ds_read_b128 v[124:127], v8 offset:6144
    s_waitcnt lgkmcnt(7)
    v_mfma_f32_16x16x32_bf16 v[48:51], a[40:43], v[96:99], v[48:51]
    v_mfma_f32_16x16x32_bf16 v[52:55], a[112:115], v[96:99], v[52:55]
    ds_read_b128 v[128:131], v8 offset:8192
    s_waitcnt lgkmcnt(7)
    v_mfma_f32_16x16x32_bf16 v[56:59], a[40:43], v[100:103], v[56:59]
    v_mfma_f32_16x16x32_bf16 v[60:63], a[112:115], v[100:103], v[60:63]
    ds_read_b128 v[132:135], v8 offset:10240
    s_waitcnt lgkmcnt(7)
    v_mfma_f32_16x16x32_bf16 v[64:67], a[40:43], v[104:107], v[64:67]
    v_mfma_f32_16x16x32_bf16 v[68:71], a[112:115], v[104:107], v[68:71]
    ds_read_b128 v[136:139], v8 offset:12288
    s_waitcnt lgkmcnt(7)
    v_mfma_f32_16x16x32_bf16 v[72:75], a[40:43], v[108:111], v[72:75]
    v_mfma_f32_16x16x32_bf16 v[76:79], a[112:115], v[108:111], v[76:79]
    ds_read_b128 v[140:143], v8 offset:14336
    s_waitcnt lgkmcnt(7)
    v_mfma_f32_16x16x32_bf16 v[16:19], a[44:47], v[112:115], v[16:19]
    v_mfma_f32_16x16x32_bf16 v[20:23], a[116:119], v[112:115], v[20:23]
    s_waitcnt lgkmcnt(6)
    v_mfma_f32_16x16x32_bf16 v[24:27], a[44:47], v[116:119], v[24:27]
    v_mfma_f32_16x16x32_bf16 v[28:31], a[116:119], v[116:119], v[28:31]
    s_waitcnt lgkmcnt(5)
    v_mfma_f32_16x16x32_bf16 v[32:35], a[44:47], v[120:123], v[32:35]
    v_mfma_f32_16x16x32_bf16 v[36:39], a[116:119], v[120:123], v[36:39]
    s_waitcnt lgkmcnt(4)
    v_mfma_f32_16x16x32_bf16 v[40:43], a[44:47], v[124:127], v[40:43]
    v_mfma_f32_16x16x32_bf16 v[44:47], a[116:119], v[124:127], v[44:47]
    s_waitcnt lgkmcnt(3)
    v_mfma_f32_16x16x32_bf16 v[48:51], a[44:47], v[128:131], v[48:51]
    v_mfma_f32_16x16x32_bf16 v[52:55], a[116:119], v[128:131], v[52:55]
    s_waitcnt lgkmcnt(2)
    v_mfma_f32_16x16x32_bf16 v[56:59], a[44:47], v[132:135], v[56:59]
    v_mfma_f32_16x16x32_bf16 v[60:63], a[116:119], v[132:135], v[60:63]
    s_waitcnt lgkmcnt(1)
    v_mfma_f32_16x16x32_bf16 v[64:67], a[44:47], v[136:139], v[64:67]
    v_mfma_f32_16x16x32_bf16 v[68:71], a[116:119], v[136:139], v[68:71]
    s_waitcnt lgkmcnt(0)
    v_mfma_f32_16x16x32_bf16 v[72:75], a[44:47], v[140:143], v[72:75]
    v_mfma_f32_16x16x32_bf16 v[76:79], a[116:119], v[140:143], v[76:79]
    s_waitcnt vmcnt(20)
    s_barrier
    s_add_u32 s50, s38, 0
    s_add_u32 m0, s39, 0
    s_nop 0
    buffer_load_dwordx4 v1, s[12:15], s50 offen sc1 lds
    s_add_u32 s50, s38, 9216
    s_add_u32 m0, s39, 1024
    s_nop 0
    buffer_load_dwordx4 v2, s[12:15], s50 offen sc1 lds
    s_add_u32 s50, s38, 18432
    s_add_u32 m0, s39, 2048
    s_nop 0
    buffer_load_dwordx4 v1, s[12:15], s50 offen sc1 lds
    s_add_u32 s50, s38, 27648
    s_add_u32 m0, s39, 3072
    s_nop 0
    buffer_load_dwordx4 v2, s[12:15], s50 offen sc1 lds
    s_add_u32 s38, s38, 128
    s_add_u32 s39, s39, 16384
    s_and_b32 s39, s39, 0x1ffff
    v_add_u32 v7, s41, v3
    v_add_u32 v8, s41, v4
    s_add_u32 s41, s41, 16384
    s_and_b32 s41, s41, 0x1ffff
    ds_read_b128 v[80:83], v7 offset:0
    ds_read_b128 v[84:87], v7 offset:2048
    ds_read_b128 v[88:91], v7 offset:4096
    ds_read_b128 v[92:95], v7 offset:6144
    ds_read_b128 v[96:99], v7 offset:8192
    ds_read_b128 v[100:103], v7 offset:10240
    ds_read_b128 v[104:107], v7 offset:12288
    ds_read_b128 v[108:111], v7 offset:14336
    s_waitcnt lgkmcnt(7)
    v_mfma_f32_16x16x32_bf16 v[16:19], a[48:51], v[80:83], v[16:19]
    v_mfma_f32_16x16x32_bf16 v[20:23], a[120:123], v[80:83], v[20:23]
    ds_read_b128 v[112:115], v8 offset:0
    s_waitcnt lgkmcnt(7)
    v_mfma_f32_16x16x32_bf16 v[24:27], a[48:51], v[84:87], v[24:27]
    v_mfma_f32_16x16x32_bf16 v[28:31], a[120:123], v[84:87], v[28:31]
    ds_read_b128 v[116:119], v8 offset:2048
    s_waitcnt lgkmcnt(7)
    v_mfma_f32_16x16x32_bf16 v[32:35], a[48:51], v[88:91], v[32:35]
    v_mfma_f32_16x16x32_bf16 v[36:39], a[120:123], v[88:91], v[36:39]
    ds_read_b128 v[120:123], v8 offset:4096
    s_waitcnt lgkmcnt(7)
    v_mfma_f32_16x16x32_bf16 v[40:43], a[48:51], v[92:95], v[40:43]
    v_mfma_f32_16x16x32_bf16 v[44:47], a[120:123], v[92:95], v[44:47]
    ds_read_b128 v[124:127], v8 offset:6144
    s_waitcnt lgkmcnt(7)
    v_mfma_f32_16x16x32_bf16 v[48:51], a[48:51], v[96:99], v[48:51]
    v_mfma_f32_16x16x32_bf16 v[52:55], a[120:123], v[96:99], v[52:55]
    ds_read_b128 v[128:131], v8 offset:8192
    s_waitcnt lgkmcnt(7)
    v_mfma_f32_16x16x32_bf16 v[56:59], a[48:51], v[100:103], v[56:59]
    v_mfma_f32_16x16x32_bf16 v[60:63], a[120:123], v[100:103], v[60:63]
    ds_read_b128 v[132:135], v8 offset:10240
    s_waitcnt lgkmcnt(7)
    v_mfma_f32_16x16x32_bf16 v[64:67], a[48:51], v[104:107], v[64:67]
    v_mfma_f32_16x16x32_bf16 v[68:71], a[120:123], v[104:107], v[68:71]
    ds_read_b128 v[136:139], v8 offset:12288
    s_waitcnt lgkmcnt(7)
    v_mfma_f32_16x16x32_bf16 v[72:75], a[48:51], v[108:111], v[72:75]
    v_mfma_f32_16x16x32_bf16 v[76:79], a[120:123], v[108:111], v[76:79]
    ds_read_b128 v[140:143], v8 offset:14336
    s_waitcnt lgkmcnt(7)
    v_mfma_f32_16x16x32_bf16 v[16:19], a[52:55], v[112:115], v[16:19]
    v_mfma_f32_16x16x32_bf16 v[20:23], a[124:127], v[112:115], v[20:23]
    s_waitcnt lgkmcnt(6)
    v_mfma_f32_16x16x32_bf16 v[24:27], a[52:55], v[116:119], v[24:27]
    v_mfma_f32_16x16x32_bf16 v[28:31], a[124:127], v[116:119], v[28:31]
    s_waitcnt lgkmcnt(5)
    v_mfma_f32_16x16x32_bf16 v[32:35], a[52:55], v[120:123], v[32:35]
    v_mfma_f32_16x16x32_bf16 v[36:39], a[124:127], v[120:123], v[36:39]
    s_waitcnt lgkmcnt(4)
    v_mfma_f32_16x16x32_bf16 v[40:43], a[52:55], v[124:127], v[40:43]
    v_mfma_f32_16x16x32_bf16 v[44:47], a[124:127], v[124:127], v[44:47]
    s_waitcnt lgkmcnt(3)
    v_mfma_f32_16x16x32_bf16 v[48:51], a[52:55], v[128:131], v[48:51]
    v_mfma_f32_16x16x32_bf16 v[52:55], a[124:127], v[128:131], v[52:55]
    s_waitcnt lgkmcnt(2)
    v_mfma_f32_16x16x32_bf16 v[56:59], a[52:55], v[132:135], v[56:59]
    v_mfma_f32_16x16x32_bf16 v[60:63], a[124:127], v[132:135], v[60:63]
    s_waitcnt lgkmcnt(1)
    v_mfma_f32_16x16x32_bf16 v[64:67], a[52:55], v[136:139], v[64:67]
    v_mfma_f32_16x16x32_bf16 v[68:71], a[124:127], v[136:139], v[68:71]
    s_waitcnt lgkmcnt(0)
    v_mfma_f32_16x16x32_bf16 v[72:75], a[52:55], v[140:143], v[72:75]
    v_mfma_f32_16x16x32_bf16 v[76:79], a[124:127], v[140:143], v[76:79]
    s_waitcnt vmcnt(20)
    s_barrier
    s_add_u32 s50, s38, 0
    s_add_u32 m0, s39, 0
    s_nop 0
    buffer_load_dwordx4 v1, s[12:15], s50 offen sc1 lds
    s_add_u32 s50, s38, 9216
    s_add_u32 m0, s39, 1024
    s_nop 0
    buffer_load_dwordx4 v2, s[12:15], s50 offen sc1 lds
    s_add_u32 s50, s38, 18432
    s_add_u32 m0, s39, 2048
    s_nop 0
    buffer_load_dwordx4 v1, s[12:15], s50 offen sc1 lds
    s_add_u32 s50, s38, 27648
    s_add_u32 m0, s39, 3072
    s_nop 0
    buffer_load_dwordx4 v2, s[12:15], s50 offen sc1 lds
    s_add_u32 s38, s38, 128
    s_add_u32 s39, s39, 16384
    s_and_b32 s39, s39, 0x1ffff
    v_add_u32 v7, s41, v3
    v_add_u32 v8, s41, v4
    s_add_u32 s41, s41, 16384
    s_and_b32 s41, s41, 0x1ffff
    ds_read_b128 v[80:83], v7 offset:0
    ds_read_b128 v[84:87], v7 offset:2048
    ds_read_b128 v[88:91], v7 offset:4096
    ds_read_b128 v[92:95], v7 offset:6144
    ds_read_b128 v[96:99], v7 offset:8192
    ds_read_b128 v[100:103], v7 offset:10240
    ds_read_b128 v[104:107], v7 offset:12288
    ds_read_b128 v[108:111], v7 offset:14336
    s_waitcnt lgkmcnt(7)
    v_mfma_f32_16x16x32_bf16 v[16:19], a[56:59], v[80:83], v[16:19]
    v_mfma_f32_16x16x32_bf16 v[20:23], a[128:131], v[80:83], v[20:23]
    ds_read_b128 v[112:115], v8 offset:0
    s_waitcnt lgkmcnt(7)
    v_mfma_f32_16x16x32_bf16 v[24:27], a[56:59], v[84:87], v[24:27]
    v_mfma_f32_16x16x32_bf16 v[28:31], a[128:131], v[84:87], v[28:31]
    ds_read_b128 v[116:119], v8 offset:2048
    s_waitcnt lgkmcnt(7)
    v_mfma_f32_16x16x32_bf16 v[32:35], a[56:59], v[88:91], v[32:35]
    v_mfma_f32_16x16x32_bf16 v[36:39], a[128:131], v[88:91], v[36:39]
    ds_read_b128 v[120:123], v8 offset:4096
    s_waitcnt lgkmcnt(7)
    v_mfma_f32_16x16x32_bf16 v[40:43], a[56:59], v[92:95], v[40:43]
    v_mfma_f32_16x16x32_bf16 v[44:47], a[128:131], v[92:95], v[44:47]
    ds_read_b128 v[124:127], v8 offset:6144
    s_waitcnt lgkmcnt(7)
    v_mfma_f32_16x16x32_bf16 v[48:51], a[56:59], v[96:99], v[48:51]
    v_mfma_f32_16x16x32_bf16 v[52:55], a[128:131], v[96:99], v[52:55]
    ds_read_b128 v[128:131], v8 offset:8192
    s_waitcnt lgkmcnt(7)
    v_mfma_f32_16x16x32_bf16 v[56:59], a[56:59], v[100:103], v[56:59]
    v_mfma_f32_16x16x32_bf16 v[60:63], a[128:131], v[100:103], v[60:63]
    ds_read_b128 v[132:135], v8 offset:10240
    s_waitcnt lgkmcnt(7)
    v_mfma_f32_16x16x32_bf16 v[64:67], a[56:59], v[104:107], v[64:67]
    v_mfma_f32_16x16x32_bf16 v[68:71], a[128:131], v[104:107], v[68:71]
    ds_read_b128 v[136:139], v8 offset:12288
    s_waitcnt lgkmcnt(7)
    v_mfma_f32_16x16x32_bf16 v[72:75], a[56:59], v[108:111], v[72:75]
    v_mfma_f32_16x16x32_bf16 v[76:79], a[128:131], v[108:111], v[76:79]
    ds_read_b128 v[140:143], v8 offset:14336
    s_waitcnt lgkmcnt(7)
    v_mfma_f32_16x16x32_bf16 v[16:19], a[60:63], v[112:115], v[16:19]
    v_mfma_f32_16x16x32_bf16 v[20:23], a[132:135], v[112:115], v[20:23]
    s_waitcnt lgkmcnt(6)
    v_mfma_f32_16x16x32_bf16 v[24:27], a[60:63], v[116:119], v[24:27]
    v_mfma_f32_16x16x32_bf16 v[28:31], a[132:135], v[116:119], v[28:31]
    s_waitcnt lgkmcnt(5)
    v_mfma_f32_16x16x32_bf16 v[32:35], a[60:63], v[120:123], v[32:35]
    v_mfma_f32_16x16x32_bf16 v[36:39], a[132:135], v[120:123], v[36:39]
    s_waitcnt lgkmcnt(4)
    v_mfma_f32_16x16x32_bf16 v[40:43], a[60:63], v[124:127], v[40:43]
    v_mfma_f32_16x16x32_bf16 v[44:47], a[132:135], v[124:127], v[44:47]
    s_waitcnt lgkmcnt(3)
    v_mfma_f32_16x16x32_bf16 v[48:51], a[60:63], v[128:131], v[48:51]
    v_mfma_f32_16x16x32_bf16 v[52:55], a[132:135], v[128:131], v[52:55]
    s_waitcnt lgkmcnt(2)
    v_mfma_f32_16x16x32_bf16 v[56:59], a[60:63], v[132:135], v[56:59]
    v_mfma_f32_16x16x32_bf16 v[60:63], a[132:135], v[132:135], v[60:63]
    s_waitcnt lgkmcnt(1)
    v_mfma_f32_16x16x32_bf16 v[64:67], a[60:63], v[136:139], v[64:67]
    v_mfma_f32_16x16x32_bf16 v[68:71], a[132:135], v[136:139], v[68:71]
    s_waitcnt lgkmcnt(0)
    v_mfma_f32_16x16x32_bf16 v[72:75], a[60:63], v[140:143], v[72:75]
    v_mfma_f32_16x16x32_bf16 v[76:79], a[132:135], v[140:143], v[76:79]
    s_waitcnt vmcnt(20)
    s_barrier
    s_add_u32 s50, s38, 0
    s_add_u32 m0, s39, 0
    s_nop 0
    buffer_load_dwordx4 v1, s[12:15], s50 offen sc1 lds
    s_add_u32 s50, s38, 9216
    s_add_u32 m0, s39, 1024
    s_nop 0
    buffer_load_dwordx4 v2, s[12:15], s50 offen sc1 lds
    s_add_u32 s50, s38, 18432
    s_add_u32 m0, s39, 2048
    s_nop 0
    buffer_load_dwordx4 v1, s[12:15], s50 offen sc1 lds
    s_add_u32 s50, s38, 27648
    s_add_u32 m0, s39, 3072
    s_nop 0
    buffer_load_dwordx4 v2, s[12:15], s50 offen sc1 lds
    s_add_u32 s38, s38, 128
    s_add_u32 s39, s39, 16384
    s_and_b32 s39, s39, 0x1ffff
    v_add_u32 v7, s41, v3
    v_add_u32 v8, s41, v4
    s_add_u32 s41, s41, 16384
    s_and_b32 s41, s41, 0x1ffff
    ds_read_b128 v[80:83], v7 offset:0
    ds_read_b128 v[84:87], v7 offset:2048
    ds_read_b128 v[88:91], v7 offset:4096
    ds_read_b128 v[92:95], v7 offset:6144
    ds_read_b128 v[96:99], v7 offset:8192
    ds_read_b128 v[100:103], v7 offset:10240
    ds_read_b128 v[104:107], v7 offset:12288
    ds_read_b128 v[108:111], v7 offset:14336
    s_waitcnt lgkmcnt(7)
    v_mfma_f32_16x16x32_bf16 v[16:19], a[64:67], v[80:83], v[16:19]
    v_mfma_f32_16x16x32_bf16 v[20:23], a[136:139], v[80:83], v[20:23]
    ds_read_b128 v[112:115], v8 offset:0
    s_waitcnt lgkmcnt(7)
    v_mfma_f32_16x16x32_bf16 v[24:27], a[64:67], v[84:87], v[24:27]
    v_mfma_f32_16x16x32_bf16 v[28:31], a[136:139], v[84:87], v[28:31]
    ds_read_b128 v[116:119], v8 offset:2048
    s_waitcnt lgkmcnt(7)
    v_mfma_f32_16x16x32_bf16 v[32:35], a[64:67], v[88:91], v[32:35]
    v_mfma_f32_16x16x32_bf16 v[36:39], a[136:139], v[88:91], v[36:39]
    ds_read_b128 v[120:123], v8 offset:4096
    s_waitcnt lgkmcnt(7)
    v_mfma_f32_16x16x32_bf16 v[40:43], a[64:67], v[92:95], v[40:43]
    v_mfma_f32_16x16x32_bf16 v[44:47], a[136:139], v[92:95], v[44:47]
    ds_read_b128 v[124:127], v8 offset:6144
    s_waitcnt lgkmcnt(7)
    v_mfma_f32_16x16x32_bf16 v[48:51], a[64:67], v[96:99], v[48:51]
    v_mfma_f32_16x16x32_bf16 v[52:55], a[136:139], v[96:99], v[52:55]
    ds_read_b128 v[128:131], v8 offset:8192
    s_waitcnt lgkmcnt(7)
    v_mfma_f32_16x16x32_bf16 v[56:59], a[64:67], v[100:103], v[56:59]
    v_mfma_f32_16x16x32_bf16 v[60:63], a[136:139], v[100:103], v[60:63]
    ds_read_b128 v[132:135], v8 offset:10240
    s_waitcnt lgkmcnt(7)
    v_mfma_f32_16x16x32_bf16 v[64:67], a[64:67], v[104:107], v[64:67]
    v_mfma_f32_16x16x32_bf16 v[68:71], a[136:139], v[104:107], v[68:71]
    ds_read_b128 v[136:139], v8 offset:12288
    s_waitcnt lgkmcnt(7)
    v_mfma_f32_16x16x32_bf16 v[72:75], a[64:67], v[108:111], v[72:75]
    v_mfma_f32_16x16x32_bf16 v[76:79], a[136:139], v[108:111], v[76:79]
    ds_read_b128 v[140:143], v8 offset:14336
    s_waitcnt lgkmcnt(7)
    v_mfma_f32_16x16x32_bf16 v[16:19], a[68:71], v[112:115], v[16:19]
    v_mfma_f32_16x16x32_bf16 v[20:23], a[140:143], v[112:115], v[20:23]
    s_waitcnt lgkmcnt(6)
    v_mfma_f32_16x16x32_bf16 v[24:27], a[68:71], v[116:119], v[24:27]
    v_mfma_f32_16x16x32_bf16 v[28:31], a[140:143], v[116:119], v[28:31]
    s_waitcnt lgkmcnt(5)
    v_mfma_f32_16x16x32_bf16 v[32:35], a[68:71], v[120:123], v[32:35]
    v_mfma_f32_16x16x32_bf16 v[36:39], a[140:143], v[120:123], v[36:39]
    s_waitcnt lgkmcnt(4)
    v_mfma_f32_16x16x32_bf16 v[40:43], a[68:71], v[124:127], v[40:43]
    v_mfma_f32_16x16x32_bf16 v[44:47], a[140:143], v[124:127], v[44:47]
    s_waitcnt lgkmcnt(3)
    v_mfma_f32_16x16x32_bf16 v[48:51], a[68:71], v[128:131], v[48:51]
    v_mfma_f32_16x16x32_bf16 v[52:55], a[140:143], v[128:131], v[52:55]
    s_waitcnt lgkmcnt(2)
    v_mfma_f32_16x16x32_bf16 v[56:59], a[68:71], v[132:135], v[56:59]
    v_mfma_f32_16x16x32_bf16 v[60:63], a[140:143], v[132:135], v[60:63]
    s_waitcnt lgkmcnt(1)
    v_mfma_f32_16x16x32_bf16 v[64:67], a[68:71], v[136:139], v[64:67]
    v_mfma_f32_16x16x32_bf16 v[68:71], a[140:143], v[136:139], v[68:71]
    s_waitcnt lgkmcnt(0)
    v_mfma_f32_16x16x32_bf16 v[72:75], a[68:71], v[140:143], v[72:75]
    v_mfma_f32_16x16x32_bf16 v[76:79], a[140:143], v[140:143], v[76:79]
    v_cvt_pk_bf16_f32 v144, v16, v17
    v_cvt_pk_bf16_f32 v145, v18, v19
    v_cvt_pk_bf16_f32 v146, v20, v21
    v_cvt_pk_bf16_f32 v147, v22, v23
    s_add_u32 s50, s36, 0
    buffer_store_dwordx4 v[144:147], v15, s[16:19], s50 offen
    v_cvt_pk_bf16_f32 v148, v24, v25
    v_cvt_pk_bf16_f32 v149, v26, v27
    v_cvt_pk_bf16_f32 v150, v28, v29
    v_cvt_pk_bf16_f32 v151, v30, v31
    s_add_u32 s50, s36, 36864
    buffer_store_dwordx4 v[148:151], v15, s[16:19], s50 offen
    v_cvt_pk_bf16_f32 v152, v32, v33
    v_cvt_pk_bf16_f32 v153, v34, v35
    v_cvt_pk_bf16_f32 v154, v36, v37
    v_cvt_pk_bf16_f32 v155, v38, v39
    s_add_u32 s50, s36, 73728
    buffer_store_dwordx4 v[152:155], v15, s[16:19], s50 offen
    v_cvt_pk_bf16_f32 v156, v40, v41
    v_cvt_pk_bf16_f32 v157, v42, v43
    v_cvt_pk_bf16_f32 v158, v44, v45
    v_cvt_pk_bf16_f32 v159, v46, v47
    s_add_u32 s50, s36, 110592
    buffer_store_dwordx4 v[156:159], v15, s[16:19], s50 offen
    v_cvt_pk_bf16_f32 v144, v48, v49
    v_cvt_pk_bf16_f32 v145, v50, v51
    v_cvt_pk_bf16_f32 v146, v52, v53
    v_cvt_pk_bf16_f32 v147, v54, v55
    s_add_u32 s50, s36, 147456
    buffer_store_dwordx4 v[144:147], v15, s[16:19], s50 offen
    v_cvt_pk_bf16_f32 v148, v56, v57
    v_cvt_pk_bf16_f32 v149, v58, v59
    v_cvt_pk_bf16_f32 v150, v60, v61
    v_cvt_pk_bf16_f32 v151, v62, v63
    s_add_u32 s50, s36, 184320
    buffer_store_dwordx4 v[148:151], v15, s[16:19], s50 offen
    v_cvt_pk_bf16_f32 v152, v64, v65
    v_cvt_pk_bf16_f32 v153, v66, v67
    v_cvt_pk_bf16_f32 v154, v68, v69
    v_cvt_pk_bf16_f32 v155, v70, v71
    s_add_u32 s50, s36, 221184
    buffer_store_dwordx4 v[152:155], v15, s[16:19], s50 offen
    v_cvt_pk_bf16_f32 v156, v72, v73
    v_cvt_pk_bf16_f32 v157, v74, v75
    v_cvt_pk_bf16_f32 v158, v76, v77
    v_cvt_pk_bf16_f32 v159, v78, v79
    s_add_u32 s50, s36, 258048
    buffer_store_dwordx4 v[156:159], v15, s[16:19], s50 offen
    s_add_u32 s34, s34, 1
    s_add_u32 s36, s36, s37
    s_cmp_lt_u32 s34, s35
    s_cbranch_scc1 BL4_BLK
    s_waitcnt vmcnt(0)
    s_barrier
    s_branch KEND
KEND:
    s_endpgm
.section .rodata,"a"
.p2align 6
.amdhsa_kernel concat_heads__memory_aug_recurrent_mem_tr__linear_attn_block__prompt_kernel
  .amdhsa_next_free_vgpr 512
  .amdhsa_next_free_sgpr 102
  .amdhsa_accum_offset 256
  .amdhsa_group_segment_fixed_size 0
  .amdhsa_kernarg_size 104
  .amdhsa_user_sgpr_count 2
  .amdhsa_user_sgpr_kernarg_segment_ptr 1
  .amdhsa_system_sgpr_workgroup_id_x 1
.end_amdhsa_kernel
```
